```python
import torch

def _softmax(x, axis=-1):
    return torch.softmax(x, dim=axis)
def _gelu(x):
    return torch.nn.functional.gelu(x, approximate="tanh")
def _silu(x):
    return torch.nn.functional.silu(x)
def _sigmoid(x):
    return torch.sigmoid(x)
def _layernorm(x, axis=-1, eps=1e-5):
    m = x.mean(dim=axis, keepdim=True)
    v = x.var(dim=axis, keepdim=True, unbiased=False)
    return (x - m) / torch.sqrt(v + eps)
def _scatter_add(tgt, idx, src, axis=0):
    return tgt.clone().index_add_(axis, idx, src)
def _segment_sum(src, seg, n):
    out = torch.zeros((n,) + src.shape[1:], dtype=src.dtype)
    return out.index_add_(0, seg, src)
def _pad(x, pw):
    flat = tuple(v for pair in reversed(pw) for v in pair)
    return torch.nn.functional.pad(x, flat)

kernel_name = 'recurrent_scan__compressed_kv_cla__glu_gated_geglu__prompt'

def setup_inputs():

    _w = (lambda a: (lambda t: t.to(torch.bfloat16) if t.is_floating_point() else t)(torch.as_tensor(a)))
    def _A_setup():
        B, H, Sq, Sk, D, M = 1, 32, 2048, 2048, 128, 512
        Dc = 4 * D
        return {
            "x": _w((lambda *s: torch.randn(*s, dtype=torch.bfloat16) * 0.05)(B, Sq, M)),
            "c_kv": _w((lambda *s: torch.randn(*s, dtype=torch.bfloat16) * 1.6)(B, Sk, Dc)),
            "w_q": _w((lambda *s: torch.randn(*s, dtype=torch.bfloat16) * 1.6)(M, H, D) * (M ** -0.5)),
            "w_uk": _w((lambda *s: torch.randn(*s, dtype=torch.bfloat16) * 1.6)(Dc, H, D) * (Dc ** -0.5)),
            "w_uv": _w((lambda *s: torch.randn(*s, dtype=torch.bfloat16) * 1.6)(Dc, H, D) * (Dc ** -0.5)),
            "w_o": _w((lambda *s: torch.randn(*s, dtype=torch.bfloat16) * 1.6)(H, D, M) * ((H * D) ** -0.5)),
        }
    _A_in = _A_setup()

    def _B_setup():
        B, S, Dm, Df = 1, 2048, 512, 1792
        return {
            "x": _w((lambda *s: torch.randn(*s, dtype=torch.bfloat16) * 0.05)(B, S, Dm)),
            "w_gate": _w((lambda *s: torch.randn(*s, dtype=torch.bfloat16) * 0.2)(Dm, Df) * (Dm ** -0.5)),
            "w_up": _w((lambda *s: torch.randn(*s, dtype=torch.bfloat16) * 0.2)(Dm, Df) * (Dm ** -0.5)),
            "w_down": _w((lambda *s: torch.randn(*s, dtype=torch.bfloat16) * 0.2)(Df, Dm) * (Df ** -0.5)),
        }
    _B_in = _B_setup()

    return {
        "A_x": _A_in["x"],
        "A_c_kv": _A_in["c_kv"],
        "A_w_q": _A_in["w_q"],
        "A_w_uk": _A_in["w_uk"],
        "A_w_uv": _A_in["w_uv"],
        "A_w_o": _A_in["w_o"],
        "B_x": _B_in["x"],
        "B_w_gate": _B_in["w_gate"],
        "B_w_up": _B_in["w_up"],
        "B_w_down": _B_in["w_down"],
    }

def reference(A_x, A_c_kv, A_w_q, A_w_uk, A_w_uv, A_w_o, B_x, B_w_gate, B_w_up, B_w_down):
    def _A_ref(x, c_kv, w_q, w_uk, w_uv, w_o):
        B, Sq, M = x.shape[0], x.shape[1], x.shape[2]
        Sk = c_kv.shape[1]
        H, D = w_q.shape[1], w_q.shape[2]
        q = torch.einsum("bqm,mhd->bhqd", x, w_q)
        k = torch.einsum("bkc,chd->bhkd", c_kv, w_uk)
        v = torch.einsum("bkc,chd->bhkd", c_kv, w_uv)
        scores = torch.einsum("bhqd,bhkd->bhqk", q, k) * (D ** -0.5)
        off = Sk - Sq
        qi = torch.arange(Sq)[:, None]
        kj = torch.arange(Sk)[None, :]
        cmask = kj <= (qi + off)
        scores = torch.where(cmask[None, None], scores, -1e9)
        p = _softmax(scores, axis=-1)
        ctx = torch.einsum("bhqk,bhkd->bhqd", p, v)
        return torch.einsum("bhqd,hdm->bqm", ctx, w_o)

    def _B_ref(x, w_gate, w_up, w_down):
        g = torch.einsum("bsd,df->bsf", x, w_gate)
        u = torch.einsum("bsd,df->bsf", x, w_up)
        h = _gelu(g) * u
        return torch.einsum("bsf,fd->bsd", h, w_down)

    x = A_x
    xn = _layernorm(x, axis=-1)
    s = _A_ref(xn, A_c_kv, A_w_q, A_w_uk, A_w_uv, A_w_o)
    g = _silu(_B_ref(xn, B_w_gate, B_w_up, B_w_down))
    return x + s * g
```

```asm
; @launch grid=(256,1,1) block=(256,1,1) lds=163840
.amdgcn_target "amdgcn-amd-amdhsa--gfx950"
.text
.globl recurrent_scan__compressed_kv_cla__glu_gated_geglu__prompt_kernel
.p2align 8
.type recurrent_scan__compressed_kv_cla__glu_gated_geglu__prompt_kernel,@function
recurrent_scan__compressed_kv_cla__glu_gated_geglu__prompt_kernel:
    s_cmp_ge_u32 s2, 256
    s_cbranch_scc1 L_f_end
    s_load_dwordx4 s[36:39], s[0:1], 0
    s_load_dwordx4 s[40:43], s[0:1], 24
    s_load_dwordx2 s[44:45], s[0:1], 96
    v_and_b32 v254, 63, v0
    v_lshrrev_b32 v255, 6, v0
    s_and_b32 s34, s2, 7
    v_readfirstlane_b32 s28, v255
    s_lshr_b32 s35, s2, 3
    v_lshlrev_b32 v252, 7, v254
    s_getpc_b64 s[4:5]
L_pc0:
    s_sub_u32 s4, s4, L_pc0-recurrent_scan__compressed_kv_cla__glu_gated_geglu__prompt_kernel
    s_subb_u32 s5, s5, 0
    s_mov_b32 s6, L_code_end-recurrent_scan__compressed_kv_cla__glu_gated_geglu__prompt_kernel
    s_mov_b32 s7, 0x20000
    v_lshrrev_b32 v244, 3, v254
    v_lshl_or_b32 v244, v244, 27, v252
    v_lshl_add_u32 v244, v255, 15, v244
    s_lshl_b32 s63, s35, 10
    buffer_load_dword v52, v244, s[4:7], s63 offen
    v_lshlrev_b32 v240, 4, v254
    v_lshrrev_b32 v244, 4, v254
    v_and_b32 v245, 15, v254
    v_lshlrev_b32 v245, 7, v245
    v_lshl_add_u32 v253, v244, 13, v245
    s_lshl_b32 s60, s35, 2
    s_add_u32 s60, s60, s28
    s_and_b32 s61, s34, 1
    s_lshl_b32 s61, s61, 20
    s_lshl_b32 s63, s60, 13
    s_add_u32 s61, s61, s63
    s_lshr_b32 s62, s34, 1
    s_lshl_b32 s62, s62, 11
    s_lshl_b32 s63, s60, 15
    s_add_u32 s62, s62, s63
    s_lshl_b32 s47, s2, 13
    s_lshl_b32 s46, s28, 11
    s_add_u32 s47, s47, s46
    s_and_b32 s57, s34, 1
    s_lshl_b32 s57, s57, 2
    s_and_b32 s56, s35, 3
    s_add_u32 s57, s57, s56
    s_lshl_b32 s57, s57, 2
    s_add_u32 s57, s57, s28
    s_lshl_b32 s31, s57, 16
    s_lshr_b32 s57, s34, 1
    s_lshl_b32 s57, s57, 3
    s_lshr_b32 s56, s35, 2
    s_add_u32 s57, s57, s56
    s_lshl_b32 s57, s57, 8
    s_mul_i32 s48, s28, 24576
    s_and_b32 s56, s28, 1
    s_lshr_b32 s52, s28, 1
    s_lshl_b32 s53, s56, 13
    s_lshl_b32 s54, s52, 12
    s_add_u32 s53, s53, s54
    s_lshl_b32 s54, s56, 6
    s_lshl_b32 s55, s52, 19
    s_add_u32 s54, s54, s55
    s_add_u32 s54, s54, s57
    v_lshrrev_b32 v241, 3, v254
    v_lshlrev_b32 v241, 13, v241
    v_and_b32 v242, 7, v254
    v_xor_b32 v243, 0, v242
    v_lshl_add_u32 v224, v243, 4, v241
    v_xor_b32 v243, 1, v242
    v_lshl_add_u32 v225, v243, 4, v241
    v_xor_b32 v243, 2, v242
    v_lshl_add_u32 v226, v243, 4, v241
    v_xor_b32 v243, 3, v242
    v_lshl_add_u32 v227, v243, 4, v241
    v_xor_b32 v243, 4, v242
    v_lshl_add_u32 v228, v243, 4, v241
    v_xor_b32 v243, 5, v242
    v_lshl_add_u32 v229, v243, 4, v241
    v_xor_b32 v243, 6, v242
    v_lshl_add_u32 v230, v243, 4, v241
    v_xor_b32 v243, 7, v242
    v_lshl_add_u32 v231, v243, 4, v241
    v_lshrrev_b32 v244, 5, v254
    v_lshlrev_b32 v244, 1, v244
    v_and_b32 v245, 3, v254
    v_xor_b32 v245, v245, v244
    v_lshlrev_b32 v245, 4, v245
    v_lshrrev_b32 v244, 2, v254
    v_lshl_add_u32 v241, v244, 13, v245
    v_mov_b32 v66, 15
    v_lshrrev_b32 v66, v242, v66
    v_and_b32 v66, 1, v66
    v_lshl_or_b32 v64, v66, 30, v252
    v_lshrrev_b32 v66, 4, v254
    v_and_b32 v67, 15, v254
    v_lshlrev_b32 v65, 7, v67
    v_lshl_add_u32 v65, v66, 20, v65
    v_and_b32 v67, 1, v254
    v_lshl_add_u32 v66, v66, 1, v67
    v_mov_b32 v67, 5
    v_lshrrev_b32 v67, v66, v67
    v_and_b32 v67, 1, v67
    v_lshl_or_b32 v65, v67, 30, v65
    s_lshr_b32 s58, s34, 1
    s_lshl_b32 s58, s58, 11
    s_lshl_b32 s59, s60, 13
    s_mov_b32 s10, 0x200000
    s_mov_b32 s11, 0x20000
    s_mov_b32 s14, 0x400000
    s_mov_b32 s15, 0x20000
    s_mov_b32 s26, 0x200000
    s_mov_b32 s27, 0x20000
    s_waitcnt lgkmcnt(0)
    s_mov_b32 s24, s36
    s_mov_b32 s25, s37
    s_mov_b32 s8, s38
    s_mov_b32 s9, s39
    s_mov_b32 s12, s40
    s_mov_b32 s13, s41
    buffer_load_dwordx4 v[0:3], v240, s[24:27], s47 offen
    buffer_load_dwordx4 v[4:7], v240, s[24:27], s47 offen offset:1024
    s_barrier
    s_add_u32 m0, s53, 98304
    s_add_u32 s57, s54, 0
    buffer_load_dwordx4 v241, s[12:15], s57 offen offset:0 lds
    s_add_u32 s57, s54, 130048
    buffer_load_dwordx4 v241, s[12:15], s57 offen offset:1024 lds
    s_add_u32 s57, s54, 260096
    buffer_load_dwordx4 v241, s[12:15], s57 offen offset:2048 lds
    s_add_u32 s57, s54, 390144
    buffer_load_dwordx4 v241, s[12:15], s57 offen offset:3072 lds
    s_add_u32 m0, s48, 0
    s_add_u32 s56, s31, 0
    buffer_load_dwordx4 v224, s[8:11], s56 offen offset:0 lds
    buffer_load_dwordx4 v225, s[8:11], s56 offen offset:1024 lds
    buffer_load_dwordx4 v226, s[8:11], s56 offen offset:2048 lds
    buffer_load_dwordx4 v227, s[8:11], s56 offen offset:3072 lds
    s_add_u32 m0, s48, 4096
    s_add_u32 s56, s31, 4096
    buffer_load_dwordx4 v228, s[8:11], s56 offen offset:0 lds
    buffer_load_dwordx4 v229, s[8:11], s56 offen offset:1024 lds
    buffer_load_dwordx4 v230, s[8:11], s56 offen offset:2048 lds
    buffer_load_dwordx4 v231, s[8:11], s56 offen offset:3072 lds
    buffer_load_dword v246, v64, s[8:11], s61 offen
    s_mov_b32 s16, s42
    s_mov_b32 s17, s43
    s_mov_b32 s18, 0x400000
    s_mov_b32 s19, 0x20000
    s_mov_b32 s20, s44
    s_mov_b32 s21, s45
    s_mov_b32 s22, 0x10000000
    s_mov_b32 s23, 0x20000
    s_mov_b32 s44, s61
    s_load_dwordx2 s[36:37], s[0:1], 16
    s_load_dwordx2 s[38:39], s[0:1], 40
    s_load_dwordx4 s[40:43], s[0:1], 56
    s_load_dwordx2 s[96:97], s[0:1], 72
    s_load_dwordx2 s[98:99], s[0:1], 88
    v_lshl_add_u32 v244, v255, 6, v254
    v_cmp_eq_u32 vcc, 0, v244
    v_mov_b32 v248, 0x7ffff000
    v_mov_b32 v249, 1
    v_mov_b32 v250, 0
    v_cndmask_b32_e64 v248, v248, 0, vcc
    s_and_b32 s47, s34, 1
    s_lshl_b32 s47, s47, 2
    s_and_b32 s46, s35, 3
    s_add_u32 s47, s47, s46
    s_lshr_b32 s3, s34, 1
    s_lshl_b32 s3, s3, 3
    s_lshr_b32 s46, s35, 2
    s_add_u32 s3, s3, s46
    s_lshl_b32 s45, s3, 3
    s_add_u32 s45, s45, s47
    s_lshl_b32 s46, s47, 2
    s_add_u32 s46, s46, s28
    s_lshl_b32 s31, s46, 16
    s_lshl_b32 s94, s46, 15
    s_lshl_b32 s47, s3, 20
    s_add_u32 s94, s94, s47
    s_add_u32 s94, s94, 0x200000
    s_lshl_b32 s95, s3, 8
    s_lshl_b32 s3, s45, 7
    s_add_u32 s3, s3, 0x5010000
    s_lshl_b32 s29, s34, 2
    s_lshr_b32 s46, s35, 3
    s_add_u32 s29, s29, s46
    s_and_b32 s30, s35, 7
    s_mul_i32 s48, s28, 24576
    s_lshl_b32 s49, s28, 12
    s_lshl_b32 s50, s28, 6
    s_add_u32 s50, s50, s95
    s_and_b32 s45, s28, 1
    s_lshr_b32 s52, s28, 1
    s_lshl_b32 s53, s45, 13
    s_lshl_b32 s54, s52, 12
    s_add_u32 s53, s53, s54
    s_lshl_b32 s54, s45, 6
    s_lshl_b32 s55, s52, 19
    s_add_u32 s55, s54, s55
    s_add_u32 s54, s55, s95
    s_lshl_b32 s56, s29, 8
    s_add_u32 s65, s55, s56
    s_sub_u32 s56, 15, s30
    s_lshl_b32 s32, s56, 3
    s_add_u32 s32, s32, s28
    s_lshl_b32 s33, s30, 3
    s_add_u32 s33, s33, s28
    s_lshl_b32 s46, s32, 14
    s_lshl_b32 s47, s33, 14
    s_mul_i32 s32, s32, 188416
    s_add_u32 s32, s32, 0x2200000
    s_mul_i32 s33, s33, 188416
    s_add_u32 s33, s33, 0x2200000
    s_sub_u32 s55, s29, s34
    s_add_u32 s55, s55, 32
    s_mul_i32 s64, s52, 229376
    s_lshl_b32 s63, s29, 6
    s_add_u32 s35, s64, s63
    s_lshl_b32 s63, s55, 6
    s_add_u32 s64, s64, s63
    s_and_b32 s63, s29, 3
    s_cmp_eq_u32 s63, 3
    s_cselect_b32 s64, 0x7f000000, s64
    s_lshl_b32 s51, s29, 20
    s_add_u32 s51, s51, 0x200000
    s_lshl_b32 s56, s29, 10
    s_add_u32 s56, s56, 131072
    s_add_u32 s100, s56, s32
    s_add_u32 s101, s56, s33
    s_lshl_b32 s61, s34, 8
    s_lshr_b32 s63, s60, 1
    s_mul_i32 s63, s63, 28672
    s_add_u32 s61, s61, s63
    s_lshl_b32 s52, s34, 10
    s_lshl_b32 s63, s60, 15
    s_add_u32 s52, s52, s63
    s_add_u32 s60, s58, s59
    v_lshrrev_b32 v241, 3, v254
    v_lshlrev_b32 v241, 13, v241
    v_and_b32 v242, 7, v254
    v_xor_b32 v243, 0, v242
    v_lshl_add_u32 v224, v243, 4, v241
    v_xor_b32 v243, 1, v242
    v_lshl_add_u32 v225, v243, 4, v241
    v_xor_b32 v243, 2, v242
    v_lshl_add_u32 v226, v243, 4, v241
    v_xor_b32 v243, 3, v242
    v_lshl_add_u32 v227, v243, 4, v241
    v_xor_b32 v243, 4, v242
    v_lshl_add_u32 v228, v243, 4, v241
    v_xor_b32 v243, 5, v242
    v_lshl_add_u32 v229, v243, 4, v241
    v_xor_b32 v243, 6, v242
    v_lshl_add_u32 v230, v243, 4, v241
    v_xor_b32 v243, 7, v242
    v_lshl_add_u32 v231, v243, 4, v241
    v_and_b32 v241, 7, v254
    v_bfe_u32 v242, v254, 3, 1
    v_lshlrev_b32 v242, 7, v242
    v_lshl_add_u32 v242, v241, 10, v242
    v_add_u32 v242, s48, v242
    v_lshrrev_b32 v243, 4, v254
    v_add_u32 v244, 0, v243
    v_xor_b32 v244, v244, v241
    v_lshl_add_u32 v232, v244, 4, v242
    v_add_u32 v244, 4, v243
    v_xor_b32 v244, v244, v241
    v_lshl_add_u32 v233, v244, 4, v242
    v_lshlrev_b32 v241, 9, v243
    v_bfe_u32 v242, v254, 2, 2
    v_lshl_add_u32 v241, v242, 6, v241
    v_and_b32 v242, 3, v254
    v_lshl_add_u32 v241, v242, 3, v241
    v_and_b32 v242, 1, v243
    v_lshl_add_u32 v234, v242, 5, v241
    v_xor_b32 v237, 32, v234
    v_add_u32 v235, 0x10000, v234
    v_add_u32 v236, 0x20000, v234
    v_add_u32 v238, 0x10000, v237
    v_add_u32 v239, 0x20000, v237
    v_lshrrev_b32 v244, 5, v254
    v_lshlrev_b32 v251, 30, v244
    v_lshlrev_b32 v244, 1, v244
    v_and_b32 v245, 3, v254
    v_xor_b32 v245, v245, v244
    v_lshlrev_b32 v245, 4, v245
    v_lshrrev_b32 v244, 2, v254
    v_lshl_add_u32 v241, v244, 13, v245
    v_mul_u32_u24 v244, 3584, v244
    v_add_u32 v242, v244, v245
    v_bfe_u32 v245, v254, 2, 3
    v_mul_u32_u24 v245, 3584, v245
    v_and_b32 v244, 1, v254
    v_lshl_add_u32 v245, v244, 7, v245
    v_bfe_u32 v244, v254, 1, 1
    s_lshl_b32 s63, s34, 6
    s_sub_u32 s63, 2048, s63
    v_mad_u32_u24 v245, v244, s63, v245
    v_or_b32 v245, v245, v251
    v_and_b32 v243, 15, v254
    v_lshlrev_b32 v243, 4, v243
    v_lshlrev_b32 v48, 7, v254
    v_lshl_add_u32 v48, v255, 5, v48
    v_add_u32 v48, 0x24000, v48
    v_lshl_add_u32 v49, v255, 11, v240
    v_add_u32 v49, 0x24000, v49
    v_lshrrev_b32 v50, 3, v254
    v_lshlrev_b32 v50, 8, v50
    v_and_b32 v51, 7, v254
    v_lshl_add_u32 v50, v51, 4, v50
    s_waitcnt lgkmcnt(0)
    s_cmp_eq_u32 s45, 0
    s_cselect_b32 s40, s40, s42
    s_cselect_b32 s41, s41, s43
    s_mov_b32 s4, s98
    s_mov_b32 s5, s99
    s_mov_b32 s6, 256
    s_mov_b32 s7, 0x20000
    s_load_dwordx2 s[42:43], s[0:1], 80
    s_lshl_b32 s56, s55, 10
    s_add_u32 s56, s56, 131072
    s_add_u32 s98, s56, s32
    s_add_u32 s99, s56, s33
    s_and_b32 s56, s29, 3
    s_cmp_eq_u32 s56, 3
    s_cselect_b32 s98, 0x7f000000, s98
    s_cselect_b32 s99, 0x7f000000, s99
    s_lshl_b32 s63, s2, 7
    s_add_u32 s63, s63, 0x5000000
    s_waitcnt vmcnt(13)
    v_lshlrev_b32 v8, 16, v0
    v_and_b32 v9, 0xffff0000, v0
    v_lshlrev_b32 v10, 16, v1
    v_and_b32 v11, 0xffff0000, v1
    v_lshlrev_b32 v12, 16, v2
    v_and_b32 v13, 0xffff0000, v2
    v_lshlrev_b32 v14, 16, v3
    v_and_b32 v15, 0xffff0000, v3
    v_lshlrev_b32 v16, 16, v4
    v_and_b32 v17, 0xffff0000, v4
    v_lshlrev_b32 v18, 16, v5
    v_and_b32 v19, 0xffff0000, v5
    v_lshlrev_b32 v20, 16, v6
    v_and_b32 v21, 0xffff0000, v6
    v_lshlrev_b32 v22, 16, v7
    v_and_b32 v23, 0xffff0000, v7
    v_add_f32 v24, v8, v9
    v_add_f32 v24, v24, v10
    v_add_f32 v24, v24, v11
    v_add_f32 v24, v24, v12
    v_add_f32 v24, v24, v13
    v_add_f32 v24, v24, v14
    v_add_f32 v24, v24, v15
    v_add_f32 v25, v16, v17
    v_add_f32 v25, v25, v18
    v_add_f32 v25, v25, v19
    v_add_f32 v25, v25, v20
    v_add_f32 v25, v25, v21
    v_add_f32 v25, v25, v22
    v_add_f32 v25, v25, v23
    s_nop 1
    v_add_f32_dpp v24, v24, v24 quad_perm:[1,0,3,2] row_mask:0xf bank_mask:0xf
    v_add_f32_dpp v25, v25, v25 quad_perm:[1,0,3,2] row_mask:0xf bank_mask:0xf
    s_nop 1
    v_add_f32_dpp v24, v24, v24 quad_perm:[2,3,0,1] row_mask:0xf bank_mask:0xf
    v_add_f32_dpp v25, v25, v25 quad_perm:[2,3,0,1] row_mask:0xf bank_mask:0xf
    s_nop 1
    v_add_f32_dpp v24, v24, v24 row_half_mirror row_mask:0xf bank_mask:0xf
    v_add_f32_dpp v25, v25, v25 row_half_mirror row_mask:0xf bank_mask:0xf
    s_nop 1
    v_add_f32_dpp v24, v24, v24 row_mirror row_mask:0xf bank_mask:0xf
    v_add_f32_dpp v25, v25, v25 row_mirror row_mask:0xf bank_mask:0xf
    s_nop 1
    v_add_f32_dpp v24, v24, v24 row_bcast:15 row_mask:0xa bank_mask:0xf
    v_add_f32_dpp v25, v25, v25 row_bcast:15 row_mask:0xa bank_mask:0xf
    s_nop 1
    v_add_f32_dpp v24, v24, v24 row_bcast:31 row_mask:0xc bank_mask:0xf
    v_add_f32_dpp v25, v25, v25 row_bcast:31 row_mask:0xc bank_mask:0xf
    s_nop 1
    v_readlane_b32 s58, v24, 63
    v_readlane_b32 s59, v25, 63
    v_mov_b32 v30, 0x3b000000
    s_nop 1
    v_mul_f32 v26, s58, v30
    v_mul_f32 v27, s59, v30
    v_sub_f32 v32, v8, v26
    v_sub_f32 v33, v9, v26
    v_sub_f32 v34, v10, v26
    v_sub_f32 v35, v11, v26
    v_sub_f32 v36, v12, v26
    v_sub_f32 v37, v13, v26
    v_sub_f32 v38, v14, v26
    v_sub_f32 v39, v15, v26
    v_mul_f32 v24, v32, v32
    v_fmac_f32 v24, v33, v33
    v_fmac_f32 v24, v34, v34
    v_fmac_f32 v24, v35, v35
    v_fmac_f32 v24, v36, v36
    v_fmac_f32 v24, v37, v37
    v_fmac_f32 v24, v38, v38
    v_fmac_f32 v24, v39, v39
    v_sub_f32 v32, v16, v27
    v_sub_f32 v33, v17, v27
    v_sub_f32 v34, v18, v27
    v_sub_f32 v35, v19, v27
    v_sub_f32 v36, v20, v27
    v_sub_f32 v37, v21, v27
    v_sub_f32 v38, v22, v27
    v_sub_f32 v39, v23, v27
    v_mul_f32 v25, v32, v32
    v_fmac_f32 v25, v33, v33
    v_fmac_f32 v25, v34, v34
    v_fmac_f32 v25, v35, v35
    v_fmac_f32 v25, v36, v36
    v_fmac_f32 v25, v37, v37
    v_fmac_f32 v25, v38, v38
    v_fmac_f32 v25, v39, v39
    s_nop 1
    v_add_f32_dpp v24, v24, v24 quad_perm:[1,0,3,2] row_mask:0xf bank_mask:0xf
    v_add_f32_dpp v25, v25, v25 quad_perm:[1,0,3,2] row_mask:0xf bank_mask:0xf
    s_nop 1
    v_add_f32_dpp v24, v24, v24 quad_perm:[2,3,0,1] row_mask:0xf bank_mask:0xf
    v_add_f32_dpp v25, v25, v25 quad_perm:[2,3,0,1] row_mask:0xf bank_mask:0xf
    s_nop 1
    v_add_f32_dpp v24, v24, v24 row_half_mirror row_mask:0xf bank_mask:0xf
    v_add_f32_dpp v25, v25, v25 row_half_mirror row_mask:0xf bank_mask:0xf
    s_nop 1
    v_add_f32_dpp v24, v24, v24 row_mirror row_mask:0xf bank_mask:0xf
    v_add_f32_dpp v25, v25, v25 row_mirror row_mask:0xf bank_mask:0xf
    s_nop 1
    v_add_f32_dpp v24, v24, v24 row_bcast:15 row_mask:0xa bank_mask:0xf
    v_add_f32_dpp v25, v25, v25 row_bcast:15 row_mask:0xa bank_mask:0xf
    s_nop 1
    v_add_f32_dpp v24, v24, v24 row_bcast:31 row_mask:0xc bank_mask:0xf
    v_add_f32_dpp v25, v25, v25 row_bcast:31 row_mask:0xc bank_mask:0xf
    s_nop 1
    v_readlane_b32 s58, v24, 63
    v_readlane_b32 s59, v25, 63
    s_nop 1
    v_mul_f32 v28, s58, v30
    v_cvt_pk_bf16_f32 v28, v28, v28
    v_and_b32 v28, 0xffff0000, v28
    v_add_f32 v28, 0x3727c5ac, v28
    v_cvt_pk_bf16_f32 v28, v28, v28
    v_and_b32 v28, 0xffff0000, v28
    v_sqrt_f32 v28, v28
    s_nop 0
    v_cvt_pk_bf16_f32 v28, v28, v28
    v_and_b32 v28, 0xffff0000, v28
    v_rcp_f32 v28, v28
    v_cvt_pk_bf16_f32 v26, v26, v26
    v_and_b32 v26, 0xffff0000, v26
    v_mul_f32 v29, s59, v30
    v_cvt_pk_bf16_f32 v29, v29, v29
    v_and_b32 v29, 0xffff0000, v29
    v_add_f32 v29, 0x3727c5ac, v29
    v_cvt_pk_bf16_f32 v29, v29, v29
    v_and_b32 v29, 0xffff0000, v29
    v_sqrt_f32 v29, v29
    s_nop 0
    v_cvt_pk_bf16_f32 v29, v29, v29
    v_and_b32 v29, 0xffff0000, v29
    v_rcp_f32 v29, v29
    v_cvt_pk_bf16_f32 v27, v27, v27
    v_and_b32 v27, 0xffff0000, v27
    v_sub_f32 v8, v8, v26
    v_sub_f32 v9, v9, v26
    v_sub_f32 v10, v10, v26
    v_sub_f32 v11, v11, v26
    v_sub_f32 v12, v12, v26
    v_sub_f32 v13, v13, v26
    v_sub_f32 v14, v14, v26
    v_sub_f32 v15, v15, v26
    v_cvt_pk_bf16_f32 v32, v8, v9
    v_cvt_pk_bf16_f32 v33, v10, v11
    v_cvt_pk_bf16_f32 v34, v12, v13
    v_cvt_pk_bf16_f32 v35, v14, v15
    v_lshlrev_b32 v8, 16, v32
    v_and_b32 v9, 0xffff0000, v32
    v_lshlrev_b32 v10, 16, v33
    v_and_b32 v11, 0xffff0000, v33
    v_lshlrev_b32 v12, 16, v34
    v_and_b32 v13, 0xffff0000, v34
    v_lshlrev_b32 v14, 16, v35
    v_and_b32 v15, 0xffff0000, v35
    v_mul_f32 v8, v8, v28
    v_mul_f32 v9, v9, v28
    v_mul_f32 v10, v10, v28
    v_mul_f32 v11, v11, v28
    v_mul_f32 v12, v12, v28
    v_mul_f32 v13, v13, v28
    v_mul_f32 v14, v14, v28
    v_mul_f32 v15, v15, v28
    v_cvt_pk_bf16_f32 v40, v8, v9
    v_cvt_pk_bf16_f32 v41, v10, v11
    v_cvt_pk_bf16_f32 v42, v12, v13
    v_cvt_pk_bf16_f32 v43, v14, v15
    v_sub_f32 v16, v16, v27
    v_sub_f32 v17, v17, v27
    v_sub_f32 v18, v18, v27
    v_sub_f32 v19, v19, v27
    v_sub_f32 v20, v20, v27
    v_sub_f32 v21, v21, v27
    v_sub_f32 v22, v22, v27
    v_sub_f32 v23, v23, v27
    v_cvt_pk_bf16_f32 v32, v16, v17
    v_cvt_pk_bf16_f32 v33, v18, v19
    v_cvt_pk_bf16_f32 v34, v20, v21
    v_cvt_pk_bf16_f32 v35, v22, v23
    v_lshlrev_b32 v16, 16, v32
    v_and_b32 v17, 0xffff0000, v32
    v_lshlrev_b32 v18, 16, v33
    v_and_b32 v19, 0xffff0000, v33
    v_lshlrev_b32 v20, 16, v34
    v_and_b32 v21, 0xffff0000, v34
    v_lshlrev_b32 v22, 16, v35
    v_and_b32 v23, 0xffff0000, v35
    v_mul_f32 v16, v16, v29
    v_mul_f32 v17, v17, v29
    v_mul_f32 v18, v18, v29
    v_mul_f32 v19, v19, v29
    v_mul_f32 v20, v20, v29
    v_mul_f32 v21, v21, v29
    v_mul_f32 v22, v22, v29
    v_mul_f32 v23, v23, v29
    v_cvt_pk_bf16_f32 v44, v16, v17
    v_cvt_pk_bf16_f32 v45, v18, v19
    v_cvt_pk_bf16_f32 v46, v20, v21
    v_cvt_pk_bf16_f32 v47, v22, v23
    ds_write_b128 v48, v[40:43]
    ds_write_b128 v48, v[44:47] offset:16
    s_lshr_b32 s58, s2, 1
    s_lshl_b32 s58, s58, 14
    s_and_b32 s59, s2, 1
    s_lshl_b32 s59, s59, 7
    s_add_u32 s58, s58, s59
    s_add_u32 s58, s58, s49
    s_waitcnt lgkmcnt(0)
    s_barrier
    ds_read_b128 v[40:43], v49
    ds_read_b128 v[44:47], v49 offset:1024
    s_lshr_b32 s59, s2, 4
    s_lshl_b32 s59, s59, 4
    s_waitcnt lgkmcnt(0)
    buffer_store_dwordx4 v[40:43], v50, s[20:23], s58 offen sc1
    buffer_store_dwordx4 v[44:47], v50, s[20:23], s58 offen offset:2048 sc1
    buffer_store_dword v250, v248, s[20:23], s63 offen sc1
    buffer_store_dword v250, v248, s[20:23], s63 offen offset:4 sc1
    buffer_store_dword v250, v248, s[20:23], s3 offen sc1
    s_add_u32 s63, s63, 0x20000
    buffer_store_dword v250, v248, s[20:23], s63 offen offset:8 sc1
    buffer_store_dword v250, v248, s[20:23], s63 offen sc1
    buffer_store_dword v250, v248, s[20:23], s63 offen offset:4 sc1
    s_add_u32 m0, s48, 8192
    s_add_u32 s56, s31, 128
    buffer_load_dwordx4 v224, s[8:11], s56 offen offset:0 lds
    buffer_load_dwordx4 v225, s[8:11], s56 offen offset:1024 lds
    buffer_load_dwordx4 v226, s[8:11], s56 offen offset:2048 lds
    buffer_load_dwordx4 v227, s[8:11], s56 offen offset:3072 lds
    s_add_u32 m0, s48, 12288
    s_add_u32 s56, s31, 4224
    buffer_load_dwordx4 v228, s[8:11], s56 offen offset:0 lds
    buffer_load_dwordx4 v229, s[8:11], s56 offen offset:1024 lds
    buffer_load_dwordx4 v230, s[8:11], s56 offen offset:2048 lds
    buffer_load_dwordx4 v231, s[8:11], s56 offen offset:3072 lds
    s_waitcnt vmcnt(17)
    s_barrier
    ds_read_b128 a[0:3], v232 offset:0
    ds_read_b128 a[64:67], v232 offset:256
    ds_read_b128 a[128:131], v232 offset:512
    ds_read_b128 a[192:195], v232 offset:768
    ds_read_b128 a[4:7], v233 offset:0
    ds_read_b128 a[68:71], v233 offset:256
    ds_read_b128 a[132:135], v233 offset:512
    ds_read_b128 a[196:199], v233 offset:768
    ds_read_b64_tr_b16 v[192:193], v235 offset:32768
    ds_read_b64_tr_b16 v[194:195], v235 offset:33024
    ds_read_b64_tr_b16 v[196:197], v235 offset:34816
    ds_read_b64_tr_b16 v[198:199], v235 offset:35072
    ds_read_b64_tr_b16 v[200:201], v238 offset:32768
    ds_read_b64_tr_b16 v[202:203], v238 offset:33024
    ds_read_b64_tr_b16 v[204:205], v238 offset:34816
    ds_read_b64_tr_b16 v[206:207], v238 offset:35072
    ds_read_b64_tr_b16 v[208:209], v235 offset:40960
    ds_read_b64_tr_b16 v[210:211], v235 offset:41216
    s_waitcnt lgkmcnt(6)
    v_mfma_f32_16x16x32_bf16 v[0:3], v[192:195], a[0:3], 0
    s_add_u32 m0, s53, 114688
    s_add_u32 s57, s54, 1048576
    ds_read_b64_tr_b16 v[212:213], v235 offset:43008
    v_mfma_f32_16x16x32_bf16 v[0:3], v[196:199], a[4:7], v[0:3]
    ds_read_b64_tr_b16 v[214:215], v235 offset:43264
    buffer_load_dwordx4 v241, s[12:15], s57 offen offset:0 lds
    v_mfma_f32_16x16x32_bf16 v[8:11], v[192:195], a[64:67], 0
    s_add_u32 s57, s54, 1178624
    buffer_load_dwordx4 v241, s[12:15], s57 offen offset:1024 lds
    v_mfma_f32_16x16x32_bf16 v[8:11], v[196:199], a[68:71], v[8:11]
    s_add_u32 s57, s54, 1308672
    buffer_load_dwordx4 v241, s[12:15], s57 offen offset:2048 lds
    v_mfma_f32_16x16x32_bf16 v[16:19], v[192:195], a[128:131], 0
    s_add_u32 s57, s54, 1438720
    ds_read_b64_tr_b16 v[216:217], v238 offset:40960
    buffer_load_dwordx4 v241, s[12:15], s57 offen offset:3072 lds
    v_mfma_f32_16x16x32_bf16 v[16:19], v[196:199], a[132:135], v[16:19]
    s_add_u32 m0, s48, 16384
    s_add_u32 s56, s31, 256
    ds_read_b64_tr_b16 v[218:219], v238 offset:41216
    v_mfma_f32_16x16x32_bf16 v[24:27], v[192:195], a[192:195], 0
    buffer_load_dwordx4 v224, s[8:11], s56 offen offset:0 lds
    v_mfma_f32_16x16x32_bf16 v[24:27], v[196:199], a[196:199], v[24:27]
    s_waitcnt lgkmcnt(6)
    buffer_load_dwordx4 v225, s[8:11], s56 offen offset:1024 lds
    v_mfma_f32_16x16x32_bf16 v[4:7], v[200:203], a[0:3], 0
    ds_read_b64_tr_b16 v[220:221], v238 offset:43008
    buffer_load_dwordx4 v226, s[8:11], s56 offen offset:2048 lds
    v_mfma_f32_16x16x32_bf16 v[4:7], v[204:207], a[4:7], v[4:7]
    ds_read_b64_tr_b16 v[222:223], v238 offset:43264
    buffer_load_dwordx4 v227, s[8:11], s56 offen offset:3072 lds
    v_mfma_f32_16x16x32_bf16 v[12:15], v[200:203], a[64:67], 0
    s_waitcnt vmcnt(8)
    s_add_u32 m0, s48, 20480
    ds_read_b128 a[8:11], v232 offset:8192
    ds_read_b128 a[72:75], v232 offset:8448
    v_mfma_f32_16x16x32_bf16 v[12:15], v[204:207], a[68:71], v[12:15]
    s_add_u32 s56, s31, 4352
    ds_read_b128 a[136:139], v232 offset:8704
    ds_read_b128 a[200:203], v232 offset:8960
    v_mfma_f32_16x16x32_bf16 v[20:23], v[200:203], a[128:131], 0
    ds_read_b64_tr_b16 v[192:193], v235 offset:36864
    buffer_load_dwordx4 v228, s[8:11], s56 offen offset:0 lds
    v_mfma_f32_16x16x32_bf16 v[20:23], v[204:207], a[132:135], v[20:23]
    ds_read_b64_tr_b16 v[194:195], v235 offset:37120
    buffer_load_dwordx4 v229, s[8:11], s56 offen offset:1024 lds
    v_mfma_f32_16x16x32_bf16 v[28:31], v[200:203], a[192:195], 0
    ds_read_b128 a[12:15], v233 offset:8192
    ds_read_b128 a[76:79], v233 offset:8448
    v_mfma_f32_16x16x32_bf16 v[28:31], v[204:207], a[196:199], v[28:31]
    s_waitcnt lgkmcnt(12)
    ds_read_b128 a[140:143], v233 offset:8704
    ds_read_b128 a[204:207], v233 offset:8960
    v_mfma_f32_16x16x32_bf16 v[32:35], v[208:211], a[0:3], 0
    ds_read_b64_tr_b16 v[196:197], v235 offset:38912
    buffer_load_dwordx4 v230, s[8:11], s56 offen offset:2048 lds
    v_mfma_f32_16x16x32_bf16 v[32:35], v[212:215], a[4:7], v[32:35]
    ds_read_b64_tr_b16 v[198:199], v235 offset:39168
    buffer_load_dwordx4 v231, s[8:11], s56 offen offset:3072 lds
    v_mfma_f32_16x16x32_bf16 v[40:43], v[208:211], a[64:67], 0
    buffer_load_dword v247, v65, s[12:15], s60 offen
    v_mfma_f32_16x16x32_bf16 v[40:43], v[212:215], a[68:71], v[40:43]
    s_add_u32 m0, s48, 0
    s_add_u32 s56, s31, 384
    v_mfma_f32_16x16x32_bf16 v[48:51], v[208:211], a[128:131], 0
    ds_read_b64_tr_b16 v[200:201], v238 offset:36864
    buffer_load_dwordx4 v224, s[8:11], s56 offen offset:0 lds
    v_mfma_f32_16x16x32_bf16 v[48:51], v[212:215], a[132:135], v[48:51]
    ds_read_b64_tr_b16 v[202:203], v238 offset:37120
    buffer_load_dwordx4 v225, s[8:11], s56 offen offset:1024 lds
    v_mfma_f32_16x16x32_bf16 v[56:59], v[208:211], a[192:195], 0
    s_waitcnt lgkmcnt(4)
    buffer_load_dwordx4 v226, s[8:11], s56 offen offset:2048 lds
    v_mfma_f32_16x16x32_bf16 v[56:59], v[212:215], a[196:199], v[56:59]
    buffer_load_dwordx4 v227, s[8:11], s56 offen offset:3072 lds
    v_mfma_f32_16x16x32_bf16 v[36:39], v[216:219], a[0:3], 0
    s_add_u32 m0, s48, 4096
    s_add_u32 s56, s31, 4480
    ds_read_b64_tr_b16 v[204:205], v238 offset:38912
    v_mfma_f32_16x16x32_bf16 v[36:39], v[220:223], a[4:7], v[36:39]
    ds_read_b64_tr_b16 v[206:207], v238 offset:39168
    buffer_load_dwordx4 v228, s[8:11], s56 offen offset:0 lds
    v_mfma_f32_16x16x32_bf16 v[44:47], v[216:219], a[64:67], 0
    buffer_load_dwordx4 v229, s[8:11], s56 offen offset:1024 lds
    v_mfma_f32_16x16x32_bf16 v[44:47], v[220:223], a[68:71], v[44:47]
    buffer_load_dwordx4 v230, s[8:11], s56 offen offset:2048 lds
    v_mfma_f32_16x16x32_bf16 v[52:55], v[216:219], a[128:131], 0
    ds_read_b64_tr_b16 v[208:209], v235 offset:45056
    buffer_load_dwordx4 v231, s[8:11], s56 offen offset:3072 lds
    v_mfma_f32_16x16x32_bf16 v[52:55], v[220:223], a[132:135], v[52:55]
    ds_read_b64_tr_b16 v[210:211], v235 offset:45312
    v_mfma_f32_16x16x32_bf16 v[60:63], v[216:219], a[192:195], 0
    v_mfma_f32_16x16x32_bf16 v[60:63], v[220:223], a[196:199], v[60:63]
    s_waitcnt lgkmcnt(6)
    v_mfma_f32_16x16x32_bf16 v[0:3], v[192:195], a[8:11], v[0:3]
    ds_read_b64_tr_b16 v[212:213], v235 offset:47104
    v_mfma_f32_16x16x32_bf16 v[0:3], v[196:199], a[12:15], v[0:3]
    ds_read_b64_tr_b16 v[214:215], v235 offset:47360
    v_mfma_f32_16x16x32_bf16 v[8:11], v[192:195], a[72:75], v[8:11]
    ds_read_b64_tr_b16 v[216:217], v238 offset:45056
    v_mfma_f32_16x16x32_bf16 v[8:11], v[196:199], a[76:79], v[8:11]
    ds_read_b64_tr_b16 v[218:219], v238 offset:45312
    v_mfma_f32_16x16x32_bf16 v[16:19], v[192:195], a[136:139], v[16:19]
    ds_read_b64_tr_b16 v[220:221], v238 offset:47104
    v_mfma_f32_16x16x32_bf16 v[16:19], v[196:199], a[140:143], v[16:19]
    s_add_u32 m0, s53, 131072
    s_add_u32 s57, s54, 2097152
    ds_read_b64_tr_b16 v[222:223], v238 offset:47360
    v_mfma_f32_16x16x32_bf16 v[24:27], v[192:195], a[200:203], v[24:27]
    v_mfma_f32_16x16x32_bf16 v[24:27], v[196:199], a[204:207], v[24:27]
    s_waitcnt lgkmcnt(8)
    v_mfma_f32_16x16x32_bf16 v[4:7], v[200:203], a[8:11], v[4:7]
    buffer_load_dwordx4 v241, s[12:15], s57 offen offset:0 lds
    v_mfma_f32_16x16x32_bf16 v[4:7], v[204:207], a[12:15], v[4:7]
    s_add_u32 s57, s54, 2227200
    buffer_load_dwordx4 v241, s[12:15], s57 offen offset:1024 lds
    v_mfma_f32_16x16x32_bf16 v[12:15], v[200:203], a[72:75], v[12:15]
    s_waitcnt vmcnt(11)
    s_waitcnt lgkmcnt(0)
    ds_read_b128 a[16:19], v232 offset:16384
    ds_read_b128 a[80:83], v232 offset:16640
    v_mfma_f32_16x16x32_bf16 v[12:15], v[204:207], a[76:79], v[12:15]
    s_add_u32 s57, s54, 2357248
    ds_read_b128 a[144:147], v232 offset:16896
    ds_read_b128 a[208:211], v232 offset:17152
    v_mfma_f32_16x16x32_bf16 v[20:23], v[200:203], a[136:139], v[20:23]
    s_barrier
    ds_read_b64_tr_b16 v[192:193], v235 offset:49152
    v_mfma_f32_16x16x32_bf16 v[20:23], v[204:207], a[140:143], v[20:23]
    ds_read_b64_tr_b16 v[194:195], v235 offset:49408
    buffer_load_dwordx4 v241, s[12:15], s57 offen offset:2048 lds
    v_mfma_f32_16x16x32_bf16 v[28:31], v[200:203], a[200:203], v[28:31]
    s_add_u32 s57, s54, 2487296
    ds_read_b128 a[20:23], v233 offset:16384
    ds_read_b128 a[84:87], v233 offset:16640
    v_mfma_f32_16x16x32_bf16 v[28:31], v[204:207], a[204:207], v[28:31]
    ds_read_b128 a[148:151], v233 offset:16896
    ds_read_b128 a[212:215], v233 offset:17152
    v_mfma_f32_16x16x32_bf16 v[32:35], v[208:211], a[8:11], v[32:35]
    ds_read_b64_tr_b16 v[196:197], v235 offset:51200
    buffer_load_dwordx4 v241, s[12:15], s57 offen offset:3072 lds
    v_mfma_f32_16x16x32_bf16 v[32:35], v[212:215], a[12:15], v[32:35]
    s_add_u32 m0, s48, 8192
    s_add_u32 s56, s31, 512
    ds_read_b64_tr_b16 v[198:199], v235 offset:51456
    v_mfma_f32_16x16x32_bf16 v[40:43], v[208:211], a[72:75], v[40:43]
    v_mfma_f32_16x16x32_bf16 v[40:43], v[212:215], a[76:79], v[40:43]
    v_mfma_f32_16x16x32_bf16 v[48:51], v[208:211], a[136:139], v[48:51]
    ds_read_b64_tr_b16 v[200:201], v238 offset:49152
    buffer_load_dwordx4 v224, s[8:11], s56 offen offset:0 lds
    v_mfma_f32_16x16x32_bf16 v[48:51], v[212:215], a[140:143], v[48:51]
    ds_read_b64_tr_b16 v[202:203], v238 offset:49408
    buffer_load_dwordx4 v225, s[8:11], s56 offen offset:1024 lds
    v_mfma_f32_16x16x32_bf16 v[56:59], v[208:211], a[200:203], v[56:59]
    s_waitcnt lgkmcnt(4)
    buffer_load_dwordx4 v226, s[8:11], s56 offen offset:2048 lds
    v_mfma_f32_16x16x32_bf16 v[56:59], v[212:215], a[204:207], v[56:59]
    buffer_load_dwordx4 v227, s[8:11], s56 offen offset:3072 lds
    v_mfma_f32_16x16x32_bf16 v[36:39], v[216:219], a[8:11], v[36:39]
    s_add_u32 m0, s48, 12288
    s_add_u32 s56, s31, 4608
    ds_read_b64_tr_b16 v[204:205], v238 offset:51200
    v_mfma_f32_16x16x32_bf16 v[36:39], v[220:223], a[12:15], v[36:39]
    ds_read_b64_tr_b16 v[206:207], v238 offset:51456
    buffer_load_dwordx4 v228, s[8:11], s56 offen offset:0 lds
    v_mfma_f32_16x16x32_bf16 v[44:47], v[216:219], a[72:75], v[44:47]
    buffer_load_dwordx4 v229, s[8:11], s56 offen offset:1024 lds
    v_mfma_f32_16x16x32_bf16 v[44:47], v[220:223], a[76:79], v[44:47]
    buffer_load_dwordx4 v230, s[8:11], s56 offen offset:2048 lds
    v_mfma_f32_16x16x32_bf16 v[52:55], v[216:219], a[136:139], v[52:55]
    ds_read_b64_tr_b16 v[208:209], v235 offset:57344
    buffer_load_dwordx4 v231, s[8:11], s56 offen offset:3072 lds
    v_mfma_f32_16x16x32_bf16 v[52:55], v[220:223], a[140:143], v[52:55]
    ds_read_b64_tr_b16 v[210:211], v235 offset:57600
    v_mfma_f32_16x16x32_bf16 v[60:63], v[216:219], a[200:203], v[60:63]
    v_mfma_f32_16x16x32_bf16 v[60:63], v[220:223], a[204:207], v[60:63]
    s_waitcnt lgkmcnt(6)
    v_mfma_f32_16x16x32_bf16 v[0:3], v[192:195], a[16:19], v[0:3]
    ds_read_b64_tr_b16 v[212:213], v235 offset:59392
    v_mfma_f32_16x16x32_bf16 v[0:3], v[196:199], a[20:23], v[0:3]
    ds_read_b64_tr_b16 v[214:215], v235 offset:59648
    v_mfma_f32_16x16x32_bf16 v[8:11], v[192:195], a[80:83], v[8:11]
    v_mfma_f32_16x16x32_bf16 v[8:11], v[196:199], a[84:87], v[8:11]
    v_mfma_f32_16x16x32_bf16 v[16:19], v[192:195], a[144:147], v[16:19]
    ds_read_b64_tr_b16 v[216:217], v238 offset:57344
    v_mfma_f32_16x16x32_bf16 v[16:19], v[196:199], a[148:151], v[16:19]
    ds_read_b64_tr_b16 v[218:219], v238 offset:57600
    v_mfma_f32_16x16x32_bf16 v[24:27], v[192:195], a[208:211], v[24:27]
    v_mfma_f32_16x16x32_bf16 v[24:27], v[196:199], a[212:215], v[24:27]
    s_waitcnt lgkmcnt(6)
    v_mfma_f32_16x16x32_bf16 v[4:7], v[200:203], a[16:19], v[4:7]
    ds_read_b64_tr_b16 v[220:221], v238 offset:59392
    v_mfma_f32_16x16x32_bf16 v[4:7], v[204:207], a[20:23], v[4:7]
    ds_read_b64_tr_b16 v[222:223], v238 offset:59648
    v_mfma_f32_16x16x32_bf16 v[12:15], v[200:203], a[80:83], v[12:15]
    s_waitcnt vmcnt(12)
    ds_read_b128 a[24:27], v232 offset:0
    ds_read_b128 a[88:91], v232 offset:256
    v_mfma_f32_16x16x32_bf16 v[12:15], v[204:207], a[84:87], v[12:15]
    ds_read_b128 a[152:155], v232 offset:512
    ds_read_b128 a[216:219], v232 offset:768
    v_mfma_f32_16x16x32_bf16 v[20:23], v[200:203], a[144:147], v[20:23]
    ds_read_b64_tr_b16 v[192:193], v235 offset:53248
    v_mfma_f32_16x16x32_bf16 v[20:23], v[204:207], a[148:151], v[20:23]
    ds_read_b64_tr_b16 v[194:195], v235 offset:53504
    v_mfma_f32_16x16x32_bf16 v[28:31], v[200:203], a[208:211], v[28:31]
    ds_read_b128 a[28:31], v233 offset:0
    ds_read_b128 a[92:95], v233 offset:256
    v_mfma_f32_16x16x32_bf16 v[28:31], v[204:207], a[212:215], v[28:31]
    s_waitcnt lgkmcnt(12)
    ds_read_b128 a[156:159], v233 offset:512
    ds_read_b128 a[220:223], v233 offset:768
    v_mfma_f32_16x16x32_bf16 v[32:35], v[208:211], a[16:19], v[32:35]
    ds_read_b64_tr_b16 v[196:197], v235 offset:55296
    v_mfma_f32_16x16x32_bf16 v[32:35], v[212:215], a[20:23], v[32:35]
    s_add_u32 m0, s48, 16384
    s_add_u32 s56, s31, 640
    ds_read_b64_tr_b16 v[198:199], v235 offset:55552
    v_mfma_f32_16x16x32_bf16 v[40:43], v[208:211], a[80:83], v[40:43]
    v_mfma_f32_16x16x32_bf16 v[40:43], v[212:215], a[84:87], v[40:43]
    v_mfma_f32_16x16x32_bf16 v[48:51], v[208:211], a[144:147], v[48:51]
    ds_read_b64_tr_b16 v[200:201], v238 offset:53248
    buffer_load_dwordx4 v224, s[8:11], s56 offen offset:0 lds
    v_mfma_f32_16x16x32_bf16 v[48:51], v[212:215], a[148:151], v[48:51]
    ds_read_b64_tr_b16 v[202:203], v238 offset:53504
    buffer_load_dwordx4 v225, s[8:11], s56 offen offset:1024 lds
    v_mfma_f32_16x16x32_bf16 v[56:59], v[208:211], a[208:211], v[56:59]
    s_waitcnt lgkmcnt(4)
    buffer_load_dwordx4 v226, s[8:11], s56 offen offset:2048 lds
    v_mfma_f32_16x16x32_bf16 v[56:59], v[212:215], a[212:215], v[56:59]
    buffer_load_dwordx4 v227, s[8:11], s56 offen offset:3072 lds
    v_mfma_f32_16x16x32_bf16 v[36:39], v[216:219], a[16:19], v[36:39]
    s_add_u32 m0, s48, 20480
    s_add_u32 s56, s31, 4736
    ds_read_b64_tr_b16 v[204:205], v238 offset:55296
    v_mfma_f32_16x16x32_bf16 v[36:39], v[220:223], a[20:23], v[36:39]
    ds_read_b64_tr_b16 v[206:207], v238 offset:55552
    buffer_load_dwordx4 v228, s[8:11], s56 offen offset:0 lds
    v_mfma_f32_16x16x32_bf16 v[44:47], v[216:219], a[80:83], v[44:47]
    buffer_load_dwordx4 v229, s[8:11], s56 offen offset:1024 lds
    v_mfma_f32_16x16x32_bf16 v[44:47], v[220:223], a[84:87], v[44:47]
    buffer_load_dwordx4 v230, s[8:11], s56 offen offset:2048 lds
    v_mfma_f32_16x16x32_bf16 v[52:55], v[216:219], a[144:147], v[52:55]
    ds_read_b64_tr_b16 v[208:209], v235 offset:61440
    buffer_load_dwordx4 v231, s[8:11], s56 offen offset:3072 lds
    v_mfma_f32_16x16x32_bf16 v[52:55], v[220:223], a[148:151], v[52:55]
    ds_read_b64_tr_b16 v[210:211], v235 offset:61696
    v_mfma_f32_16x16x32_bf16 v[60:63], v[216:219], a[208:211], v[60:63]
    v_mfma_f32_16x16x32_bf16 v[60:63], v[220:223], a[212:215], v[60:63]
    s_waitcnt lgkmcnt(6)
    v_mfma_f32_16x16x32_bf16 v[0:3], v[192:195], a[24:27], v[0:3]
    ds_read_b64_tr_b16 v[212:213], v235 offset:63488
    v_mfma_f32_16x16x32_bf16 v[0:3], v[196:199], a[28:31], v[0:3]
    s_add_u32 m0, s53, 147456
    s_add_u32 s57, s54, 3145728
    ds_read_b64_tr_b16 v[214:215], v235 offset:63744
    v_mfma_f32_16x16x32_bf16 v[8:11], v[192:195], a[88:91], v[8:11]
    ds_read_b64_tr_b16 v[216:217], v238 offset:61440
    v_mfma_f32_16x16x32_bf16 v[8:11], v[196:199], a[92:95], v[8:11]
    ds_read_b64_tr_b16 v[218:219], v238 offset:61696
    v_mfma_f32_16x16x32_bf16 v[16:19], v[192:195], a[152:155], v[16:19]
    ds_read_b64_tr_b16 v[220:221], v238 offset:63488
    buffer_load_dwordx4 v241, s[12:15], s57 offen offset:0 lds
    v_mfma_f32_16x16x32_bf16 v[16:19], v[196:199], a[156:159], v[16:19]
    s_add_u32 s57, s54, 3275776
    ds_read_b64_tr_b16 v[222:223], v238 offset:63744
    buffer_load_dwordx4 v241, s[12:15], s57 offen offset:1024 lds
    v_mfma_f32_16x16x32_bf16 v[24:27], v[192:195], a[216:219], v[24:27]
    s_add_u32 s57, s54, 3405824
    buffer_load_dwordx4 v241, s[12:15], s57 offen offset:2048 lds
    v_mfma_f32_16x16x32_bf16 v[24:27], v[196:199], a[220:223], v[24:27]
    s_waitcnt lgkmcnt(8)
    s_add_u32 s57, s54, 3535872
    buffer_load_dwordx4 v241, s[12:15], s57 offen offset:3072 lds
    v_mfma_f32_16x16x32_bf16 v[4:7], v[200:203], a[24:27], v[4:7]
    v_mfma_f32_16x16x32_bf16 v[4:7], v[204:207], a[28:31], v[4:7]
    v_mfma_f32_16x16x32_bf16 v[12:15], v[200:203], a[88:91], v[12:15]
    s_waitcnt vmcnt(12)
    s_waitcnt lgkmcnt(0)
    ds_read_b128 a[32:35], v232 offset:8192
    ds_read_b128 a[96:99], v232 offset:8448
    v_mfma_f32_16x16x32_bf16 v[12:15], v[204:207], a[92:95], v[12:15]
    ds_read_b128 a[160:163], v232 offset:8704
    ds_read_b128 a[224:227], v232 offset:8960
    v_mfma_f32_16x16x32_bf16 v[20:23], v[200:203], a[152:155], v[20:23]
    s_barrier
    ds_read_b64_tr_b16 v[192:193], v236 offset:0
    v_mfma_f32_16x16x32_bf16 v[20:23], v[204:207], a[156:159], v[20:23]
    ds_read_b64_tr_b16 v[194:195], v236 offset:256
    v_mfma_f32_16x16x32_bf16 v[28:31], v[200:203], a[216:219], v[28:31]
    ds_read_b128 a[36:39], v233 offset:8192
    ds_read_b128 a[100:103], v233 offset:8448
    v_mfma_f32_16x16x32_bf16 v[28:31], v[204:207], a[220:223], v[28:31]
    ds_read_b128 a[164:167], v233 offset:8704
    ds_read_b128 a[228:231], v233 offset:8960
    v_mfma_f32_16x16x32_bf16 v[32:35], v[208:211], a[24:27], v[32:35]
    ds_read_b64_tr_b16 v[196:197], v236 offset:2048
    v_mfma_f32_16x16x32_bf16 v[32:35], v[212:215], a[28:31], v[32:35]
    s_add_u32 m0, s48, 0
    s_add_u32 s56, s31, 768
    ds_read_b64_tr_b16 v[198:199], v236 offset:2304
    v_mfma_f32_16x16x32_bf16 v[40:43], v[208:211], a[88:91], v[40:43]
    v_mfma_f32_16x16x32_bf16 v[40:43], v[212:215], a[92:95], v[40:43]
    v_mfma_f32_16x16x32_bf16 v[48:51], v[208:211], a[152:155], v[48:51]
    ds_read_b64_tr_b16 v[200:201], v239 offset:0
    buffer_load_dwordx4 v224, s[8:11], s56 offen offset:0 lds
    v_mfma_f32_16x16x32_bf16 v[48:51], v[212:215], a[156:159], v[48:51]
    ds_read_b64_tr_b16 v[202:203], v239 offset:256
    buffer_load_dwordx4 v225, s[8:11], s56 offen offset:1024 lds
    v_mfma_f32_16x16x32_bf16 v[56:59], v[208:211], a[216:219], v[56:59]
    s_waitcnt lgkmcnt(4)
    buffer_load_dwordx4 v226, s[8:11], s56 offen offset:2048 lds
    v_mfma_f32_16x16x32_bf16 v[56:59], v[212:215], a[220:223], v[56:59]
    buffer_load_dwordx4 v227, s[8:11], s56 offen offset:3072 lds
    v_mfma_f32_16x16x32_bf16 v[36:39], v[216:219], a[24:27], v[36:39]
    s_add_u32 m0, s48, 4096
    s_add_u32 s56, s31, 4864
    ds_read_b64_tr_b16 v[204:205], v239 offset:2048
    v_mfma_f32_16x16x32_bf16 v[36:39], v[220:223], a[28:31], v[36:39]
    ds_read_b64_tr_b16 v[206:207], v239 offset:2304
    buffer_load_dwordx4 v228, s[8:11], s56 offen offset:0 lds
    v_mfma_f32_16x16x32_bf16 v[44:47], v[216:219], a[88:91], v[44:47]
    buffer_load_dwordx4 v229, s[8:11], s56 offen offset:1024 lds
    v_mfma_f32_16x16x32_bf16 v[44:47], v[220:223], a[92:95], v[44:47]
    buffer_load_dwordx4 v230, s[8:11], s56 offen offset:2048 lds
    v_mfma_f32_16x16x32_bf16 v[52:55], v[216:219], a[152:155], v[52:55]
    ds_read_b64_tr_b16 v[208:209], v236 offset:8192
    buffer_load_dwordx4 v231, s[8:11], s56 offen offset:3072 lds
    v_mfma_f32_16x16x32_bf16 v[52:55], v[220:223], a[156:159], v[52:55]
    ds_read_b64_tr_b16 v[210:211], v236 offset:8448
    v_mfma_f32_16x16x32_bf16 v[60:63], v[216:219], a[216:219], v[60:63]
    v_mfma_f32_16x16x32_bf16 v[60:63], v[220:223], a[220:223], v[60:63]
    s_waitcnt lgkmcnt(6)
    v_mfma_f32_16x16x32_bf16 v[0:3], v[192:195], a[32:35], v[0:3]
    ds_read_b64_tr_b16 v[212:213], v236 offset:10240
    v_mfma_f32_16x16x32_bf16 v[0:3], v[196:199], a[36:39], v[0:3]
    ds_read_b64_tr_b16 v[214:215], v236 offset:10496
    v_mfma_f32_16x16x32_bf16 v[8:11], v[192:195], a[96:99], v[8:11]
    v_mfma_f32_16x16x32_bf16 v[8:11], v[196:199], a[100:103], v[8:11]
    v_mfma_f32_16x16x32_bf16 v[16:19], v[192:195], a[160:163], v[16:19]
    ds_read_b64_tr_b16 v[216:217], v239 offset:8192
    v_mfma_f32_16x16x32_bf16 v[16:19], v[196:199], a[164:167], v[16:19]
    ds_read_b64_tr_b16 v[218:219], v239 offset:8448
    v_mfma_f32_16x16x32_bf16 v[24:27], v[192:195], a[224:227], v[24:27]
    v_mfma_f32_16x16x32_bf16 v[24:27], v[196:199], a[228:231], v[24:27]
    s_waitcnt lgkmcnt(6)
    v_mfma_f32_16x16x32_bf16 v[4:7], v[200:203], a[32:35], v[4:7]
    ds_read_b64_tr_b16 v[220:221], v239 offset:10240
    v_mfma_f32_16x16x32_bf16 v[4:7], v[204:207], a[36:39], v[4:7]
    ds_read_b64_tr_b16 v[222:223], v239 offset:10496
    v_mfma_f32_16x16x32_bf16 v[12:15], v[200:203], a[96:99], v[12:15]
    s_waitcnt vmcnt(12)
    ds_read_b128 a[40:43], v232 offset:16384
    ds_read_b128 a[104:107], v232 offset:16640
    v_mfma_f32_16x16x32_bf16 v[12:15], v[204:207], a[100:103], v[12:15]
    ds_read_b128 a[168:171], v232 offset:16896
    ds_read_b128 a[232:235], v232 offset:17152
    v_mfma_f32_16x16x32_bf16 v[20:23], v[200:203], a[160:163], v[20:23]
    ds_read_b64_tr_b16 v[192:193], v236 offset:4096
    v_mfma_f32_16x16x32_bf16 v[20:23], v[204:207], a[164:167], v[20:23]
    s_add_u32 m0, s48, 8192
    s_add_u32 s56, s31, 896
    ds_read_b64_tr_b16 v[194:195], v236 offset:4352
    v_mfma_f32_16x16x32_bf16 v[28:31], v[200:203], a[224:227], v[28:31]
    ds_read_b128 a[44:47], v233 offset:16384
    ds_read_b128 a[108:111], v233 offset:16640
    v_mfma_f32_16x16x32_bf16 v[28:31], v[204:207], a[228:231], v[28:31]
    s_waitcnt lgkmcnt(12)
    ds_read_b128 a[172:175], v233 offset:16896
    ds_read_b128 a[236:239], v233 offset:17152
    v_mfma_f32_16x16x32_bf16 v[32:35], v[208:211], a[32:35], v[32:35]
    ds_read_b64_tr_b16 v[196:197], v236 offset:6144
    buffer_load_dwordx4 v224, s[8:11], s56 offen offset:0 lds
    v_mfma_f32_16x16x32_bf16 v[32:35], v[212:215], a[36:39], v[32:35]
    ds_read_b64_tr_b16 v[198:199], v236 offset:6400
    buffer_load_dwordx4 v225, s[8:11], s56 offen offset:1024 lds
    v_mfma_f32_16x16x32_bf16 v[40:43], v[208:211], a[96:99], v[40:43]
    buffer_load_dwordx4 v226, s[8:11], s56 offen offset:2048 lds
    v_mfma_f32_16x16x32_bf16 v[40:43], v[212:215], a[100:103], v[40:43]
    buffer_load_dwordx4 v227, s[8:11], s56 offen offset:3072 lds
    v_mfma_f32_16x16x32_bf16 v[48:51], v[208:211], a[160:163], v[48:51]
    s_add_u32 m0, s48, 12288
    s_add_u32 s56, s31, 4992
    ds_read_b64_tr_b16 v[200:201], v239 offset:4096
    v_mfma_f32_16x16x32_bf16 v[48:51], v[212:215], a[164:167], v[48:51]
    ds_read_b64_tr_b16 v[202:203], v239 offset:4352
    buffer_load_dwordx4 v228, s[8:11], s56 offen offset:0 lds
    v_mfma_f32_16x16x32_bf16 v[56:59], v[208:211], a[224:227], v[56:59]
    s_waitcnt lgkmcnt(4)
    buffer_load_dwordx4 v229, s[8:11], s56 offen offset:1024 lds
    v_mfma_f32_16x16x32_bf16 v[56:59], v[212:215], a[228:231], v[56:59]
    buffer_load_dwordx4 v230, s[8:11], s56 offen offset:2048 lds
    v_mfma_f32_16x16x32_bf16 v[36:39], v[216:219], a[32:35], v[36:39]
    ds_read_b64_tr_b16 v[204:205], v239 offset:6144
    buffer_load_dwordx4 v231, s[8:11], s56 offen offset:3072 lds
    v_mfma_f32_16x16x32_bf16 v[36:39], v[220:223], a[36:39], v[36:39]
    s_add_u32 m0, s53, 98304
    s_add_u32 s57, s54, 128
    ds_read_b64_tr_b16 v[206:207], v239 offset:6400
    v_mfma_f32_16x16x32_bf16 v[44:47], v[216:219], a[96:99], v[44:47]
    v_mfma_f32_16x16x32_bf16 v[44:47], v[220:223], a[100:103], v[44:47]
    v_mfma_f32_16x16x32_bf16 v[52:55], v[216:219], a[160:163], v[52:55]
    ds_read_b64_tr_b16 v[208:209], v236 offset:12288
    buffer_load_dwordx4 v241, s[12:15], s57 offen offset:0 lds
    v_mfma_f32_16x16x32_bf16 v[52:55], v[220:223], a[164:167], v[52:55]
    s_add_u32 s57, s54, 130176
    ds_read_b64_tr_b16 v[210:211], v236 offset:12544
    buffer_load_dwordx4 v241, s[12:15], s57 offen offset:1024 lds
    v_mfma_f32_16x16x32_bf16 v[60:63], v[216:219], a[224:227], v[60:63]
    s_add_u32 s57, s54, 260224
    buffer_load_dwordx4 v241, s[12:15], s57 offen offset:2048 lds
    v_mfma_f32_16x16x32_bf16 v[60:63], v[220:223], a[228:231], v[60:63]
    s_waitcnt lgkmcnt(6)
    s_add_u32 s57, s54, 390272
    buffer_load_dwordx4 v241, s[12:15], s57 offen offset:3072 lds
    v_mfma_f32_16x16x32_bf16 v[0:3], v[192:195], a[40:43], v[0:3]
    s_add_u32 m0, s53, 114688
    s_add_u32 s57, s54, 1048704
    ds_read_b64_tr_b16 v[212:213], v236 offset:14336
    v_mfma_f32_16x16x32_bf16 v[0:3], v[196:199], a[44:47], v[0:3]
    ds_read_b64_tr_b16 v[214:215], v236 offset:14592
    buffer_load_dwordx4 v241, s[12:15], s57 offen offset:0 lds
    v_mfma_f32_16x16x32_bf16 v[8:11], v[192:195], a[104:107], v[8:11]
    s_add_u32 s57, s54, 1178752
    ds_read_b64_tr_b16 v[216:217], v239 offset:12288
    buffer_load_dwordx4 v241, s[12:15], s57 offen offset:1024 lds
    v_mfma_f32_16x16x32_bf16 v[8:11], v[196:199], a[108:111], v[8:11]
    s_add_u32 s57, s54, 1308800
    ds_read_b64_tr_b16 v[218:219], v239 offset:12544
    buffer_load_dwordx4 v241, s[12:15], s57 offen offset:2048 lds
    v_mfma_f32_16x16x32_bf16 v[16:19], v[192:195], a[168:171], v[16:19]
    s_add_u32 s57, s54, 1438848
    ds_read_b64_tr_b16 v[220:221], v239 offset:14336
    buffer_load_dwordx4 v241, s[12:15], s57 offen offset:3072 lds
    v_mfma_f32_16x16x32_bf16 v[16:19], v[196:199], a[172:175], v[16:19]
    ds_read_b64_tr_b16 v[222:223], v239 offset:14592
    v_mfma_f32_16x16x32_bf16 v[24:27], v[192:195], a[232:235], v[24:27]
    v_mfma_f32_16x16x32_bf16 v[24:27], v[196:199], a[236:239], v[24:27]
    s_waitcnt lgkmcnt(8)
    v_mfma_f32_16x16x32_bf16 v[4:7], v[200:203], a[40:43], v[4:7]
    v_mfma_f32_16x16x32_bf16 v[4:7], v[204:207], a[44:47], v[4:7]
    v_mfma_f32_16x16x32_bf16 v[12:15], v[200:203], a[104:107], v[12:15]
    s_waitcnt vmcnt(16)
    s_waitcnt lgkmcnt(0)
    ds_read_b128 a[48:51], v232 offset:0
    ds_read_b128 a[112:115], v232 offset:256
    v_mfma_f32_16x16x32_bf16 v[12:15], v[204:207], a[108:111], v[12:15]
    ds_read_b128 a[176:179], v232 offset:512
    ds_read_b128 a[240:243], v232 offset:768
    v_mfma_f32_16x16x32_bf16 v[20:23], v[200:203], a[168:171], v[20:23]
    s_barrier
    ds_read_b64_tr_b16 v[192:193], v236 offset:16384
    v_mfma_f32_16x16x32_bf16 v[20:23], v[204:207], a[172:175], v[20:23]
    ds_read_b64_tr_b16 v[194:195], v236 offset:16640
    buffer_atomic_add v249, v248, s[4:7], s59 offen
    v_mfma_f32_16x16x32_bf16 v[28:31], v[200:203], a[232:235], v[28:31]
    ds_read_b128 a[52:55], v233 offset:0
    ds_read_b128 a[116:119], v233 offset:256
    v_mfma_f32_16x16x32_bf16 v[28:31], v[204:207], a[236:239], v[28:31]
    ds_read_b128 a[180:183], v233 offset:512
    ds_read_b128 a[244:247], v233 offset:768
    v_mfma_f32_16x16x32_bf16 v[32:35], v[208:211], a[40:43], v[32:35]
    ds_read_b64_tr_b16 v[196:197], v236 offset:18432
    buffer_load_dword v246, v253, s[16:19], s62 offen
    v_mfma_f32_16x16x32_bf16 v[32:35], v[212:215], a[44:47], v[32:35]
    s_add_u32 m0, s53, 131072
    s_add_u32 s57, s54, 2097280
    ds_read_b64_tr_b16 v[198:199], v236 offset:18688
    v_mfma_f32_16x16x32_bf16 v[40:43], v[208:211], a[104:107], v[40:43]
    buffer_load_dwordx4 v241, s[12:15], s57 offen offset:0 lds
    v_mfma_f32_16x16x32_bf16 v[40:43], v[212:215], a[108:111], v[40:43]
    s_add_u32 s57, s54, 2227328
    buffer_load_dwordx4 v241, s[12:15], s57 offen offset:1024 lds
    v_mfma_f32_16x16x32_bf16 v[48:51], v[208:211], a[168:171], v[48:51]
    s_add_u32 s57, s54, 2357376
    ds_read_b64_tr_b16 v[200:201], v239 offset:16384
    buffer_load_dwordx4 v241, s[12:15], s57 offen offset:2048 lds
    v_mfma_f32_16x16x32_bf16 v[48:51], v[212:215], a[172:175], v[48:51]
    s_add_u32 s57, s54, 2487424
    ds_read_b64_tr_b16 v[202:203], v239 offset:16640
    buffer_load_dwordx4 v241, s[12:15], s57 offen offset:3072 lds
    v_mfma_f32_16x16x32_bf16 v[56:59], v[208:211], a[232:235], v[56:59]
    s_waitcnt lgkmcnt(4)
    v_mfma_f32_16x16x32_bf16 v[56:59], v[212:215], a[236:239], v[56:59]
    v_mfma_f32_16x16x32_bf16 v[36:39], v[216:219], a[40:43], v[36:39]
    ds_read_b64_tr_b16 v[204:205], v239 offset:18432
    v_mfma_f32_16x16x32_bf16 v[36:39], v[220:223], a[44:47], v[36:39]
    ds_read_b64_tr_b16 v[206:207], v239 offset:18688
    v_mfma_f32_16x16x32_bf16 v[44:47], v[216:219], a[104:107], v[44:47]
    v_mfma_f32_16x16x32_bf16 v[44:47], v[220:223], a[108:111], v[44:47]
    v_mfma_f32_16x16x32_bf16 v[52:55], v[216:219], a[168:171], v[52:55]
    ds_read_b64_tr_b16 v[208:209], v236 offset:24576
    v_mfma_f32_16x16x32_bf16 v[52:55], v[220:223], a[172:175], v[52:55]
    ds_read_b64_tr_b16 v[210:211], v236 offset:24832
    v_mfma_f32_16x16x32_bf16 v[60:63], v[216:219], a[232:235], v[60:63]
    v_mfma_f32_16x16x32_bf16 v[60:63], v[220:223], a[236:239], v[60:63]
    s_waitcnt lgkmcnt(6)
    v_mfma_f32_16x16x32_bf16 v[0:3], v[192:195], a[48:51], v[0:3]
    ds_read_b64_tr_b16 v[212:213], v236 offset:26624
    v_mfma_f32_16x16x32_bf16 v[0:3], v[196:199], a[52:55], v[0:3]
    ds_read_b64_tr_b16 v[214:215], v236 offset:26880
    v_mfma_f32_16x16x32_bf16 v[8:11], v[192:195], a[112:115], v[8:11]
    v_mfma_f32_16x16x32_bf16 v[8:11], v[196:199], a[116:119], v[8:11]
    v_mfma_f32_16x16x32_bf16 v[16:19], v[192:195], a[176:179], v[16:19]
    ds_read_b64_tr_b16 v[216:217], v239 offset:24576
    v_mfma_f32_16x16x32_bf16 v[16:19], v[196:199], a[180:183], v[16:19]
    ds_read_b64_tr_b16 v[218:219], v239 offset:24832
    v_mfma_f32_16x16x32_bf16 v[24:27], v[192:195], a[240:243], v[24:27]
    v_mfma_f32_16x16x32_bf16 v[24:27], v[196:199], a[244:247], v[24:27]
    s_waitcnt lgkmcnt(6)
    v_mfma_f32_16x16x32_bf16 v[4:7], v[200:203], a[48:51], v[4:7]
    ds_read_b64_tr_b16 v[220:221], v239 offset:26624
    v_mfma_f32_16x16x32_bf16 v[4:7], v[204:207], a[52:55], v[4:7]
    ds_read_b64_tr_b16 v[222:223], v239 offset:26880
    v_mfma_f32_16x16x32_bf16 v[12:15], v[200:203], a[112:115], v[12:15]
    s_waitcnt vmcnt(14)
    ds_read_b128 a[56:59], v232 offset:8192
    ds_read_b128 a[120:123], v232 offset:8448
    v_mfma_f32_16x16x32_bf16 v[12:15], v[204:207], a[116:119], v[12:15]
    ds_read_b128 a[184:187], v232 offset:8704
    ds_read_b128 a[248:251], v232 offset:8960
    v_mfma_f32_16x16x32_bf16 v[20:23], v[200:203], a[176:179], v[20:23]
    ds_read_b64_tr_b16 v[192:193], v236 offset:20480
    v_mfma_f32_16x16x32_bf16 v[20:23], v[204:207], a[180:183], v[20:23]
    ds_read_b64_tr_b16 v[194:195], v236 offset:20736
    v_mfma_f32_16x16x32_bf16 v[28:31], v[200:203], a[240:243], v[28:31]
    ds_read_b128 a[60:63], v233 offset:8192
    ds_read_b128 a[124:127], v233 offset:8448
    v_mfma_f32_16x16x32_bf16 v[28:31], v[204:207], a[244:247], v[28:31]
    s_waitcnt lgkmcnt(12)
    ds_read_b128 a[188:191], v233 offset:8704
    ds_read_b128 a[252:255], v233 offset:8960
    v_mfma_f32_16x16x32_bf16 v[32:35], v[208:211], a[48:51], v[32:35]
    ds_read_b64_tr_b16 v[196:197], v236 offset:22528
    v_mfma_f32_16x16x32_bf16 v[32:35], v[212:215], a[52:55], v[32:35]
    ds_read_b64_tr_b16 v[198:199], v236 offset:22784
    v_mfma_f32_16x16x32_bf16 v[40:43], v[208:211], a[112:115], v[40:43]
    v_mfma_f32_16x16x32_bf16 v[40:43], v[212:215], a[116:119], v[40:43]
    v_mfma_f32_16x16x32_bf16 v[48:51], v[208:211], a[176:179], v[48:51]
    ds_read_b64_tr_b16 v[200:201], v239 offset:20480
    v_mfma_f32_16x16x32_bf16 v[48:51], v[212:215], a[180:183], v[48:51]
    ds_read_b64_tr_b16 v[202:203], v239 offset:20736
    v_mfma_f32_16x16x32_bf16 v[56:59], v[208:211], a[240:243], v[56:59]
    s_waitcnt lgkmcnt(4)
    v_mfma_f32_16x16x32_bf16 v[56:59], v[212:215], a[244:247], v[56:59]
    v_mfma_f32_16x16x32_bf16 v[36:39], v[216:219], a[48:51], v[36:39]
    ds_read_b64_tr_b16 v[204:205], v239 offset:22528
    v_mfma_f32_16x16x32_bf16 v[36:39], v[220:223], a[52:55], v[36:39]
    ds_read_b64_tr_b16 v[206:207], v239 offset:22784
    v_mfma_f32_16x16x32_bf16 v[44:47], v[216:219], a[112:115], v[44:47]
    v_mfma_f32_16x16x32_bf16 v[44:47], v[220:223], a[116:119], v[44:47]
    v_mfma_f32_16x16x32_bf16 v[52:55], v[216:219], a[176:179], v[52:55]
    ds_read_b64_tr_b16 v[208:209], v236 offset:28672
    v_mfma_f32_16x16x32_bf16 v[52:55], v[220:223], a[180:183], v[52:55]
    ds_read_b64_tr_b16 v[210:211], v236 offset:28928
    v_mfma_f32_16x16x32_bf16 v[60:63], v[216:219], a[240:243], v[60:63]
    v_mfma_f32_16x16x32_bf16 v[60:63], v[220:223], a[244:247], v[60:63]
    s_waitcnt lgkmcnt(6)
    v_mfma_f32_16x16x32_bf16 v[0:3], v[192:195], a[56:59], v[0:3]
    ds_read_b64_tr_b16 v[212:213], v236 offset:30720
    v_mfma_f32_16x16x32_bf16 v[0:3], v[196:199], a[60:63], v[0:3]
    ds_read_b64_tr_b16 v[214:215], v236 offset:30976
    v_mfma_f32_16x16x32_bf16 v[8:11], v[192:195], a[120:123], v[8:11]
    ds_read_b64_tr_b16 v[216:217], v239 offset:28672
    v_mfma_f32_16x16x32_bf16 v[8:11], v[196:199], a[124:127], v[8:11]
    ds_read_b64_tr_b16 v[218:219], v239 offset:28928
    v_mfma_f32_16x16x32_bf16 v[16:19], v[192:195], a[184:187], v[16:19]
    ds_read_b64_tr_b16 v[220:221], v239 offset:30720
    v_mfma_f32_16x16x32_bf16 v[16:19], v[196:199], a[188:191], v[16:19]
    ds_read_b64_tr_b16 v[222:223], v239 offset:30976
    v_mfma_f32_16x16x32_bf16 v[24:27], v[192:195], a[248:251], v[24:27]
    v_mfma_f32_16x16x32_bf16 v[24:27], v[196:199], a[252:255], v[24:27]
    s_waitcnt lgkmcnt(8)
    v_mfma_f32_16x16x32_bf16 v[4:7], v[200:203], a[56:59], v[4:7]
    v_mfma_f32_16x16x32_bf16 v[4:7], v[204:207], a[60:63], v[4:7]
    v_mfma_f32_16x16x32_bf16 v[12:15], v[200:203], a[120:123], v[12:15]
    s_waitcnt lgkmcnt(0)
    v_mfma_f32_16x16x32_bf16 v[12:15], v[204:207], a[124:127], v[12:15]
    v_mfma_f32_16x16x32_bf16 v[20:23], v[200:203], a[184:187], v[20:23]
    s_waitcnt vmcnt(10)
    s_barrier
    v_mfma_f32_16x16x32_bf16 v[20:23], v[204:207], a[188:191], v[20:23]
    v_mfma_f32_16x16x32_bf16 v[28:31], v[200:203], a[248:251], v[28:31]
    v_mfma_f32_16x16x32_bf16 v[28:31], v[204:207], a[252:255], v[28:31]
    v_mfma_f32_16x16x32_bf16 v[32:35], v[208:211], a[56:59], v[32:35]
    ds_read_b64_tr_b16 v[192:193], v235 offset:32768
    v_mfma_f32_16x16x32_bf16 v[32:35], v[212:215], a[60:63], v[32:35]
    ds_read_b64_tr_b16 v[194:195], v235 offset:33024
    v_mfma_f32_16x16x32_bf16 v[40:43], v[208:211], a[120:123], v[40:43]
    ds_read_b64_tr_b16 v[196:197], v235 offset:34816
    v_mfma_f32_16x16x32_bf16 v[40:43], v[212:215], a[124:127], v[40:43]
    ds_read_b64_tr_b16 v[198:199], v235 offset:35072
    v_mfma_f32_16x16x32_bf16 v[48:51], v[208:211], a[184:187], v[48:51]
    ds_read_b64_tr_b16 v[200:201], v235 offset:36864
    v_mfma_f32_16x16x32_bf16 v[48:51], v[212:215], a[188:191], v[48:51]
    ds_read_b64_tr_b16 v[202:203], v235 offset:37120
    v_mfma_f32_16x16x32_bf16 v[56:59], v[208:211], a[248:251], v[56:59]
    ds_read_b64_tr_b16 v[204:205], v235 offset:38912
    v_mfma_f32_16x16x32_bf16 v[56:59], v[212:215], a[252:255], v[56:59]
    ds_read_b64_tr_b16 v[206:207], v235 offset:39168
    v_mfma_f32_16x16x32_bf16 v[36:39], v[216:219], a[56:59], v[36:39]
    v_mfma_f32_16x16x32_bf16 v[36:39], v[220:223], a[60:63], v[36:39]
    v_mfma_f32_16x16x32_bf16 v[44:47], v[216:219], a[120:123], v[44:47]
    s_mov_b32 s58, 0x3e0293ee
    v_mfma_f32_16x16x32_bf16 v[44:47], v[220:223], a[124:127], v[44:47]
    v_mfma_f32_16x16x32_bf16 v[52:55], v[216:219], a[184:187], v[52:55]
    v_mfma_f32_16x16x32_bf16 v[52:55], v[220:223], a[188:191], v[52:55]
    v_mfma_f32_16x16x32_bf16 v[60:63], v[216:219], a[248:251], v[60:63]
    v_mfma_f32_16x16x32_bf16 v[60:63], v[220:223], a[252:255], v[60:63]
    s_waitcnt lgkmcnt(4)
    v_mfma_f32_16x16x32_bf16 v[64:67], v[192:195], a[0:3], 0
    ds_read_b64_tr_b16 v[208:209], v238 offset:32768
    v_mfma_f32_16x16x32_bf16 v[64:67], v[196:199], a[4:7], v[64:67]
    s_waitcnt lgkmcnt(1)
    ds_read_b64_tr_b16 v[210:211], v238 offset:33024
    v_mfma_f32_16x16x32_bf16 v[64:67], v[200:203], a[8:11], v[64:67]
    ds_read_b64_tr_b16 v[212:213], v238 offset:34816
    v_mfma_f32_16x16x32_bf16 v[64:67], v[204:207], a[12:15], v[64:67]
    ds_read_b64_tr_b16 v[214:215], v238 offset:35072
    v_mfma_f32_16x16x32_bf16 v[72:75], v[204:207], a[76:79], 0
    ds_read_b64_tr_b16 v[216:217], v238 offset:36864
    v_mfma_f32_16x16x32_bf16 v[72:75], v[200:203], a[72:75], v[72:75]
    ds_read_b64_tr_b16 v[218:219], v238 offset:37120
    v_mfma_f32_16x16x32_bf16 v[72:75], v[196:199], a[68:71], v[72:75]
    ds_read_b64_tr_b16 v[220:221], v238 offset:38912
    v_mul_f32 v0, s58, v0
    v_mfma_f32_16x16x32_bf16 v[72:75], v[192:195], a[64:67], v[72:75]
    ds_read_b64_tr_b16 v[222:223], v238 offset:39168
    v_mul_f32 v1, s58, v1
    v_mfma_f32_16x16x32_bf16 v[80:83], v[192:195], a[128:131], 0
    v_mul_f32 v2, s58, v2
    v_mul_f32 v3, s58, v3
    v_mfma_f32_16x16x32_bf16 v[80:83], v[196:199], a[132:135], v[80:83]
    v_mul_f32 v4, s58, v4
    v_mul_f32 v5, s58, v5
    v_mfma_f32_16x16x32_bf16 v[80:83], v[200:203], a[136:139], v[80:83]
    v_mul_f32 v6, s58, v6
    v_mul_f32 v7, s58, v7
    v_mfma_f32_16x16x32_bf16 v[80:83], v[204:207], a[140:143], v[80:83]
    v_cvt_pk_bf16_f32 v0, v0, v1
    v_cvt_pk_bf16_f32 v1, v2, v3
    v_mfma_f32_16x16x32_bf16 v[88:91], v[204:207], a[204:207], 0
    v_cvt_pk_bf16_f32 v2, v4, v5
    v_cvt_pk_bf16_f32 v3, v6, v7
    v_mfma_f32_16x16x32_bf16 v[88:91], v[200:203], a[200:203], v[88:91]
    s_add_u32 s95, s94, 0
    v_mfma_f32_16x16x32_bf16 v[88:91], v[196:199], a[196:199], v[88:91]
    v_mfma_f32_16x16x32_bf16 v[88:91], v[192:195], a[192:195], v[88:91]
    s_waitcnt lgkmcnt(4)
    v_mfma_f32_16x16x32_bf16 v[68:71], v[208:211], a[0:3], 0
    ds_read_b64_tr_b16 v[192:193], v235 offset:40960
    v_mfma_f32_16x16x32_bf16 v[68:71], v[212:215], a[4:7], v[68:71]
    s_waitcnt lgkmcnt(1)
    ds_read_b64_tr_b16 v[194:195], v235 offset:41216
    v_mfma_f32_16x16x32_bf16 v[68:71], v[216:219], a[8:11], v[68:71]
    ds_read_b64_tr_b16 v[196:197], v235 offset:43008
    v_mfma_f32_16x16x32_bf16 v[68:71], v[220:223], a[12:15], v[68:71]
    ds_read_b64_tr_b16 v[198:199], v235 offset:43264
    v_mfma_f32_16x16x32_bf16 v[76:79], v[220:223], a[76:79], 0
    ds_read_b64_tr_b16 v[200:201], v235 offset:45056
    v_mfma_f32_16x16x32_bf16 v[76:79], v[216:219], a[72:75], v[76:79]
    ds_read_b64_tr_b16 v[202:203], v235 offset:45312
    v_mfma_f32_16x16x32_bf16 v[76:79], v[212:215], a[68:71], v[76:79]
    ds_read_b64_tr_b16 v[204:205], v235 offset:47104
    v_mfma_f32_16x16x32_bf16 v[76:79], v[208:211], a[64:67], v[76:79]
    ds_read_b64_tr_b16 v[206:207], v235 offset:47360
    v_mfma_f32_16x16x32_bf16 v[84:87], v[208:211], a[128:131], 0
    buffer_store_dwordx4 v[0:3], v240, s[20:23], s95 offen offset:0 sc1
    v_mfma_f32_16x16x32_bf16 v[84:87], v[212:215], a[132:135], v[84:87]
    v_mul_f32 v8, s58, v8
    v_mul_f32 v9, s58, v9
    v_mfma_f32_16x16x32_bf16 v[84:87], v[216:219], a[136:139], v[84:87]
    v_mul_f32 v10, s58, v10
    v_mul_f32 v11, s58, v11
    v_mfma_f32_16x16x32_bf16 v[84:87], v[220:223], a[140:143], v[84:87]
    v_mul_f32 v12, s58, v12
    v_mul_f32 v13, s58, v13
    v_mfma_f32_16x16x32_bf16 v[92:95], v[220:223], a[204:207], 0
    v_mul_f32 v14, s58, v14
    v_mul_f32 v15, s58, v15
    v_mfma_f32_16x16x32_bf16 v[92:95], v[216:219], a[200:203], v[92:95]
    v_cvt_pk_bf16_f32 v8, v8, v9
    v_cvt_pk_bf16_f32 v9, v10, v11
    v_mfma_f32_16x16x32_bf16 v[92:95], v[212:215], a[196:199], v[92:95]
    v_cvt_pk_bf16_f32 v10, v12, v13
    v_cvt_pk_bf16_f32 v11, v14, v15
    v_mfma_f32_16x16x32_bf16 v[92:95], v[208:211], a[192:195], v[92:95]
    s_waitcnt lgkmcnt(4)
    s_add_u32 s95, s94, 4096
    v_mfma_f32_16x16x32_bf16 v[96:99], v[192:195], a[0:3], 0
    ds_read_b64_tr_b16 v[208:209], v238 offset:40960
    v_mfma_f32_16x16x32_bf16 v[96:99], v[196:199], a[4:7], v[96:99]
    s_waitcnt lgkmcnt(1)
    ds_read_b64_tr_b16 v[210:211], v238 offset:41216
    v_mfma_f32_16x16x32_bf16 v[96:99], v[200:203], a[8:11], v[96:99]
    ds_read_b64_tr_b16 v[212:213], v238 offset:43008
    v_mfma_f32_16x16x32_bf16 v[96:99], v[204:207], a[12:15], v[96:99]
    ds_read_b64_tr_b16 v[214:215], v238 offset:43264
    v_mfma_f32_16x16x32_bf16 v[104:107], v[204:207], a[76:79], 0
    ds_read_b64_tr_b16 v[216:217], v238 offset:45056
    v_mfma_f32_16x16x32_bf16 v[104:107], v[200:203], a[72:75], v[104:107]
    ds_read_b64_tr_b16 v[218:219], v238 offset:45312
    v_mfma_f32_16x16x32_bf16 v[104:107], v[196:199], a[68:71], v[104:107]
    ds_read_b64_tr_b16 v[220:221], v238 offset:47104
    v_mfma_f32_16x16x32_bf16 v[104:107], v[192:195], a[64:67], v[104:107]
    ds_read_b64_tr_b16 v[222:223], v238 offset:47360
    v_mfma_f32_16x16x32_bf16 v[112:115], v[192:195], a[128:131], 0
    v_mfma_f32_16x16x32_bf16 v[112:115], v[196:199], a[132:135], v[112:115]
    v_mfma_f32_16x16x32_bf16 v[112:115], v[200:203], a[136:139], v[112:115]
    s_waitcnt lgkmcnt(0)
    v_mfma_f32_16x16x32_bf16 v[112:115], v[204:207], a[140:143], v[112:115]
    v_mfma_f32_16x16x32_bf16 v[120:123], v[204:207], a[204:207], 0
    s_waitcnt vmcnt(7)
    s_barrier
    v_mfma_f32_16x16x32_bf16 v[120:123], v[200:203], a[200:203], v[120:123]
    buffer_store_dwordx4 v[8:11], v240, s[20:23], s95 offen offset:0 sc1
    v_mfma_f32_16x16x32_bf16 v[120:123], v[196:199], a[196:199], v[120:123]
    v_mul_f32 v16, s58, v16
    v_mul_f32 v17, s58, v17
    v_mfma_f32_16x16x32_bf16 v[120:123], v[192:195], a[192:195], v[120:123]
    v_mul_f32 v18, s58, v18
    v_mul_f32 v19, s58, v19
    v_mfma_f32_16x16x32_bf16 v[100:103], v[208:211], a[0:3], 0
    ds_read_b64_tr_b16 v[192:193], v235 offset:49152
    v_mul_f32 v20, s58, v20
    v_mfma_f32_16x16x32_bf16 v[100:103], v[212:215], a[4:7], v[100:103]
    ds_read_b64_tr_b16 v[194:195], v235 offset:49408
    v_mul_f32 v21, s58, v21
    v_mfma_f32_16x16x32_bf16 v[100:103], v[216:219], a[8:11], v[100:103]
    ds_read_b64_tr_b16 v[196:197], v235 offset:51200
    v_mul_f32 v22, s58, v22
    v_mfma_f32_16x16x32_bf16 v[100:103], v[220:223], a[12:15], v[100:103]
    ds_read_b64_tr_b16 v[198:199], v235 offset:51456
    v_mul_f32 v23, s58, v23
    v_mfma_f32_16x16x32_bf16 v[108:111], v[220:223], a[76:79], 0
    ds_read_b64_tr_b16 v[200:201], v235 offset:53248
    v_cvt_pk_bf16_f32 v16, v16, v17
    v_mfma_f32_16x16x32_bf16 v[108:111], v[216:219], a[72:75], v[108:111]
    ds_read_b64_tr_b16 v[202:203], v235 offset:53504
    v_cvt_pk_bf16_f32 v17, v18, v19
    v_mfma_f32_16x16x32_bf16 v[108:111], v[212:215], a[68:71], v[108:111]
    ds_read_b64_tr_b16 v[204:205], v235 offset:55296
    v_cvt_pk_bf16_f32 v18, v20, v21
    v_mfma_f32_16x16x32_bf16 v[108:111], v[208:211], a[64:67], v[108:111]
    ds_read_b64_tr_b16 v[206:207], v235 offset:55552
    v_cvt_pk_bf16_f32 v19, v22, v23
    v_mfma_f32_16x16x32_bf16 v[116:119], v[208:211], a[128:131], 0
    s_add_u32 s95, s94, 8192
    v_mfma_f32_16x16x32_bf16 v[116:119], v[212:215], a[132:135], v[116:119]
    s_add_u32 m0, s53, 147456
    s_add_u32 s57, s54, 3145856
    v_mfma_f32_16x16x32_bf16 v[116:119], v[216:219], a[136:139], v[116:119]
    v_mfma_f32_16x16x32_bf16 v[116:119], v[220:223], a[140:143], v[116:119]
    v_mfma_f32_16x16x32_bf16 v[124:127], v[220:223], a[204:207], 0
    buffer_load_dwordx4 v241, s[12:15], s57 offen offset:0 lds
    v_mfma_f32_16x16x32_bf16 v[124:127], v[216:219], a[200:203], v[124:127]
    s_add_u32 s57, s54, 3275904
    v_mfma_f32_16x16x32_bf16 v[124:127], v[212:215], a[196:199], v[124:127]
    v_mfma_f32_16x16x32_bf16 v[124:127], v[208:211], a[192:195], v[124:127]
    s_waitcnt lgkmcnt(4)
    v_mfma_f32_16x16x32_bf16 v[64:67], v[192:195], a[16:19], v[64:67]
    ds_read_b64_tr_b16 v[208:209], v238 offset:49152
    buffer_load_dwordx4 v241, s[12:15], s57 offen offset:1024 lds
    v_mfma_f32_16x16x32_bf16 v[64:67], v[196:199], a[20:23], v[64:67]
    s_waitcnt lgkmcnt(1)
    s_add_u32 s57, s54, 3405952
    ds_read_b64_tr_b16 v[210:211], v238 offset:49408
    v_mfma_f32_16x16x32_bf16 v[64:67], v[200:203], a[24:27], v[64:67]
    ds_read_b64_tr_b16 v[212:213], v238 offset:51200
    v_mfma_f32_16x16x32_bf16 v[64:67], v[204:207], a[28:31], v[64:67]
    ds_read_b64_tr_b16 v[214:215], v238 offset:51456
    v_mfma_f32_16x16x32_bf16 v[72:75], v[204:207], a[92:95], v[72:75]
    ds_read_b64_tr_b16 v[216:217], v238 offset:53248
    buffer_load_dwordx4 v241, s[12:15], s57 offen offset:2048 lds
    v_mfma_f32_16x16x32_bf16 v[72:75], v[200:203], a[88:91], v[72:75]
    s_add_u32 s57, s54, 3536000
    ds_read_b64_tr_b16 v[218:219], v238 offset:53504
    v_mfma_f32_16x16x32_bf16 v[72:75], v[196:199], a[84:87], v[72:75]
    ds_read_b64_tr_b16 v[220:221], v238 offset:55296
    v_mfma_f32_16x16x32_bf16 v[72:75], v[192:195], a[80:83], v[72:75]
    ds_read_b64_tr_b16 v[222:223], v238 offset:55552
    v_mfma_f32_16x16x32_bf16 v[80:83], v[192:195], a[144:147], v[80:83]
    buffer_load_dwordx4 v241, s[12:15], s57 offen offset:3072 lds
    v_mfma_f32_16x16x32_bf16 v[80:83], v[196:199], a[148:151], v[80:83]
    v_mfma_f32_16x16x32_bf16 v[80:83], v[200:203], a[152:155], v[80:83]
    buffer_store_dwordx4 v[16:19], v240, s[20:23], s95 offen offset:0 sc1
    v_mfma_f32_16x16x32_bf16 v[80:83], v[204:207], a[156:159], v[80:83]
    v_mul_f32 v24, s58, v24
    v_mul_f32 v25, s58, v25
    v_mfma_f32_16x16x32_bf16 v[88:91], v[204:207], a[220:223], v[88:91]
    v_mul_f32 v26, s58, v26
    v_mul_f32 v27, s58, v27
    v_mfma_f32_16x16x32_bf16 v[88:91], v[200:203], a[216:219], v[88:91]
    v_mul_f32 v28, s58, v28
    v_mul_f32 v29, s58, v29
    v_mfma_f32_16x16x32_bf16 v[88:91], v[196:199], a[212:215], v[88:91]
    v_mul_f32 v30, s58, v30
    v_mul_f32 v31, s58, v31
    v_mfma_f32_16x16x32_bf16 v[88:91], v[192:195], a[208:211], v[88:91]
    s_waitcnt lgkmcnt(4)
    v_cvt_pk_bf16_f32 v24, v24, v25
    v_cvt_pk_bf16_f32 v25, v26, v27
    v_mfma_f32_16x16x32_bf16 v[68:71], v[208:211], a[16:19], v[68:71]
    ds_read_b64_tr_b16 v[192:193], v235 offset:57344
    v_cvt_pk_bf16_f32 v26, v28, v29
    v_mfma_f32_16x16x32_bf16 v[68:71], v[212:215], a[20:23], v[68:71]
    s_waitcnt lgkmcnt(1)
    s_add_u32 m0, s49, 0
    s_add_u32 s57, s50, 0
    ds_read_b64_tr_b16 v[194:195], v235 offset:57600
    v_mfma_f32_16x16x32_bf16 v[68:71], v[216:219], a[24:27], v[68:71]
    ds_read_b64_tr_b16 v[196:197], v235 offset:59392
    v_cvt_pk_bf16_f32 v27, v30, v31
    v_mfma_f32_16x16x32_bf16 v[68:71], v[220:223], a[28:31], v[68:71]
    s_add_u32 s95, s94, 12288
    ds_read_b64_tr_b16 v[198:199], v235 offset:59648
    v_mfma_f32_16x16x32_bf16 v[76:79], v[220:223], a[92:95], v[76:79]
    ds_read_b64_tr_b16 v[200:201], v235 offset:61440
    buffer_load_dwordx4 v241, s[16:19], s57 offen offset:0 lds
    v_mfma_f32_16x16x32_bf16 v[76:79], v[216:219], a[88:91], v[76:79]
    s_add_u32 s57, s50, 130048
    ds_read_b64_tr_b16 v[202:203], v235 offset:61696
    v_mfma_f32_16x16x32_bf16 v[76:79], v[212:215], a[84:87], v[76:79]
    ds_read_b64_tr_b16 v[204:205], v235 offset:63488
    v_mfma_f32_16x16x32_bf16 v[76:79], v[208:211], a[80:83], v[76:79]
    ds_read_b64_tr_b16 v[206:207], v235 offset:63744
    buffer_load_dwordx4 v241, s[16:19], s57 offen offset:1024 lds
    v_mfma_f32_16x16x32_bf16 v[84:87], v[208:211], a[144:147], v[84:87]
    s_add_u32 s57, s50, 260096
    v_mfma_f32_16x16x32_bf16 v[84:87], v[212:215], a[148:151], v[84:87]
    v_mfma_f32_16x16x32_bf16 v[84:87], v[216:219], a[152:155], v[84:87]
    buffer_load_dwordx4 v241, s[16:19], s57 offen offset:2048 lds
    v_mfma_f32_16x16x32_bf16 v[84:87], v[220:223], a[156:159], v[84:87]
    s_add_u32 s57, s50, 390144
    v_mfma_f32_16x16x32_bf16 v[92:95], v[220:223], a[220:223], v[92:95]
    v_mfma_f32_16x16x32_bf16 v[92:95], v[216:219], a[216:219], v[92:95]
    buffer_load_dwordx4 v241, s[16:19], s57 offen offset:3072 lds
    v_mfma_f32_16x16x32_bf16 v[92:95], v[212:215], a[212:215], v[92:95]
    v_mfma_f32_16x16x32_bf16 v[92:95], v[208:211], a[208:211], v[92:95]
    s_waitcnt lgkmcnt(4)
    s_add_u32 m0, s49, 16384
    s_add_u32 s57, s50, 524288
    v_mfma_f32_16x16x32_bf16 v[96:99], v[192:195], a[16:19], v[96:99]
    ds_read_b64_tr_b16 v[208:209], v238 offset:57344
    v_mfma_f32_16x16x32_bf16 v[96:99], v[196:199], a[20:23], v[96:99]
    s_waitcnt lgkmcnt(1)
    ds_read_b64_tr_b16 v[210:211], v238 offset:57600
    v_mfma_f32_16x16x32_bf16 v[96:99], v[200:203], a[24:27], v[96:99]
    ds_read_b64_tr_b16 v[212:213], v238 offset:59392
    buffer_load_dwordx4 v241, s[16:19], s57 offen offset:0 lds
    v_mfma_f32_16x16x32_bf16 v[96:99], v[204:207], a[28:31], v[96:99]
    s_add_u32 s57, s50, 654336
    ds_read_b64_tr_b16 v[214:215], v238 offset:59648
    v_mfma_f32_16x16x32_bf16 v[104:107], v[204:207], a[92:95], v[104:107]
    ds_read_b64_tr_b16 v[216:217], v238 offset:61440
    v_mfma_f32_16x16x32_bf16 v[104:107], v[200:203], a[88:91], v[104:107]
    ds_read_b64_tr_b16 v[218:219], v238 offset:61696
    buffer_load_dwordx4 v241, s[16:19], s57 offen offset:1024 lds
    v_mfma_f32_16x16x32_bf16 v[104:107], v[196:199], a[84:87], v[104:107]
    s_add_u32 s57, s50, 784384
    ds_read_b64_tr_b16 v[220:221], v238 offset:63488
    v_mfma_f32_16x16x32_bf16 v[104:107], v[192:195], a[80:83], v[104:107]
    ds_read_b64_tr_b16 v[222:223], v238 offset:63744
    v_mfma_f32_16x16x32_bf16 v[112:115], v[192:195], a[144:147], v[112:115]
    buffer_load_dwordx4 v241, s[16:19], s57 offen offset:2048 lds
    v_mfma_f32_16x16x32_bf16 v[112:115], v[196:199], a[148:151], v[112:115]
    s_add_u32 s57, s50, 914432
    buffer_store_dwordx4 v[24:27], v240, s[20:23], s95 offen offset:0 sc1
    v_mfma_f32_16x16x32_bf16 v[112:115], v[200:203], a[152:155], v[112:115]
    s_waitcnt lgkmcnt(0)
    v_mul_f32 v32, s58, v32
    v_mul_f32 v33, s58, v33
    v_mfma_f32_16x16x32_bf16 v[112:115], v[204:207], a[156:159], v[112:115]
    buffer_load_dwordx4 v241, s[16:19], s57 offen offset:3072 lds
    v_mfma_f32_16x16x32_bf16 v[120:123], v[204:207], a[220:223], v[120:123]
    s_waitcnt vmcnt(16)
    s_barrier
    v_mul_f32 v34, s58, v34
    v_mfma_f32_16x16x32_bf16 v[120:123], v[200:203], a[216:219], v[120:123]
    s_add_u32 m0, s49, 32768
    s_add_u32 s57, s50, 1048576
    v_mul_f32 v35, s58, v35
    v_mfma_f32_16x16x32_bf16 v[120:123], v[196:199], a[212:215], v[120:123]
    v_mul_f32 v36, s58, v36
    v_mul_f32 v37, s58, v37
    v_mfma_f32_16x16x32_bf16 v[120:123], v[192:195], a[208:211], v[120:123]
    v_mul_f32 v38, s58, v38
    v_mul_f32 v39, s58, v39
    v_mfma_f32_16x16x32_bf16 v[100:103], v[208:211], a[16:19], v[100:103]
    ds_read_b64_tr_b16 v[192:193], v236 offset:0
    buffer_load_dwordx4 v241, s[16:19], s57 offen offset:0 lds
    v_mfma_f32_16x16x32_bf16 v[100:103], v[212:215], a[20:23], v[100:103]
    s_add_u32 s57, s50, 1178624
    ds_read_b64_tr_b16 v[194:195], v236 offset:256
    v_mfma_f32_16x16x32_bf16 v[100:103], v[216:219], a[24:27], v[100:103]
    ds_read_b64_tr_b16 v[196:197], v236 offset:2048
    v_cvt_pk_bf16_f32 v32, v32, v33
    v_mfma_f32_16x16x32_bf16 v[100:103], v[220:223], a[28:31], v[100:103]
    ds_read_b64_tr_b16 v[198:199], v236 offset:2304
    buffer_load_dwordx4 v241, s[16:19], s57 offen offset:1024 lds
    v_mfma_f32_16x16x32_bf16 v[108:111], v[220:223], a[92:95], v[108:111]
    s_add_u32 s57, s50, 1308672
    ds_read_b64_tr_b16 v[200:201], v236 offset:4096
    v_cvt_pk_bf16_f32 v33, v34, v35
    v_mfma_f32_16x16x32_bf16 v[108:111], v[216:219], a[88:91], v[108:111]
    ds_read_b64_tr_b16 v[202:203], v236 offset:4352
    v_cvt_pk_bf16_f32 v34, v36, v37
    v_mfma_f32_16x16x32_bf16 v[108:111], v[212:215], a[84:87], v[108:111]
    ds_read_b64_tr_b16 v[204:205], v236 offset:6144
    buffer_load_dwordx4 v241, s[16:19], s57 offen offset:2048 lds
    v_mfma_f32_16x16x32_bf16 v[108:111], v[208:211], a[80:83], v[108:111]
    s_add_u32 s57, s50, 1438720
    ds_read_b64_tr_b16 v[206:207], v236 offset:6400
    v_cvt_pk_bf16_f32 v35, v38, v39
    v_mfma_f32_16x16x32_bf16 v[116:119], v[208:211], a[144:147], v[116:119]
    s_add_u32 s95, s94, 0
    v_mfma_f32_16x16x32_bf16 v[116:119], v[212:215], a[148:151], v[116:119]
    buffer_load_dwordx4 v241, s[16:19], s57 offen offset:3072 lds
    v_mfma_f32_16x16x32_bf16 v[116:119], v[216:219], a[152:155], v[116:119]
    v_mfma_f32_16x16x32_bf16 v[116:119], v[220:223], a[156:159], v[116:119]
    s_add_u32 m0, s49, 49152
    s_add_u32 s57, s50, 1572864
    v_mfma_f32_16x16x32_bf16 v[124:127], v[220:223], a[220:223], v[124:127]
    v_mfma_f32_16x16x32_bf16 v[124:127], v[216:219], a[216:219], v[124:127]
    v_mfma_f32_16x16x32_bf16 v[124:127], v[212:215], a[212:215], v[124:127]
    buffer_load_dwordx4 v241, s[16:19], s57 offen offset:0 lds
    v_mfma_f32_16x16x32_bf16 v[124:127], v[208:211], a[208:211], v[124:127]
    s_waitcnt lgkmcnt(4)
    s_add_u32 s57, s50, 1702912
    v_mfma_f32_16x16x32_bf16 v[64:67], v[192:195], a[32:35], v[64:67]
    ds_read_b64_tr_b16 v[208:209], v239 offset:0
    v_mfma_f32_16x16x32_bf16 v[64:67], v[196:199], a[36:39], v[64:67]
    s_waitcnt lgkmcnt(1)
    ds_read_b64_tr_b16 v[210:211], v239 offset:256
    buffer_load_dwordx4 v241, s[16:19], s57 offen offset:1024 lds
    v_mfma_f32_16x16x32_bf16 v[64:67], v[200:203], a[40:43], v[64:67]
    s_add_u32 s57, s50, 1832960
    ds_read_b64_tr_b16 v[212:213], v239 offset:2048
    v_mfma_f32_16x16x32_bf16 v[64:67], v[204:207], a[44:47], v[64:67]
    ds_read_b64_tr_b16 v[214:215], v239 offset:2304
    v_mfma_f32_16x16x32_bf16 v[72:75], v[204:207], a[108:111], v[72:75]
    ds_read_b64_tr_b16 v[216:217], v239 offset:4096
    buffer_load_dwordx4 v241, s[16:19], s57 offen offset:2048 lds
    v_mfma_f32_16x16x32_bf16 v[72:75], v[200:203], a[104:107], v[72:75]
    s_add_u32 s57, s50, 1963008
    ds_read_b64_tr_b16 v[218:219], v239 offset:4352
    v_mfma_f32_16x16x32_bf16 v[72:75], v[196:199], a[100:103], v[72:75]
    ds_read_b64_tr_b16 v[220:221], v239 offset:6144
    v_mfma_f32_16x16x32_bf16 v[72:75], v[192:195], a[96:99], v[72:75]
    ds_read_b64_tr_b16 v[222:223], v239 offset:6400
    buffer_load_dwordx4 v241, s[16:19], s57 offen offset:3072 lds
    v_mfma_f32_16x16x32_bf16 v[80:83], v[192:195], a[160:163], v[80:83]
    buffer_store_dwordx4 v[32:35], v240, s[20:23], s95 offen offset:1024 sc1
    v_mfma_f32_16x16x32_bf16 v[80:83], v[196:199], a[164:167], v[80:83]
    s_add_u32 m0, s49, 65536
    s_add_u32 s57, s50, 2097152
    v_mul_f32 v40, s58, v40
    v_mfma_f32_16x16x32_bf16 v[80:83], v[200:203], a[168:171], v[80:83]
    v_mul_f32 v41, s58, v41
    v_mul_f32 v42, s58, v42
    v_mfma_f32_16x16x32_bf16 v[80:83], v[204:207], a[172:175], v[80:83]
    v_mul_f32 v43, s58, v43
    v_mul_f32 v44, s58, v44
    v_mfma_f32_16x16x32_bf16 v[88:91], v[204:207], a[236:239], v[88:91]
    buffer_load_dwordx4 v241, s[16:19], s57 offen offset:0 lds
    v_mfma_f32_16x16x32_bf16 v[88:91], v[200:203], a[232:235], v[88:91]
    s_add_u32 s57, s50, 2227200
    v_mul_f32 v45, s58, v45
    v_mul_f32 v46, s58, v46
    v_mfma_f32_16x16x32_bf16 v[88:91], v[196:199], a[228:231], v[88:91]
    v_mul_f32 v47, s58, v47
    v_cvt_pk_bf16_f32 v40, v40, v41
    v_mfma_f32_16x16x32_bf16 v[88:91], v[192:195], a[224:227], v[88:91]
    s_waitcnt lgkmcnt(4)
    buffer_load_dwordx4 v241, s[16:19], s57 offen offset:1024 lds
    v_mfma_f32_16x16x32_bf16 v[68:71], v[208:211], a[32:35], v[68:71]
    s_add_u32 s57, s50, 2357248
    ds_read_b64_tr_b16 v[192:193], v236 offset:8192
    v_cvt_pk_bf16_f32 v41, v42, v43
    v_mfma_f32_16x16x32_bf16 v[68:71], v[212:215], a[36:39], v[68:71]
    s_waitcnt lgkmcnt(1)
    ds_read_b64_tr_b16 v[194:195], v236 offset:8448
    v_cvt_pk_bf16_f32 v42, v44, v45
    v_mfma_f32_16x16x32_bf16 v[68:71], v[216:219], a[40:43], v[68:71]
    ds_read_b64_tr_b16 v[196:197], v236 offset:10240
    buffer_load_dwordx4 v241, s[16:19], s57 offen offset:2048 lds
    v_mfma_f32_16x16x32_bf16 v[68:71], v[220:223], a[44:47], v[68:71]
    s_add_u32 s57, s50, 2487296
    ds_read_b64_tr_b16 v[198:199], v236 offset:10496
    v_cvt_pk_bf16_f32 v43, v46, v47
    v_mfma_f32_16x16x32_bf16 v[76:79], v[220:223], a[108:111], v[76:79]
    s_add_u32 s95, s94, 4096
    ds_read_b64_tr_b16 v[200:201], v236 offset:12288
    v_mfma_f32_16x16x32_bf16 v[76:79], v[216:219], a[104:107], v[76:79]
    ds_read_b64_tr_b16 v[202:203], v236 offset:12544
    buffer_load_dwordx4 v241, s[16:19], s57 offen offset:3072 lds
    v_mfma_f32_16x16x32_bf16 v[76:79], v[212:215], a[100:103], v[76:79]
    ds_read_b64_tr_b16 v[204:205], v236 offset:14336
    v_mfma_f32_16x16x32_bf16 v[76:79], v[208:211], a[96:99], v[76:79]
    ds_read_b64_tr_b16 v[206:207], v236 offset:14592
    v_mfma_f32_16x16x32_bf16 v[84:87], v[208:211], a[160:163], v[84:87]
    v_mfma_f32_16x16x32_bf16 v[84:87], v[212:215], a[164:167], v[84:87]
    v_mfma_f32_16x16x32_bf16 v[84:87], v[216:219], a[168:171], v[84:87]
    v_mfma_f32_16x16x32_bf16 v[84:87], v[220:223], a[172:175], v[84:87]
    v_mfma_f32_16x16x32_bf16 v[92:95], v[220:223], a[236:239], v[92:95]
    v_mfma_f32_16x16x32_bf16 v[92:95], v[216:219], a[232:235], v[92:95]
    v_mfma_f32_16x16x32_bf16 v[92:95], v[212:215], a[228:231], v[92:95]
    v_mfma_f32_16x16x32_bf16 v[92:95], v[208:211], a[224:227], v[92:95]
    s_waitcnt lgkmcnt(4)
    v_mfma_f32_16x16x32_bf16 v[96:99], v[192:195], a[32:35], v[96:99]
    ds_read_b64_tr_b16 v[208:209], v239 offset:8192
    v_mfma_f32_16x16x32_bf16 v[96:99], v[196:199], a[36:39], v[96:99]
    s_waitcnt lgkmcnt(1)
    ds_read_b64_tr_b16 v[210:211], v239 offset:8448
    v_mfma_f32_16x16x32_bf16 v[96:99], v[200:203], a[40:43], v[96:99]
    ds_read_b64_tr_b16 v[212:213], v239 offset:10240
    buffer_load_dword v244, v243, s[4:7], 0 offen sc1
    v_mfma_f32_16x16x32_bf16 v[96:99], v[204:207], a[44:47], v[96:99]
    ds_read_b64_tr_b16 v[214:215], v239 offset:10496
    v_mfma_f32_16x16x32_bf16 v[104:107], v[204:207], a[108:111], v[104:107]
    ds_read_b64_tr_b16 v[216:217], v239 offset:12288
    v_mfma_f32_16x16x32_bf16 v[104:107], v[200:203], a[104:107], v[104:107]
    ds_read_b64_tr_b16 v[218:219], v239 offset:12544
    v_mfma_f32_16x16x32_bf16 v[104:107], v[196:199], a[100:103], v[104:107]
    ds_read_b64_tr_b16 v[220:221], v239 offset:14336
    v_mfma_f32_16x16x32_bf16 v[104:107], v[192:195], a[96:99], v[104:107]
    ds_read_b64_tr_b16 v[222:223], v239 offset:14592
    v_mfma_f32_16x16x32_bf16 v[112:115], v[192:195], a[160:163], v[112:115]
    buffer_store_dwordx4 v[40:43], v240, s[20:23], s95 offen offset:1024 sc1
    v_mfma_f32_16x16x32_bf16 v[112:115], v[196:199], a[164:167], v[112:115]
    v_mul_f32 v48, s58, v48
    v_mul_f32 v49, s58, v49
    v_mfma_f32_16x16x32_bf16 v[112:115], v[200:203], a[168:171], v[112:115]
    s_waitcnt lgkmcnt(0)
    v_mul_f32 v50, s58, v50
    v_mul_f32 v51, s58, v51
    v_mfma_f32_16x16x32_bf16 v[112:115], v[204:207], a[172:175], v[112:115]
    v_mul_f32 v52, s58, v52
    v_mul_f32 v53, s58, v53
    v_mfma_f32_16x16x32_bf16 v[120:123], v[204:207], a[236:239], v[120:123]
    s_waitcnt vmcnt(25)
    s_barrier
    v_mul_f32 v54, s58, v54
    v_mfma_f32_16x16x32_bf16 v[120:123], v[200:203], a[232:235], v[120:123]
    s_mov_b32 s12, s40
    v_mul_f32 v55, s58, v55
    v_cvt_pk_bf16_f32 v48, v48, v49
    v_mfma_f32_16x16x32_bf16 v[120:123], v[196:199], a[228:231], v[120:123]
    s_mov_b32 s13, s41
    v_cvt_pk_bf16_f32 v49, v50, v51
    v_cvt_pk_bf16_f32 v50, v52, v53
    v_mfma_f32_16x16x32_bf16 v[120:123], v[192:195], a[224:227], v[120:123]
    s_mov_b32 s14, 1835008
    v_cvt_pk_bf16_f32 v51, v54, v55
    v_mfma_f32_16x16x32_bf16 v[100:103], v[208:211], a[32:35], v[100:103]
    ds_read_b64_tr_b16 v[192:193], v236 offset:16384
    buffer_load_dword v250, v245, s[12:15], s61 offen
    v_mfma_f32_16x16x32_bf16 v[100:103], v[212:215], a[36:39], v[100:103]
    s_add_u32 s95, s94, 8192
    ds_read_b64_tr_b16 v[194:195], v236 offset:16640
    v_mfma_f32_16x16x32_bf16 v[100:103], v[216:219], a[40:43], v[100:103]
    ds_read_b64_tr_b16 v[196:197], v236 offset:18432
    v_mfma_f32_16x16x32_bf16 v[100:103], v[220:223], a[44:47], v[100:103]
    ds_read_b64_tr_b16 v[198:199], v236 offset:18688
    v_mfma_f32_16x16x32_bf16 v[108:111], v[220:223], a[108:111], v[108:111]
    ds_read_b64_tr_b16 v[200:201], v236 offset:20480
    v_mfma_f32_16x16x32_bf16 v[108:111], v[216:219], a[104:107], v[108:111]
    ds_read_b64_tr_b16 v[202:203], v236 offset:20736
    v_mfma_f32_16x16x32_bf16 v[108:111], v[212:215], a[100:103], v[108:111]
    ds_read_b64_tr_b16 v[204:205], v236 offset:22528
    v_mfma_f32_16x16x32_bf16 v[108:111], v[208:211], a[96:99], v[108:111]
    ds_read_b64_tr_b16 v[206:207], v236 offset:22784
    v_mfma_f32_16x16x32_bf16 v[116:119], v[208:211], a[160:163], v[116:119]
    v_mfma_f32_16x16x32_bf16 v[116:119], v[212:215], a[164:167], v[116:119]
    v_mfma_f32_16x16x32_bf16 v[116:119], v[216:219], a[168:171], v[116:119]
    v_mfma_f32_16x16x32_bf16 v[116:119], v[220:223], a[172:175], v[116:119]
    v_mfma_f32_16x16x32_bf16 v[124:127], v[220:223], a[236:239], v[124:127]
    v_mfma_f32_16x16x32_bf16 v[124:127], v[216:219], a[232:235], v[124:127]
    v_mfma_f32_16x16x32_bf16 v[124:127], v[212:215], a[228:231], v[124:127]
    buffer_store_dwordx4 v[48:51], v240, s[20:23], s95 offen offset:1024 sc1
    v_mfma_f32_16x16x32_bf16 v[124:127], v[208:211], a[224:227], v[124:127]
    s_waitcnt lgkmcnt(4)
    v_mul_f32 v56, s58, v56
    v_mul_f32 v57, s58, v57
    v_mfma_f32_16x16x32_bf16 v[64:67], v[192:195], a[48:51], v[64:67]
    ds_read_b64_tr_b16 v[208:209], v239 offset:16384
    v_mul_f32 v58, s58, v58
    v_mfma_f32_16x16x32_bf16 v[64:67], v[196:199], a[52:55], v[64:67]
    s_waitcnt lgkmcnt(1)
    ds_read_b64_tr_b16 v[210:211], v239 offset:16640
    v_mul_f32 v59, s58, v59
    v_mfma_f32_16x16x32_bf16 v[64:67], v[200:203], a[56:59], v[64:67]
    ds_read_b64_tr_b16 v[212:213], v239 offset:18432
    v_mul_f32 v60, s58, v60
    v_mfma_f32_16x16x32_bf16 v[64:67], v[204:207], a[60:63], v[64:67]
    ds_read_b64_tr_b16 v[214:215], v239 offset:18688
    v_mul_f32 v61, s58, v61
    v_mfma_f32_16x16x32_bf16 v[72:75], v[204:207], a[124:127], v[72:75]
    ds_read_b64_tr_b16 v[216:217], v239 offset:20480
    v_mul_f32 v62, s58, v62
    v_mfma_f32_16x16x32_bf16 v[72:75], v[200:203], a[120:123], v[72:75]
    ds_read_b64_tr_b16 v[218:219], v239 offset:20736
    v_mul_f32 v63, s58, v63
    v_mfma_f32_16x16x32_bf16 v[72:75], v[196:199], a[116:119], v[72:75]
    ds_read_b64_tr_b16 v[220:221], v239 offset:22528
    v_cvt_pk_bf16_f32 v56, v56, v57
    v_mfma_f32_16x16x32_bf16 v[72:75], v[192:195], a[112:115], v[72:75]
    ds_read_b64_tr_b16 v[222:223], v239 offset:22784
    v_cvt_pk_bf16_f32 v57, v58, v59
    v_mfma_f32_16x16x32_bf16 v[80:83], v[192:195], a[176:179], v[80:83]
    v_cvt_pk_bf16_f32 v58, v60, v61
    v_cvt_pk_bf16_f32 v59, v62, v63
    v_mfma_f32_16x16x32_bf16 v[80:83], v[196:199], a[180:183], v[80:83]
    s_add_u32 s95, s94, 12288
    v_mfma_f32_16x16x32_bf16 v[80:83], v[200:203], a[184:187], v[80:83]
    v_mfma_f32_16x16x32_bf16 v[80:83], v[204:207], a[188:191], v[80:83]
    v_mfma_f32_16x16x32_bf16 v[88:91], v[204:207], a[252:255], v[88:91]
    v_mfma_f32_16x16x32_bf16 v[88:91], v[200:203], a[248:251], v[88:91]
    v_mfma_f32_16x16x32_bf16 v[88:91], v[196:199], a[244:247], v[88:91]
    v_mfma_f32_16x16x32_bf16 v[88:91], v[192:195], a[240:243], v[88:91]
    s_waitcnt lgkmcnt(4)
    v_mfma_f32_16x16x32_bf16 v[68:71], v[208:211], a[48:51], v[68:71]
    ds_read_b64_tr_b16 v[192:193], v236 offset:24576
    v_mfma_f32_16x16x32_bf16 v[68:71], v[212:215], a[52:55], v[68:71]
    s_waitcnt lgkmcnt(1)
    ds_read_b64_tr_b16 v[194:195], v236 offset:24832
    v_mfma_f32_16x16x32_bf16 v[68:71], v[216:219], a[56:59], v[68:71]
    ds_read_b64_tr_b16 v[196:197], v236 offset:26624
    v_mfma_f32_16x16x32_bf16 v[68:71], v[220:223], a[60:63], v[68:71]
    ds_read_b64_tr_b16 v[198:199], v236 offset:26880
    v_mfma_f32_16x16x32_bf16 v[76:79], v[220:223], a[124:127], v[76:79]
    ds_read_b64_tr_b16 v[200:201], v236 offset:28672
    v_mfma_f32_16x16x32_bf16 v[76:79], v[216:219], a[120:123], v[76:79]
    ds_read_b64_tr_b16 v[202:203], v236 offset:28928
    v_mfma_f32_16x16x32_bf16 v[76:79], v[212:215], a[116:119], v[76:79]
    ds_read_b64_tr_b16 v[204:205], v236 offset:30720
    v_mfma_f32_16x16x32_bf16 v[76:79], v[208:211], a[112:115], v[76:79]
    ds_read_b64_tr_b16 v[206:207], v236 offset:30976
    v_mfma_f32_16x16x32_bf16 v[84:87], v[208:211], a[176:179], v[84:87]
    v_mfma_f32_16x16x32_bf16 v[84:87], v[212:215], a[180:183], v[84:87]
    v_mfma_f32_16x16x32_bf16 v[84:87], v[216:219], a[184:187], v[84:87]
    v_mfma_f32_16x16x32_bf16 v[84:87], v[220:223], a[188:191], v[84:87]
    buffer_store_dwordx4 v[56:59], v240, s[20:23], s95 offen offset:1024 sc1
    v_mfma_f32_16x16x32_bf16 v[92:95], v[220:223], a[252:255], v[92:95]
    v_mfma_f32_16x16x32_bf16 v[92:95], v[216:219], a[248:251], v[92:95]
    v_mfma_f32_16x16x32_bf16 v[92:95], v[212:215], a[244:247], v[92:95]
    v_mfma_f32_16x16x32_bf16 v[92:95], v[208:211], a[240:243], v[92:95]
    s_waitcnt lgkmcnt(4)
    v_mfma_f32_16x16x32_bf16 v[96:99], v[192:195], a[48:51], v[96:99]
    ds_read_b64_tr_b16 v[208:209], v239 offset:24576
    v_mfma_f32_16x16x32_bf16 v[96:99], v[196:199], a[52:55], v[96:99]
    s_waitcnt lgkmcnt(1)
    ds_read_b64_tr_b16 v[210:211], v239 offset:24832
    v_mfma_f32_16x16x32_bf16 v[96:99], v[200:203], a[56:59], v[96:99]
    ds_read_b64_tr_b16 v[212:213], v239 offset:26624
    v_mfma_f32_16x16x32_bf16 v[96:99], v[204:207], a[60:63], v[96:99]
    ds_read_b64_tr_b16 v[214:215], v239 offset:26880
    v_mfma_f32_16x16x32_bf16 v[104:107], v[204:207], a[124:127], v[104:107]
    ds_read_b64_tr_b16 v[216:217], v239 offset:28672
    v_mfma_f32_16x16x32_bf16 v[104:107], v[200:203], a[120:123], v[104:107]
    ds_read_b64_tr_b16 v[218:219], v239 offset:28928
    v_mfma_f32_16x16x32_bf16 v[104:107], v[196:199], a[116:119], v[104:107]
    ds_read_b64_tr_b16 v[220:221], v239 offset:30720
    v_mfma_f32_16x16x32_bf16 v[104:107], v[192:195], a[112:115], v[104:107]
    ds_read_b64_tr_b16 v[222:223], v239 offset:30976
    v_mfma_f32_16x16x32_bf16 v[112:115], v[192:195], a[176:179], v[112:115]
    v_mfma_f32_16x16x32_bf16 v[112:115], v[196:199], a[180:183], v[112:115]
    v_mfma_f32_16x16x32_bf16 v[112:115], v[200:203], a[184:187], v[112:115]
    s_waitcnt lgkmcnt(0)
    v_mfma_f32_16x16x32_bf16 v[112:115], v[204:207], a[188:191], v[112:115]
    v_mfma_f32_16x16x32_bf16 v[120:123], v[204:207], a[252:255], v[120:123]
    s_waitcnt vmcnt(18)
    s_barrier
    v_mfma_f32_16x16x32_bf16 v[120:123], v[200:203], a[248:251], v[120:123]
    v_mfma_f32_16x16x32_bf16 v[120:123], v[196:199], a[244:247], v[120:123]
    v_mfma_f32_16x16x32_bf16 v[120:123], v[192:195], a[240:243], v[120:123]
    v_mfma_f32_16x16x32_bf16 v[100:103], v[208:211], a[48:51], v[100:103]
    ds_read_b64_tr_b16 v[192:193], v234 offset:0
    v_mfma_f32_16x16x32_bf16 v[100:103], v[212:215], a[52:55], v[100:103]
    ds_read_b64_tr_b16 v[194:195], v234 offset:256
    v_mfma_f32_16x16x32_bf16 v[100:103], v[216:219], a[56:59], v[100:103]
    ds_read_b64_tr_b16 v[196:197], v234 offset:2048
    v_mfma_f32_16x16x32_bf16 v[100:103], v[220:223], a[60:63], v[100:103]
    ds_read_b64_tr_b16 v[198:199], v234 offset:2304
    v_mfma_f32_16x16x32_bf16 v[108:111], v[220:223], a[124:127], v[108:111]
    ds_read_b64_tr_b16 v[200:201], v237 offset:0
    v_mfma_f32_16x16x32_bf16 v[108:111], v[216:219], a[120:123], v[108:111]
    ds_read_b64_tr_b16 v[202:203], v237 offset:256
    v_mfma_f32_16x16x32_bf16 v[108:111], v[212:215], a[116:119], v[108:111]
    ds_read_b64_tr_b16 v[204:205], v237 offset:2048
    v_mfma_f32_16x16x32_bf16 v[108:111], v[208:211], a[112:115], v[108:111]
    ds_read_b64_tr_b16 v[206:207], v237 offset:2304
    v_mfma_f32_16x16x32_bf16 v[116:119], v[208:211], a[176:179], v[116:119]
    v_mfma_f32_16x16x32_bf16 v[116:119], v[212:215], a[180:183], v[116:119]
    v_mfma_f32_16x16x32_bf16 v[116:119], v[216:219], a[184:187], v[116:119]
    v_mfma_f32_16x16x32_bf16 v[116:119], v[220:223], a[188:191], v[116:119]
    v_mfma_f32_16x16x32_bf16 v[124:127], v[220:223], a[252:255], v[124:127]
    v_mfma_f32_16x16x32_bf16 v[124:127], v[216:219], a[248:251], v[124:127]
    v_mfma_f32_16x16x32_bf16 v[124:127], v[212:215], a[244:247], v[124:127]
    v_mfma_f32_16x16x32_bf16 v[124:127], v[208:211], a[240:243], v[124:127]
    s_waitcnt lgkmcnt(4)
    v_mfma_f32_16x16x32_bf16 v[128:131], a[0:3], v[192:195], 0
    ds_read_b64_tr_b16 v[208:209], v234 offset:4096
    v_mfma_f32_16x16x32_bf16 v[128:131], a[4:7], v[196:199], v[128:131]
    ds_read_b64_tr_b16 v[210:211], v234 offset:4352
    v_mfma_f32_16x16x32_bf16 v[132:135], a[64:67], v[192:195], 0
    ds_read_b64_tr_b16 v[212:213], v234 offset:6144
    v_mfma_f32_16x16x32_bf16 v[132:135], a[68:71], v[196:199], v[132:135]
    ds_read_b64_tr_b16 v[214:215], v234 offset:6400
    v_mfma_f32_16x16x32_bf16 v[136:139], a[128:131], v[192:195], 0
    ds_read_b64_tr_b16 v[216:217], v237 offset:4096
    v_mfma_f32_16x16x32_bf16 v[136:139], a[132:135], v[196:199], v[136:139]
    ds_read_b64_tr_b16 v[218:219], v237 offset:4352
    v_mfma_f32_16x16x32_bf16 v[140:143], a[192:195], v[192:195], 0
    ds_read_b64_tr_b16 v[220:221], v237 offset:6144
    v_mul_f32 v64, s58, v64
    v_mfma_f32_16x16x32_bf16 v[140:143], a[196:199], v[196:199], v[140:143]
    s_waitcnt lgkmcnt(7)
    ds_read_b64_tr_b16 v[222:223], v237 offset:6400
    v_mul_f32 v65, s58, v65
    v_mfma_f32_16x16x32_bf16 v[144:147], a[0:3], v[200:203], 0
    v_mul_f32 v66, s58, v66
    v_mul_f32 v67, s58, v67
    v_mfma_f32_16x16x32_bf16 v[144:147], a[4:7], v[204:207], v[144:147]
    v_mul_f32 v68, s58, v68
    v_mul_f32 v69, s58, v69
    v_mfma_f32_16x16x32_bf16 v[148:151], a[64:67], v[200:203], 0
    v_mul_f32 v70, s58, v70
    v_mul_f32 v71, s58, v71
    v_mfma_f32_16x16x32_bf16 v[148:151], a[68:71], v[204:207], v[148:151]
    v_cvt_pk_bf16_f32 v64, v64, v65
    v_cvt_pk_bf16_f32 v65, v66, v67
    v_mfma_f32_16x16x32_bf16 v[152:155], a[128:131], v[200:203], 0
    ds_read_b64_tr_b16 v[192:193], v234 offset:8192
    v_cvt_pk_bf16_f32 v66, v68, v69
    v_mfma_f32_16x16x32_bf16 v[152:155], a[132:135], v[204:207], v[152:155]
    ds_read_b64_tr_b16 v[194:195], v234 offset:8448
    v_cvt_pk_bf16_f32 v67, v70, v71
    v_mfma_f32_16x16x32_bf16 v[156:159], a[192:195], v[200:203], 0
    s_add_u32 s95, s94, 0
    v_mfma_f32_16x16x32_bf16 v[156:159], a[196:199], v[204:207], v[156:159]
    s_waitcnt lgkmcnt(6)
    v_mfma_f32_16x16x32_bf16 v[160:163], a[0:3], v[208:211], 0
    ds_read_b64_tr_b16 v[196:197], v234 offset:10240
    v_mfma_f32_16x16x32_bf16 v[160:163], a[4:7], v[212:215], v[160:163]
    ds_read_b64_tr_b16 v[198:199], v234 offset:10496
    v_mfma_f32_16x16x32_bf16 v[164:167], a[64:67], v[208:211], 0
    buffer_store_dwordx4 v[64:67], v240, s[20:23], s95 offen offset:2048 sc1
    v_mfma_f32_16x16x32_bf16 v[164:167], a[68:71], v[212:215], v[164:167]
    v_mul_f32 v72, s58, v72
    v_mul_f32 v73, s58, v73
    v_mfma_f32_16x16x32_bf16 v[168:171], a[128:131], v[208:211], 0
    ds_read_b64_tr_b16 v[200:201], v237 offset:8192
    v_mul_f32 v74, s58, v74
    v_mfma_f32_16x16x32_bf16 v[168:171], a[132:135], v[212:215], v[168:171]
    ds_read_b64_tr_b16 v[202:203], v237 offset:8448
    v_mul_f32 v75, s58, v75
    v_mfma_f32_16x16x32_bf16 v[172:175], a[192:195], v[208:211], 0
    v_mul_f32 v76, s58, v76
    v_mul_f32 v77, s58, v77
    v_mfma_f32_16x16x32_bf16 v[172:175], a[196:199], v[212:215], v[172:175]
    s_waitcnt lgkmcnt(6)
    v_mul_f32 v78, s58, v78
    v_mul_f32 v79, s58, v79
    v_mfma_f32_16x16x32_bf16 v[176:179], a[0:3], v[216:219], 0
    ds_read_b64_tr_b16 v[204:205], v237 offset:10240
    v_cvt_pk_bf16_f32 v72, v72, v73
    v_mfma_f32_16x16x32_bf16 v[176:179], a[4:7], v[220:223], v[176:179]
    ds_read_b64_tr_b16 v[206:207], v237 offset:10496
    v_cvt_pk_bf16_f32 v73, v74, v75
    v_mfma_f32_16x16x32_bf16 v[180:183], a[64:67], v[216:219], 0
    v_cvt_pk_bf16_f32 v74, v76, v77
    v_cvt_pk_bf16_f32 v75, v78, v79
    v_mfma_f32_16x16x32_bf16 v[180:183], a[68:71], v[220:223], v[180:183]
    s_add_u32 s95, s94, 4096
    v_mfma_f32_16x16x32_bf16 v[184:187], a[128:131], v[216:219], 0
    s_waitcnt vmcnt(5)
    ds_read_b64_tr_b16 v[208:209], v234 offset:12288
    v_cmp_gt_u32 vcc, 16, v244
    v_add_u32 v247, 0x10000, v240
    v_mfma_f32_16x16x32_bf16 v[184:187], a[132:135], v[220:223], v[184:187]
    ds_read_b64_tr_b16 v[210:211], v234 offset:12544
    v_mfma_f32_16x16x32_bf16 v[188:191], a[192:195], v[216:219], 0
    s_cbranch_vccnz L_xnwait
L_xnok:
    v_mfma_f32_16x16x32_bf16 v[188:191], a[196:199], v[220:223], v[188:191]
    s_waitcnt lgkmcnt(6)
    v_mfma_f32_16x16x32_bf16 v[0:3], a[0:3], v[192:195], 0
    ds_read_b64_tr_b16 v[212:213], v234 offset:14336
    v_mfma_f32_16x16x32_bf16 v[0:3], a[4:7], v[196:199], v[0:3]
    ds_read_b64_tr_b16 v[214:215], v234 offset:14592
    v_mfma_f32_16x16x32_bf16 v[4:7], a[64:67], v[192:195], 0
    ds_read_b64_tr_b16 v[216:217], v237 offset:12288
    v_mfma_f32_16x16x32_bf16 v[4:7], a[68:71], v[196:199], v[4:7]
    ds_read_b64_tr_b16 v[218:219], v237 offset:12544
    v_mfma_f32_16x16x32_bf16 v[8:11], a[128:131], v[192:195], 0
    ds_read_b64_tr_b16 v[220:221], v237 offset:14336
    v_mfma_f32_16x16x32_bf16 v[8:11], a[132:135], v[196:199], v[8:11]
    ds_read_b64_tr_b16 v[222:223], v237 offset:14592
    v_mfma_f32_16x16x32_bf16 v[12:15], a[192:195], v[192:195], 0
    v_mfma_f32_16x16x32_bf16 v[12:15], a[196:199], v[196:199], v[12:15]
    s_waitcnt lgkmcnt(8)
    v_mfma_f32_16x16x32_bf16 v[16:19], a[0:3], v[200:203], 0
    v_mfma_f32_16x16x32_bf16 v[16:19], a[4:7], v[204:207], v[16:19]
    v_mfma_f32_16x16x32_bf16 v[20:23], a[64:67], v[200:203], 0
    s_add_u32 m0, s49, 81920
    s_add_u32 s57, s50, 2621440
    v_mfma_f32_16x16x32_bf16 v[20:23], a[68:71], v[204:207], v[20:23]
    v_mfma_f32_16x16x32_bf16 v[24:27], a[128:131], v[200:203], 0
    ds_read_b64_tr_b16 v[192:193], v234 offset:16384
    v_mfma_f32_16x16x32_bf16 v[24:27], a[132:135], v[204:207], v[24:27]
    ds_read_b64_tr_b16 v[194:195], v234 offset:16640
    v_mfma_f32_16x16x32_bf16 v[28:31], a[192:195], v[200:203], 0
    buffer_load_dwordx4 v241, s[16:19], s57 offen offset:0 lds
    v_mfma_f32_16x16x32_bf16 v[28:31], a[196:199], v[204:207], v[28:31]
    s_waitcnt lgkmcnt(6)
    v_mfma_f32_16x16x32_bf16 v[32:35], a[0:3], v[208:211], 0
    ds_read_b64_tr_b16 v[196:197], v234 offset:18432
    v_mfma_f32_16x16x32_bf16 v[32:35], a[4:7], v[212:215], v[32:35]
    ds_read_b64_tr_b16 v[198:199], v234 offset:18688
    v_mfma_f32_16x16x32_bf16 v[36:39], a[64:67], v[208:211], 0
    s_add_u32 s57, s50, 2751488
    v_mfma_f32_16x16x32_bf16 v[36:39], a[68:71], v[212:215], v[36:39]
    v_mfma_f32_16x16x32_bf16 v[40:43], a[128:131], v[208:211], 0
    ds_read_b64_tr_b16 v[200:201], v237 offset:16384
    v_mfma_f32_16x16x32_bf16 v[40:43], a[132:135], v[212:215], v[40:43]
    ds_read_b64_tr_b16 v[202:203], v237 offset:16640
    v_mfma_f32_16x16x32_bf16 v[44:47], a[192:195], v[208:211], 0
    buffer_load_dwordx4 v241, s[16:19], s57 offen offset:1024 lds
    v_mfma_f32_16x16x32_bf16 v[44:47], a[196:199], v[212:215], v[44:47]
    s_waitcnt lgkmcnt(6)
    v_mfma_f32_16x16x32_bf16 v[48:51], a[0:3], v[216:219], 0
    ds_read_b64_tr_b16 v[204:205], v237 offset:18432
    v_mfma_f32_16x16x32_bf16 v[48:51], a[4:7], v[220:223], v[48:51]
    ds_read_b64_tr_b16 v[206:207], v237 offset:18688
    v_mfma_f32_16x16x32_bf16 v[52:55], a[64:67], v[216:219], 0
    s_add_u32 s57, s50, 2881536
    v_mfma_f32_16x16x32_bf16 v[52:55], a[68:71], v[220:223], v[52:55]
    v_mfma_f32_16x16x32_bf16 v[56:59], a[128:131], v[216:219], 0
    ds_read_b64_tr_b16 v[208:209], v234 offset:20480
    v_mfma_f32_16x16x32_bf16 v[56:59], a[132:135], v[220:223], v[56:59]
    ds_read_b64_tr_b16 v[210:211], v234 offset:20736
    v_mfma_f32_16x16x32_bf16 v[60:63], a[192:195], v[216:219], 0
    buffer_load_dwordx4 v241, s[16:19], s57 offen offset:2048 lds
    v_mfma_f32_16x16x32_bf16 v[60:63], a[196:199], v[220:223], v[60:63]
    s_waitcnt lgkmcnt(6)
    v_mfma_f32_16x16x32_bf16 v[128:131], a[8:11], v[192:195], v[128:131]
    ds_read_b64_tr_b16 v[212:213], v234 offset:22528
    v_mfma_f32_16x16x32_bf16 v[128:131], a[12:15], v[196:199], v[128:131]
    ds_read_b64_tr_b16 v[214:215], v234 offset:22784
    v_mfma_f32_16x16x32_bf16 v[132:135], a[72:75], v[192:195], v[132:135]
    s_add_u32 s57, s50, 3011584
    buffer_store_dwordx4 v[72:75], v240, s[20:23], s95 offen offset:2048 sc1
    v_mfma_f32_16x16x32_bf16 v[132:135], a[76:79], v[196:199], v[132:135]
    s_add_u32 s62, s46, 0
    buffer_load_dwordx4 a[0:3], v240, s[20:23], s62 offen offset:0 sc1
    v_mfma_f32_16x16x32_bf16 v[136:139], a[136:139], v[192:195], v[136:139]
    ds_read_b64_tr_b16 v[216:217], v237 offset:20480
    v_mul_f32 v80, s58, v80
    v_mfma_f32_16x16x32_bf16 v[136:139], a[140:143], v[196:199], v[136:139]
    ds_read_b64_tr_b16 v[218:219], v237 offset:20736
    v_mul_f32 v81, s58, v81
    v_mfma_f32_16x16x32_bf16 v[140:143], a[200:203], v[192:195], v[140:143]
    buffer_load_dwordx4 v241, s[16:19], s57 offen offset:3072 lds
    v_mfma_f32_16x16x32_bf16 v[140:143], a[204:207], v[196:199], v[140:143]
    s_waitcnt lgkmcnt(6)
    buffer_load_dwordx4 a[64:67], v247, s[20:23], s62 offen offset:0 sc1
    v_mfma_f32_16x16x32_bf16 v[144:147], a[8:11], v[200:203], v[144:147]
    ds_read_b64_tr_b16 v[220:221], v237 offset:22528
    v_mul_f32 v82, s58, v82
    v_mfma_f32_16x16x32_bf16 v[144:147], a[12:15], v[204:207], v[144:147]
    ds_read_b64_tr_b16 v[222:223], v237 offset:22784
    v_mul_f32 v83, s58, v83
    v_mfma_f32_16x16x32_bf16 v[148:151], a[72:75], v[200:203], v[148:151]
    v_mul_f32 v84, s58, v84
    v_mul_f32 v85, s58, v85
    v_mfma_f32_16x16x32_bf16 v[148:151], a[76:79], v[204:207], v[148:151]
    v_mul_f32 v86, s58, v86
    v_mul_f32 v87, s58, v87
    v_mfma_f32_16x16x32_bf16 v[152:155], a[136:139], v[200:203], v[152:155]
    ds_read_b64_tr_b16 v[192:193], v234 offset:24576
    v_cvt_pk_bf16_f32 v80, v80, v81
    v_mfma_f32_16x16x32_bf16 v[152:155], a[140:143], v[204:207], v[152:155]
    ds_read_b64_tr_b16 v[194:195], v234 offset:24832
    v_cvt_pk_bf16_f32 v81, v82, v83
    v_mfma_f32_16x16x32_bf16 v[156:159], a[200:203], v[200:203], v[156:159]
    s_add_u32 s63, s47, 0
    buffer_load_dwordx4 a[128:131], v240, s[20:23], s63 offen offset:0 sc1
    v_mfma_f32_16x16x32_bf16 v[156:159], a[204:207], v[204:207], v[156:159]
    s_waitcnt lgkmcnt(6)
    v_cvt_pk_bf16_f32 v82, v84, v85
    v_cvt_pk_bf16_f32 v83, v86, v87
    v_mfma_f32_16x16x32_bf16 v[160:163], a[8:11], v[208:211], v[160:163]
    s_add_u32 s95, s94, 8192
    ds_read_b64_tr_b16 v[196:197], v234 offset:26624
    v_mfma_f32_16x16x32_bf16 v[160:163], a[12:15], v[212:215], v[160:163]
    ds_read_b64_tr_b16 v[198:199], v234 offset:26880
    v_mfma_f32_16x16x32_bf16 v[164:167], a[72:75], v[208:211], v[164:167]
    v_mfma_f32_16x16x32_bf16 v[164:167], a[76:79], v[212:215], v[164:167]
    v_mfma_f32_16x16x32_bf16 v[168:171], a[136:139], v[208:211], v[168:171]
    ds_read_b64_tr_b16 v[200:201], v237 offset:24576
    v_mfma_f32_16x16x32_bf16 v[168:171], a[140:143], v[212:215], v[168:171]
    ds_read_b64_tr_b16 v[202:203], v237 offset:24832
    v_mfma_f32_16x16x32_bf16 v[172:175], a[200:203], v[208:211], v[172:175]
    s_add_u32 m0, s49, 98304
    s_add_u32 s57, s50, 3145728
    v_mfma_f32_16x16x32_bf16 v[172:175], a[204:207], v[212:215], v[172:175]
    s_waitcnt lgkmcnt(6)
    buffer_load_dwordx4 a[192:195], v247, s[20:23], s63 offen offset:0 sc1
    v_mfma_f32_16x16x32_bf16 v[176:179], a[8:11], v[216:219], v[176:179]
    ds_read_b64_tr_b16 v[204:205], v237 offset:26624
    v_mfma_f32_16x16x32_bf16 v[176:179], a[12:15], v[220:223], v[176:179]
    ds_read_b64_tr_b16 v[206:207], v237 offset:26880
    v_mfma_f32_16x16x32_bf16 v[180:183], a[72:75], v[216:219], v[180:183]
    buffer_load_dwordx4 v241, s[16:19], s57 offen offset:0 lds
    v_mfma_f32_16x16x32_bf16 v[180:183], a[76:79], v[220:223], v[180:183]
    v_mfma_f32_16x16x32_bf16 v[184:187], a[136:139], v[216:219], v[184:187]
    ds_read_b64_tr_b16 v[208:209], v234 offset:28672
    v_mfma_f32_16x16x32_bf16 v[184:187], a[140:143], v[220:223], v[184:187]
    ds_read_b64_tr_b16 v[210:211], v234 offset:28928
    v_mfma_f32_16x16x32_bf16 v[188:191], a[200:203], v[216:219], v[188:191]
    s_add_u32 s57, s50, 3275776
    buffer_load_dwordx4 a[4:7], v240, s[20:23], s62 offen offset:1024 sc1
    v_mfma_f32_16x16x32_bf16 v[188:191], a[204:207], v[220:223], v[188:191]
    s_waitcnt lgkmcnt(6)
    v_mfma_f32_16x16x32_bf16 v[0:3], a[8:11], v[192:195], v[0:3]
    ds_read_b64_tr_b16 v[212:213], v234 offset:30720
    v_mfma_f32_16x16x32_bf16 v[0:3], a[12:15], v[196:199], v[0:3]
    ds_read_b64_tr_b16 v[214:215], v234 offset:30976
    v_mfma_f32_16x16x32_bf16 v[4:7], a[72:75], v[192:195], v[4:7]
    ds_read_b64_tr_b16 v[216:217], v237 offset:28672
    v_mfma_f32_16x16x32_bf16 v[4:7], a[76:79], v[196:199], v[4:7]
    ds_read_b64_tr_b16 v[218:219], v237 offset:28928
    v_mfma_f32_16x16x32_bf16 v[8:11], a[136:139], v[192:195], v[8:11]
    ds_read_b64_tr_b16 v[220:221], v237 offset:30720
    v_mfma_f32_16x16x32_bf16 v[8:11], a[140:143], v[196:199], v[8:11]
    ds_read_b64_tr_b16 v[222:223], v237 offset:30976
    v_mfma_f32_16x16x32_bf16 v[12:15], a[200:203], v[192:195], v[12:15]
    buffer_load_dwordx4 v241, s[16:19], s57 offen offset:1024 lds
    v_mfma_f32_16x16x32_bf16 v[12:15], a[204:207], v[196:199], v[12:15]
    s_waitcnt lgkmcnt(8)
    s_add_u32 s57, s50, 3405824
    v_mfma_f32_16x16x32_bf16 v[16:19], a[8:11], v[200:203], v[16:19]
    buffer_load_dwordx4 a[68:71], v247, s[20:23], s62 offen offset:1024 sc1
    v_mfma_f32_16x16x32_bf16 v[16:19], a[12:15], v[204:207], v[16:19]
    buffer_load_dwordx4 v241, s[16:19], s57 offen offset:2048 lds
    v_mfma_f32_16x16x32_bf16 v[20:23], a[72:75], v[200:203], v[20:23]
    s_waitcnt lgkmcnt(0)
    buffer_load_dwordx4 a[132:135], v240, s[20:23], s63 offen offset:1024 sc1
    v_mfma_f32_16x16x32_bf16 v[20:23], a[76:79], v[204:207], v[20:23]
    v_mfma_f32_16x16x32_bf16 v[24:27], a[136:139], v[200:203], v[24:27]
    s_barrier
    ds_read_b64_tr_b16 v[192:193], v234 offset:32768
    v_mfma_f32_16x16x32_bf16 v[24:27], a[140:143], v[204:207], v[24:27]
    ds_read_b64_tr_b16 v[194:195], v234 offset:33024
    v_mfma_f32_16x16x32_bf16 v[28:31], a[200:203], v[200:203], v[28:31]
    s_add_u32 s57, s50, 3535872
    v_mfma_f32_16x16x32_bf16 v[28:31], a[204:207], v[204:207], v[28:31]
    v_mfma_f32_16x16x32_bf16 v[32:35], a[8:11], v[208:211], v[32:35]
    ds_read_b64_tr_b16 v[196:197], v234 offset:34816
    v_mfma_f32_16x16x32_bf16 v[32:35], a[12:15], v[212:215], v[32:35]
    ds_read_b64_tr_b16 v[198:199], v234 offset:35072
    v_mfma_f32_16x16x32_bf16 v[36:39], a[72:75], v[208:211], v[36:39]
    buffer_load_dwordx4 v241, s[16:19], s57 offen offset:3072 lds
    v_mfma_f32_16x16x32_bf16 v[36:39], a[76:79], v[212:215], v[36:39]
    buffer_load_dwordx4 a[196:199], v247, s[20:23], s63 offen offset:1024 sc1
    v_mfma_f32_16x16x32_bf16 v[40:43], a[136:139], v[208:211], v[40:43]
    ds_read_b64_tr_b16 v[200:201], v237 offset:32768
    v_mfma_f32_16x16x32_bf16 v[40:43], a[140:143], v[212:215], v[40:43]
    ds_read_b64_tr_b16 v[202:203], v237 offset:33024
    v_mfma_f32_16x16x32_bf16 v[44:47], a[200:203], v[208:211], v[44:47]
    buffer_store_dwordx4 v[80:83], v240, s[20:23], s95 offen offset:2048 sc1
    v_mfma_f32_16x16x32_bf16 v[44:47], a[204:207], v[212:215], v[44:47]
    v_mul_f32 v88, s58, v88
    v_mul_f32 v89, s58, v89
    v_mfma_f32_16x16x32_bf16 v[48:51], a[8:11], v[216:219], v[48:51]
    ds_read_b64_tr_b16 v[204:205], v237 offset:34816
    v_mul_f32 v90, s58, v90
    v_mfma_f32_16x16x32_bf16 v[48:51], a[12:15], v[220:223], v[48:51]
    ds_read_b64_tr_b16 v[206:207], v237 offset:35072
    v_mul_f32 v91, s58, v91
    v_mfma_f32_16x16x32_bf16 v[52:55], a[72:75], v[216:219], v[52:55]
    v_mul_f32 v92, s58, v92
    v_mul_f32 v93, s58, v93
    v_mfma_f32_16x16x32_bf16 v[52:55], a[76:79], v[220:223], v[52:55]
    v_mul_f32 v94, s58, v94
    v_mul_f32 v95, s58, v95
    v_mfma_f32_16x16x32_bf16 v[56:59], a[136:139], v[216:219], v[56:59]
    ds_read_b64_tr_b16 v[208:209], v234 offset:36864
    v_cvt_pk_bf16_f32 v88, v88, v89
    v_mfma_f32_16x16x32_bf16 v[56:59], a[140:143], v[220:223], v[56:59]
    ds_read_b64_tr_b16 v[210:211], v234 offset:37120
    v_cvt_pk_bf16_f32 v89, v90, v91
    v_mfma_f32_16x16x32_bf16 v[60:63], a[200:203], v[216:219], v[60:63]
    v_cvt_pk_bf16_f32 v90, v92, v93
    v_cvt_pk_bf16_f32 v91, v94, v95
    v_mfma_f32_16x16x32_bf16 v[60:63], a[204:207], v[220:223], v[60:63]
    s_waitcnt lgkmcnt(6)
    s_add_u32 s95, s94, 12288
    v_mfma_f32_16x16x32_bf16 v[128:131], a[16:19], v[192:195], v[128:131]
    ds_read_b64_tr_b16 v[212:213], v234 offset:38912
    v_mfma_f32_16x16x32_bf16 v[128:131], a[20:23], v[196:199], v[128:131]
    ds_read_b64_tr_b16 v[214:215], v234 offset:39168
    v_mfma_f32_16x16x32_bf16 v[132:135], a[80:83], v[192:195], v[132:135]
    s_add_u32 m0, s49, 114688
    s_add_u32 s57, s50, 3670016
    v_mfma_f32_16x16x32_bf16 v[132:135], a[84:87], v[196:199], v[132:135]
    buffer_load_dwordx4 a[8:11], v240, s[20:23], s62 offen offset:2048 sc1
    v_mfma_f32_16x16x32_bf16 v[136:139], a[144:147], v[192:195], v[136:139]
    ds_read_b64_tr_b16 v[216:217], v237 offset:36864
    v_mfma_f32_16x16x32_bf16 v[136:139], a[148:151], v[196:199], v[136:139]
    ds_read_b64_tr_b16 v[218:219], v237 offset:37120
    v_mfma_f32_16x16x32_bf16 v[140:143], a[208:211], v[192:195], v[140:143]
    buffer_load_dwordx4 v241, s[16:19], s57 offen offset:0 lds
    v_mfma_f32_16x16x32_bf16 v[140:143], a[212:215], v[196:199], v[140:143]
    s_waitcnt lgkmcnt(6)
    buffer_load_dwordx4 a[72:75], v247, s[20:23], s62 offen offset:2048 sc1
    v_mfma_f32_16x16x32_bf16 v[144:147], a[16:19], v[200:203], v[144:147]
    ds_read_b64_tr_b16 v[220:221], v237 offset:38912
    v_mfma_f32_16x16x32_bf16 v[144:147], a[20:23], v[204:207], v[144:147]
    ds_read_b64_tr_b16 v[222:223], v237 offset:39168
    v_mfma_f32_16x16x32_bf16 v[148:151], a[80:83], v[200:203], v[148:151]
    s_add_u32 s57, s50, 3800064
    v_mfma_f32_16x16x32_bf16 v[148:151], a[84:87], v[204:207], v[148:151]
    v_mfma_f32_16x16x32_bf16 v[152:155], a[144:147], v[200:203], v[152:155]
    ds_read_b64_tr_b16 v[192:193], v234 offset:40960
    v_mfma_f32_16x16x32_bf16 v[152:155], a[148:151], v[204:207], v[152:155]
    ds_read_b64_tr_b16 v[194:195], v234 offset:41216
    v_mfma_f32_16x16x32_bf16 v[156:159], a[208:211], v[200:203], v[156:159]
    buffer_load_dwordx4 v241, s[16:19], s57 offen offset:1024 lds
    v_mfma_f32_16x16x32_bf16 v[156:159], a[212:215], v[204:207], v[156:159]
    s_waitcnt lgkmcnt(6)
    buffer_load_dwordx4 a[136:139], v240, s[20:23], s63 offen offset:2048 sc1
    v_mfma_f32_16x16x32_bf16 v[160:163], a[16:19], v[208:211], v[160:163]
    ds_read_b64_tr_b16 v[196:197], v234 offset:43008
    v_mfma_f32_16x16x32_bf16 v[160:163], a[20:23], v[212:215], v[160:163]
    ds_read_b64_tr_b16 v[198:199], v234 offset:43264
    v_mfma_f32_16x16x32_bf16 v[164:167], a[80:83], v[208:211], v[164:167]
    s_add_u32 s57, s50, 3930112
    v_mfma_f32_16x16x32_bf16 v[164:167], a[84:87], v[212:215], v[164:167]
    v_mfma_f32_16x16x32_bf16 v[168:171], a[144:147], v[208:211], v[168:171]
    ds_read_b64_tr_b16 v[200:201], v237 offset:40960
    v_mfma_f32_16x16x32_bf16 v[168:171], a[148:151], v[212:215], v[168:171]
    ds_read_b64_tr_b16 v[202:203], v237 offset:41216
    v_mfma_f32_16x16x32_bf16 v[172:175], a[208:211], v[208:211], v[172:175]
    buffer_load_dwordx4 v241, s[16:19], s57 offen offset:2048 lds
    v_mfma_f32_16x16x32_bf16 v[172:175], a[212:215], v[212:215], v[172:175]
    s_waitcnt lgkmcnt(6)
    buffer_load_dwordx4 a[200:203], v247, s[20:23], s63 offen offset:2048 sc1
    v_mfma_f32_16x16x32_bf16 v[176:179], a[16:19], v[216:219], v[176:179]
    ds_read_b64_tr_b16 v[204:205], v237 offset:43008
    v_mfma_f32_16x16x32_bf16 v[176:179], a[20:23], v[220:223], v[176:179]
    ds_read_b64_tr_b16 v[206:207], v237 offset:43264
    v_mfma_f32_16x16x32_bf16 v[180:183], a[80:83], v[216:219], v[180:183]
    s_add_u32 s57, s50, 4060160
    v_mfma_f32_16x16x32_bf16 v[180:183], a[84:87], v[220:223], v[180:183]
    v_mfma_f32_16x16x32_bf16 v[184:187], a[144:147], v[216:219], v[184:187]
    ds_read_b64_tr_b16 v[208:209], v234 offset:45056
    v_mfma_f32_16x16x32_bf16 v[184:187], a[148:151], v[220:223], v[184:187]
    ds_read_b64_tr_b16 v[210:211], v234 offset:45312
    v_mfma_f32_16x16x32_bf16 v[188:191], a[208:211], v[216:219], v[188:191]
    buffer_load_dwordx4 v241, s[16:19], s57 offen offset:3072 lds
    v_mfma_f32_16x16x32_bf16 v[188:191], a[212:215], v[220:223], v[188:191]
    s_waitcnt lgkmcnt(6)
    buffer_load_dwordx4 a[12:15], v240, s[20:23], s62 offen offset:3072 sc1
    v_mfma_f32_16x16x32_bf16 v[0:3], a[16:19], v[192:195], v[0:3]
    ds_read_b64_tr_b16 v[212:213], v234 offset:47104
    v_mfma_f32_16x16x32_bf16 v[0:3], a[20:23], v[196:199], v[0:3]
    ds_read_b64_tr_b16 v[214:215], v234 offset:47360
    v_mfma_f32_16x16x32_bf16 v[4:7], a[80:83], v[192:195], v[4:7]
    ds_read_b64_tr_b16 v[216:217], v237 offset:45056
    v_mfma_f32_16x16x32_bf16 v[4:7], a[84:87], v[196:199], v[4:7]
    ds_read_b64_tr_b16 v[218:219], v237 offset:45312
    v_mfma_f32_16x16x32_bf16 v[8:11], a[144:147], v[192:195], v[8:11]
    ds_read_b64_tr_b16 v[220:221], v237 offset:47104
    v_mfma_f32_16x16x32_bf16 v[8:11], a[148:151], v[196:199], v[8:11]
    ds_read_b64_tr_b16 v[222:223], v237 offset:47360
    v_mfma_f32_16x16x32_bf16 v[12:15], a[208:211], v[192:195], v[12:15]
    buffer_load_dwordx4 a[76:79], v247, s[20:23], s62 offen offset:3072 sc1
    v_mfma_f32_16x16x32_bf16 v[12:15], a[212:215], v[196:199], v[12:15]
    s_waitcnt lgkmcnt(8)
    buffer_store_dwordx4 v[88:91], v240, s[20:23], s95 offen offset:2048 sc1
    v_mfma_f32_16x16x32_bf16 v[16:19], a[16:19], v[200:203], v[16:19]
    v_mul_f32 v96, s58, v96
    v_mul_f32 v97, s58, v97
    v_mfma_f32_16x16x32_bf16 v[16:19], a[20:23], v[204:207], v[16:19]
    v_mul_f32 v98, s58, v98
    v_mul_f32 v99, s58, v99
    v_mfma_f32_16x16x32_bf16 v[20:23], a[80:83], v[200:203], v[20:23]
    buffer_load_dwordx4 a[140:143], v240, s[20:23], s63 offen offset:3072 sc1
    v_mfma_f32_16x16x32_bf16 v[20:23], a[84:87], v[204:207], v[20:23]
    v_mul_f32 v100, s58, v100
    v_mul_f32 v101, s58, v101
    v_mfma_f32_16x16x32_bf16 v[24:27], a[144:147], v[200:203], v[24:27]
    ds_read_b64_tr_b16 v[192:193], v234 offset:49152
    v_mul_f32 v102, s58, v102
    v_mfma_f32_16x16x32_bf16 v[24:27], a[148:151], v[204:207], v[24:27]
    ds_read_b64_tr_b16 v[194:195], v234 offset:49408
    v_mul_f32 v103, s58, v103
    v_mfma_f32_16x16x32_bf16 v[28:31], a[208:211], v[200:203], v[28:31]
    s_add_u32 m0, s53, 131072
    s_add_u32 s57, s35, 0
    v_cvt_pk_bf16_f32 v96, v96, v97
    v_mfma_f32_16x16x32_bf16 v[28:31], a[212:215], v[204:207], v[28:31]
    s_waitcnt lgkmcnt(6)
    v_cvt_pk_bf16_f32 v97, v98, v99
    v_cvt_pk_bf16_f32 v98, v100, v101
    v_mfma_f32_16x16x32_bf16 v[32:35], a[16:19], v[208:211], v[32:35]
    ds_read_b64_tr_b16 v[196:197], v234 offset:51200
    v_cvt_pk_bf16_f32 v99, v102, v103
    v_mfma_f32_16x16x32_bf16 v[32:35], a[20:23], v[212:215], v[32:35]
    s_add_u32 s95, s94, 0
    ds_read_b64_tr_b16 v[198:199], v234 offset:51456
    v_mfma_f32_16x16x32_bf16 v[36:39], a[80:83], v[208:211], v[36:39]
    buffer_load_dwordx4 v242, s[12:15], s57 offen offset:0 lds
    v_mfma_f32_16x16x32_bf16 v[36:39], a[84:87], v[212:215], v[36:39]
    buffer_load_dwordx4 a[204:207], v247, s[20:23], s63 offen offset:3072 sc1
    v_mfma_f32_16x16x32_bf16 v[40:43], a[144:147], v[208:211], v[40:43]
    ds_read_b64_tr_b16 v[200:201], v237 offset:49152
    v_mfma_f32_16x16x32_bf16 v[40:43], a[148:151], v[212:215], v[40:43]
    ds_read_b64_tr_b16 v[202:203], v237 offset:49408
    v_mfma_f32_16x16x32_bf16 v[44:47], a[208:211], v[208:211], v[44:47]
    s_add_u32 s57, s35, 56320
    v_mfma_f32_16x16x32_bf16 v[44:47], a[212:215], v[212:215], v[44:47]
    s_waitcnt lgkmcnt(6)
    v_mfma_f32_16x16x32_bf16 v[48:51], a[16:19], v[216:219], v[48:51]
    ds_read_b64_tr_b16 v[204:205], v237 offset:51200
    v_mfma_f32_16x16x32_bf16 v[48:51], a[20:23], v[220:223], v[48:51]
    ds_read_b64_tr_b16 v[206:207], v237 offset:51456
    v_mfma_f32_16x16x32_bf16 v[52:55], a[80:83], v[216:219], v[52:55]
    buffer_load_dwordx4 v242, s[12:15], s57 offen offset:1024 lds
    v_mfma_f32_16x16x32_bf16 v[52:55], a[84:87], v[220:223], v[52:55]
    v_mfma_f32_16x16x32_bf16 v[56:59], a[144:147], v[216:219], v[56:59]
    ds_read_b64_tr_b16 v[208:209], v234 offset:53248
    v_mfma_f32_16x16x32_bf16 v[56:59], a[148:151], v[220:223], v[56:59]
    ds_read_b64_tr_b16 v[210:211], v234 offset:53504
    v_mfma_f32_16x16x32_bf16 v[60:63], a[208:211], v[216:219], v[60:63]
    s_add_u32 s57, s35, 112640
    v_mfma_f32_16x16x32_bf16 v[60:63], a[212:215], v[220:223], v[60:63]
    s_waitcnt lgkmcnt(6)
    v_mfma_f32_16x16x32_bf16 v[128:131], a[24:27], v[192:195], v[128:131]
    ds_read_b64_tr_b16 v[212:213], v234 offset:55296
    v_mfma_f32_16x16x32_bf16 v[128:131], a[28:31], v[196:199], v[128:131]
    ds_read_b64_tr_b16 v[214:215], v234 offset:55552
    v_mfma_f32_16x16x32_bf16 v[132:135], a[88:91], v[192:195], v[132:135]
    buffer_load_dwordx4 v242, s[12:15], s57 offen offset:2048 lds
    v_mfma_f32_16x16x32_bf16 v[132:135], a[92:95], v[196:199], v[132:135]
    s_add_u32 s62, s46, 4096
    buffer_load_dwordx4 a[16:19], v240, s[20:23], s62 offen offset:0 sc1
    v_mfma_f32_16x16x32_bf16 v[136:139], a[152:155], v[192:195], v[136:139]
    ds_read_b64_tr_b16 v[216:217], v237 offset:53248
    v_mfma_f32_16x16x32_bf16 v[136:139], a[156:159], v[196:199], v[136:139]
    ds_read_b64_tr_b16 v[218:219], v237 offset:53504
    v_mfma_f32_16x16x32_bf16 v[140:143], a[216:219], v[192:195], v[140:143]
    s_add_u32 s57, s35, 168960
    v_mfma_f32_16x16x32_bf16 v[140:143], a[220:223], v[196:199], v[140:143]
    s_waitcnt lgkmcnt(6)
    buffer_load_dwordx4 a[80:83], v247, s[20:23], s62 offen offset:0 sc1
    v_mfma_f32_16x16x32_bf16 v[144:147], a[24:27], v[200:203], v[144:147]
    ds_read_b64_tr_b16 v[220:221], v237 offset:55296
    v_mfma_f32_16x16x32_bf16 v[144:147], a[28:31], v[204:207], v[144:147]
    ds_read_b64_tr_b16 v[222:223], v237 offset:55552
    v_mfma_f32_16x16x32_bf16 v[148:151], a[88:91], v[200:203], v[148:151]
    buffer_load_dwordx4 v242, s[12:15], s57 offen offset:3072 lds
    v_mfma_f32_16x16x32_bf16 v[148:151], a[92:95], v[204:207], v[148:151]
    v_mfma_f32_16x16x32_bf16 v[152:155], a[152:155], v[200:203], v[152:155]
    ds_read_b64_tr_b16 v[192:193], v234 offset:57344
    v_mfma_f32_16x16x32_bf16 v[152:155], a[156:159], v[204:207], v[152:155]
    ds_read_b64_tr_b16 v[194:195], v234 offset:57600
    v_mfma_f32_16x16x32_bf16 v[156:159], a[216:219], v[200:203], v[156:159]
    s_add_u32 s63, s47, 4096
    buffer_load_dwordx4 a[144:147], v240, s[20:23], s63 offen offset:0 sc1
    v_mfma_f32_16x16x32_bf16 v[156:159], a[220:223], v[204:207], v[156:159]
    s_waitcnt lgkmcnt(6)
    v_mfma_f32_16x16x32_bf16 v[160:163], a[24:27], v[208:211], v[160:163]
    ds_read_b64_tr_b16 v[196:197], v234 offset:59392
    v_mfma_f32_16x16x32_bf16 v[160:163], a[28:31], v[212:215], v[160:163]
    ds_read_b64_tr_b16 v[198:199], v234 offset:59648
    v_mfma_f32_16x16x32_bf16 v[164:167], a[88:91], v[208:211], v[164:167]
    v_mfma_f32_16x16x32_bf16 v[164:167], a[92:95], v[212:215], v[164:167]
    v_mfma_f32_16x16x32_bf16 v[168:171], a[152:155], v[208:211], v[168:171]
    ds_read_b64_tr_b16 v[200:201], v237 offset:57344
    v_mfma_f32_16x16x32_bf16 v[168:171], a[156:159], v[212:215], v[168:171]
    ds_read_b64_tr_b16 v[202:203], v237 offset:57600
    v_mfma_f32_16x16x32_bf16 v[172:175], a[216:219], v[208:211], v[172:175]
    buffer_load_dwordx4 a[208:211], v247, s[20:23], s63 offen offset:0 sc1
    v_mfma_f32_16x16x32_bf16 v[172:175], a[220:223], v[212:215], v[172:175]
    s_waitcnt lgkmcnt(6)
    v_mfma_f32_16x16x32_bf16 v[176:179], a[24:27], v[216:219], v[176:179]
    ds_read_b64_tr_b16 v[204:205], v237 offset:59392
    v_mfma_f32_16x16x32_bf16 v[176:179], a[28:31], v[220:223], v[176:179]
    ds_read_b64_tr_b16 v[206:207], v237 offset:59648
    v_mfma_f32_16x16x32_bf16 v[180:183], a[88:91], v[216:219], v[180:183]
    s_add_u32 m0, s53, 147456
    s_add_u32 s57, s35, 458752
    v_mfma_f32_16x16x32_bf16 v[180:183], a[92:95], v[220:223], v[180:183]
    buffer_store_dwordx4 v[96:99], v240, s[20:23], s95 offen offset:3072 sc1
    v_mfma_f32_16x16x32_bf16 v[184:187], a[152:155], v[216:219], v[184:187]
    ds_read_b64_tr_b16 v[208:209], v234 offset:61440
    v_mul_f32 v104, s58, v104
    v_mfma_f32_16x16x32_bf16 v[184:187], a[156:159], v[220:223], v[184:187]
    ds_read_b64_tr_b16 v[210:211], v234 offset:61696
    v_mul_f32 v105, s58, v105
    v_mfma_f32_16x16x32_bf16 v[188:191], a[216:219], v[216:219], v[188:191]
    buffer_load_dwordx4 v242, s[12:15], s57 offen offset:0 lds
    v_mfma_f32_16x16x32_bf16 v[188:191], a[220:223], v[220:223], v[188:191]
    s_waitcnt lgkmcnt(6)
    buffer_load_dwordx4 a[20:23], v240, s[20:23], s62 offen offset:1024 sc1
    v_mfma_f32_16x16x32_bf16 v[0:3], a[24:27], v[192:195], v[0:3]
    ds_read_b64_tr_b16 v[212:213], v234 offset:63488
    v_mul_f32 v106, s58, v106
    v_mfma_f32_16x16x32_bf16 v[0:3], a[28:31], v[196:199], v[0:3]
    ds_read_b64_tr_b16 v[214:215], v234 offset:63744
    v_mul_f32 v107, s58, v107
    v_mfma_f32_16x16x32_bf16 v[4:7], a[88:91], v[192:195], v[4:7]
    s_add_u32 s57, s35, 515072
    ds_read_b64_tr_b16 v[216:217], v237 offset:61440
    v_mul_f32 v108, s58, v108
    v_mfma_f32_16x16x32_bf16 v[4:7], a[92:95], v[196:199], v[4:7]
    ds_read_b64_tr_b16 v[218:219], v237 offset:61696
    v_mul_f32 v109, s58, v109
    v_mfma_f32_16x16x32_bf16 v[8:11], a[152:155], v[192:195], v[8:11]
    ds_read_b64_tr_b16 v[220:221], v237 offset:63488
    v_mul_f32 v110, s58, v110
    v_mfma_f32_16x16x32_bf16 v[8:11], a[156:159], v[196:199], v[8:11]
    ds_read_b64_tr_b16 v[222:223], v237 offset:63744
    v_mul_f32 v111, s58, v111
    v_mfma_f32_16x16x32_bf16 v[12:15], a[216:219], v[192:195], v[12:15]
    buffer_load_dwordx4 v242, s[12:15], s57 offen offset:1024 lds
    v_mfma_f32_16x16x32_bf16 v[12:15], a[220:223], v[196:199], v[12:15]
    s_waitcnt lgkmcnt(8)
    buffer_load_dwordx4 a[84:87], v247, s[20:23], s62 offen offset:1024 sc1
    v_mfma_f32_16x16x32_bf16 v[16:19], a[24:27], v[200:203], v[16:19]
    v_cvt_pk_bf16_f32 v104, v104, v105
    v_cvt_pk_bf16_f32 v105, v106, v107
    v_mfma_f32_16x16x32_bf16 v[16:19], a[28:31], v[204:207], v[16:19]
    v_cvt_pk_bf16_f32 v106, v108, v109
    v_cvt_pk_bf16_f32 v107, v110, v111
    v_mfma_f32_16x16x32_bf16 v[20:23], a[88:91], v[200:203], v[20:23]
    s_waitcnt lgkmcnt(0)
    s_add_u32 s57, s35, 571392
    s_add_u32 s95, s94, 4096
    v_mfma_f32_16x16x32_bf16 v[20:23], a[92:95], v[204:207], v[20:23]
    buffer_load_dwordx4 a[148:151], v240, s[20:23], s63 offen offset:1024 sc1
    v_mfma_f32_16x16x32_bf16 v[24:27], a[152:155], v[200:203], v[24:27]
    s_waitcnt vmcnt(39)
    s_barrier
    ds_read_b64_tr_b16 v[192:193], v235 offset:0
    v_mfma_f32_16x16x32_bf16 v[24:27], a[156:159], v[204:207], v[24:27]
    ds_read_b64_tr_b16 v[194:195], v235 offset:256
    v_mfma_f32_16x16x32_bf16 v[28:31], a[216:219], v[200:203], v[28:31]
    buffer_load_dwordx4 v242, s[12:15], s57 offen offset:2048 lds
    v_mfma_f32_16x16x32_bf16 v[28:31], a[220:223], v[204:207], v[28:31]
    v_mfma_f32_16x16x32_bf16 v[32:35], a[24:27], v[208:211], v[32:35]
    ds_read_b64_tr_b16 v[196:197], v235 offset:2048
    v_mfma_f32_16x16x32_bf16 v[32:35], a[28:31], v[212:215], v[32:35]
    ds_read_b64_tr_b16 v[198:199], v235 offset:2304
    v_mfma_f32_16x16x32_bf16 v[36:39], a[88:91], v[208:211], v[36:39]
    s_add_u32 s57, s35, 627712
    buffer_load_dwordx4 a[212:215], v247, s[20:23], s63 offen offset:1024 sc1
    v_mfma_f32_16x16x32_bf16 v[36:39], a[92:95], v[212:215], v[36:39]
    v_mfma_f32_16x16x32_bf16 v[40:43], a[152:155], v[208:211], v[40:43]
    ds_read_b64_tr_b16 v[200:201], v238 offset:0
    v_mfma_f32_16x16x32_bf16 v[40:43], a[156:159], v[212:215], v[40:43]
    ds_read_b64_tr_b16 v[202:203], v238 offset:256
    v_mfma_f32_16x16x32_bf16 v[44:47], a[216:219], v[208:211], v[44:47]
    buffer_load_dwordx4 v242, s[12:15], s57 offen offset:3072 lds
    v_mfma_f32_16x16x32_bf16 v[44:47], a[220:223], v[212:215], v[44:47]
    v_mfma_f32_16x16x32_bf16 v[48:51], a[24:27], v[216:219], v[48:51]
    ds_read_b64_tr_b16 v[204:205], v238 offset:2048
    v_mfma_f32_16x16x32_bf16 v[48:51], a[28:31], v[220:223], v[48:51]
    ds_read_b64_tr_b16 v[206:207], v238 offset:2304
    v_mfma_f32_16x16x32_bf16 v[52:55], a[88:91], v[216:219], v[52:55]
    v_mfma_f32_16x16x32_bf16 v[52:55], a[92:95], v[220:223], v[52:55]
    v_mfma_f32_16x16x32_bf16 v[56:59], a[152:155], v[216:219], v[56:59]
    ds_read_b64_tr_b16 v[208:209], v235 offset:4096
    v_mfma_f32_16x16x32_bf16 v[56:59], a[156:159], v[220:223], v[56:59]
    ds_read_b64_tr_b16 v[210:211], v235 offset:4352
    v_mfma_f32_16x16x32_bf16 v[60:63], a[216:219], v[216:219], v[60:63]
    v_mfma_f32_16x16x32_bf16 v[60:63], a[220:223], v[220:223], v[60:63]
    s_waitcnt lgkmcnt(6)
    v_mfma_f32_16x16x32_bf16 v[128:131], a[32:35], v[192:195], v[128:131]
    ds_read_b64_tr_b16 v[212:213], v235 offset:6144
    v_and_b32 v253, 0xfffffbff, v253
    v_mfma_f32_16x16x32_bf16 v[128:131], a[36:39], v[196:199], v[128:131]
    ds_read_b64_tr_b16 v[214:215], v235 offset:6400
    v_bfe_u32 v246, v254, 3, 1
    v_mfma_f32_16x16x32_bf16 v[132:135], a[96:99], v[192:195], v[132:135]
    v_lshl_or_b32 v253, v246, 30, v253
    v_mfma_f32_16x16x32_bf16 v[132:135], a[100:103], v[196:199], v[132:135]
    buffer_load_dwordx4 a[24:27], v240, s[20:23], s62 offen offset:2048 sc1
    v_mfma_f32_16x16x32_bf16 v[136:139], a[160:163], v[192:195], v[136:139]
    ds_read_b64_tr_b16 v[216:217], v238 offset:4096
    v_mfma_f32_16x16x32_bf16 v[136:139], a[164:167], v[196:199], v[136:139]
    ds_read_b64_tr_b16 v[218:219], v238 offset:4352
    v_mfma_f32_16x16x32_bf16 v[140:143], a[224:227], v[192:195], v[140:143]
    v_mfma_f32_16x16x32_bf16 v[140:143], a[228:231], v[196:199], v[140:143]
    s_waitcnt lgkmcnt(6)
    buffer_load_dwordx4 a[88:91], v247, s[20:23], s62 offen offset:2048 sc1
    v_mfma_f32_16x16x32_bf16 v[144:147], a[32:35], v[200:203], v[144:147]
    ds_read_b64_tr_b16 v[220:221], v238 offset:6144
    v_mfma_f32_16x16x32_bf16 v[144:147], a[36:39], v[204:207], v[144:147]
    ds_read_b64_tr_b16 v[222:223], v238 offset:6400
    v_mfma_f32_16x16x32_bf16 v[148:151], a[96:99], v[200:203], v[148:151]
    buffer_store_dwordx4 v[104:107], v240, s[20:23], s95 offen offset:3072 sc1
    v_mfma_f32_16x16x32_bf16 v[148:151], a[100:103], v[204:207], v[148:151]
    v_mul_f32 v112, s58, v112
    v_mul_f32 v113, s58, v113
    v_mfma_f32_16x16x32_bf16 v[152:155], a[160:163], v[200:203], v[152:155]
    ds_read_b64_tr_b16 v[192:193], v235 offset:8192
    v_mul_f32 v114, s58, v114
    v_mfma_f32_16x16x32_bf16 v[152:155], a[164:167], v[204:207], v[152:155]
    ds_read_b64_tr_b16 v[194:195], v235 offset:8448
    v_mul_f32 v115, s58, v115
    v_mfma_f32_16x16x32_bf16 v[156:159], a[224:227], v[200:203], v[156:159]
    buffer_load_dwordx4 a[152:155], v240, s[20:23], s63 offen offset:2048 sc1
    v_mfma_f32_16x16x32_bf16 v[156:159], a[228:231], v[204:207], v[156:159]
    s_waitcnt lgkmcnt(6)
    v_mul_f32 v116, s58, v116
    v_mul_f32 v117, s58, v117
    v_mfma_f32_16x16x32_bf16 v[160:163], a[32:35], v[208:211], v[160:163]
    ds_read_b64_tr_b16 v[196:197], v235 offset:10240
    v_mul_f32 v118, s58, v118
    v_mfma_f32_16x16x32_bf16 v[160:163], a[36:39], v[212:215], v[160:163]
    ds_read_b64_tr_b16 v[198:199], v235 offset:10496
    v_mul_f32 v119, s58, v119
    v_mfma_f32_16x16x32_bf16 v[164:167], a[96:99], v[208:211], v[164:167]
    v_cvt_pk_bf16_f32 v112, v112, v113
    v_cvt_pk_bf16_f32 v113, v114, v115
    v_mfma_f32_16x16x32_bf16 v[164:167], a[100:103], v[212:215], v[164:167]
    v_cvt_pk_bf16_f32 v114, v116, v117
    v_cvt_pk_bf16_f32 v115, v118, v119
    v_mfma_f32_16x16x32_bf16 v[168:171], a[160:163], v[208:211], v[168:171]
    s_add_u32 s95, s94, 8192
    ds_read_b64_tr_b16 v[200:201], v238 offset:8192
    v_mfma_f32_16x16x32_bf16 v[168:171], a[164:167], v[212:215], v[168:171]
    ds_read_b64_tr_b16 v[202:203], v238 offset:8448
    v_mfma_f32_16x16x32_bf16 v[172:175], a[224:227], v[208:211], v[172:175]
    buffer_load_dwordx4 a[216:219], v247, s[20:23], s63 offen offset:2048 sc1
    v_mfma_f32_16x16x32_bf16 v[172:175], a[228:231], v[212:215], v[172:175]
    s_waitcnt lgkmcnt(6)
    v_mfma_f32_16x16x32_bf16 v[176:179], a[32:35], v[216:219], v[176:179]
    ds_read_b64_tr_b16 v[204:205], v238 offset:10240
    v_mfma_f32_16x16x32_bf16 v[176:179], a[36:39], v[220:223], v[176:179]
    ds_read_b64_tr_b16 v[206:207], v238 offset:10496
    v_mfma_f32_16x16x32_bf16 v[180:183], a[96:99], v[216:219], v[180:183]
    v_mfma_f32_16x16x32_bf16 v[180:183], a[100:103], v[220:223], v[180:183]
    v_mfma_f32_16x16x32_bf16 v[184:187], a[160:163], v[216:219], v[184:187]
    ds_read_b64_tr_b16 v[208:209], v235 offset:12288
    v_mfma_f32_16x16x32_bf16 v[184:187], a[164:167], v[220:223], v[184:187]
    ds_read_b64_tr_b16 v[210:211], v235 offset:12544
    v_mfma_f32_16x16x32_bf16 v[188:191], a[224:227], v[216:219], v[188:191]
    buffer_load_dwordx4 a[28:31], v240, s[20:23], s62 offen offset:3072 sc1
    v_mfma_f32_16x16x32_bf16 v[188:191], a[228:231], v[220:223], v[188:191]
    s_waitcnt lgkmcnt(6)
    v_mfma_f32_16x16x32_bf16 v[0:3], a[32:35], v[192:195], v[0:3]
    ds_read_b64_tr_b16 v[212:213], v235 offset:14336
    v_mfma_f32_16x16x32_bf16 v[0:3], a[36:39], v[196:199], v[0:3]
    ds_read_b64_tr_b16 v[214:215], v235 offset:14592
    v_mfma_f32_16x16x32_bf16 v[4:7], a[96:99], v[192:195], v[4:7]
    ds_read_b64_tr_b16 v[216:217], v238 offset:12288
    v_mfma_f32_16x16x32_bf16 v[4:7], a[100:103], v[196:199], v[4:7]
    ds_read_b64_tr_b16 v[218:219], v238 offset:12544
    v_mfma_f32_16x16x32_bf16 v[8:11], a[160:163], v[192:195], v[8:11]
    ds_read_b64_tr_b16 v[220:221], v238 offset:14336
    v_mfma_f32_16x16x32_bf16 v[8:11], a[164:167], v[196:199], v[8:11]
    ds_read_b64_tr_b16 v[222:223], v238 offset:14592
    v_mfma_f32_16x16x32_bf16 v[12:15], a[224:227], v[192:195], v[12:15]
    buffer_load_dwordx4 a[92:95], v247, s[20:23], s62 offen offset:3072 sc1
    v_mfma_f32_16x16x32_bf16 v[12:15], a[228:231], v[196:199], v[12:15]
    s_waitcnt lgkmcnt(8)
    v_mfma_f32_16x16x32_bf16 v[16:19], a[32:35], v[200:203], v[16:19]
    v_mfma_f32_16x16x32_bf16 v[16:19], a[36:39], v[204:207], v[16:19]
    v_mfma_f32_16x16x32_bf16 v[20:23], a[96:99], v[200:203], v[20:23]
    buffer_load_dwordx4 a[156:159], v240, s[20:23], s63 offen offset:3072 sc1
    v_mfma_f32_16x16x32_bf16 v[20:23], a[100:103], v[204:207], v[20:23]
    v_mfma_f32_16x16x32_bf16 v[24:27], a[160:163], v[200:203], v[24:27]
    ds_read_b64_tr_b16 v[192:193], v235 offset:16384
    v_mfma_f32_16x16x32_bf16 v[24:27], a[164:167], v[204:207], v[24:27]
    ds_read_b64_tr_b16 v[194:195], v235 offset:16640
    v_mfma_f32_16x16x32_bf16 v[28:31], a[224:227], v[200:203], v[28:31]
    v_mfma_f32_16x16x32_bf16 v[28:31], a[228:231], v[204:207], v[28:31]
    s_waitcnt lgkmcnt(6)
    v_mfma_f32_16x16x32_bf16 v[32:35], a[32:35], v[208:211], v[32:35]
    ds_read_b64_tr_b16 v[196:197], v235 offset:18432
    v_mfma_f32_16x16x32_bf16 v[32:35], a[36:39], v[212:215], v[32:35]
    ds_read_b64_tr_b16 v[198:199], v235 offset:18688
    v_mfma_f32_16x16x32_bf16 v[36:39], a[96:99], v[208:211], v[36:39]
    buffer_load_dwordx4 a[220:223], v247, s[20:23], s63 offen offset:3072 sc1
    v_mfma_f32_16x16x32_bf16 v[36:39], a[100:103], v[212:215], v[36:39]
    v_mfma_f32_16x16x32_bf16 v[40:43], a[160:163], v[208:211], v[40:43]
    ds_read_b64_tr_b16 v[200:201], v238 offset:16384
    v_mfma_f32_16x16x32_bf16 v[40:43], a[164:167], v[212:215], v[40:43]
    ds_read_b64_tr_b16 v[202:203], v238 offset:16640
    v_mfma_f32_16x16x32_bf16 v[44:47], a[224:227], v[208:211], v[44:47]
    v_mfma_f32_16x16x32_bf16 v[44:47], a[228:231], v[212:215], v[44:47]
    s_waitcnt lgkmcnt(6)
    v_mfma_f32_16x16x32_bf16 v[48:51], a[32:35], v[216:219], v[48:51]
    ds_read_b64_tr_b16 v[204:205], v238 offset:18432
    v_mfma_f32_16x16x32_bf16 v[48:51], a[36:39], v[220:223], v[48:51]
    ds_read_b64_tr_b16 v[206:207], v238 offset:18688
    v_mfma_f32_16x16x32_bf16 v[52:55], a[96:99], v[216:219], v[52:55]
    v_mfma_f32_16x16x32_bf16 v[52:55], a[100:103], v[220:223], v[52:55]
    v_mfma_f32_16x16x32_bf16 v[56:59], a[160:163], v[216:219], v[56:59]
    ds_read_b64_tr_b16 v[208:209], v235 offset:20480
    v_mfma_f32_16x16x32_bf16 v[56:59], a[164:167], v[220:223], v[56:59]
    ds_read_b64_tr_b16 v[210:211], v235 offset:20736
    v_mfma_f32_16x16x32_bf16 v[60:63], a[224:227], v[216:219], v[60:63]
    buffer_store_dwordx4 v[112:115], v240, s[20:23], s95 offen offset:3072 sc1
    v_mfma_f32_16x16x32_bf16 v[60:63], a[228:231], v[220:223], v[60:63]
    s_waitcnt lgkmcnt(6)
    v_mul_f32 v120, s58, v120
    v_mul_f32 v121, s58, v121
    v_mfma_f32_16x16x32_bf16 v[128:131], a[40:43], v[192:195], v[128:131]
    ds_read_b64_tr_b16 v[212:213], v235 offset:22528
    v_mul_f32 v122, s58, v122
    v_mfma_f32_16x16x32_bf16 v[128:131], a[44:47], v[196:199], v[128:131]
    ds_read_b64_tr_b16 v[214:215], v235 offset:22784
    v_mul_f32 v123, s58, v123
    v_mfma_f32_16x16x32_bf16 v[132:135], a[104:107], v[192:195], v[132:135]
    s_add_u32 s62, s46, 8192
    buffer_load_dwordx4 a[32:35], v240, s[20:23], s62 offen offset:0 sc1
    v_mfma_f32_16x16x32_bf16 v[132:135], a[108:111], v[196:199], v[132:135]
    v_mul_f32 v124, s58, v124
    v_mul_f32 v125, s58, v125
    v_mfma_f32_16x16x32_bf16 v[136:139], a[168:171], v[192:195], v[136:139]
    ds_read_b64_tr_b16 v[216:217], v238 offset:20480
    v_mul_f32 v126, s58, v126
    v_mfma_f32_16x16x32_bf16 v[136:139], a[172:175], v[196:199], v[136:139]
    ds_read_b64_tr_b16 v[218:219], v238 offset:20736
    v_mul_f32 v127, s58, v127
    v_mfma_f32_16x16x32_bf16 v[140:143], a[232:235], v[192:195], v[140:143]
    v_cvt_pk_bf16_f32 v120, v120, v121
    v_cvt_pk_bf16_f32 v121, v122, v123
    v_mfma_f32_16x16x32_bf16 v[140:143], a[236:239], v[196:199], v[140:143]
    s_waitcnt lgkmcnt(6)
    buffer_load_dwordx4 a[96:99], v247, s[20:23], s62 offen offset:0 sc1
    v_mfma_f32_16x16x32_bf16 v[144:147], a[40:43], v[200:203], v[144:147]
    ds_read_b64_tr_b16 v[220:221], v238 offset:22528
    v_cvt_pk_bf16_f32 v122, v124, v125
    v_mfma_f32_16x16x32_bf16 v[144:147], a[44:47], v[204:207], v[144:147]
    ds_read_b64_tr_b16 v[222:223], v238 offset:22784
    v_cvt_pk_bf16_f32 v123, v126, v127
    v_mfma_f32_16x16x32_bf16 v[148:151], a[104:107], v[200:203], v[148:151]
    s_add_u32 s95, s94, 12288
    v_mfma_f32_16x16x32_bf16 v[148:151], a[108:111], v[204:207], v[148:151]
    v_mfma_f32_16x16x32_bf16 v[152:155], a[168:171], v[200:203], v[152:155]
    ds_read_b64_tr_b16 v[192:193], v235 offset:24576
    v_mfma_f32_16x16x32_bf16 v[152:155], a[172:175], v[204:207], v[152:155]
    ds_read_b64_tr_b16 v[194:195], v235 offset:24832
    v_mfma_f32_16x16x32_bf16 v[156:159], a[232:235], v[200:203], v[156:159]
    s_add_u32 s63, s47, 8192
    buffer_load_dwordx4 a[160:163], v240, s[20:23], s63 offen offset:0 sc1
    v_mfma_f32_16x16x32_bf16 v[156:159], a[236:239], v[204:207], v[156:159]
    s_waitcnt lgkmcnt(6)
    v_mfma_f32_16x16x32_bf16 v[160:163], a[40:43], v[208:211], v[160:163]
    ds_read_b64_tr_b16 v[196:197], v235 offset:26624
    v_mfma_f32_16x16x32_bf16 v[160:163], a[44:47], v[212:215], v[160:163]
    ds_read_b64_tr_b16 v[198:199], v235 offset:26880
    v_mfma_f32_16x16x32_bf16 v[164:167], a[104:107], v[208:211], v[164:167]
    v_mfma_f32_16x16x32_bf16 v[164:167], a[108:111], v[212:215], v[164:167]
    v_mfma_f32_16x16x32_bf16 v[168:171], a[168:171], v[208:211], v[168:171]
    ds_read_b64_tr_b16 v[200:201], v238 offset:24576
    v_mfma_f32_16x16x32_bf16 v[168:171], a[172:175], v[212:215], v[168:171]
    ds_read_b64_tr_b16 v[202:203], v238 offset:24832
    v_mfma_f32_16x16x32_bf16 v[172:175], a[232:235], v[208:211], v[172:175]
    buffer_load_dwordx4 a[224:227], v247, s[20:23], s63 offen offset:0 sc1
    v_mfma_f32_16x16x32_bf16 v[172:175], a[236:239], v[212:215], v[172:175]
    s_waitcnt lgkmcnt(6)
    v_mfma_f32_16x16x32_bf16 v[176:179], a[40:43], v[216:219], v[176:179]
    ds_read_b64_tr_b16 v[204:205], v238 offset:26624
    v_mfma_f32_16x16x32_bf16 v[176:179], a[44:47], v[220:223], v[176:179]
    ds_read_b64_tr_b16 v[206:207], v238 offset:26880
    v_mfma_f32_16x16x32_bf16 v[180:183], a[104:107], v[216:219], v[180:183]
    v_mfma_f32_16x16x32_bf16 v[180:183], a[108:111], v[220:223], v[180:183]
    v_mfma_f32_16x16x32_bf16 v[184:187], a[168:171], v[216:219], v[184:187]
    ds_read_b64_tr_b16 v[208:209], v235 offset:28672
    v_mfma_f32_16x16x32_bf16 v[184:187], a[172:175], v[220:223], v[184:187]
    ds_read_b64_tr_b16 v[210:211], v235 offset:28928
    v_mfma_f32_16x16x32_bf16 v[188:191], a[232:235], v[216:219], v[188:191]
    buffer_load_dwordx4 a[36:39], v240, s[20:23], s62 offen offset:1024 sc1
    v_mfma_f32_16x16x32_bf16 v[188:191], a[236:239], v[220:223], v[188:191]
    s_waitcnt lgkmcnt(6)
    v_mfma_f32_16x16x32_bf16 v[0:3], a[40:43], v[192:195], v[0:3]
    ds_read_b64_tr_b16 v[212:213], v235 offset:30720
    v_mfma_f32_16x16x32_bf16 v[0:3], a[44:47], v[196:199], v[0:3]
    ds_read_b64_tr_b16 v[214:215], v235 offset:30976
    v_mfma_f32_16x16x32_bf16 v[4:7], a[104:107], v[192:195], v[4:7]
    ds_read_b64_tr_b16 v[216:217], v238 offset:28672
    v_mfma_f32_16x16x32_bf16 v[4:7], a[108:111], v[196:199], v[4:7]
    ds_read_b64_tr_b16 v[218:219], v238 offset:28928
    v_mfma_f32_16x16x32_bf16 v[8:11], a[168:171], v[192:195], v[8:11]
    ds_read_b64_tr_b16 v[220:221], v238 offset:30720
    v_mfma_f32_16x16x32_bf16 v[8:11], a[172:175], v[196:199], v[8:11]
    ds_read_b64_tr_b16 v[222:223], v238 offset:30976
    v_mfma_f32_16x16x32_bf16 v[12:15], a[232:235], v[192:195], v[12:15]
    buffer_load_dwordx4 a[100:103], v247, s[20:23], s62 offen offset:1024 sc1
    v_mfma_f32_16x16x32_bf16 v[12:15], a[236:239], v[196:199], v[12:15]
    s_waitcnt lgkmcnt(8)
    v_mfma_f32_16x16x32_bf16 v[16:19], a[40:43], v[200:203], v[16:19]
    v_mfma_f32_16x16x32_bf16 v[16:19], a[44:47], v[204:207], v[16:19]
    v_mfma_f32_16x16x32_bf16 v[20:23], a[104:107], v[200:203], v[20:23]
    s_waitcnt lgkmcnt(0)
    s_add_u32 m0, s53, 0
    s_add_u32 s57, s35, 917504
    v_mfma_f32_16x16x32_bf16 v[20:23], a[108:111], v[204:207], v[20:23]
    buffer_load_dwordx4 a[164:167], v240, s[20:23], s63 offen offset:1024 sc1
    v_mfma_f32_16x16x32_bf16 v[24:27], a[168:171], v[200:203], v[24:27]
    s_waitcnt vmcnt(39)
    s_barrier
    ds_read_b64_tr_b16 v[192:193], v235 offset:32768
    v_mfma_f32_16x16x32_bf16 v[24:27], a[172:175], v[204:207], v[24:27]
    ds_read_b64_tr_b16 v[194:195], v235 offset:33024
    v_mfma_f32_16x16x32_bf16 v[28:31], a[232:235], v[200:203], v[28:31]
    buffer_load_dwordx4 v242, s[12:15], s57 offen offset:0 lds
    v_mfma_f32_16x16x32_bf16 v[28:31], a[236:239], v[204:207], v[28:31]
    buffer_store_dwordx4 v[120:123], v240, s[20:23], s95 offen offset:3072 sc1
    v_mfma_f32_16x16x32_bf16 v[32:35], a[40:43], v[208:211], v[32:35]
    ds_read_b64_tr_b16 v[196:197], v235 offset:34816
    v_mfma_f32_16x16x32_bf16 v[32:35], a[44:47], v[212:215], v[32:35]
    ds_read_b64_tr_b16 v[198:199], v235 offset:35072
    v_mfma_f32_16x16x32_bf16 v[36:39], a[104:107], v[208:211], v[36:39]
    s_add_u32 s57, s35, 973824
    buffer_load_dwordx4 a[228:231], v247, s[20:23], s63 offen offset:1024 sc1
    v_mfma_f32_16x16x32_bf16 v[36:39], a[108:111], v[212:215], v[36:39]
    v_mfma_f32_16x16x32_bf16 v[40:43], a[168:171], v[208:211], v[40:43]
    ds_read_b64_tr_b16 v[200:201], v238 offset:32768
    v_mfma_f32_16x16x32_bf16 v[40:43], a[172:175], v[212:215], v[40:43]
    ds_read_b64_tr_b16 v[202:203], v238 offset:33024
    v_mfma_f32_16x16x32_bf16 v[44:47], a[232:235], v[208:211], v[44:47]
    buffer_load_dwordx4 v242, s[12:15], s57 offen offset:1024 lds
    v_mfma_f32_16x16x32_bf16 v[44:47], a[236:239], v[212:215], v[44:47]
    v_mfma_f32_16x16x32_bf16 v[48:51], a[40:43], v[216:219], v[48:51]
    ds_read_b64_tr_b16 v[204:205], v238 offset:34816
    v_mfma_f32_16x16x32_bf16 v[48:51], a[44:47], v[220:223], v[48:51]
    ds_read_b64_tr_b16 v[206:207], v238 offset:35072
    v_mfma_f32_16x16x32_bf16 v[52:55], a[104:107], v[216:219], v[52:55]
    s_add_u32 s57, s35, 1030144
    v_mfma_f32_16x16x32_bf16 v[52:55], a[108:111], v[220:223], v[52:55]
    v_mfma_f32_16x16x32_bf16 v[56:59], a[168:171], v[216:219], v[56:59]
    ds_read_b64_tr_b16 v[208:209], v235 offset:36864
    v_mfma_f32_16x16x32_bf16 v[56:59], a[172:175], v[220:223], v[56:59]
    ds_read_b64_tr_b16 v[210:211], v235 offset:37120
    v_mfma_f32_16x16x32_bf16 v[60:63], a[232:235], v[216:219], v[60:63]
    buffer_load_dwordx4 v242, s[12:15], s57 offen offset:2048 lds
    v_mfma_f32_16x16x32_bf16 v[60:63], a[236:239], v[220:223], v[60:63]
    s_waitcnt lgkmcnt(6)
    v_mfma_f32_16x16x32_bf16 v[128:131], a[48:51], v[192:195], v[128:131]
    ds_read_b64_tr_b16 v[212:213], v235 offset:38912
    v_mfma_f32_16x16x32_bf16 v[128:131], a[52:55], v[196:199], v[128:131]
    ds_read_b64_tr_b16 v[214:215], v235 offset:39168
    v_mfma_f32_16x16x32_bf16 v[132:135], a[112:115], v[192:195], v[132:135]
    s_add_u32 s57, s35, 1086464
    buffer_load_dwordx4 a[40:43], v240, s[20:23], s62 offen offset:2048 sc1
    v_mfma_f32_16x16x32_bf16 v[132:135], a[116:119], v[196:199], v[132:135]
    v_mfma_f32_16x16x32_bf16 v[136:139], a[176:179], v[192:195], v[136:139]
    ds_read_b64_tr_b16 v[216:217], v238 offset:36864
    v_mfma_f32_16x16x32_bf16 v[136:139], a[180:183], v[196:199], v[136:139]
    ds_read_b64_tr_b16 v[218:219], v238 offset:37120
    v_mfma_f32_16x16x32_bf16 v[140:143], a[240:243], v[192:195], v[140:143]
    buffer_load_dwordx4 v242, s[12:15], s57 offen offset:3072 lds
    v_mfma_f32_16x16x32_bf16 v[140:143], a[244:247], v[196:199], v[140:143]
    s_waitcnt lgkmcnt(6)
    buffer_load_dwordx4 a[104:107], v247, s[20:23], s62 offen offset:2048 sc1
    v_mfma_f32_16x16x32_bf16 v[144:147], a[48:51], v[200:203], v[144:147]
    ds_read_b64_tr_b16 v[220:221], v238 offset:38912
    v_mfma_f32_16x16x32_bf16 v[144:147], a[52:55], v[204:207], v[144:147]
    ds_read_b64_tr_b16 v[222:223], v238 offset:39168
    v_mfma_f32_16x16x32_bf16 v[148:151], a[112:115], v[200:203], v[148:151]
    v_mfma_f32_16x16x32_bf16 v[148:151], a[116:119], v[204:207], v[148:151]
    v_mfma_f32_16x16x32_bf16 v[152:155], a[176:179], v[200:203], v[152:155]
    ds_read_b64_tr_b16 v[192:193], v235 offset:40960
    v_mfma_f32_16x16x32_bf16 v[152:155], a[180:183], v[204:207], v[152:155]
    ds_read_b64_tr_b16 v[194:195], v235 offset:41216
    v_mfma_f32_16x16x32_bf16 v[156:159], a[240:243], v[200:203], v[156:159]
    buffer_load_dwordx4 a[168:171], v240, s[20:23], s63 offen offset:2048 sc1
    v_mfma_f32_16x16x32_bf16 v[156:159], a[244:247], v[204:207], v[156:159]
    s_waitcnt lgkmcnt(6)
    v_mfma_f32_16x16x32_bf16 v[160:163], a[48:51], v[208:211], v[160:163]
    ds_read_b64_tr_b16 v[196:197], v235 offset:43008
    v_mfma_f32_16x16x32_bf16 v[160:163], a[52:55], v[212:215], v[160:163]
    ds_read_b64_tr_b16 v[198:199], v235 offset:43264
    v_mfma_f32_16x16x32_bf16 v[164:167], a[112:115], v[208:211], v[164:167]
    v_mfma_f32_16x16x32_bf16 v[164:167], a[116:119], v[212:215], v[164:167]
    v_mfma_f32_16x16x32_bf16 v[168:171], a[176:179], v[208:211], v[168:171]
    ds_read_b64_tr_b16 v[200:201], v238 offset:40960
    v_mfma_f32_16x16x32_bf16 v[168:171], a[180:183], v[212:215], v[168:171]
    ds_read_b64_tr_b16 v[202:203], v238 offset:41216
    v_mfma_f32_16x16x32_bf16 v[172:175], a[240:243], v[208:211], v[172:175]
    buffer_load_dwordx4 a[232:235], v247, s[20:23], s63 offen offset:2048 sc1
    v_mfma_f32_16x16x32_bf16 v[172:175], a[244:247], v[212:215], v[172:175]
    s_waitcnt lgkmcnt(6)
    v_mfma_f32_16x16x32_bf16 v[176:179], a[48:51], v[216:219], v[176:179]
    ds_read_b64_tr_b16 v[204:205], v238 offset:43008
    v_mfma_f32_16x16x32_bf16 v[176:179], a[52:55], v[220:223], v[176:179]
    ds_read_b64_tr_b16 v[206:207], v238 offset:43264
    v_mfma_f32_16x16x32_bf16 v[180:183], a[112:115], v[216:219], v[180:183]
    v_mfma_f32_16x16x32_bf16 v[180:183], a[116:119], v[220:223], v[180:183]
    v_mfma_f32_16x16x32_bf16 v[184:187], a[176:179], v[216:219], v[184:187]
    ds_read_b64_tr_b16 v[208:209], v235 offset:45056
    v_mfma_f32_16x16x32_bf16 v[184:187], a[180:183], v[220:223], v[184:187]
    ds_read_b64_tr_b16 v[210:211], v235 offset:45312
    v_mfma_f32_16x16x32_bf16 v[188:191], a[240:243], v[216:219], v[188:191]
    buffer_load_dwordx4 a[44:47], v240, s[20:23], s62 offen offset:3072 sc1
    v_mfma_f32_16x16x32_bf16 v[188:191], a[244:247], v[220:223], v[188:191]
    s_waitcnt lgkmcnt(6)
    v_mfma_f32_16x16x32_bf16 v[0:3], a[48:51], v[192:195], v[0:3]
    ds_read_b64_tr_b16 v[212:213], v235 offset:47104
    v_mfma_f32_16x16x32_bf16 v[0:3], a[52:55], v[196:199], v[0:3]
    ds_read_b64_tr_b16 v[214:215], v235 offset:47360
    v_mfma_f32_16x16x32_bf16 v[4:7], a[112:115], v[192:195], v[4:7]
    ds_read_b64_tr_b16 v[216:217], v238 offset:45056
    v_mfma_f32_16x16x32_bf16 v[4:7], a[116:119], v[196:199], v[4:7]
    ds_read_b64_tr_b16 v[218:219], v238 offset:45312
    v_mfma_f32_16x16x32_bf16 v[8:11], a[176:179], v[192:195], v[8:11]
    ds_read_b64_tr_b16 v[220:221], v238 offset:47104
    v_mfma_f32_16x16x32_bf16 v[8:11], a[180:183], v[196:199], v[8:11]
    ds_read_b64_tr_b16 v[222:223], v238 offset:47360
    v_mfma_f32_16x16x32_bf16 v[12:15], a[240:243], v[192:195], v[12:15]
    buffer_load_dwordx4 a[108:111], v247, s[20:23], s62 offen offset:3072 sc1
    v_mfma_f32_16x16x32_bf16 v[12:15], a[244:247], v[196:199], v[12:15]
    s_waitcnt lgkmcnt(8)
    v_mfma_f32_16x16x32_bf16 v[16:19], a[48:51], v[200:203], v[16:19]
    v_mfma_f32_16x16x32_bf16 v[16:19], a[52:55], v[204:207], v[16:19]
    v_mfma_f32_16x16x32_bf16 v[20:23], a[112:115], v[200:203], v[20:23]
    s_add_u32 m0, s53, 16384
    s_add_u32 s57, s35, 1376256
    v_mfma_f32_16x16x32_bf16 v[20:23], a[116:119], v[204:207], v[20:23]
    buffer_load_dwordx4 a[172:175], v240, s[20:23], s63 offen offset:3072 sc1
    v_mfma_f32_16x16x32_bf16 v[24:27], a[176:179], v[200:203], v[24:27]
    ds_read_b64_tr_b16 v[192:193], v235 offset:49152
    v_mfma_f32_16x16x32_bf16 v[24:27], a[180:183], v[204:207], v[24:27]
    ds_read_b64_tr_b16 v[194:195], v235 offset:49408
    v_mfma_f32_16x16x32_bf16 v[28:31], a[240:243], v[200:203], v[28:31]
    buffer_load_dwordx4 v242, s[12:15], s57 offen offset:0 lds
    v_mfma_f32_16x16x32_bf16 v[28:31], a[244:247], v[204:207], v[28:31]
    s_waitcnt lgkmcnt(6)
    v_mfma_f32_16x16x32_bf16 v[32:35], a[48:51], v[208:211], v[32:35]
    ds_read_b64_tr_b16 v[196:197], v235 offset:51200
    v_mfma_f32_16x16x32_bf16 v[32:35], a[52:55], v[212:215], v[32:35]
    ds_read_b64_tr_b16 v[198:199], v235 offset:51456
    v_mfma_f32_16x16x32_bf16 v[36:39], a[112:115], v[208:211], v[36:39]
    s_add_u32 s57, s35, 1432576
    buffer_load_dwordx4 a[236:239], v247, s[20:23], s63 offen offset:3072 sc1
    v_mfma_f32_16x16x32_bf16 v[36:39], a[116:119], v[212:215], v[36:39]
    v_mfma_f32_16x16x32_bf16 v[40:43], a[176:179], v[208:211], v[40:43]
    ds_read_b64_tr_b16 v[200:201], v238 offset:49152
    v_mfma_f32_16x16x32_bf16 v[40:43], a[180:183], v[212:215], v[40:43]
    ds_read_b64_tr_b16 v[202:203], v238 offset:49408
    v_mfma_f32_16x16x32_bf16 v[44:47], a[240:243], v[208:211], v[44:47]
    buffer_load_dwordx4 v242, s[12:15], s57 offen offset:1024 lds
    v_mfma_f32_16x16x32_bf16 v[44:47], a[244:247], v[212:215], v[44:47]
    s_waitcnt lgkmcnt(6)
    v_mfma_f32_16x16x32_bf16 v[48:51], a[48:51], v[216:219], v[48:51]
    ds_read_b64_tr_b16 v[204:205], v238 offset:51200
    v_mfma_f32_16x16x32_bf16 v[48:51], a[52:55], v[220:223], v[48:51]
    ds_read_b64_tr_b16 v[206:207], v238 offset:51456
    v_mfma_f32_16x16x32_bf16 v[52:55], a[112:115], v[216:219], v[52:55]
    s_add_u32 s57, s35, 1488896
    v_mfma_f32_16x16x32_bf16 v[52:55], a[116:119], v[220:223], v[52:55]
    v_mfma_f32_16x16x32_bf16 v[56:59], a[176:179], v[216:219], v[56:59]
    ds_read_b64_tr_b16 v[208:209], v235 offset:53248
    v_mfma_f32_16x16x32_bf16 v[56:59], a[180:183], v[220:223], v[56:59]
    ds_read_b64_tr_b16 v[210:211], v235 offset:53504
    v_mfma_f32_16x16x32_bf16 v[60:63], a[240:243], v[216:219], v[60:63]
    buffer_load_dwordx4 v242, s[12:15], s57 offen offset:2048 lds
    v_mfma_f32_16x16x32_bf16 v[60:63], a[244:247], v[220:223], v[60:63]
    s_waitcnt lgkmcnt(6)
    v_mfma_f32_16x16x32_bf16 v[128:131], a[56:59], v[192:195], v[128:131]
    ds_read_b64_tr_b16 v[212:213], v235 offset:55296
    v_mfma_f32_16x16x32_bf16 v[128:131], a[60:63], v[196:199], v[128:131]
    ds_read_b64_tr_b16 v[214:215], v235 offset:55552
    v_mfma_f32_16x16x32_bf16 v[132:135], a[120:123], v[192:195], v[132:135]
    s_add_u32 s57, s35, 1545216
    v_mfma_f32_16x16x32_bf16 v[132:135], a[124:127], v[196:199], v[132:135]
    s_add_u32 s62, s46, 12288
    buffer_load_dwordx4 a[48:51], v240, s[20:23], s62 offen offset:0 sc1
    v_mfma_f32_16x16x32_bf16 v[136:139], a[184:187], v[192:195], v[136:139]
    ds_read_b64_tr_b16 v[216:217], v238 offset:53248
    v_mfma_f32_16x16x32_bf16 v[136:139], a[188:191], v[196:199], v[136:139]
    ds_read_b64_tr_b16 v[218:219], v238 offset:53504
    v_mfma_f32_16x16x32_bf16 v[140:143], a[248:251], v[192:195], v[140:143]
    buffer_load_dwordx4 v242, s[12:15], s57 offen offset:3072 lds
    v_mfma_f32_16x16x32_bf16 v[140:143], a[252:255], v[196:199], v[140:143]
    s_waitcnt lgkmcnt(6)
    buffer_load_dwordx4 a[112:115], v247, s[20:23], s62 offen offset:0 sc1
    v_mfma_f32_16x16x32_bf16 v[144:147], a[56:59], v[200:203], v[144:147]
    ds_read_b64_tr_b16 v[220:221], v238 offset:55296
    v_mfma_f32_16x16x32_bf16 v[144:147], a[60:63], v[204:207], v[144:147]
    ds_read_b64_tr_b16 v[222:223], v238 offset:55552
    v_mfma_f32_16x16x32_bf16 v[148:151], a[120:123], v[200:203], v[148:151]
    v_mfma_f32_16x16x32_bf16 v[148:151], a[124:127], v[204:207], v[148:151]
    v_mfma_f32_16x16x32_bf16 v[152:155], a[184:187], v[200:203], v[152:155]
    ds_read_b64_tr_b16 v[192:193], v235 offset:57344
    v_mfma_f32_16x16x32_bf16 v[152:155], a[188:191], v[204:207], v[152:155]
    ds_read_b64_tr_b16 v[194:195], v235 offset:57600
    v_mfma_f32_16x16x32_bf16 v[156:159], a[248:251], v[200:203], v[156:159]
    s_add_u32 s63, s47, 12288
    buffer_load_dwordx4 a[176:179], v240, s[20:23], s63 offen offset:0 sc1
    v_mfma_f32_16x16x32_bf16 v[156:159], a[252:255], v[204:207], v[156:159]
    s_waitcnt lgkmcnt(6)
    v_mfma_f32_16x16x32_bf16 v[160:163], a[56:59], v[208:211], v[160:163]
    ds_read_b64_tr_b16 v[196:197], v235 offset:59392
    v_mfma_f32_16x16x32_bf16 v[160:163], a[60:63], v[212:215], v[160:163]
    ds_read_b64_tr_b16 v[198:199], v235 offset:59648
    v_mfma_f32_16x16x32_bf16 v[164:167], a[120:123], v[208:211], v[164:167]
    v_mfma_f32_16x16x32_bf16 v[164:167], a[124:127], v[212:215], v[164:167]
    v_mfma_f32_16x16x32_bf16 v[168:171], a[184:187], v[208:211], v[168:171]
    ds_read_b64_tr_b16 v[200:201], v238 offset:57344
    v_mfma_f32_16x16x32_bf16 v[168:171], a[188:191], v[212:215], v[168:171]
    ds_read_b64_tr_b16 v[202:203], v238 offset:57600
    v_mfma_f32_16x16x32_bf16 v[172:175], a[248:251], v[208:211], v[172:175]
    buffer_load_dwordx4 a[240:243], v247, s[20:23], s63 offen offset:0 sc1
    v_mfma_f32_16x16x32_bf16 v[172:175], a[252:255], v[212:215], v[172:175]
    s_waitcnt lgkmcnt(6)
    v_mfma_f32_16x16x32_bf16 v[176:179], a[56:59], v[216:219], v[176:179]
    ds_read_b64_tr_b16 v[204:205], v238 offset:59392
    v_mfma_f32_16x16x32_bf16 v[176:179], a[60:63], v[220:223], v[176:179]
    ds_read_b64_tr_b16 v[206:207], v238 offset:59648
    v_mfma_f32_16x16x32_bf16 v[180:183], a[120:123], v[216:219], v[180:183]
    v_mfma_f32_16x16x32_bf16 v[180:183], a[124:127], v[220:223], v[180:183]
    v_mfma_f32_16x16x32_bf16 v[184:187], a[184:187], v[216:219], v[184:187]
    ds_read_b64_tr_b16 v[208:209], v235 offset:61440
    v_mfma_f32_16x16x32_bf16 v[184:187], a[188:191], v[220:223], v[184:187]
    ds_read_b64_tr_b16 v[210:211], v235 offset:61696
    v_mfma_f32_16x16x32_bf16 v[188:191], a[248:251], v[216:219], v[188:191]
    buffer_load_dwordx4 a[52:55], v240, s[20:23], s62 offen offset:1024 sc1
    v_mfma_f32_16x16x32_bf16 v[188:191], a[252:255], v[220:223], v[188:191]
    s_waitcnt lgkmcnt(6)
    v_mfma_f32_16x16x32_bf16 v[0:3], a[56:59], v[192:195], v[0:3]
    ds_read_b64_tr_b16 v[212:213], v235 offset:63488
    v_mfma_f32_16x16x32_bf16 v[0:3], a[60:63], v[196:199], v[0:3]
    ds_read_b64_tr_b16 v[214:215], v235 offset:63744
    v_mfma_f32_16x16x32_bf16 v[4:7], a[120:123], v[192:195], v[4:7]
    ds_read_b64_tr_b16 v[216:217], v238 offset:61440
    v_mfma_f32_16x16x32_bf16 v[4:7], a[124:127], v[196:199], v[4:7]
    ds_read_b64_tr_b16 v[218:219], v238 offset:61696
    v_mfma_f32_16x16x32_bf16 v[8:11], a[184:187], v[192:195], v[8:11]
    ds_read_b64_tr_b16 v[220:221], v238 offset:63488
    v_mfma_f32_16x16x32_bf16 v[8:11], a[188:191], v[196:199], v[8:11]
    ds_read_b64_tr_b16 v[222:223], v238 offset:63744
    v_mfma_f32_16x16x32_bf16 v[12:15], a[248:251], v[192:195], v[12:15]
    buffer_load_dwordx4 a[116:119], v247, s[20:23], s62 offen offset:1024 sc1
    v_mfma_f32_16x16x32_bf16 v[12:15], a[252:255], v[196:199], v[12:15]
    s_waitcnt lgkmcnt(8)
    v_mfma_f32_16x16x32_bf16 v[16:19], a[56:59], v[200:203], v[16:19]
    v_mfma_f32_16x16x32_bf16 v[16:19], a[60:63], v[204:207], v[16:19]
    v_mfma_f32_16x16x32_bf16 v[20:23], a[120:123], v[200:203], v[20:23]
    s_waitcnt lgkmcnt(0)
    s_add_u32 m0, s53, 32768
    s_add_u32 s57, s64, 0
    v_mfma_f32_16x16x32_bf16 v[20:23], a[124:127], v[204:207], v[20:23]
    buffer_load_dwordx4 a[180:183], v240, s[20:23], s63 offen offset:1024 sc1
    v_mfma_f32_16x16x32_bf16 v[24:27], a[184:187], v[200:203], v[24:27]
    s_waitcnt vmcnt(42)
    s_barrier
    v_mfma_f32_16x16x32_bf16 v[24:27], a[188:191], v[204:207], v[24:27]
    buffer_load_dwordx4 v242, s[12:15], s57 offen offset:0 lds
    v_mfma_f32_16x16x32_bf16 v[28:31], a[248:251], v[200:203], v[28:31]
    v_mfma_f32_16x16x32_bf16 v[28:31], a[252:255], v[204:207], v[28:31]
    v_mfma_f32_16x16x32_bf16 v[32:35], a[56:59], v[208:211], v[32:35]
    ds_read_b64_tr_b16 v[192:193], v236 offset:0
    v_mfma_f32_16x16x32_bf16 v[32:35], a[60:63], v[212:215], v[32:35]
    ds_read_b64_tr_b16 v[194:195], v236 offset:256
    v_mfma_f32_16x16x32_bf16 v[36:39], a[120:123], v[208:211], v[36:39]
    s_add_u32 s57, s64, 56320
    ds_read_b64_tr_b16 v[196:197], v236 offset:2048
    v_mfma_f32_16x16x32_bf16 v[36:39], a[124:127], v[212:215], v[36:39]
    ds_read_b64_tr_b16 v[198:199], v236 offset:2304
    v_mfma_f32_16x16x32_bf16 v[40:43], a[184:187], v[208:211], v[40:43]
    ds_read_b64_tr_b16 v[200:201], v236 offset:4096
    v_mfma_f32_16x16x32_bf16 v[40:43], a[188:191], v[212:215], v[40:43]
    ds_read_b64_tr_b16 v[202:203], v236 offset:4352
    v_mfma_f32_16x16x32_bf16 v[44:47], a[248:251], v[208:211], v[44:47]
    ds_read_b64_tr_b16 v[204:205], v236 offset:6144
    v_mfma_f32_16x16x32_bf16 v[44:47], a[252:255], v[212:215], v[44:47]
    ds_read_b64_tr_b16 v[206:207], v236 offset:6400
    v_mfma_f32_16x16x32_bf16 v[48:51], a[56:59], v[216:219], v[48:51]
    buffer_load_dwordx4 v242, s[12:15], s57 offen offset:1024 lds
    v_mfma_f32_16x16x32_bf16 v[48:51], a[60:63], v[220:223], v[48:51]
    buffer_load_dwordx4 a[244:247], v247, s[20:23], s63 offen offset:1024 sc1
    v_mfma_f32_16x16x32_bf16 v[52:55], a[120:123], v[216:219], v[52:55]
    s_add_u32 s57, s64, 112640
    v_mfma_f32_16x16x32_bf16 v[52:55], a[124:127], v[220:223], v[52:55]
    v_mfma_f32_16x16x32_bf16 v[56:59], a[184:187], v[216:219], v[56:59]
    v_mfma_f32_16x16x32_bf16 v[56:59], a[188:191], v[220:223], v[56:59]
    buffer_load_dwordx4 v242, s[12:15], s57 offen offset:2048 lds
    v_mfma_f32_16x16x32_bf16 v[60:63], a[248:251], v[216:219], v[60:63]
    v_mfma_f32_16x16x32_bf16 v[60:63], a[252:255], v[220:223], v[60:63]
    s_waitcnt lgkmcnt(4)
    v_mfma_f32_16x16x32_bf16 v[64:67], v[192:195], a[0:3], 0
    ds_read_b64_tr_b16 v[208:209], v239 offset:0
    v_mfma_f32_16x16x32_bf16 v[64:67], v[196:199], a[4:7], v[64:67]
    s_waitcnt lgkmcnt(1)
    ds_read_b64_tr_b16 v[210:211], v239 offset:256
    v_mfma_f32_16x16x32_bf16 v[64:67], v[200:203], a[8:11], v[64:67]
    s_add_u32 s57, s64, 168960
    ds_read_b64_tr_b16 v[212:213], v239 offset:2048
    v_mfma_f32_16x16x32_bf16 v[64:67], v[204:207], a[12:15], v[64:67]
    ds_read_b64_tr_b16 v[214:215], v239 offset:2304
    v_mfma_f32_16x16x32_bf16 v[72:75], v[204:207], a[76:79], 0
    ds_read_b64_tr_b16 v[216:217], v239 offset:4096
    v_mfma_f32_16x16x32_bf16 v[72:75], v[200:203], a[72:75], v[72:75]
    ds_read_b64_tr_b16 v[218:219], v239 offset:4352
    v_mfma_f32_16x16x32_bf16 v[72:75], v[196:199], a[68:71], v[72:75]
    ds_read_b64_tr_b16 v[220:221], v239 offset:6144
    v_cvt_pk_bf16_f32 v128, v128, v129
    v_mfma_f32_16x16x32_bf16 v[72:75], v[192:195], a[64:67], v[72:75]
    ds_read_b64_tr_b16 v[222:223], v239 offset:6400
    v_cvt_pk_bf16_f32 v129, v130, v131
    v_mfma_f32_16x16x32_bf16 v[80:83], v[192:195], a[128:131], 0
    buffer_load_dwordx4 v242, s[12:15], s57 offen offset:3072 lds
    v_mfma_f32_16x16x32_bf16 v[80:83], v[196:199], a[132:135], v[80:83]
    buffer_load_dwordx4 a[56:59], v240, s[20:23], s62 offen offset:2048 sc1
    v_mfma_f32_16x16x32_bf16 v[80:83], v[200:203], a[136:139], v[80:83]
    buffer_load_dwordx4 a[120:123], v247, s[20:23], s62 offen offset:2048 sc1
    v_mfma_f32_16x16x32_bf16 v[80:83], v[204:207], a[140:143], v[80:83]
    buffer_load_dwordx4 a[184:187], v240, s[20:23], s63 offen offset:2048 sc1
    v_mfma_f32_16x16x32_bf16 v[88:91], v[204:207], a[204:207], 0
    buffer_load_dwordx4 a[248:251], v247, s[20:23], s63 offen offset:2048 sc1
    v_mfma_f32_16x16x32_bf16 v[88:91], v[200:203], a[200:203], v[88:91]
    buffer_load_dwordx4 a[60:63], v240, s[20:23], s62 offen offset:3072 sc1
    v_mfma_f32_16x16x32_bf16 v[88:91], v[196:199], a[196:199], v[88:91]
    v_cvt_pk_bf16_f32 v130, v132, v133
    v_cvt_pk_bf16_f32 v131, v134, v135
    v_mfma_f32_16x16x32_bf16 v[88:91], v[192:195], a[192:195], v[88:91]
    s_waitcnt lgkmcnt(4)
    buffer_load_dwordx4 a[124:127], v247, s[20:23], s62 offen offset:3072 sc1
    v_mfma_f32_16x16x32_bf16 v[68:71], v[208:211], a[0:3], 0
    s_add_u32 s95, s94, 16384
    ds_read_b64_tr_b16 v[192:193], v236 offset:8192
    v_mfma_f32_16x16x32_bf16 v[68:71], v[212:215], a[4:7], v[68:71]
    s_waitcnt lgkmcnt(1)
    ds_read_b64_tr_b16 v[194:195], v236 offset:8448
    v_mfma_f32_16x16x32_bf16 v[68:71], v[216:219], a[8:11], v[68:71]
    ds_read_b64_tr_b16 v[196:197], v236 offset:10240
    v_mfma_f32_16x16x32_bf16 v[68:71], v[220:223], a[12:15], v[68:71]
    ds_read_b64_tr_b16 v[198:199], v236 offset:10496
    v_mfma_f32_16x16x32_bf16 v[76:79], v[220:223], a[76:79], 0
    ds_read_b64_tr_b16 v[200:201], v236 offset:12288
    v_mfma_f32_16x16x32_bf16 v[76:79], v[216:219], a[72:75], v[76:79]
    ds_read_b64_tr_b16 v[202:203], v236 offset:12544
    v_mfma_f32_16x16x32_bf16 v[76:79], v[212:215], a[68:71], v[76:79]
    ds_read_b64_tr_b16 v[204:205], v236 offset:14336
    v_mfma_f32_16x16x32_bf16 v[76:79], v[208:211], a[64:67], v[76:79]
    ds_read_b64_tr_b16 v[206:207], v236 offset:14592
    v_mfma_f32_16x16x32_bf16 v[84:87], v[208:211], a[128:131], 0
    buffer_load_dwordx4 a[188:191], v240, s[20:23], s63 offen offset:3072 sc1
    v_mfma_f32_16x16x32_bf16 v[84:87], v[212:215], a[132:135], v[84:87]
    buffer_load_dwordx4 a[252:255], v247, s[20:23], s63 offen offset:3072 sc1
    v_mfma_f32_16x16x32_bf16 v[84:87], v[216:219], a[136:139], v[84:87]
    buffer_store_dwordx4 v[128:131], v240, s[20:23], s95 offen offset:0 sc1
    v_mfma_f32_16x16x32_bf16 v[84:87], v[220:223], a[140:143], v[84:87]
    v_cvt_pk_bf16_f32 v136, v136, v137
    v_cvt_pk_bf16_f32 v137, v138, v139
    v_mfma_f32_16x16x32_bf16 v[92:95], v[220:223], a[204:207], 0
    v_cvt_pk_bf16_f32 v138, v140, v141
    v_cvt_pk_bf16_f32 v139, v142, v143
    v_mfma_f32_16x16x32_bf16 v[92:95], v[216:219], a[200:203], v[92:95]
    s_add_u32 s95, s94, 24576
    v_mfma_f32_16x16x32_bf16 v[92:95], v[212:215], a[196:199], v[92:95]
    v_mfma_f32_16x16x32_bf16 v[92:95], v[208:211], a[192:195], v[92:95]
    s_waitcnt lgkmcnt(4)
    v_mfma_f32_16x16x32_bf16 v[96:99], v[192:195], a[0:3], 0
    ds_read_b64_tr_b16 v[208:209], v239 offset:8192
    v_mfma_f32_16x16x32_bf16 v[96:99], v[196:199], a[4:7], v[96:99]
    s_waitcnt lgkmcnt(1)
    ds_read_b64_tr_b16 v[210:211], v239 offset:8448
    v_mfma_f32_16x16x32_bf16 v[96:99], v[200:203], a[8:11], v[96:99]
    ds_read_b64_tr_b16 v[212:213], v239 offset:10240
    v_mfma_f32_16x16x32_bf16 v[96:99], v[204:207], a[12:15], v[96:99]
    ds_read_b64_tr_b16 v[214:215], v239 offset:10496
    v_mfma_f32_16x16x32_bf16 v[104:107], v[204:207], a[76:79], 0
    ds_read_b64_tr_b16 v[216:217], v239 offset:12288
    v_mfma_f32_16x16x32_bf16 v[104:107], v[200:203], a[72:75], v[104:107]
    ds_read_b64_tr_b16 v[218:219], v239 offset:12544
    v_mfma_f32_16x16x32_bf16 v[104:107], v[196:199], a[68:71], v[104:107]
    ds_read_b64_tr_b16 v[220:221], v239 offset:14336
    v_mfma_f32_16x16x32_bf16 v[104:107], v[192:195], a[64:67], v[104:107]
    ds_read_b64_tr_b16 v[222:223], v239 offset:14592
    v_mfma_f32_16x16x32_bf16 v[112:115], v[192:195], a[128:131], 0
    buffer_store_dwordx4 v[136:139], v240, s[20:23], s95 offen offset:0 sc1
    v_mfma_f32_16x16x32_bf16 v[112:115], v[196:199], a[132:135], v[112:115]
    v_cvt_pk_bf16_f32 v144, v144, v145
    v_cvt_pk_bf16_f32 v145, v146, v147
    v_mfma_f32_16x16x32_bf16 v[112:115], v[200:203], a[136:139], v[112:115]
    s_add_u32 m0, s53, 49152
    s_add_u32 s57, s64, 458752
    v_cvt_pk_bf16_f32 v146, v148, v149
    v_mfma_f32_16x16x32_bf16 v[112:115], v[204:207], a[140:143], v[112:115]
    v_cvt_pk_bf16_f32 v147, v150, v151
    v_mfma_f32_16x16x32_bf16 v[120:123], v[204:207], a[204:207], 0
    s_add_u32 s95, s94, 16384
    v_mfma_f32_16x16x32_bf16 v[120:123], v[200:203], a[200:203], v[120:123]
    buffer_load_dwordx4 v242, s[12:15], s57 offen offset:0 lds
    v_mfma_f32_16x16x32_bf16 v[120:123], v[196:199], a[196:199], v[120:123]
    v_mfma_f32_16x16x32_bf16 v[120:123], v[192:195], a[192:195], v[120:123]
    s_waitcnt lgkmcnt(4)
    v_mfma_f32_16x16x32_bf16 v[100:103], v[208:211], a[0:3], 0
    ds_read_b64_tr_b16 v[192:193], v236 offset:16384
    v_mfma_f32_16x16x32_bf16 v[100:103], v[212:215], a[4:7], v[100:103]
    s_waitcnt lgkmcnt(1)
    ds_read_b64_tr_b16 v[194:195], v236 offset:16640
    v_mfma_f32_16x16x32_bf16 v[100:103], v[216:219], a[8:11], v[100:103]
    s_add_u32 s57, s64, 515072
    ds_read_b64_tr_b16 v[196:197], v236 offset:18432
    v_mfma_f32_16x16x32_bf16 v[100:103], v[220:223], a[12:15], v[100:103]
    ds_read_b64_tr_b16 v[198:199], v236 offset:18688
    v_mfma_f32_16x16x32_bf16 v[108:111], v[220:223], a[76:79], 0
    ds_read_b64_tr_b16 v[200:201], v236 offset:20480
    v_mfma_f32_16x16x32_bf16 v[108:111], v[216:219], a[72:75], v[108:111]
    ds_read_b64_tr_b16 v[202:203], v236 offset:20736
    v_mfma_f32_16x16x32_bf16 v[108:111], v[212:215], a[68:71], v[108:111]
    ds_read_b64_tr_b16 v[204:205], v236 offset:22528
    v_mfma_f32_16x16x32_bf16 v[108:111], v[208:211], a[64:67], v[108:111]
    ds_read_b64_tr_b16 v[206:207], v236 offset:22784
    v_mfma_f32_16x16x32_bf16 v[116:119], v[208:211], a[128:131], 0
    buffer_load_dwordx4 v242, s[12:15], s57 offen offset:1024 lds
    v_mfma_f32_16x16x32_bf16 v[116:119], v[212:215], a[132:135], v[116:119]
    v_mfma_f32_16x16x32_bf16 v[116:119], v[216:219], a[136:139], v[116:119]
    s_add_u32 s57, s64, 571392
    v_mfma_f32_16x16x32_bf16 v[116:119], v[220:223], a[140:143], v[116:119]
    v_mfma_f32_16x16x32_bf16 v[124:127], v[220:223], a[204:207], 0
    v_mfma_f32_16x16x32_bf16 v[124:127], v[216:219], a[200:203], v[124:127]
    buffer_load_dwordx4 v242, s[12:15], s57 offen offset:2048 lds
    v_mfma_f32_16x16x32_bf16 v[124:127], v[212:215], a[196:199], v[124:127]
    s_waitcnt vmcnt(55)
    s_waitcnt vmcnt(51)
    v_mfma_f32_16x16x32_bf16 v[124:127], v[208:211], a[192:195], v[124:127]
    s_waitcnt lgkmcnt(4)
    v_mfma_f32_16x16x32_bf16 v[64:67], v[192:195], a[16:19], v[64:67]
    ds_read_b64_tr_b16 v[208:209], v239 offset:16384
    v_mov_b32 v232, 0xc0135761
    v_mfma_f32_16x16x32_bf16 v[64:67], v[196:199], a[20:23], v[64:67]
    s_waitcnt lgkmcnt(1)
    ds_read_b64_tr_b16 v[210:211], v239 offset:16640
    v_mov_b32 v233, 0xbdd2d3e8
    v_mfma_f32_16x16x32_bf16 v[64:67], v[200:203], a[24:27], v[64:67]
    s_add_u32 s57, s64, 627712
    ds_read_b64_tr_b16 v[212:213], v239 offset:18432
    v_add_u32 v246, 753664, v240
    v_mfma_f32_16x16x32_bf16 v[64:67], v[204:207], a[28:31], v[64:67]
    ds_read_b64_tr_b16 v[214:215], v239 offset:18688
    v_mfma_f32_16x16x32_bf16 v[72:75], v[204:207], a[92:95], v[72:75]
    ds_read_b64_tr_b16 v[216:217], v239 offset:20480
    v_mfma_f32_16x16x32_bf16 v[72:75], v[200:203], a[88:91], v[72:75]
    ds_read_b64_tr_b16 v[218:219], v239 offset:20736
    v_mfma_f32_16x16x32_bf16 v[72:75], v[196:199], a[84:87], v[72:75]
    ds_read_b64_tr_b16 v[220:221], v239 offset:22528
    v_mfma_f32_16x16x32_bf16 v[72:75], v[192:195], a[80:83], v[72:75]
    ds_read_b64_tr_b16 v[222:223], v239 offset:22784
    v_mfma_f32_16x16x32_bf16 v[80:83], v[192:195], a[144:147], v[80:83]
    buffer_load_dwordx4 v242, s[12:15], s57 offen offset:3072 lds
    v_mfma_f32_16x16x32_bf16 v[80:83], v[196:199], a[148:151], v[80:83]
    buffer_store_dwordx4 v[144:147], v240, s[20:23], s95 offen offset:1024 sc1
    v_mfma_f32_16x16x32_bf16 v[80:83], v[200:203], a[152:155], v[80:83]
    v_cvt_pk_bf16_f32 v152, v152, v153
    v_cvt_pk_bf16_f32 v153, v154, v155
    v_mfma_f32_16x16x32_bf16 v[80:83], v[204:207], a[156:159], v[80:83]
    v_cvt_pk_bf16_f32 v154, v156, v157
    v_cvt_pk_bf16_f32 v155, v158, v159
    v_mfma_f32_16x16x32_bf16 v[88:91], v[204:207], a[220:223], v[88:91]
    s_add_u32 s95, s94, 24576
    v_mfma_f32_16x16x32_bf16 v[88:91], v[200:203], a[216:219], v[88:91]
    v_mfma_f32_16x16x32_bf16 v[88:91], v[196:199], a[212:215], v[88:91]
    v_mfma_f32_16x16x32_bf16 v[88:91], v[192:195], a[208:211], v[88:91]
    s_waitcnt lgkmcnt(4)
    v_mfma_f32_16x16x32_bf16 v[68:71], v[208:211], a[16:19], v[68:71]
    ds_read_b64_tr_b16 v[192:193], v236 offset:24576
    v_mfma_f32_16x16x32_bf16 v[68:71], v[212:215], a[20:23], v[68:71]
    s_waitcnt lgkmcnt(1)
    ds_read_b64_tr_b16 v[194:195], v236 offset:24832
    v_mfma_f32_16x16x32_bf16 v[68:71], v[216:219], a[24:27], v[68:71]
    ds_read_b64_tr_b16 v[196:197], v236 offset:26624
    v_mfma_f32_16x16x32_bf16 v[68:71], v[220:223], a[28:31], v[68:71]
    ds_read_b64_tr_b16 v[198:199], v236 offset:26880
    v_mfma_f32_16x16x32_bf16 v[76:79], v[220:223], a[92:95], v[76:79]
    ds_read_b64_tr_b16 v[200:201], v236 offset:28672
    v_mfma_f32_16x16x32_bf16 v[76:79], v[216:219], a[88:91], v[76:79]
    ds_read_b64_tr_b16 v[202:203], v236 offset:28928
    v_mfma_f32_16x16x32_bf16 v[76:79], v[212:215], a[84:87], v[76:79]
    ds_read_b64_tr_b16 v[204:205], v236 offset:30720
    v_mfma_f32_16x16x32_bf16 v[76:79], v[208:211], a[80:83], v[76:79]
    ds_read_b64_tr_b16 v[206:207], v236 offset:30976
    v_mfma_f32_16x16x32_bf16 v[84:87], v[208:211], a[144:147], v[84:87]
    v_mfma_f32_16x16x32_bf16 v[84:87], v[212:215], a[148:151], v[84:87]
    v_mfma_f32_16x16x32_bf16 v[84:87], v[216:219], a[152:155], v[84:87]
    buffer_store_dwordx4 v[152:155], v240, s[20:23], s95 offen offset:1024 sc1
    v_mfma_f32_16x16x32_bf16 v[84:87], v[220:223], a[156:159], v[84:87]
    v_cvt_pk_bf16_f32 v160, v160, v161
    v_cvt_pk_bf16_f32 v161, v162, v163
    v_mfma_f32_16x16x32_bf16 v[92:95], v[220:223], a[220:223], v[92:95]
    v_cvt_pk_bf16_f32 v162, v164, v165
    v_cvt_pk_bf16_f32 v163, v166, v167
    v_mfma_f32_16x16x32_bf16 v[92:95], v[216:219], a[216:219], v[92:95]
    s_add_u32 s95, s94, 16384
    v_mfma_f32_16x16x32_bf16 v[92:95], v[212:215], a[212:215], v[92:95]
    v_mfma_f32_16x16x32_bf16 v[92:95], v[208:211], a[208:211], v[92:95]
    s_waitcnt lgkmcnt(4)
    v_mfma_f32_16x16x32_bf16 v[96:99], v[192:195], a[16:19], v[96:99]
    ds_read_b64_tr_b16 v[208:209], v239 offset:24576
    v_mfma_f32_16x16x32_bf16 v[96:99], v[196:199], a[20:23], v[96:99]
    s_waitcnt lgkmcnt(1)
    ds_read_b64_tr_b16 v[210:211], v239 offset:24832
    v_mfma_f32_16x16x32_bf16 v[96:99], v[200:203], a[24:27], v[96:99]
    ds_read_b64_tr_b16 v[212:213], v239 offset:26624
    v_mfma_f32_16x16x32_bf16 v[96:99], v[204:207], a[28:31], v[96:99]
    ds_read_b64_tr_b16 v[214:215], v239 offset:26880
    v_mfma_f32_16x16x32_bf16 v[104:107], v[204:207], a[92:95], v[104:107]
    ds_read_b64_tr_b16 v[216:217], v239 offset:28672
    v_mfma_f32_16x16x32_bf16 v[104:107], v[200:203], a[88:91], v[104:107]
    ds_read_b64_tr_b16 v[218:219], v239 offset:28928
    v_mfma_f32_16x16x32_bf16 v[104:107], v[196:199], a[84:87], v[104:107]
    ds_read_b64_tr_b16 v[220:221], v239 offset:30720
    v_mfma_f32_16x16x32_bf16 v[104:107], v[192:195], a[80:83], v[104:107]
    ds_read_b64_tr_b16 v[222:223], v239 offset:30976
    v_mfma_f32_16x16x32_bf16 v[112:115], v[192:195], a[144:147], v[112:115]
    v_mfma_f32_16x16x32_bf16 v[112:115], v[196:199], a[148:151], v[112:115]
    v_mfma_f32_16x16x32_bf16 v[112:115], v[200:203], a[152:155], v[112:115]
    s_waitcnt lgkmcnt(0)
    s_add_u32 m0, s53, 98304
    s_add_u32 s57, s64, 917504
    v_mfma_f32_16x16x32_bf16 v[112:115], v[204:207], a[156:159], v[112:115]
    v_mfma_f32_16x16x32_bf16 v[120:123], v[204:207], a[220:223], v[120:123]
    s_waitcnt vmcnt(27)
    s_barrier
    v_mfma_f32_16x16x32_bf16 v[120:123], v[200:203], a[216:219], v[120:123]
    buffer_load_dwordx4 v242, s[12:15], s57 offen offset:0 lds
    v_mfma_f32_16x16x32_bf16 v[120:123], v[196:199], a[212:215], v[120:123]
    v_mfma_f32_16x16x32_bf16 v[120:123], v[192:195], a[208:211], v[120:123]
    v_mfma_f32_16x16x32_bf16 v[100:103], v[208:211], a[16:19], v[100:103]
    ds_read_b64_tr_b16 v[192:193], v234 offset:0
    v_mfma_f32_16x16x32_bf16 v[100:103], v[212:215], a[20:23], v[100:103]
    ds_read_b64_tr_b16 v[194:195], v234 offset:256
    v_mfma_f32_16x16x32_bf16 v[100:103], v[216:219], a[24:27], v[100:103]
    s_add_u32 s57, s64, 973824
    ds_read_b64_tr_b16 v[196:197], v234 offset:2048
    v_mfma_f32_16x16x32_bf16 v[100:103], v[220:223], a[28:31], v[100:103]
    ds_read_b64_tr_b16 v[198:199], v234 offset:2304
    v_mfma_f32_16x16x32_bf16 v[108:111], v[220:223], a[92:95], v[108:111]
    ds_read_b64_tr_b16 v[200:201], v234 offset:4096
    v_mfma_f32_16x16x32_bf16 v[108:111], v[216:219], a[88:91], v[108:111]
    ds_read_b64_tr_b16 v[202:203], v234 offset:4352
    v_mfma_f32_16x16x32_bf16 v[108:111], v[212:215], a[84:87], v[108:111]
    ds_read_b64_tr_b16 v[204:205], v234 offset:6144
    v_mfma_f32_16x16x32_bf16 v[108:111], v[208:211], a[80:83], v[108:111]
    ds_read_b64_tr_b16 v[206:207], v234 offset:6400
    v_mfma_f32_16x16x32_bf16 v[116:119], v[208:211], a[144:147], v[116:119]
    buffer_load_dwordx4 v242, s[12:15], s57 offen offset:1024 lds
    v_mfma_f32_16x16x32_bf16 v[116:119], v[212:215], a[148:151], v[116:119]
    buffer_store_dwordx4 v[160:163], v240, s[20:23], s95 offen offset:2048 sc1
    v_mfma_f32_16x16x32_bf16 v[116:119], v[216:219], a[152:155], v[116:119]
    s_add_u32 s57, s64, 1030144
    v_cvt_pk_bf16_f32 v168, v168, v169
    v_cvt_pk_bf16_f32 v169, v170, v171
    v_mfma_f32_16x16x32_bf16 v[116:119], v[220:223], a[156:159], v[116:119]
    v_cvt_pk_bf16_f32 v170, v172, v173
    v_cvt_pk_bf16_f32 v171, v174, v175
    v_mfma_f32_16x16x32_bf16 v[124:127], v[220:223], a[220:223], v[124:127]
    s_add_u32 s95, s94, 24576
    v_mfma_f32_16x16x32_bf16 v[124:127], v[216:219], a[216:219], v[124:127]
    buffer_load_dwordx4 v242, s[12:15], s57 offen offset:2048 lds
    v_mfma_f32_16x16x32_bf16 v[124:127], v[212:215], a[212:215], v[124:127]
    v_mfma_f32_16x16x32_bf16 v[124:127], v[208:211], a[208:211], v[124:127]
    s_waitcnt lgkmcnt(4)
    v_mfma_f32_16x16x32_bf16 v[64:67], v[192:195], a[32:35], v[64:67]
    ds_read_b64_tr_b16 v[208:209], v237 offset:0
    v_mfma_f32_16x16x32_bf16 v[64:67], v[196:199], a[36:39], v[64:67]
    s_waitcnt lgkmcnt(1)
    ds_read_b64_tr_b16 v[210:211], v237 offset:256
    v_mfma_f32_16x16x32_bf16 v[64:67], v[200:203], a[40:43], v[64:67]
    s_add_u32 s57, s64, 1086464
    ds_read_b64_tr_b16 v[212:213], v237 offset:2048
    v_mfma_f32_16x16x32_bf16 v[64:67], v[204:207], a[44:47], v[64:67]
    ds_read_b64_tr_b16 v[214:215], v237 offset:2304
    v_mfma_f32_16x16x32_bf16 v[72:75], v[204:207], a[108:111], v[72:75]
    ds_read_b64_tr_b16 v[216:217], v237 offset:4096
    v_mfma_f32_16x16x32_bf16 v[72:75], v[200:203], a[104:107], v[72:75]
    ds_read_b64_tr_b16 v[218:219], v237 offset:4352
    v_mfma_f32_16x16x32_bf16 v[72:75], v[196:199], a[100:103], v[72:75]
    ds_read_b64_tr_b16 v[220:221], v237 offset:6144
    v_mfma_f32_16x16x32_bf16 v[72:75], v[192:195], a[96:99], v[72:75]
    ds_read_b64_tr_b16 v[222:223], v237 offset:6400
    v_mfma_f32_16x16x32_bf16 v[80:83], v[192:195], a[160:163], v[80:83]
    buffer_load_dwordx4 v242, s[12:15], s57 offen offset:3072 lds
    v_mfma_f32_16x16x32_bf16 v[80:83], v[196:199], a[164:167], v[80:83]
    v_mfma_f32_16x16x32_bf16 v[80:83], v[200:203], a[168:171], v[80:83]
    v_mfma_f32_16x16x32_bf16 v[80:83], v[204:207], a[172:175], v[80:83]
    v_mfma_f32_16x16x32_bf16 v[88:91], v[204:207], a[236:239], v[88:91]
    v_mfma_f32_16x16x32_bf16 v[88:91], v[200:203], a[232:235], v[88:91]
    v_mfma_f32_16x16x32_bf16 v[88:91], v[196:199], a[228:231], v[88:91]
    buffer_store_dwordx4 v[168:171], v240, s[20:23], s95 offen offset:2048 sc1
    v_mfma_f32_16x16x32_bf16 v[88:91], v[192:195], a[224:227], v[88:91]
    s_waitcnt lgkmcnt(4)
    v_cvt_pk_bf16_f32 v176, v176, v177
    v_cvt_pk_bf16_f32 v177, v178, v179
    v_mfma_f32_16x16x32_bf16 v[68:71], v[208:211], a[32:35], v[68:71]
    ds_read_b64_tr_b16 v[192:193], v234 offset:8192
    v_cvt_pk_bf16_f32 v178, v180, v181
    v_mfma_f32_16x16x32_bf16 v[68:71], v[212:215], a[36:39], v[68:71]
    s_waitcnt lgkmcnt(1)
    ds_read_b64_tr_b16 v[194:195], v234 offset:8448
    v_cvt_pk_bf16_f32 v179, v182, v183
    v_mfma_f32_16x16x32_bf16 v[68:71], v[216:219], a[40:43], v[68:71]
    s_add_u32 s95, s94, 16384
    ds_read_b64_tr_b16 v[196:197], v234 offset:10240
    v_mfma_f32_16x16x32_bf16 v[68:71], v[220:223], a[44:47], v[68:71]
    ds_read_b64_tr_b16 v[198:199], v234 offset:10496
    v_mfma_f32_16x16x32_bf16 v[76:79], v[220:223], a[108:111], v[76:79]
    ds_read_b64_tr_b16 v[200:201], v234 offset:12288
    v_mfma_f32_16x16x32_bf16 v[76:79], v[216:219], a[104:107], v[76:79]
    ds_read_b64_tr_b16 v[202:203], v234 offset:12544
    v_mfma_f32_16x16x32_bf16 v[76:79], v[212:215], a[100:103], v[76:79]
    ds_read_b64_tr_b16 v[204:205], v234 offset:14336
    v_mfma_f32_16x16x32_bf16 v[76:79], v[208:211], a[96:99], v[76:79]
    ds_read_b64_tr_b16 v[206:207], v234 offset:14592
    v_mfma_f32_16x16x32_bf16 v[84:87], v[208:211], a[160:163], v[84:87]
    v_mfma_f32_16x16x32_bf16 v[84:87], v[212:215], a[164:167], v[84:87]
    v_mfma_f32_16x16x32_bf16 v[84:87], v[216:219], a[168:171], v[84:87]
    v_mfma_f32_16x16x32_bf16 v[84:87], v[220:223], a[172:175], v[84:87]
    v_mfma_f32_16x16x32_bf16 v[92:95], v[220:223], a[236:239], v[92:95]
    v_mfma_f32_16x16x32_bf16 v[92:95], v[216:219], a[232:235], v[92:95]
    v_mfma_f32_16x16x32_bf16 v[92:95], v[212:215], a[228:231], v[92:95]
    v_mfma_f32_16x16x32_bf16 v[92:95], v[208:211], a[224:227], v[92:95]
    s_waitcnt lgkmcnt(4)
    v_mfma_f32_16x16x32_bf16 v[96:99], v[192:195], a[32:35], v[96:99]
    ds_read_b64_tr_b16 v[208:209], v237 offset:8192
    v_mfma_f32_16x16x32_bf16 v[96:99], v[196:199], a[36:39], v[96:99]
    s_waitcnt lgkmcnt(1)
    ds_read_b64_tr_b16 v[210:211], v237 offset:8448
    v_mfma_f32_16x16x32_bf16 v[96:99], v[200:203], a[40:43], v[96:99]
    ds_read_b64_tr_b16 v[212:213], v237 offset:10240
    v_mfma_f32_16x16x32_bf16 v[96:99], v[204:207], a[44:47], v[96:99]
    ds_read_b64_tr_b16 v[214:215], v237 offset:10496
    v_mfma_f32_16x16x32_bf16 v[104:107], v[204:207], a[108:111], v[104:107]
    ds_read_b64_tr_b16 v[216:217], v237 offset:12288
    v_mfma_f32_16x16x32_bf16 v[104:107], v[200:203], a[104:107], v[104:107]
    ds_read_b64_tr_b16 v[218:219], v237 offset:12544
    v_mfma_f32_16x16x32_bf16 v[104:107], v[196:199], a[100:103], v[104:107]
    ds_read_b64_tr_b16 v[220:221], v237 offset:14336
    v_mfma_f32_16x16x32_bf16 v[104:107], v[192:195], a[96:99], v[104:107]
    ds_read_b64_tr_b16 v[222:223], v237 offset:14592
    v_mfma_f32_16x16x32_bf16 v[112:115], v[192:195], a[160:163], v[112:115]
    buffer_store_dwordx4 v[176:179], v240, s[20:23], s95 offen offset:3072 sc1
    v_mfma_f32_16x16x32_bf16 v[112:115], v[196:199], a[164:167], v[112:115]
    v_cvt_pk_bf16_f32 v184, v184, v185
    v_cvt_pk_bf16_f32 v185, v186, v187
    v_mfma_f32_16x16x32_bf16 v[112:115], v[200:203], a[168:171], v[112:115]
    s_add_u32 m0, s53, 114688
    s_add_u32 s57, s64, 1376256
    v_cvt_pk_bf16_f32 v186, v188, v189
    v_mfma_f32_16x16x32_bf16 v[112:115], v[204:207], a[172:175], v[112:115]
    v_cvt_pk_bf16_f32 v187, v190, v191
    v_mfma_f32_16x16x32_bf16 v[120:123], v[204:207], a[236:239], v[120:123]
    s_add_u32 s95, s94, 24576
    v_mfma_f32_16x16x32_bf16 v[120:123], v[200:203], a[232:235], v[120:123]
    buffer_load_dwordx4 v242, s[12:15], s57 offen offset:0 lds
    v_mfma_f32_16x16x32_bf16 v[120:123], v[196:199], a[228:231], v[120:123]
    v_mfma_f32_16x16x32_bf16 v[120:123], v[192:195], a[224:227], v[120:123]
    s_waitcnt lgkmcnt(4)
    v_mfma_f32_16x16x32_bf16 v[100:103], v[208:211], a[32:35], v[100:103]
    ds_read_b64_tr_b16 v[192:193], v234 offset:16384
    v_mfma_f32_16x16x32_bf16 v[100:103], v[212:215], a[36:39], v[100:103]
    s_waitcnt lgkmcnt(1)
    ds_read_b64_tr_b16 v[194:195], v234 offset:16640
    v_mfma_f32_16x16x32_bf16 v[100:103], v[216:219], a[40:43], v[100:103]
    s_add_u32 s57, s64, 1432576
    ds_read_b64_tr_b16 v[196:197], v234 offset:18432
    v_mfma_f32_16x16x32_bf16 v[100:103], v[220:223], a[44:47], v[100:103]
    ds_read_b64_tr_b16 v[198:199], v234 offset:18688
    v_mfma_f32_16x16x32_bf16 v[108:111], v[220:223], a[108:111], v[108:111]
    ds_read_b64_tr_b16 v[200:201], v234 offset:20480
    v_mfma_f32_16x16x32_bf16 v[108:111], v[216:219], a[104:107], v[108:111]
    ds_read_b64_tr_b16 v[202:203], v234 offset:20736
    v_mfma_f32_16x16x32_bf16 v[108:111], v[212:215], a[100:103], v[108:111]
    ds_read_b64_tr_b16 v[204:205], v234 offset:22528
    v_mfma_f32_16x16x32_bf16 v[108:111], v[208:211], a[96:99], v[108:111]
    ds_read_b64_tr_b16 v[206:207], v234 offset:22784
    v_mfma_f32_16x16x32_bf16 v[116:119], v[208:211], a[160:163], v[116:119]
    buffer_load_dwordx4 v242, s[12:15], s57 offen offset:1024 lds
    v_mfma_f32_16x16x32_bf16 v[116:119], v[212:215], a[164:167], v[116:119]
    v_mfma_f32_16x16x32_bf16 v[116:119], v[216:219], a[168:171], v[116:119]
    s_add_u32 s57, s64, 1488896
    v_mfma_f32_16x16x32_bf16 v[116:119], v[220:223], a[172:175], v[116:119]
    v_mfma_f32_16x16x32_bf16 v[124:127], v[220:223], a[236:239], v[124:127]
    v_mfma_f32_16x16x32_bf16 v[124:127], v[216:219], a[232:235], v[124:127]
    buffer_load_dwordx4 v242, s[12:15], s57 offen offset:2048 lds
    v_mfma_f32_16x16x32_bf16 v[124:127], v[212:215], a[228:231], v[124:127]
    s_waitcnt vmcnt(34)
    s_waitcnt vmcnt(28)
    s_waitcnt vmcnt(22)
    s_waitcnt vmcnt(18)
    v_mfma_f32_16x16x32_bf16 v[124:127], v[208:211], a[224:227], v[124:127]
    s_waitcnt lgkmcnt(4)
    v_mfma_f32_16x16x32_bf16 v[64:67], v[192:195], a[48:51], v[64:67]
    ds_read_b64_tr_b16 v[208:209], v237 offset:16384
    v_mfma_f32_16x16x32_bf16 v[64:67], v[196:199], a[52:55], v[64:67]
    s_waitcnt lgkmcnt(1)
    ds_read_b64_tr_b16 v[210:211], v237 offset:16640
    v_mfma_f32_16x16x32_bf16 v[64:67], v[200:203], a[56:59], v[64:67]
    s_add_u32 s57, s64, 1545216
    ds_read_b64_tr_b16 v[212:213], v237 offset:18432
    v_mfma_f32_16x16x32_bf16 v[64:67], v[204:207], a[60:63], v[64:67]
    ds_read_b64_tr_b16 v[214:215], v237 offset:18688
    v_mfma_f32_16x16x32_bf16 v[72:75], v[204:207], a[124:127], v[72:75]
    ds_read_b64_tr_b16 v[216:217], v237 offset:20480
    v_mfma_f32_16x16x32_bf16 v[72:75], v[200:203], a[120:123], v[72:75]
    ds_read_b64_tr_b16 v[218:219], v237 offset:20736
    v_mfma_f32_16x16x32_bf16 v[72:75], v[196:199], a[116:119], v[72:75]
    ds_read_b64_tr_b16 v[220:221], v237 offset:22528
    v_mfma_f32_16x16x32_bf16 v[72:75], v[192:195], a[112:115], v[72:75]
    ds_read_b64_tr_b16 v[222:223], v237 offset:22784
    v_mfma_f32_16x16x32_bf16 v[80:83], v[192:195], a[176:179], v[80:83]
    buffer_load_dwordx4 v242, s[12:15], s57 offen offset:3072 lds
    v_mfma_f32_16x16x32_bf16 v[80:83], v[196:199], a[180:183], v[80:83]
    buffer_store_dwordx4 v[184:187], v240, s[20:23], s95 offen offset:3072 sc1
    v_mfma_f32_16x16x32_bf16 v[80:83], v[200:203], a[184:187], v[80:83]
    v_cvt_pk_bf16_f32 v0, v0, v1
    v_cvt_pk_bf16_f32 v1, v2, v3
    v_mfma_f32_16x16x32_bf16 v[80:83], v[204:207], a[188:191], v[80:83]
    v_cvt_pk_bf16_f32 v2, v4, v5
    v_cvt_pk_bf16_f32 v3, v6, v7
    v_mfma_f32_16x16x32_bf16 v[88:91], v[204:207], a[252:255], v[88:91]
    s_add_u32 s95, s94, 20480
    v_mfma_f32_16x16x32_bf16 v[88:91], v[200:203], a[248:251], v[88:91]
    v_mfma_f32_16x16x32_bf16 v[88:91], v[196:199], a[244:247], v[88:91]
    v_mfma_f32_16x16x32_bf16 v[88:91], v[192:195], a[240:243], v[88:91]
    s_waitcnt lgkmcnt(4)
    v_mfma_f32_16x16x32_bf16 v[68:71], v[208:211], a[48:51], v[68:71]
    ds_read_b64_tr_b16 v[192:193], v234 offset:24576
    v_mfma_f32_16x16x32_bf16 v[68:71], v[212:215], a[52:55], v[68:71]
    s_waitcnt lgkmcnt(1)
    ds_read_b64_tr_b16 v[194:195], v234 offset:24832
    v_mfma_f32_16x16x32_bf16 v[68:71], v[216:219], a[56:59], v[68:71]
    ds_read_b64_tr_b16 v[196:197], v234 offset:26624
    v_mfma_f32_16x16x32_bf16 v[68:71], v[220:223], a[60:63], v[68:71]
    ds_read_b64_tr_b16 v[198:199], v234 offset:26880
    v_mfma_f32_16x16x32_bf16 v[76:79], v[220:223], a[124:127], v[76:79]
    ds_read_b64_tr_b16 v[200:201], v234 offset:28672
    v_mfma_f32_16x16x32_bf16 v[76:79], v[216:219], a[120:123], v[76:79]
    ds_read_b64_tr_b16 v[202:203], v234 offset:28928
    v_mfma_f32_16x16x32_bf16 v[76:79], v[212:215], a[116:119], v[76:79]
    ds_read_b64_tr_b16 v[204:205], v234 offset:30720
    v_mfma_f32_16x16x32_bf16 v[76:79], v[208:211], a[112:115], v[76:79]
    ds_read_b64_tr_b16 v[206:207], v234 offset:30976
    v_mfma_f32_16x16x32_bf16 v[84:87], v[208:211], a[176:179], v[84:87]
    v_mfma_f32_16x16x32_bf16 v[84:87], v[212:215], a[180:183], v[84:87]
    v_mfma_f32_16x16x32_bf16 v[84:87], v[216:219], a[184:187], v[84:87]
    v_mfma_f32_16x16x32_bf16 v[84:87], v[220:223], a[188:191], v[84:87]
    v_mfma_f32_16x16x32_bf16 v[92:95], v[220:223], a[252:255], v[92:95]
    buffer_store_dwordx4 v[0:3], v240, s[20:23], s95 offen offset:0 sc1
    v_mfma_f32_16x16x32_bf16 v[92:95], v[216:219], a[248:251], v[92:95]
    v_cvt_pk_bf16_f32 v8, v8, v9
    v_cvt_pk_bf16_f32 v9, v10, v11
    v_mfma_f32_16x16x32_bf16 v[92:95], v[212:215], a[244:247], v[92:95]
    v_cvt_pk_bf16_f32 v10, v12, v13
    v_cvt_pk_bf16_f32 v11, v14, v15
    v_mfma_f32_16x16x32_bf16 v[92:95], v[208:211], a[240:243], v[92:95]
    s_waitcnt lgkmcnt(4)
    s_add_u32 s95, s94, 28672
    v_mfma_f32_16x16x32_bf16 v[96:99], v[192:195], a[48:51], v[96:99]
    ds_read_b64_tr_b16 v[208:209], v237 offset:24576
    v_mfma_f32_16x16x32_bf16 v[96:99], v[196:199], a[52:55], v[96:99]
    s_waitcnt lgkmcnt(1)
    ds_read_b64_tr_b16 v[210:211], v237 offset:24832
    v_mfma_f32_16x16x32_bf16 v[96:99], v[200:203], a[56:59], v[96:99]
    ds_read_b64_tr_b16 v[212:213], v237 offset:26624
    v_mfma_f32_16x16x32_bf16 v[96:99], v[204:207], a[60:63], v[96:99]
    ds_read_b64_tr_b16 v[214:215], v237 offset:26880
    v_mfma_f32_16x16x32_bf16 v[104:107], v[204:207], a[124:127], v[104:107]
    ds_read_b64_tr_b16 v[216:217], v237 offset:28672
    v_mfma_f32_16x16x32_bf16 v[104:107], v[200:203], a[120:123], v[104:107]
    ds_read_b64_tr_b16 v[218:219], v237 offset:28928
    v_mfma_f32_16x16x32_bf16 v[104:107], v[196:199], a[116:119], v[104:107]
    ds_read_b64_tr_b16 v[220:221], v237 offset:30720
    v_mfma_f32_16x16x32_bf16 v[104:107], v[192:195], a[112:115], v[104:107]
    ds_read_b64_tr_b16 v[222:223], v237 offset:30976
    v_mfma_f32_16x16x32_bf16 v[112:115], v[192:195], a[176:179], v[112:115]
    v_mfma_f32_16x16x32_bf16 v[112:115], v[196:199], a[180:183], v[112:115]
    v_mfma_f32_16x16x32_bf16 v[112:115], v[200:203], a[184:187], v[112:115]
    s_waitcnt lgkmcnt(0)
    v_mfma_f32_16x16x32_bf16 v[112:115], v[204:207], a[188:191], v[112:115]
    v_mfma_f32_16x16x32_bf16 v[120:123], v[204:207], a[252:255], v[120:123]
    s_waitcnt vmcnt(15)
    s_barrier
    v_mfma_f32_16x16x32_bf16 v[120:123], v[200:203], a[248:251], v[120:123]
    s_mov_b32 s8, s36
    v_mfma_f32_16x16x32_bf16 v[120:123], v[196:199], a[244:247], v[120:123]
    s_mov_b32 s9, s37
    v_mfma_f32_16x16x32_bf16 v[120:123], v[192:195], a[240:243], v[120:123]
    s_mov_b32 s10, 0x400000
    v_mfma_f32_16x16x32_bf16 v[100:103], v[208:211], a[48:51], v[100:103]
    ds_read_b64_tr_b16 v[192:193], v234 offset:32768
    v_mfma_f32_16x16x32_bf16 v[100:103], v[212:215], a[52:55], v[100:103]
    ds_read_b64_tr_b16 v[194:195], v234 offset:33024
    v_mfma_f32_16x16x32_bf16 v[100:103], v[216:219], a[56:59], v[100:103]
    ds_read_b64_tr_b16 v[196:197], v234 offset:34816
    v_mfma_f32_16x16x32_bf16 v[100:103], v[220:223], a[60:63], v[100:103]
    ds_read_b64_tr_b16 v[198:199], v234 offset:35072
    v_mfma_f32_16x16x32_bf16 v[108:111], v[220:223], a[124:127], v[108:111]
    ds_read_b64_tr_b16 v[200:201], v234 offset:36864
    v_mfma_f32_16x16x32_bf16 v[108:111], v[216:219], a[120:123], v[108:111]
    ds_read_b64_tr_b16 v[202:203], v234 offset:37120
    v_mfma_f32_16x16x32_bf16 v[108:111], v[212:215], a[116:119], v[108:111]
    ds_read_b64_tr_b16 v[204:205], v234 offset:38912
    v_mfma_f32_16x16x32_bf16 v[108:111], v[208:211], a[112:115], v[108:111]
    ds_read_b64_tr_b16 v[206:207], v234 offset:39168
    v_mfma_f32_16x16x32_bf16 v[116:119], v[208:211], a[176:179], v[116:119]
    buffer_load_dword v244, v253, s[8:11], s52 offen
    v_mfma_f32_16x16x32_bf16 v[116:119], v[212:215], a[180:183], v[116:119]
    buffer_store_dwordx4 v[8:11], v240, s[20:23], s95 offen offset:0 sc1
    v_mfma_f32_16x16x32_bf16 v[116:119], v[216:219], a[184:187], v[116:119]
    v_cvt_pk_bf16_f32 v16, v16, v17
    v_cvt_pk_bf16_f32 v17, v18, v19
    v_mfma_f32_16x16x32_bf16 v[116:119], v[220:223], a[188:191], v[116:119]
    v_cvt_pk_bf16_f32 v18, v20, v21
    v_cvt_pk_bf16_f32 v19, v22, v23
    v_mfma_f32_16x16x32_bf16 v[124:127], v[220:223], a[252:255], v[124:127]
    s_add_u32 s95, s94, 20480
    v_mfma_f32_16x16x32_bf16 v[124:127], v[216:219], a[248:251], v[124:127]
    v_mfma_f32_16x16x32_bf16 v[124:127], v[212:215], a[244:247], v[124:127]
    v_mfma_f32_16x16x32_bf16 v[124:127], v[208:211], a[240:243], v[124:127]
    s_waitcnt lgkmcnt(4)
    v_mfma_f32_16x16x32_bf16 v[128:131], v[192:195], a[0:3], 0
    ds_read_b64_tr_b16 v[208:209], v237 offset:32768
    v_mfma_f32_16x16x32_bf16 v[128:131], v[196:199], a[4:7], v[128:131]
    s_waitcnt lgkmcnt(1)
    ds_read_b64_tr_b16 v[210:211], v237 offset:33024
    v_mfma_f32_16x16x32_bf16 v[128:131], v[200:203], a[8:11], v[128:131]
    ds_read_b64_tr_b16 v[212:213], v237 offset:34816
    v_mfma_f32_16x16x32_bf16 v[128:131], v[204:207], a[12:15], v[128:131]
    ds_read_b64_tr_b16 v[214:215], v237 offset:35072
    v_mfma_f32_16x16x32_bf16 v[136:139], v[204:207], a[76:79], 0
    ds_read_b64_tr_b16 v[216:217], v237 offset:36864
    v_mfma_f32_16x16x32_bf16 v[136:139], v[200:203], a[72:75], v[136:139]
    ds_read_b64_tr_b16 v[218:219], v237 offset:37120
    v_mfma_f32_16x16x32_bf16 v[136:139], v[196:199], a[68:71], v[136:139]
    ds_read_b64_tr_b16 v[220:221], v237 offset:38912
    v_mul_f32 v224, v64, v64
    v_mfma_f32_16x16x32_bf16 v[136:139], v[192:195], a[64:67], v[136:139]
    ds_read_b64_tr_b16 v[222:223], v237 offset:39168
    v_fma_f32 v224, v224, v233, v232
    v_mfma_f32_16x16x32_bf16 v[144:147], v[192:195], a[128:131], 0
    v_mul_f32 v228, v72, v72
    v_mul_f32 v224, v224, v64
    v_mfma_f32_16x16x32_bf16 v[144:147], v[196:199], a[132:135], v[144:147]
    v_fma_f32 v228, v228, v233, v232
    v_mul_f32 v228, v228, v72
    v_mfma_f32_16x16x32_bf16 v[144:147], v[200:203], a[136:139], v[144:147]
    v_exp_f32 v224, v224
    v_mfma_f32_16x16x32_bf16 v[144:147], v[204:207], a[140:143], v[144:147]
    v_mul_f32 v64, v64, v96
    v_add_f32 v224, 1.0, v224
    v_mfma_f32_16x16x32_bf16 v[152:155], v[204:207], a[204:207], 0
    v_exp_f32 v228, v228
    v_mfma_f32_16x16x32_bf16 v[152:155], v[200:203], a[200:203], v[152:155]
    v_mul_f32 v72, v72, v104
    v_add_f32 v228, 1.0, v228
    v_mfma_f32_16x16x32_bf16 v[152:155], v[196:199], a[196:199], v[152:155]
    v_rcp_f32 v224, v224
    v_mfma_f32_16x16x32_bf16 v[152:155], v[192:195], a[192:195], v[152:155]
    s_waitcnt lgkmcnt(4)
    v_mul_f32 v64, v64, v224
    v_mul_f32 v225, v65, v65
    v_mfma_f32_16x16x32_bf16 v[132:135], v[208:211], a[0:3], 0
    ds_read_b64_tr_b16 v[192:193], v234 offset:40960
    v_fma_f32 v225, v225, v233, v232
    v_mfma_f32_16x16x32_bf16 v[132:135], v[212:215], a[4:7], v[132:135]
    s_waitcnt lgkmcnt(1)
    ds_read_b64_tr_b16 v[194:195], v234 offset:41216
    v_mul_f32 v225, v225, v65
    v_mfma_f32_16x16x32_bf16 v[132:135], v[216:219], a[8:11], v[132:135]
    ds_read_b64_tr_b16 v[196:197], v234 offset:43008
    v_mfma_f32_16x16x32_bf16 v[132:135], v[220:223], a[12:15], v[132:135]
    ds_read_b64_tr_b16 v[198:199], v234 offset:43264
    v_mfma_f32_16x16x32_bf16 v[140:143], v[220:223], a[76:79], 0
    ds_read_b64_tr_b16 v[200:201], v234 offset:45056
    v_mfma_f32_16x16x32_bf16 v[140:143], v[216:219], a[72:75], v[140:143]
    ds_read_b64_tr_b16 v[202:203], v234 offset:45312
    v_mfma_f32_16x16x32_bf16 v[140:143], v[212:215], a[68:71], v[140:143]
    ds_read_b64_tr_b16 v[204:205], v234 offset:47104
    v_mfma_f32_16x16x32_bf16 v[140:143], v[208:211], a[64:67], v[140:143]
    ds_read_b64_tr_b16 v[206:207], v234 offset:47360
    v_mfma_f32_16x16x32_bf16 v[148:151], v[208:211], a[128:131], 0
    buffer_store_dwordx4 v[16:19], v240, s[20:23], s95 offen offset:1024 sc1
    v_mfma_f32_16x16x32_bf16 v[148:151], v[212:215], a[132:135], v[148:151]
    v_cvt_pk_bf16_f32 v24, v24, v25
    v_cvt_pk_bf16_f32 v25, v26, v27
    v_mfma_f32_16x16x32_bf16 v[148:151], v[216:219], a[136:139], v[148:151]
    v_cvt_pk_bf16_f32 v26, v28, v29
    v_cvt_pk_bf16_f32 v27, v30, v31
    v_mfma_f32_16x16x32_bf16 v[148:151], v[220:223], a[140:143], v[148:151]
    s_add_u32 s95, s94, 28672
    v_rcp_f32 v228, v228
    v_mfma_f32_16x16x32_bf16 v[156:159], v[220:223], a[204:207], 0
    v_mul_f32 v72, v72, v228
    v_mul_f32 v229, v73, v73
    v_mfma_f32_16x16x32_bf16 v[156:159], v[216:219], a[200:203], v[156:159]
    v_fma_f32 v229, v229, v233, v232
    v_mul_f32 v229, v229, v73
    v_mfma_f32_16x16x32_bf16 v[156:159], v[212:215], a[196:199], v[156:159]
    v_exp_f32 v225, v225
    v_mfma_f32_16x16x32_bf16 v[156:159], v[208:211], a[192:195], v[156:159]
    s_waitcnt lgkmcnt(4)
    v_mul_f32 v65, v65, v97
    v_add_f32 v225, 1.0, v225
    v_mfma_f32_16x16x32_bf16 v[160:163], v[192:195], a[0:3], 0
    ds_read_b64_tr_b16 v[208:209], v237 offset:40960
    v_mfma_f32_16x16x32_bf16 v[160:163], v[196:199], a[4:7], v[160:163]
    s_waitcnt lgkmcnt(1)
    ds_read_b64_tr_b16 v[210:211], v237 offset:41216
    v_mfma_f32_16x16x32_bf16 v[160:163], v[200:203], a[8:11], v[160:163]
    ds_read_b64_tr_b16 v[212:213], v237 offset:43008
    v_mfma_f32_16x16x32_bf16 v[160:163], v[204:207], a[12:15], v[160:163]
    ds_read_b64_tr_b16 v[214:215], v237 offset:43264
    v_mfma_f32_16x16x32_bf16 v[168:171], v[204:207], a[76:79], 0
    ds_read_b64_tr_b16 v[216:217], v237 offset:45056
    v_mfma_f32_16x16x32_bf16 v[168:171], v[200:203], a[72:75], v[168:171]
    ds_read_b64_tr_b16 v[218:219], v237 offset:45312
    v_mfma_f32_16x16x32_bf16 v[168:171], v[196:199], a[68:71], v[168:171]
    ds_read_b64_tr_b16 v[220:221], v237 offset:47104
    v_mfma_f32_16x16x32_bf16 v[168:171], v[192:195], a[64:67], v[168:171]
    ds_read_b64_tr_b16 v[222:223], v237 offset:47360
    v_mfma_f32_16x16x32_bf16 v[176:179], v[192:195], a[128:131], 0
    v_exp_f32 v229, v229
    v_mfma_f32_16x16x32_bf16 v[176:179], v[196:199], a[132:135], v[176:179]
    v_mul_f32 v73, v73, v105
    v_add_f32 v229, 1.0, v229
    v_mfma_f32_16x16x32_bf16 v[176:179], v[200:203], a[136:139], v[176:179]
    buffer_store_dwordx4 v[24:27], v240, s[20:23], s95 offen offset:1024 sc1
    v_mfma_f32_16x16x32_bf16 v[176:179], v[204:207], a[140:143], v[176:179]
    v_cvt_pk_bf16_f32 v32, v32, v33
    v_cvt_pk_bf16_f32 v33, v34, v35
    v_mfma_f32_16x16x32_bf16 v[184:187], v[204:207], a[204:207], 0
    v_cvt_pk_bf16_f32 v34, v36, v37
    v_cvt_pk_bf16_f32 v35, v38, v39
    v_mfma_f32_16x16x32_bf16 v[184:187], v[200:203], a[200:203], v[184:187]
    s_add_u32 s95, s94, 20480
    v_rcp_f32 v225, v225
    v_mfma_f32_16x16x32_bf16 v[184:187], v[196:199], a[196:199], v[184:187]
    v_mul_f32 v65, v65, v225
    v_mul_f32 v226, v66, v66
    v_mfma_f32_16x16x32_bf16 v[184:187], v[192:195], a[192:195], v[184:187]
    s_waitcnt lgkmcnt(4)
    v_rcp_f32 v229, v229
    v_mfma_f32_16x16x32_bf16 v[164:167], v[208:211], a[0:3], 0
    ds_read_b64_tr_b16 v[192:193], v234 offset:49152
    v_mul_f32 v73, v73, v229
    v_mfma_f32_16x16x32_bf16 v[164:167], v[212:215], a[4:7], v[164:167]
    s_waitcnt lgkmcnt(1)
    ds_read_b64_tr_b16 v[194:195], v234 offset:49408
    v_fma_f32 v226, v226, v233, v232
    v_mfma_f32_16x16x32_bf16 v[164:167], v[216:219], a[8:11], v[164:167]
    ds_read_b64_tr_b16 v[196:197], v234 offset:51200
    v_mul_f32 v230, v74, v74
    v_mfma_f32_16x16x32_bf16 v[164:167], v[220:223], a[12:15], v[164:167]
    ds_read_b64_tr_b16 v[198:199], v234 offset:51456
    v_mul_f32 v226, v226, v66
    v_mfma_f32_16x16x32_bf16 v[172:175], v[220:223], a[76:79], 0
    ds_read_b64_tr_b16 v[200:201], v234 offset:53248
    v_fma_f32 v230, v230, v233, v232
    v_mfma_f32_16x16x32_bf16 v[172:175], v[216:219], a[72:75], v[172:175]
    ds_read_b64_tr_b16 v[202:203], v234 offset:53504
    v_mul_f32 v230, v230, v74
    v_mfma_f32_16x16x32_bf16 v[172:175], v[212:215], a[68:71], v[172:175]
    ds_read_b64_tr_b16 v[204:205], v234 offset:55296
    v_mfma_f32_16x16x32_bf16 v[172:175], v[208:211], a[64:67], v[172:175]
    ds_read_b64_tr_b16 v[206:207], v234 offset:55552
    v_mfma_f32_16x16x32_bf16 v[180:183], v[208:211], a[128:131], 0
    v_exp_f32 v226, v226
    v_mfma_f32_16x16x32_bf16 v[180:183], v[212:215], a[132:135], v[180:183]
    v_mul_f32 v66, v66, v98
    v_add_f32 v226, 1.0, v226
    v_mfma_f32_16x16x32_bf16 v[180:183], v[216:219], a[136:139], v[180:183]
    v_exp_f32 v230, v230
    v_mfma_f32_16x16x32_bf16 v[180:183], v[220:223], a[140:143], v[180:183]
    v_mul_f32 v74, v74, v106
    v_add_f32 v230, 1.0, v230
    v_mfma_f32_16x16x32_bf16 v[188:191], v[220:223], a[204:207], 0
    v_rcp_f32 v226, v226
    v_mfma_f32_16x16x32_bf16 v[188:191], v[216:219], a[200:203], v[188:191]
    v_mul_f32 v66, v66, v226
    v_mul_f32 v227, v67, v67
    v_mfma_f32_16x16x32_bf16 v[188:191], v[212:215], a[196:199], v[188:191]
    s_add_u32 m0, s53, 131072
    s_add_u32 s57, s65, 0
    v_fma_f32 v227, v227, v233, v232
    v_mfma_f32_16x16x32_bf16 v[188:191], v[208:211], a[192:195], v[188:191]
    s_waitcnt lgkmcnt(4)
    v_rcp_f32 v230, v230
    v_mfma_f32_16x16x32_bf16 v[128:131], v[192:195], a[16:19], v[128:131]
    ds_read_b64_tr_b16 v[208:209], v237 offset:49152
    v_mul_f32 v74, v74, v230
    v_mfma_f32_16x16x32_bf16 v[128:131], v[196:199], a[20:23], v[128:131]
    s_waitcnt lgkmcnt(1)
    ds_read_b64_tr_b16 v[210:211], v237 offset:49408
    v_mul_f32 v231, v75, v75
    v_mfma_f32_16x16x32_bf16 v[128:131], v[200:203], a[24:27], v[128:131]
    ds_read_b64_tr_b16 v[212:213], v237 offset:51200
    v_mul_f32 v227, v227, v67
    v_mfma_f32_16x16x32_bf16 v[128:131], v[204:207], a[28:31], v[128:131]
    ds_read_b64_tr_b16 v[214:215], v237 offset:51456
    v_fma_f32 v231, v231, v233, v232
    v_mfma_f32_16x16x32_bf16 v[136:139], v[204:207], a[92:95], v[136:139]
    ds_read_b64_tr_b16 v[216:217], v237 offset:53248
    v_mul_f32 v231, v231, v75
    v_mfma_f32_16x16x32_bf16 v[136:139], v[200:203], a[88:91], v[136:139]
    ds_read_b64_tr_b16 v[218:219], v237 offset:53504
    v_mfma_f32_16x16x32_bf16 v[136:139], v[196:199], a[84:87], v[136:139]
    ds_read_b64_tr_b16 v[220:221], v237 offset:55296
    v_mfma_f32_16x16x32_bf16 v[136:139], v[192:195], a[80:83], v[136:139]
    ds_read_b64_tr_b16 v[222:223], v237 offset:55552
    v_mfma_f32_16x16x32_bf16 v[144:147], v[192:195], a[144:147], v[144:147]
    buffer_load_dwordx4 v241, s[8:11], s57 offen offset:0 lds
    v_mfma_f32_16x16x32_bf16 v[144:147], v[196:199], a[148:151], v[144:147]
    s_add_u32 s57, s65, 130048
    buffer_load_dwordx4 v241, s[8:11], s57 offen offset:1024 lds
    v_mfma_f32_16x16x32_bf16 v[144:147], v[200:203], a[152:155], v[144:147]
    buffer_store_dwordx4 v[32:35], v240, s[20:23], s95 offen offset:2048 sc1
    v_mfma_f32_16x16x32_bf16 v[144:147], v[204:207], a[156:159], v[144:147]
    v_cvt_pk_bf16_f32 v40, v40, v41
    v_cvt_pk_bf16_f32 v41, v42, v43
    v_mfma_f32_16x16x32_bf16 v[152:155], v[204:207], a[220:223], v[152:155]
    v_cvt_pk_bf16_f32 v42, v44, v45
    v_cvt_pk_bf16_f32 v43, v46, v47
    v_mfma_f32_16x16x32_bf16 v[152:155], v[200:203], a[216:219], v[152:155]
    s_add_u32 s95, s94, 28672
    v_exp_f32 v227, v227
    v_mfma_f32_16x16x32_bf16 v[152:155], v[196:199], a[212:215], v[152:155]
    s_add_u32 s57, s65, 260096
    v_mul_f32 v67, v67, v99
    v_add_f32 v227, 1.0, v227
    v_mfma_f32_16x16x32_bf16 v[152:155], v[192:195], a[208:211], v[152:155]
    s_waitcnt lgkmcnt(4)
    v_exp_f32 v231, v231
    v_mfma_f32_16x16x32_bf16 v[132:135], v[208:211], a[16:19], v[132:135]
    ds_read_b64_tr_b16 v[192:193], v234 offset:57344
    v_mul_f32 v75, v75, v107
    v_mfma_f32_16x16x32_bf16 v[132:135], v[212:215], a[20:23], v[132:135]
    s_waitcnt lgkmcnt(1)
    ds_read_b64_tr_b16 v[194:195], v234 offset:57600
    v_add_f32 v231, 1.0, v231
    v_mfma_f32_16x16x32_bf16 v[132:135], v[216:219], a[24:27], v[132:135]
    ds_read_b64_tr_b16 v[196:197], v234 offset:59392
    v_mfma_f32_16x16x32_bf16 v[132:135], v[220:223], a[28:31], v[132:135]
    ds_read_b64_tr_b16 v[198:199], v234 offset:59648
    v_mfma_f32_16x16x32_bf16 v[140:143], v[220:223], a[92:95], v[140:143]
    ds_read_b64_tr_b16 v[200:201], v234 offset:61440
    v_mfma_f32_16x16x32_bf16 v[140:143], v[216:219], a[88:91], v[140:143]
    ds_read_b64_tr_b16 v[202:203], v234 offset:61696
    v_mfma_f32_16x16x32_bf16 v[140:143], v[212:215], a[84:87], v[140:143]
    ds_read_b64_tr_b16 v[204:205], v234 offset:63488
    v_mfma_f32_16x16x32_bf16 v[140:143], v[208:211], a[80:83], v[140:143]
    ds_read_b64_tr_b16 v[206:207], v234 offset:63744
    v_mfma_f32_16x16x32_bf16 v[148:151], v[208:211], a[144:147], v[148:151]
    buffer_load_dwordx4 v241, s[8:11], s57 offen offset:2048 lds
    v_mfma_f32_16x16x32_bf16 v[148:151], v[212:215], a[148:151], v[148:151]
    s_add_u32 s57, s65, 390144
    buffer_load_dwordx4 v241, s[8:11], s57 offen offset:3072 lds
    v_mfma_f32_16x16x32_bf16 v[148:151], v[216:219], a[152:155], v[148:151]
    v_rcp_f32 v227, v227
    v_mfma_f32_16x16x32_bf16 v[148:151], v[220:223], a[156:159], v[148:151]
    v_mul_f32 v67, v67, v227
    v_mul_f32 v224, v68, v68
    v_mfma_f32_16x16x32_bf16 v[156:159], v[220:223], a[220:223], v[156:159]
    v_rcp_f32 v231, v231
    v_mfma_f32_16x16x32_bf16 v[156:159], v[216:219], a[216:219], v[156:159]
    v_mul_f32 v75, v75, v231
    v_fma_f32 v224, v224, v233, v232
    v_mfma_f32_16x16x32_bf16 v[156:159], v[212:215], a[212:215], v[156:159]
    buffer_store_dwordx4 v[40:43], v240, s[20:23], s95 offen offset:2048 sc1
    v_mfma_f32_16x16x32_bf16 v[156:159], v[208:211], a[208:211], v[156:159]
    s_waitcnt lgkmcnt(4)
    v_cvt_pk_bf16_f32 v48, v48, v49
    v_cvt_pk_bf16_f32 v49, v50, v51
    v_mfma_f32_16x16x32_bf16 v[160:163], v[192:195], a[16:19], v[160:163]
    ds_read_b64_tr_b16 v[208:209], v237 offset:57344
    v_cvt_pk_bf16_f32 v50, v52, v53
    v_mfma_f32_16x16x32_bf16 v[160:163], v[196:199], a[20:23], v[160:163]
    s_waitcnt lgkmcnt(1)
    ds_read_b64_tr_b16 v[210:211], v237 offset:57600
    v_cvt_pk_bf16_f32 v51, v54, v55
    v_mfma_f32_16x16x32_bf16 v[160:163], v[200:203], a[24:27], v[160:163]
    s_add_u32 m0, s53, 147456
    s_add_u32 s57, s65, 1048576
    ds_read_b64_tr_b16 v[212:213], v237 offset:59392
    v_mfma_f32_16x16x32_bf16 v[160:163], v[204:207], a[28:31], v[160:163]
    s_add_u32 s95, s94, 20480
    ds_read_b64_tr_b16 v[214:215], v237 offset:59648
    v_mul_f32 v228, v76, v76
    v_mfma_f32_16x16x32_bf16 v[168:171], v[204:207], a[92:95], v[168:171]
    ds_read_b64_tr_b16 v[216:217], v237 offset:61440
    v_mul_f32 v224, v224, v68
    v_mfma_f32_16x16x32_bf16 v[168:171], v[200:203], a[88:91], v[168:171]
    ds_read_b64_tr_b16 v[218:219], v237 offset:61696
    v_fma_f32 v228, v228, v233, v232
    v_mfma_f32_16x16x32_bf16 v[168:171], v[196:199], a[84:87], v[168:171]
    ds_read_b64_tr_b16 v[220:221], v237 offset:63488
    v_mul_f32 v228, v228, v76
    v_mfma_f32_16x16x32_bf16 v[168:171], v[192:195], a[80:83], v[168:171]
    ds_read_b64_tr_b16 v[222:223], v237 offset:63744
    v_mfma_f32_16x16x32_bf16 v[176:179], v[192:195], a[144:147], v[176:179]
    buffer_load_dwordx4 v241, s[8:11], s57 offen offset:0 lds
    v_mfma_f32_16x16x32_bf16 v[176:179], v[196:199], a[148:151], v[176:179]
    v_exp_f32 v224, v224
    v_mfma_f32_16x16x32_bf16 v[176:179], v[200:203], a[152:155], v[176:179]
    s_waitcnt lgkmcnt(0)
    s_add_u32 s57, s65, 1178624
    v_mul_f32 v68, v68, v100
    v_mfma_f32_16x16x32_bf16 v[176:179], v[204:207], a[156:159], v[176:179]
    v_exp_f32 v228, v228
    v_mfma_f32_16x16x32_bf16 v[184:187], v[204:207], a[220:223], v[184:187]
    s_waitcnt vmcnt(13)
    s_barrier
    v_add_f32 v224, 1.0, v224
    v_mfma_f32_16x16x32_bf16 v[184:187], v[200:203], a[216:219], v[184:187]
    buffer_load_dwordx4 v241, s[8:11], s57 offen offset:1024 lds
    v_mfma_f32_16x16x32_bf16 v[184:187], v[196:199], a[212:215], v[184:187]
    v_mul_f32 v76, v76, v108
    v_add_f32 v228, 1.0, v228
    v_mfma_f32_16x16x32_bf16 v[184:187], v[192:195], a[208:211], v[184:187]
    v_rcp_f32 v224, v224
    v_mfma_f32_16x16x32_bf16 v[164:167], v[208:211], a[16:19], v[164:167]
    ds_read_b64_tr_b16 v[192:193], v235 offset:32768
    v_mul_f32 v68, v68, v224
    v_mfma_f32_16x16x32_bf16 v[164:167], v[212:215], a[20:23], v[164:167]
    ds_read_b64_tr_b16 v[194:195], v235 offset:33024
    v_mul_f32 v225, v69, v69
    v_mfma_f32_16x16x32_bf16 v[164:167], v[216:219], a[24:27], v[164:167]
    s_add_u32 s57, s65, 1308672
    ds_read_b64_tr_b16 v[196:197], v235 offset:34816
    v_fma_f32 v225, v225, v233, v232
    v_mfma_f32_16x16x32_bf16 v[164:167], v[220:223], a[28:31], v[164:167]
    ds_read_b64_tr_b16 v[198:199], v235 offset:35072
    v_mul_f32 v225, v225, v69
    v_mfma_f32_16x16x32_bf16 v[172:175], v[220:223], a[92:95], v[172:175]
    ds_read_b64_tr_b16 v[200:201], v235 offset:36864
    v_mfma_f32_16x16x32_bf16 v[172:175], v[216:219], a[88:91], v[172:175]
    ds_read_b64_tr_b16 v[202:203], v235 offset:37120
    v_mfma_f32_16x16x32_bf16 v[172:175], v[212:215], a[84:87], v[172:175]
    ds_read_b64_tr_b16 v[204:205], v235 offset:38912
    v_mfma_f32_16x16x32_bf16 v[172:175], v[208:211], a[80:83], v[172:175]
    ds_read_b64_tr_b16 v[206:207], v235 offset:39168
    v_mfma_f32_16x16x32_bf16 v[180:183], v[208:211], a[144:147], v[180:183]
    buffer_load_dwordx4 v241, s[8:11], s57 offen offset:2048 lds
    v_mfma_f32_16x16x32_bf16 v[180:183], v[212:215], a[148:151], v[180:183]
    buffer_store_dwordx4 v[48:51], v240, s[20:23], s95 offen offset:3072 sc1
    v_mfma_f32_16x16x32_bf16 v[180:183], v[216:219], a[152:155], v[180:183]
    s_add_u32 s57, s65, 1438720
    v_cvt_pk_bf16_f32 v56, v56, v57
    v_cvt_pk_bf16_f32 v57, v58, v59
    v_mfma_f32_16x16x32_bf16 v[180:183], v[220:223], a[156:159], v[180:183]
    v_cvt_pk_bf16_f32 v58, v60, v61
    v_cvt_pk_bf16_f32 v59, v62, v63
    v_mfma_f32_16x16x32_bf16 v[188:191], v[220:223], a[220:223], v[188:191]
    s_add_u32 s95, s94, 28672
    v_rcp_f32 v228, v228
    v_mfma_f32_16x16x32_bf16 v[188:191], v[216:219], a[216:219], v[188:191]
    buffer_load_dwordx4 v241, s[8:11], s57 offen offset:3072 lds
    v_mfma_f32_16x16x32_bf16 v[188:191], v[212:215], a[212:215], v[188:191]
    v_mul_f32 v76, v76, v228
    v_mul_f32 v229, v77, v77
    v_mfma_f32_16x16x32_bf16 v[188:191], v[208:211], a[208:211], v[188:191]
    s_waitcnt lgkmcnt(4)
    v_fma_f32 v229, v229, v233, v232
    v_mul_f32 v229, v229, v77
    v_mfma_f32_16x16x32_bf16 v[128:131], v[192:195], a[32:35], v[128:131]
    ds_read_b64_tr_b16 v[208:209], v238 offset:32768
    v_mfma_f32_16x16x32_bf16 v[128:131], v[196:199], a[36:39], v[128:131]
    s_waitcnt lgkmcnt(1)
    ds_read_b64_tr_b16 v[210:211], v238 offset:33024
    v_mfma_f32_16x16x32_bf16 v[128:131], v[200:203], a[40:43], v[128:131]
    ds_read_b64_tr_b16 v[212:213], v238 offset:34816
    v_mfma_f32_16x16x32_bf16 v[128:131], v[204:207], a[44:47], v[128:131]
    ds_read_b64_tr_b16 v[214:215], v238 offset:35072
    v_mfma_f32_16x16x32_bf16 v[136:139], v[204:207], a[108:111], v[136:139]
    ds_read_b64_tr_b16 v[216:217], v238 offset:36864
    v_mfma_f32_16x16x32_bf16 v[136:139], v[200:203], a[104:107], v[136:139]
    ds_read_b64_tr_b16 v[218:219], v238 offset:37120
    v_mfma_f32_16x16x32_bf16 v[136:139], v[196:199], a[100:103], v[136:139]
    s_add_u32 m0, s53, 65536
    s_add_u32 s57, s65, 2097152
    ds_read_b64_tr_b16 v[220:221], v238 offset:38912
    v_mfma_f32_16x16x32_bf16 v[136:139], v[192:195], a[96:99], v[136:139]
    ds_read_b64_tr_b16 v[222:223], v238 offset:39168
    v_mfma_f32_16x16x32_bf16 v[144:147], v[192:195], a[160:163], v[144:147]
    v_exp_f32 v225, v225
    v_mfma_f32_16x16x32_bf16 v[144:147], v[196:199], a[164:167], v[144:147]
    buffer_load_dwordx4 v241, s[8:11], s57 offen offset:0 lds
    v_mfma_f32_16x16x32_bf16 v[144:147], v[200:203], a[168:171], v[144:147]
    v_mul_f32 v69, v69, v101
    v_add_f32 v225, 1.0, v225
    v_mfma_f32_16x16x32_bf16 v[144:147], v[204:207], a[172:175], v[144:147]
    v_exp_f32 v229, v229
    v_mfma_f32_16x16x32_bf16 v[152:155], v[204:207], a[236:239], v[152:155]
    v_mul_f32 v77, v77, v109
    v_add_f32 v229, 1.0, v229
    v_mfma_f32_16x16x32_bf16 v[152:155], v[200:203], a[232:235], v[152:155]
    v_rcp_f32 v225, v225
    v_mfma_f32_16x16x32_bf16 v[152:155], v[196:199], a[228:231], v[152:155]
    s_add_u32 s57, s65, 2227200
    v_mul_f32 v69, v69, v225
    v_mul_f32 v226, v70, v70
    v_mfma_f32_16x16x32_bf16 v[152:155], v[192:195], a[224:227], v[152:155]
    s_waitcnt lgkmcnt(4)
    v_rcp_f32 v229, v229
    v_mfma_f32_16x16x32_bf16 v[132:135], v[208:211], a[32:35], v[132:135]
    ds_read_b64_tr_b16 v[192:193], v235 offset:40960
    v_mul_f32 v77, v77, v229
    v_mfma_f32_16x16x32_bf16 v[132:135], v[212:215], a[36:39], v[132:135]
    s_waitcnt lgkmcnt(1)
    ds_read_b64_tr_b16 v[194:195], v235 offset:41216
    v_fma_f32 v226, v226, v233, v232
    v_mfma_f32_16x16x32_bf16 v[132:135], v[216:219], a[40:43], v[132:135]
    ds_read_b64_tr_b16 v[196:197], v235 offset:43008
    v_mul_f32 v230, v78, v78
    v_mfma_f32_16x16x32_bf16 v[132:135], v[220:223], a[44:47], v[132:135]
    ds_read_b64_tr_b16 v[198:199], v235 offset:43264
    v_mul_f32 v226, v226, v70
    v_mfma_f32_16x16x32_bf16 v[140:143], v[220:223], a[108:111], v[140:143]
    ds_read_b64_tr_b16 v[200:201], v235 offset:45056
    v_fma_f32 v230, v230, v233, v232
    v_mfma_f32_16x16x32_bf16 v[140:143], v[216:219], a[104:107], v[140:143]
    ds_read_b64_tr_b16 v[202:203], v235 offset:45312
    v_mul_f32 v230, v230, v78
    v_mfma_f32_16x16x32_bf16 v[140:143], v[212:215], a[100:103], v[140:143]
    ds_read_b64_tr_b16 v[204:205], v235 offset:47104
    v_mfma_f32_16x16x32_bf16 v[140:143], v[208:211], a[96:99], v[140:143]
    ds_read_b64_tr_b16 v[206:207], v235 offset:47360
    v_mfma_f32_16x16x32_bf16 v[148:151], v[208:211], a[160:163], v[148:151]
    buffer_load_dwordx4 v241, s[8:11], s57 offen offset:1024 lds
    v_mfma_f32_16x16x32_bf16 v[148:151], v[212:215], a[164:167], v[148:151]
    s_add_u32 s57, s65, 2357248
    buffer_load_dwordx4 v241, s[8:11], s57 offen offset:2048 lds
    v_mfma_f32_16x16x32_bf16 v[148:151], v[216:219], a[168:171], v[148:151]
    buffer_store_dwordx4 v[56:59], v240, s[20:23], s95 offen offset:3072 sc1
    v_mfma_f32_16x16x32_bf16 v[148:151], v[220:223], a[172:175], v[148:151]
    v_exp_f32 v226, v226
    v_mfma_f32_16x16x32_bf16 v[156:159], v[220:223], a[236:239], v[156:159]
    v_mul_f32 v70, v70, v102
    v_add_f32 v226, 1.0, v226
    v_mfma_f32_16x16x32_bf16 v[156:159], v[216:219], a[232:235], v[156:159]
    v_exp_f32 v230, v230
    v_mfma_f32_16x16x32_bf16 v[156:159], v[212:215], a[228:231], v[156:159]
    s_add_u32 s57, s65, 2487296
    v_mul_f32 v78, v78, v110
    v_add_f32 v230, 1.0, v230
    v_mfma_f32_16x16x32_bf16 v[156:159], v[208:211], a[224:227], v[156:159]
    s_waitcnt lgkmcnt(4)
    v_rcp_f32 v226, v226
    v_mfma_f32_16x16x32_bf16 v[160:163], v[192:195], a[32:35], v[160:163]
    ds_read_b64_tr_b16 v[208:209], v238 offset:40960
    v_mul_f32 v70, v70, v226
    v_mfma_f32_16x16x32_bf16 v[160:163], v[196:199], a[36:39], v[160:163]
    s_waitcnt lgkmcnt(1)
    ds_read_b64_tr_b16 v[210:211], v238 offset:41216
    v_mul_f32 v227, v71, v71
    v_mfma_f32_16x16x32_bf16 v[160:163], v[200:203], a[40:43], v[160:163]
    ds_read_b64_tr_b16 v[212:213], v238 offset:43008
    v_fma_f32 v227, v227, v233, v232
    v_mfma_f32_16x16x32_bf16 v[160:163], v[204:207], a[44:47], v[160:163]
    ds_read_b64_tr_b16 v[214:215], v238 offset:43264
    v_mul_f32 v227, v227, v71
    v_mfma_f32_16x16x32_bf16 v[168:171], v[204:207], a[108:111], v[168:171]
    ds_read_b64_tr_b16 v[216:217], v238 offset:45056
    v_mfma_f32_16x16x32_bf16 v[168:171], v[200:203], a[104:107], v[168:171]
    ds_read_b64_tr_b16 v[218:219], v238 offset:45312
    v_mfma_f32_16x16x32_bf16 v[168:171], v[196:199], a[100:103], v[168:171]
    ds_read_b64_tr_b16 v[220:221], v238 offset:47104
    v_mfma_f32_16x16x32_bf16 v[168:171], v[192:195], a[96:99], v[168:171]
    ds_read_b64_tr_b16 v[222:223], v238 offset:47360
    v_mfma_f32_16x16x32_bf16 v[176:179], v[192:195], a[160:163], v[176:179]
    buffer_load_dwordx4 v241, s[8:11], s57 offen offset:3072 lds
    v_mfma_f32_16x16x32_bf16 v[176:179], v[196:199], a[164:167], v[176:179]
    v_rcp_f32 v230, v230
    v_mfma_f32_16x16x32_bf16 v[176:179], v[200:203], a[168:171], v[176:179]
    s_add_u32 m0, s53, 81920
    s_add_u32 s57, s65, 3145728
    v_mul_f32 v78, v78, v230
    v_mfma_f32_16x16x32_bf16 v[176:179], v[204:207], a[172:175], v[176:179]
    v_mul_f32 v231, v79, v79
    v_fma_f32 v231, v231, v233, v232
    v_mfma_f32_16x16x32_bf16 v[184:187], v[204:207], a[236:239], v[184:187]
    v_mul_f32 v231, v231, v79
    v_mfma_f32_16x16x32_bf16 v[184:187], v[200:203], a[232:235], v[184:187]
    buffer_load_dwordx4 v241, s[8:11], s57 offen offset:0 lds
    v_mfma_f32_16x16x32_bf16 v[184:187], v[196:199], a[228:231], v[184:187]
    v_exp_f32 v227, v227
    v_mfma_f32_16x16x32_bf16 v[184:187], v[192:195], a[224:227], v[184:187]
    s_waitcnt lgkmcnt(4)
    v_mul_f32 v71, v71, v103
    v_add_f32 v227, 1.0, v227
    v_mfma_f32_16x16x32_bf16 v[164:167], v[208:211], a[32:35], v[164:167]
    ds_read_b64_tr_b16 v[192:193], v235 offset:49152
    v_mfma_f32_16x16x32_bf16 v[164:167], v[212:215], a[36:39], v[164:167]
    s_waitcnt lgkmcnt(1)
    ds_read_b64_tr_b16 v[194:195], v235 offset:49408
    v_mfma_f32_16x16x32_bf16 v[164:167], v[216:219], a[40:43], v[164:167]
    s_add_u32 s57, s65, 3275776
    ds_read_b64_tr_b16 v[196:197], v235 offset:51200
    v_mfma_f32_16x16x32_bf16 v[164:167], v[220:223], a[44:47], v[164:167]
    ds_read_b64_tr_b16 v[198:199], v235 offset:51456
    v_mfma_f32_16x16x32_bf16 v[172:175], v[220:223], a[108:111], v[172:175]
    ds_read_b64_tr_b16 v[200:201], v235 offset:53248
    v_mfma_f32_16x16x32_bf16 v[172:175], v[216:219], a[104:107], v[172:175]
    ds_read_b64_tr_b16 v[202:203], v235 offset:53504
    v_mfma_f32_16x16x32_bf16 v[172:175], v[212:215], a[100:103], v[172:175]
    ds_read_b64_tr_b16 v[204:205], v235 offset:55296
    v_mfma_f32_16x16x32_bf16 v[172:175], v[208:211], a[96:99], v[172:175]
    ds_read_b64_tr_b16 v[206:207], v235 offset:55552
    v_mfma_f32_16x16x32_bf16 v[180:183], v[208:211], a[160:163], v[180:183]
    buffer_load_dwordx4 v241, s[8:11], s57 offen offset:1024 lds
    v_mfma_f32_16x16x32_bf16 v[180:183], v[212:215], a[164:167], v[180:183]
    v_exp_f32 v231, v231
    v_mfma_f32_16x16x32_bf16 v[180:183], v[216:219], a[168:171], v[180:183]
    s_add_u32 s57, s65, 3405824
    v_mul_f32 v79, v79, v111
    v_add_f32 v231, 1.0, v231
    v_mfma_f32_16x16x32_bf16 v[180:183], v[220:223], a[172:175], v[180:183]
    v_rcp_f32 v227, v227
    v_mfma_f32_16x16x32_bf16 v[188:191], v[220:223], a[236:239], v[188:191]
    v_mul_f32 v71, v71, v227
    v_cvt_pk_bf16_f32 v64, v64, v65
    v_mfma_f32_16x16x32_bf16 v[188:191], v[216:219], a[232:235], v[188:191]
    buffer_load_dwordx4 v241, s[8:11], s57 offen offset:2048 lds
    v_mfma_f32_16x16x32_bf16 v[188:191], v[212:215], a[228:231], v[188:191]
    v_rcp_f32 v231, v231
    v_mfma_f32_16x16x32_bf16 v[188:191], v[208:211], a[224:227], v[188:191]
    s_waitcnt lgkmcnt(4)
    v_mul_f32 v79, v79, v231
    v_cvt_pk_bf16_f32 v65, v66, v67
    v_mfma_f32_16x16x32_bf16 v[128:131], v[192:195], a[48:51], v[128:131]
    ds_read_b64_tr_b16 v[208:209], v238 offset:49152
    v_cvt_pk_bf16_f32 v72, v72, v73
    v_mfma_f32_16x16x32_bf16 v[128:131], v[196:199], a[52:55], v[128:131]
    s_waitcnt lgkmcnt(1)
    ds_read_b64_tr_b16 v[210:211], v238 offset:49408
    v_cvt_pk_bf16_f32 v66, v68, v69
    v_mfma_f32_16x16x32_bf16 v[128:131], v[200:203], a[56:59], v[128:131]
    s_add_u32 s57, s65, 3535872
    ds_read_b64_tr_b16 v[212:213], v238 offset:51200
    v_cvt_pk_bf16_f32 v73, v74, v75
    v_mfma_f32_16x16x32_bf16 v[128:131], v[204:207], a[60:63], v[128:131]
    ds_read_b64_tr_b16 v[214:215], v238 offset:51456
    v_cvt_pk_bf16_f32 v67, v70, v71
    v_mfma_f32_16x16x32_bf16 v[136:139], v[204:207], a[124:127], v[136:139]
    ds_read_b64_tr_b16 v[216:217], v238 offset:53248
    v_cvt_pk_bf16_f32 v74, v76, v77
    v_mfma_f32_16x16x32_bf16 v[136:139], v[200:203], a[120:123], v[136:139]
    ds_read_b64_tr_b16 v[218:219], v238 offset:53504
    v_mul_f32 v224, v80, v80
    v_mfma_f32_16x16x32_bf16 v[136:139], v[196:199], a[116:119], v[136:139]
    ds_read_b64_tr_b16 v[220:221], v238 offset:55296
    v_cvt_pk_bf16_f32 v75, v78, v79
    v_mfma_f32_16x16x32_bf16 v[136:139], v[192:195], a[112:115], v[136:139]
    ds_read_b64_tr_b16 v[222:223], v238 offset:55552
    v_fma_f32 v224, v224, v233, v232
    v_mfma_f32_16x16x32_bf16 v[144:147], v[192:195], a[176:179], v[144:147]
    buffer_load_dwordx4 v241, s[8:11], s57 offen offset:3072 lds
    v_mfma_f32_16x16x32_bf16 v[144:147], v[196:199], a[180:183], v[144:147]
    v_mul_f32 v228, v88, v88
    v_mul_f32 v224, v224, v80
    v_mfma_f32_16x16x32_bf16 v[144:147], v[200:203], a[184:187], v[144:147]
    v_fma_f32 v228, v228, v233, v232
    v_mul_f32 v228, v228, v88
    v_mfma_f32_16x16x32_bf16 v[144:147], v[204:207], a[188:191], v[144:147]
    v_exp_f32 v224, v224
    v_mfma_f32_16x16x32_bf16 v[152:155], v[204:207], a[252:255], v[152:155]
    v_mul_f32 v80, v80, v112
    v_add_f32 v224, 1.0, v224
    v_mfma_f32_16x16x32_bf16 v[152:155], v[200:203], a[248:251], v[152:155]
    v_exp_f32 v228, v228
    v_mfma_f32_16x16x32_bf16 v[152:155], v[196:199], a[244:247], v[152:155]
    v_mul_f32 v88, v88, v120
    v_add_f32 v228, 1.0, v228
    v_mfma_f32_16x16x32_bf16 v[152:155], v[192:195], a[240:243], v[152:155]
    s_waitcnt lgkmcnt(4)
    v_rcp_f32 v224, v224
    v_mfma_f32_16x16x32_bf16 v[132:135], v[208:211], a[48:51], v[132:135]
    ds_read_b64_tr_b16 v[192:193], v235 offset:57344
    v_mul_f32 v80, v80, v224
    v_mfma_f32_16x16x32_bf16 v[132:135], v[212:215], a[52:55], v[132:135]
    s_waitcnt lgkmcnt(1)
    ds_read_b64_tr_b16 v[194:195], v235 offset:57600
    v_mul_f32 v225, v81, v81
    v_mfma_f32_16x16x32_bf16 v[132:135], v[216:219], a[56:59], v[132:135]
    ds_read_b64_tr_b16 v[196:197], v235 offset:59392
    v_fma_f32 v225, v225, v233, v232
    v_mfma_f32_16x16x32_bf16 v[132:135], v[220:223], a[60:63], v[132:135]
    ds_read_b64_tr_b16 v[198:199], v235 offset:59648
    v_mul_f32 v225, v225, v81
    v_mfma_f32_16x16x32_bf16 v[140:143], v[220:223], a[124:127], v[140:143]
    ds_read_b64_tr_b16 v[200:201], v235 offset:61440
    v_mfma_f32_16x16x32_bf16 v[140:143], v[216:219], a[120:123], v[140:143]
    ds_read_b64_tr_b16 v[202:203], v235 offset:61696
    v_mfma_f32_16x16x32_bf16 v[140:143], v[212:215], a[116:119], v[140:143]
    ds_read_b64_tr_b16 v[204:205], v235 offset:63488
    v_mfma_f32_16x16x32_bf16 v[140:143], v[208:211], a[112:115], v[140:143]
    ds_read_b64_tr_b16 v[206:207], v235 offset:63744
    v_mfma_f32_16x16x32_bf16 v[148:151], v[208:211], a[176:179], v[148:151]
    v_rcp_f32 v228, v228
    v_mfma_f32_16x16x32_bf16 v[148:151], v[212:215], a[180:183], v[148:151]
    v_mul_f32 v88, v88, v228
    v_mul_f32 v229, v89, v89
    v_mfma_f32_16x16x32_bf16 v[148:151], v[216:219], a[184:187], v[148:151]
    v_fma_f32 v229, v229, v233, v232
    v_mul_f32 v229, v229, v89
    v_mfma_f32_16x16x32_bf16 v[148:151], v[220:223], a[188:191], v[148:151]
    v_exp_f32 v225, v225
    v_mfma_f32_16x16x32_bf16 v[156:159], v[220:223], a[252:255], v[156:159]
    v_mul_f32 v81, v81, v113
    v_add_f32 v225, 1.0, v225
    v_mfma_f32_16x16x32_bf16 v[156:159], v[216:219], a[248:251], v[156:159]
    v_exp_f32 v229, v229
    v_mfma_f32_16x16x32_bf16 v[156:159], v[212:215], a[244:247], v[156:159]
    v_mul_f32 v89, v89, v121
    v_add_f32 v229, 1.0, v229
    v_mfma_f32_16x16x32_bf16 v[156:159], v[208:211], a[240:243], v[156:159]
    s_waitcnt lgkmcnt(4)
    v_rcp_f32 v225, v225
    v_mfma_f32_16x16x32_bf16 v[160:163], v[192:195], a[48:51], v[160:163]
    ds_read_b64_tr_b16 v[208:209], v238 offset:57344
    v_mul_f32 v81, v81, v225
    v_mfma_f32_16x16x32_bf16 v[160:163], v[196:199], a[52:55], v[160:163]
    s_waitcnt lgkmcnt(1)
    ds_read_b64_tr_b16 v[210:211], v238 offset:57600
    v_mul_f32 v226, v82, v82
    v_mfma_f32_16x16x32_bf16 v[160:163], v[200:203], a[56:59], v[160:163]
    ds_read_b64_tr_b16 v[212:213], v238 offset:59392
    v_fma_f32 v226, v226, v233, v232
    v_mfma_f32_16x16x32_bf16 v[160:163], v[204:207], a[60:63], v[160:163]
    ds_read_b64_tr_b16 v[214:215], v238 offset:59648
    v_mul_f32 v226, v226, v82
    v_mfma_f32_16x16x32_bf16 v[168:171], v[204:207], a[124:127], v[168:171]
    ds_read_b64_tr_b16 v[216:217], v238 offset:61440
    v_mfma_f32_16x16x32_bf16 v[168:171], v[200:203], a[120:123], v[168:171]
    ds_read_b64_tr_b16 v[218:219], v238 offset:61696
    v_mfma_f32_16x16x32_bf16 v[168:171], v[196:199], a[116:119], v[168:171]
    ds_read_b64_tr_b16 v[220:221], v238 offset:63488
    v_mfma_f32_16x16x32_bf16 v[168:171], v[192:195], a[112:115], v[168:171]
    ds_read_b64_tr_b16 v[222:223], v238 offset:63744
    v_mfma_f32_16x16x32_bf16 v[176:179], v[192:195], a[176:179], v[176:179]
    v_rcp_f32 v229, v229
    v_mfma_f32_16x16x32_bf16 v[176:179], v[196:199], a[180:183], v[176:179]
    v_mul_f32 v89, v89, v229
    v_mul_f32 v230, v90, v90
    v_mfma_f32_16x16x32_bf16 v[176:179], v[200:203], a[184:187], v[176:179]
    s_waitcnt lgkmcnt(0)
    s_add_u32 m0, s53, 98304
    s_add_u32 s57, s65, 128
    v_mfma_f32_16x16x32_bf16 v[176:179], v[204:207], a[188:191], v[176:179]
    v_fma_f32 v230, v230, v233, v232
    v_mul_f32 v230, v230, v90
    v_mfma_f32_16x16x32_bf16 v[184:187], v[204:207], a[252:255], v[184:187]
    s_waitcnt vmcnt(5)
    s_barrier
    v_mfma_f32_16x16x32_bf16 v[184:187], v[200:203], a[248:251], v[184:187]
    buffer_load_dwordx4 v241, s[8:11], s57 offen offset:0 lds
    v_mfma_f32_16x16x32_bf16 v[184:187], v[196:199], a[244:247], v[184:187]
    buffer_store_dword v249, v248, s[20:23], s3 offen sc1
    v_exp_f32 v226, v226
    v_mfma_f32_16x16x32_bf16 v[184:187], v[192:195], a[240:243], v[184:187]
    v_mul_f32 v82, v82, v114
    v_add_f32 v226, 1.0, v226
    v_mfma_f32_16x16x32_bf16 v[164:167], v[208:211], a[48:51], v[164:167]
    ds_read_b64_tr_b16 v[192:193], v236 offset:0
    v_mfma_f32_16x16x32_bf16 v[164:167], v[212:215], a[52:55], v[164:167]
    ds_read_b64_tr_b16 v[194:195], v236 offset:256
    v_mfma_f32_16x16x32_bf16 v[164:167], v[216:219], a[56:59], v[164:167]
    s_add_u32 s57, s65, 130176
    ds_read_b64_tr_b16 v[196:197], v236 offset:2048
    v_mfma_f32_16x16x32_bf16 v[164:167], v[220:223], a[60:63], v[164:167]
    ds_read_b64_tr_b16 v[198:199], v236 offset:2304
    v_mfma_f32_16x16x32_bf16 v[172:175], v[220:223], a[124:127], v[172:175]
    ds_read_b64_tr_b16 v[200:201], v236 offset:4096
    v_mfma_f32_16x16x32_bf16 v[172:175], v[216:219], a[120:123], v[172:175]
    ds_read_b64_tr_b16 v[202:203], v236 offset:4352
    v_mfma_f32_16x16x32_bf16 v[172:175], v[212:215], a[116:119], v[172:175]
    ds_read_b64_tr_b16 v[204:205], v236 offset:6144
    v_mfma_f32_16x16x32_bf16 v[172:175], v[208:211], a[112:115], v[172:175]
    ds_read_b64_tr_b16 v[206:207], v236 offset:6400
    v_mfma_f32_16x16x32_bf16 v[180:183], v[208:211], a[176:179], v[180:183]
    buffer_load_dwordx4 v241, s[8:11], s57 offen offset:1024 lds
    v_mfma_f32_16x16x32_bf16 v[180:183], v[212:215], a[180:183], v[180:183]
    v_exp_f32 v230, v230
    v_mfma_f32_16x16x32_bf16 v[180:183], v[216:219], a[184:187], v[180:183]
    s_add_u32 s57, s65, 260224
    v_mul_f32 v90, v90, v122
    v_add_f32 v230, 1.0, v230
    v_mfma_f32_16x16x32_bf16 v[180:183], v[220:223], a[188:191], v[180:183]
    v_rcp_f32 v226, v226
    v_mfma_f32_16x16x32_bf16 v[188:191], v[220:223], a[252:255], v[188:191]
    v_mul_f32 v82, v82, v226
    v_mul_f32 v227, v83, v83
    v_mfma_f32_16x16x32_bf16 v[188:191], v[216:219], a[248:251], v[188:191]
    buffer_load_dwordx4 v241, s[8:11], s57 offen offset:2048 lds
    v_mfma_f32_16x16x32_bf16 v[188:191], v[212:215], a[244:247], v[188:191]
    v_rcp_f32 v230, v230
    v_mfma_f32_16x16x32_bf16 v[188:191], v[208:211], a[240:243], v[188:191]
    s_waitcnt lgkmcnt(4)
    v_mul_f32 v90, v90, v230
    v_fma_f32 v227, v227, v233, v232
    v_mfma_f32_16x16x32_bf16 v[0:3], v[192:195], a[0:3], 0
    ds_read_b64_tr_b16 v[208:209], v239 offset:0
    v_mul_f32 v231, v91, v91
    v_mfma_f32_16x16x32_bf16 v[0:3], v[196:199], a[4:7], v[0:3]
    s_waitcnt lgkmcnt(1)
    ds_read_b64_tr_b16 v[210:211], v239 offset:256
    v_mul_f32 v227, v227, v83
    v_mfma_f32_16x16x32_bf16 v[0:3], v[200:203], a[8:11], v[0:3]
    s_add_u32 s57, s65, 390272
    ds_read_b64_tr_b16 v[212:213], v239 offset:2048
    v_fma_f32 v231, v231, v233, v232
    v_mfma_f32_16x16x32_bf16 v[0:3], v[204:207], a[12:15], v[0:3]
    ds_read_b64_tr_b16 v[214:215], v239 offset:2304
    v_mul_f32 v231, v231, v91
    v_mfma_f32_16x16x32_bf16 v[8:11], v[204:207], a[76:79], 0
    ds_read_b64_tr_b16 v[216:217], v239 offset:4096
    v_mfma_f32_16x16x32_bf16 v[8:11], v[200:203], a[72:75], v[8:11]
    ds_read_b64_tr_b16 v[218:219], v239 offset:4352
    v_mfma_f32_16x16x32_bf16 v[8:11], v[196:199], a[68:71], v[8:11]
    ds_read_b64_tr_b16 v[220:221], v239 offset:6144
    v_mfma_f32_16x16x32_bf16 v[8:11], v[192:195], a[64:67], v[8:11]
    ds_read_b64_tr_b16 v[222:223], v239 offset:6400
    v_mfma_f32_16x16x32_bf16 v[16:19], v[192:195], a[128:131], 0
    buffer_load_dwordx4 v241, s[8:11], s57 offen offset:3072 lds
    v_mfma_f32_16x16x32_bf16 v[16:19], v[196:199], a[132:135], v[16:19]
    s_add_u32 m0, s53, 114688
    s_add_u32 s57, s65, 1048704
    v_mfma_f32_16x16x32_bf16 v[16:19], v[200:203], a[136:139], v[16:19]
    buffer_load_dwordx4 v241, s[8:11], s57 offen offset:0 lds
    v_mfma_f32_16x16x32_bf16 v[16:19], v[204:207], a[140:143], v[16:19]
    s_add_u32 s57, s65, 1178752
    buffer_load_dwordx4 v241, s[8:11], s57 offen offset:1024 lds
    v_mfma_f32_16x16x32_bf16 v[24:27], v[204:207], a[204:207], 0
    s_add_u32 s57, s65, 1308800
    buffer_load_dwordx4 v241, s[8:11], s57 offen offset:2048 lds
    v_mfma_f32_16x16x32_bf16 v[24:27], v[200:203], a[200:203], v[24:27]
    s_add_u32 s57, s65, 1438848
    buffer_load_dwordx4 v241, s[8:11], s57 offen offset:3072 lds
    v_mfma_f32_16x16x32_bf16 v[24:27], v[196:199], a[196:199], v[24:27]
    v_exp_f32 v227, v227
    v_mfma_f32_16x16x32_bf16 v[24:27], v[192:195], a[192:195], v[24:27]
    s_waitcnt lgkmcnt(4)
    v_mul_f32 v83, v83, v115
    v_add_f32 v227, 1.0, v227
    v_mfma_f32_16x16x32_bf16 v[4:7], v[208:211], a[0:3], 0
    ds_read_b64_tr_b16 v[192:193], v236 offset:8192
    v_mfma_f32_16x16x32_bf16 v[4:7], v[212:215], a[4:7], v[4:7]
    s_waitcnt lgkmcnt(1)
    ds_read_b64_tr_b16 v[194:195], v236 offset:8448
    v_mfma_f32_16x16x32_bf16 v[4:7], v[216:219], a[8:11], v[4:7]
    ds_read_b64_tr_b16 v[196:197], v236 offset:10240
    v_mfma_f32_16x16x32_bf16 v[4:7], v[220:223], a[12:15], v[4:7]
    ds_read_b64_tr_b16 v[198:199], v236 offset:10496
    v_mfma_f32_16x16x32_bf16 v[12:15], v[220:223], a[76:79], 0
    ds_read_b64_tr_b16 v[200:201], v236 offset:12288
    v_mfma_f32_16x16x32_bf16 v[12:15], v[216:219], a[72:75], v[12:15]
    ds_read_b64_tr_b16 v[202:203], v236 offset:12544
    v_mfma_f32_16x16x32_bf16 v[12:15], v[212:215], a[68:71], v[12:15]
    ds_read_b64_tr_b16 v[204:205], v236 offset:14336
    v_mfma_f32_16x16x32_bf16 v[12:15], v[208:211], a[64:67], v[12:15]
    ds_read_b64_tr_b16 v[206:207], v236 offset:14592
    v_mfma_f32_16x16x32_bf16 v[20:23], v[208:211], a[128:131], 0
    v_exp_f32 v231, v231
    v_mfma_f32_16x16x32_bf16 v[20:23], v[212:215], a[132:135], v[20:23]
    v_mul_f32 v91, v91, v123
    v_add_f32 v231, 1.0, v231
    v_mfma_f32_16x16x32_bf16 v[20:23], v[216:219], a[136:139], v[20:23]
    v_rcp_f32 v227, v227
    v_mfma_f32_16x16x32_bf16 v[20:23], v[220:223], a[140:143], v[20:23]
    v_mul_f32 v83, v83, v227
    v_mul_f32 v224, v84, v84
    v_mfma_f32_16x16x32_bf16 v[28:31], v[220:223], a[204:207], 0
    v_rcp_f32 v231, v231
    v_mfma_f32_16x16x32_bf16 v[28:31], v[216:219], a[200:203], v[28:31]
    v_mul_f32 v91, v91, v231
    v_fma_f32 v224, v224, v233, v232
    v_mfma_f32_16x16x32_bf16 v[28:31], v[212:215], a[196:199], v[28:31]
    v_mul_f32 v228, v92, v92
    v_mul_f32 v224, v224, v84
    v_mfma_f32_16x16x32_bf16 v[28:31], v[208:211], a[192:195], v[28:31]
    s_waitcnt lgkmcnt(4)
    v_fma_f32 v228, v228, v233, v232
    v_mul_f32 v228, v228, v92
    v_mfma_f32_16x16x32_bf16 v[32:35], v[192:195], a[0:3], 0
    ds_read_b64_tr_b16 v[208:209], v239 offset:8192
    v_mfma_f32_16x16x32_bf16 v[32:35], v[196:199], a[4:7], v[32:35]
    s_waitcnt lgkmcnt(1)
    ds_read_b64_tr_b16 v[210:211], v239 offset:8448
    v_mfma_f32_16x16x32_bf16 v[32:35], v[200:203], a[8:11], v[32:35]
    ds_read_b64_tr_b16 v[212:213], v239 offset:10240
    v_mfma_f32_16x16x32_bf16 v[32:35], v[204:207], a[12:15], v[32:35]
    ds_read_b64_tr_b16 v[214:215], v239 offset:10496
    v_mfma_f32_16x16x32_bf16 v[40:43], v[204:207], a[76:79], 0
    ds_read_b64_tr_b16 v[216:217], v239 offset:12288
    v_mfma_f32_16x16x32_bf16 v[40:43], v[200:203], a[72:75], v[40:43]
    ds_read_b64_tr_b16 v[218:219], v239 offset:12544
    v_mfma_f32_16x16x32_bf16 v[40:43], v[196:199], a[68:71], v[40:43]
    ds_read_b64_tr_b16 v[220:221], v239 offset:14336
    v_mfma_f32_16x16x32_bf16 v[40:43], v[192:195], a[64:67], v[40:43]
    ds_read_b64_tr_b16 v[222:223], v239 offset:14592
    v_mfma_f32_16x16x32_bf16 v[48:51], v[192:195], a[128:131], 0
    v_exp_f32 v224, v224
    v_mfma_f32_16x16x32_bf16 v[48:51], v[196:199], a[132:135], v[48:51]
    v_mul_f32 v84, v84, v116
    v_add_f32 v224, 1.0, v224
    v_mfma_f32_16x16x32_bf16 v[48:51], v[200:203], a[136:139], v[48:51]
    v_exp_f32 v228, v228
    v_mfma_f32_16x16x32_bf16 v[48:51], v[204:207], a[140:143], v[48:51]
    v_mul_f32 v92, v92, v124
    v_add_f32 v228, 1.0, v228
    v_mfma_f32_16x16x32_bf16 v[56:59], v[204:207], a[204:207], 0
    v_rcp_f32 v224, v224
    v_mfma_f32_16x16x32_bf16 v[56:59], v[200:203], a[200:203], v[56:59]
    v_mul_f32 v84, v84, v224
    v_mul_f32 v225, v85, v85
    v_mfma_f32_16x16x32_bf16 v[56:59], v[196:199], a[196:199], v[56:59]
    v_rcp_f32 v228, v228
    v_mfma_f32_16x16x32_bf16 v[56:59], v[192:195], a[192:195], v[56:59]
    s_waitcnt lgkmcnt(4)
    v_mul_f32 v92, v92, v228
    v_fma_f32 v225, v225, v233, v232
    v_mfma_f32_16x16x32_bf16 v[36:39], v[208:211], a[0:3], 0
    ds_read_b64_tr_b16 v[192:193], v236 offset:16384
    v_mul_f32 v229, v93, v93
    v_mfma_f32_16x16x32_bf16 v[36:39], v[212:215], a[4:7], v[36:39]
    s_waitcnt lgkmcnt(1)
    ds_read_b64_tr_b16 v[194:195], v236 offset:16640
    v_mul_f32 v225, v225, v85
    v_mfma_f32_16x16x32_bf16 v[36:39], v[216:219], a[8:11], v[36:39]
    ds_read_b64_tr_b16 v[196:197], v236 offset:18432
    v_fma_f32 v229, v229, v233, v232
    v_mfma_f32_16x16x32_bf16 v[36:39], v[220:223], a[12:15], v[36:39]
    ds_read_b64_tr_b16 v[198:199], v236 offset:18688
    v_mul_f32 v229, v229, v93
    v_mfma_f32_16x16x32_bf16 v[44:47], v[220:223], a[76:79], 0
    ds_read_b64_tr_b16 v[200:201], v236 offset:20480
    v_mfma_f32_16x16x32_bf16 v[44:47], v[216:219], a[72:75], v[44:47]
    ds_read_b64_tr_b16 v[202:203], v236 offset:20736
    v_mfma_f32_16x16x32_bf16 v[44:47], v[212:215], a[68:71], v[44:47]
    ds_read_b64_tr_b16 v[204:205], v236 offset:22528
    v_mfma_f32_16x16x32_bf16 v[44:47], v[208:211], a[64:67], v[44:47]
    ds_read_b64_tr_b16 v[206:207], v236 offset:22784
    v_mfma_f32_16x16x32_bf16 v[52:55], v[208:211], a[128:131], 0
    v_exp_f32 v225, v225
    v_mfma_f32_16x16x32_bf16 v[52:55], v[212:215], a[132:135], v[52:55]
    v_mul_f32 v85, v85, v117
    v_add_f32 v225, 1.0, v225
    v_mfma_f32_16x16x32_bf16 v[52:55], v[216:219], a[136:139], v[52:55]
    v_exp_f32 v229, v229
    v_mfma_f32_16x16x32_bf16 v[52:55], v[220:223], a[140:143], v[52:55]
    v_mul_f32 v93, v93, v125
    v_add_f32 v229, 1.0, v229
    v_mfma_f32_16x16x32_bf16 v[60:63], v[220:223], a[204:207], 0
    v_rcp_f32 v225, v225
    v_mfma_f32_16x16x32_bf16 v[60:63], v[216:219], a[200:203], v[60:63]
    v_mul_f32 v85, v85, v225
    v_mul_f32 v226, v86, v86
    v_mfma_f32_16x16x32_bf16 v[60:63], v[212:215], a[196:199], v[60:63]
    v_rcp_f32 v229, v229
    v_mfma_f32_16x16x32_bf16 v[60:63], v[208:211], a[192:195], v[60:63]
    s_waitcnt lgkmcnt(4)
    v_mul_f32 v93, v93, v229
    v_fma_f32 v226, v226, v233, v232
    v_mfma_f32_16x16x32_bf16 v[0:3], v[192:195], a[16:19], v[0:3]
    ds_read_b64_tr_b16 v[208:209], v239 offset:16384
    v_mul_f32 v230, v94, v94
    v_mfma_f32_16x16x32_bf16 v[0:3], v[196:199], a[20:23], v[0:3]
    s_waitcnt lgkmcnt(1)
    ds_read_b64_tr_b16 v[210:211], v239 offset:16640
    v_mul_f32 v226, v226, v86
    v_mfma_f32_16x16x32_bf16 v[0:3], v[200:203], a[24:27], v[0:3]
    ds_read_b64_tr_b16 v[212:213], v239 offset:18432
    v_fma_f32 v230, v230, v233, v232
    v_mfma_f32_16x16x32_bf16 v[0:3], v[204:207], a[28:31], v[0:3]
    ds_read_b64_tr_b16 v[214:215], v239 offset:18688
    v_mul_f32 v230, v230, v94
    v_mfma_f32_16x16x32_bf16 v[8:11], v[204:207], a[92:95], v[8:11]
    ds_read_b64_tr_b16 v[216:217], v239 offset:20480
    v_mfma_f32_16x16x32_bf16 v[8:11], v[200:203], a[88:91], v[8:11]
    ds_read_b64_tr_b16 v[218:219], v239 offset:20736
    v_mfma_f32_16x16x32_bf16 v[8:11], v[196:199], a[84:87], v[8:11]
    ds_read_b64_tr_b16 v[220:221], v239 offset:22528
    v_mfma_f32_16x16x32_bf16 v[8:11], v[192:195], a[80:83], v[8:11]
    ds_read_b64_tr_b16 v[222:223], v239 offset:22784
    v_mfma_f32_16x16x32_bf16 v[16:19], v[192:195], a[144:147], v[16:19]
    v_exp_f32 v226, v226
    v_mfma_f32_16x16x32_bf16 v[16:19], v[196:199], a[148:151], v[16:19]
    v_mul_f32 v86, v86, v118
    v_add_f32 v226, 1.0, v226
    v_mfma_f32_16x16x32_bf16 v[16:19], v[200:203], a[152:155], v[16:19]
    v_exp_f32 v230, v230
    v_mfma_f32_16x16x32_bf16 v[16:19], v[204:207], a[156:159], v[16:19]
    v_mul_f32 v94, v94, v126
    v_add_f32 v230, 1.0, v230
    v_mfma_f32_16x16x32_bf16 v[24:27], v[204:207], a[220:223], v[24:27]
    v_rcp_f32 v226, v226
    v_mfma_f32_16x16x32_bf16 v[24:27], v[200:203], a[216:219], v[24:27]
    v_mul_f32 v86, v86, v226
    v_mul_f32 v227, v87, v87
    v_mfma_f32_16x16x32_bf16 v[24:27], v[196:199], a[212:215], v[24:27]
    v_rcp_f32 v230, v230
    v_mfma_f32_16x16x32_bf16 v[24:27], v[192:195], a[208:211], v[24:27]
    s_waitcnt lgkmcnt(4)
    v_mul_f32 v94, v94, v230
    v_fma_f32 v227, v227, v233, v232
    v_mfma_f32_16x16x32_bf16 v[4:7], v[208:211], a[16:19], v[4:7]
    ds_read_b64_tr_b16 v[192:193], v236 offset:24576
    v_mul_f32 v231, v95, v95
    v_mfma_f32_16x16x32_bf16 v[4:7], v[212:215], a[20:23], v[4:7]
    s_waitcnt lgkmcnt(1)
    ds_read_b64_tr_b16 v[194:195], v236 offset:24832
    v_mul_f32 v227, v227, v87
    v_mfma_f32_16x16x32_bf16 v[4:7], v[216:219], a[24:27], v[4:7]
    ds_read_b64_tr_b16 v[196:197], v236 offset:26624
    v_fma_f32 v231, v231, v233, v232
    v_mfma_f32_16x16x32_bf16 v[4:7], v[220:223], a[28:31], v[4:7]
    ds_read_b64_tr_b16 v[198:199], v236 offset:26880
    v_mul_f32 v231, v231, v95
    v_mfma_f32_16x16x32_bf16 v[12:15], v[220:223], a[92:95], v[12:15]
    ds_read_b64_tr_b16 v[200:201], v236 offset:28672
    v_mfma_f32_16x16x32_bf16 v[12:15], v[216:219], a[88:91], v[12:15]
    ds_read_b64_tr_b16 v[202:203], v236 offset:28928
    v_mfma_f32_16x16x32_bf16 v[12:15], v[212:215], a[84:87], v[12:15]
    ds_read_b64_tr_b16 v[204:205], v236 offset:30720
    v_mfma_f32_16x16x32_bf16 v[12:15], v[208:211], a[80:83], v[12:15]
    ds_read_b64_tr_b16 v[206:207], v236 offset:30976
    v_mfma_f32_16x16x32_bf16 v[20:23], v[208:211], a[144:147], v[20:23]
    v_exp_f32 v227, v227
    v_mfma_f32_16x16x32_bf16 v[20:23], v[212:215], a[148:151], v[20:23]
    v_mul_f32 v87, v87, v119
    v_add_f32 v227, 1.0, v227
    v_mfma_f32_16x16x32_bf16 v[20:23], v[216:219], a[152:155], v[20:23]
    v_exp_f32 v231, v231
    v_mfma_f32_16x16x32_bf16 v[20:23], v[220:223], a[156:159], v[20:23]
    v_mul_f32 v95, v95, v127
    v_add_f32 v231, 1.0, v231
    v_mfma_f32_16x16x32_bf16 v[28:31], v[220:223], a[220:223], v[28:31]
    v_rcp_f32 v227, v227
    v_mfma_f32_16x16x32_bf16 v[28:31], v[216:219], a[216:219], v[28:31]
    v_mul_f32 v87, v87, v227
    v_cvt_pk_bf16_f32 v80, v80, v81
    v_mfma_f32_16x16x32_bf16 v[28:31], v[212:215], a[212:215], v[28:31]
    v_rcp_f32 v231, v231
    v_mfma_f32_16x16x32_bf16 v[28:31], v[208:211], a[208:211], v[28:31]
    s_waitcnt lgkmcnt(4)
    v_mul_f32 v95, v95, v231
    v_cvt_pk_bf16_f32 v81, v82, v83
    v_mfma_f32_16x16x32_bf16 v[32:35], v[192:195], a[16:19], v[32:35]
    ds_read_b64_tr_b16 v[208:209], v239 offset:24576
    v_cvt_pk_bf16_f32 v88, v88, v89
    v_mfma_f32_16x16x32_bf16 v[32:35], v[196:199], a[20:23], v[32:35]
    s_waitcnt lgkmcnt(1)
    ds_read_b64_tr_b16 v[210:211], v239 offset:24832
    v_cvt_pk_bf16_f32 v82, v84, v85
    v_mfma_f32_16x16x32_bf16 v[32:35], v[200:203], a[24:27], v[32:35]
    ds_read_b64_tr_b16 v[212:213], v239 offset:26624
    v_cvt_pk_bf16_f32 v89, v90, v91
    v_mfma_f32_16x16x32_bf16 v[32:35], v[204:207], a[28:31], v[32:35]
    ds_read_b64_tr_b16 v[214:215], v239 offset:26880
    v_cvt_pk_bf16_f32 v83, v86, v87
    v_mfma_f32_16x16x32_bf16 v[40:43], v[204:207], a[92:95], v[40:43]
    ds_read_b64_tr_b16 v[216:217], v239 offset:28672
    v_cvt_pk_bf16_f32 v90, v92, v93
    v_mfma_f32_16x16x32_bf16 v[40:43], v[200:203], a[88:91], v[40:43]
    ds_read_b64_tr_b16 v[218:219], v239 offset:28928
    v_cvt_pk_bf16_f32 v91, v94, v95
    v_mfma_f32_16x16x32_bf16 v[40:43], v[196:199], a[84:87], v[40:43]
    ds_read_b64_tr_b16 v[220:221], v239 offset:30720
    v_mul_f32 v224, v128, v128
    v_mfma_f32_16x16x32_bf16 v[40:43], v[192:195], a[80:83], v[40:43]
    ds_read_b64_tr_b16 v[222:223], v239 offset:30976
    v_fma_f32 v224, v224, v233, v232
    v_mfma_f32_16x16x32_bf16 v[48:51], v[192:195], a[144:147], v[48:51]
    buffer_store_dwordx4 v[64:67], v240, s[20:23], s100 offen sc1
    v_mfma_f32_16x16x32_bf16 v[48:51], v[196:199], a[148:151], v[48:51]
    buffer_store_dwordx4 v[72:75], v246, s[20:23], s100 offen sc1
    v_mfma_f32_16x16x32_bf16 v[48:51], v[200:203], a[152:155], v[48:51]
    s_waitcnt lgkmcnt(0)
    s_add_u32 m0, s53, 131072
    s_add_u32 s57, s65, 2097280
    v_mfma_f32_16x16x32_bf16 v[48:51], v[204:207], a[156:159], v[48:51]
    buffer_store_dwordx4 v[80:83], v240, s[20:23], s101 offen sc1
    v_mfma_f32_16x16x32_bf16 v[56:59], v[204:207], a[220:223], v[56:59]
    s_waitcnt vmcnt(12)
    s_barrier
    v_mul_f32 v228, v136, v136
    v_mfma_f32_16x16x32_bf16 v[56:59], v[200:203], a[216:219], v[56:59]
    buffer_load_dwordx4 v241, s[8:11], s57 offen offset:0 lds
    v_mfma_f32_16x16x32_bf16 v[56:59], v[196:199], a[212:215], v[56:59]
    buffer_store_dwordx4 v[88:91], v246, s[20:23], s101 offen sc1
    v_mfma_f32_16x16x32_bf16 v[56:59], v[192:195], a[208:211], v[56:59]
    v_mul_f32 v224, v224, v128
    v_fma_f32 v228, v228, v233, v232
    v_mfma_f32_16x16x32_bf16 v[36:39], v[208:211], a[16:19], v[36:39]
    ds_read_b64_tr_b16 v[192:193], v235 offset:0
    v_mul_f32 v228, v228, v136
    v_mfma_f32_16x16x32_bf16 v[36:39], v[212:215], a[20:23], v[36:39]
    ds_read_b64_tr_b16 v[194:195], v235 offset:256
    v_mfma_f32_16x16x32_bf16 v[36:39], v[216:219], a[24:27], v[36:39]
    s_add_u32 s57, s65, 2227328
    ds_read_b64_tr_b16 v[196:197], v235 offset:2048
    v_mfma_f32_16x16x32_bf16 v[36:39], v[220:223], a[28:31], v[36:39]
    ds_read_b64_tr_b16 v[198:199], v235 offset:2304
    v_mfma_f32_16x16x32_bf16 v[44:47], v[220:223], a[92:95], v[44:47]
    ds_read_b64_tr_b16 v[200:201], v235 offset:4096
    v_mfma_f32_16x16x32_bf16 v[44:47], v[216:219], a[88:91], v[44:47]
    ds_read_b64_tr_b16 v[202:203], v235 offset:4352
    v_mfma_f32_16x16x32_bf16 v[44:47], v[212:215], a[84:87], v[44:47]
    ds_read_b64_tr_b16 v[204:205], v235 offset:6144
    v_mfma_f32_16x16x32_bf16 v[44:47], v[208:211], a[80:83], v[44:47]
    ds_read_b64_tr_b16 v[206:207], v235 offset:6400
    v_mfma_f32_16x16x32_bf16 v[52:55], v[208:211], a[144:147], v[52:55]
    buffer_load_dwordx4 v241, s[8:11], s57 offen offset:1024 lds
    v_mfma_f32_16x16x32_bf16 v[52:55], v[212:215], a[148:151], v[52:55]
    v_exp_f32 v224, v224
    v_mfma_f32_16x16x32_bf16 v[52:55], v[216:219], a[152:155], v[52:55]
    s_add_u32 s57, s65, 2357376
    v_mul_f32 v128, v128, v160
    v_add_f32 v224, 1.0, v224
    v_mfma_f32_16x16x32_bf16 v[52:55], v[220:223], a[156:159], v[52:55]
    v_exp_f32 v228, v228
    v_mfma_f32_16x16x32_bf16 v[60:63], v[220:223], a[220:223], v[60:63]
    v_mul_f32 v136, v136, v168
    v_add_f32 v228, 1.0, v228
    v_mfma_f32_16x16x32_bf16 v[60:63], v[216:219], a[216:219], v[60:63]
    buffer_load_dwordx4 v241, s[8:11], s57 offen offset:2048 lds
    v_mfma_f32_16x16x32_bf16 v[60:63], v[212:215], a[212:215], v[60:63]
    v_rcp_f32 v224, v224
    v_mfma_f32_16x16x32_bf16 v[60:63], v[208:211], a[208:211], v[60:63]
    s_waitcnt lgkmcnt(4)
    v_mul_f32 v128, v128, v224
    v_mul_f32 v225, v129, v129
    v_mfma_f32_16x16x32_bf16 v[0:3], v[192:195], a[32:35], v[0:3]
    ds_read_b64_tr_b16 v[208:209], v238 offset:0
    v_and_b32 v243, 0x380, v252
    s_add_u32 s16, s20, s51
    s_addc_u32 s17, s21, 0
    v_mfma_f32_16x16x32_bf16 v[0:3], v[196:199], a[36:39], v[0:3]
    s_waitcnt lgkmcnt(1)
    ds_read_b64_tr_b16 v[210:211], v238 offset:256
    s_sub_u32 s18, 16, s30
    s_lshl_b32 s18, s18, 16
    v_mfma_f32_16x16x32_bf16 v[0:3], v[200:203], a[40:43], v[0:3]
    s_add_u32 s57, s65, 2487424
    ds_read_b64_tr_b16 v[212:213], v238 offset:2048
    v_fma_f32 v225, v225, v233, v232
    v_mfma_f32_16x16x32_bf16 v[0:3], v[204:207], a[44:47], v[0:3]
    ds_read_b64_tr_b16 v[214:215], v238 offset:2304
    v_mul_f32 v225, v225, v129
    v_mfma_f32_16x16x32_bf16 v[8:11], v[204:207], a[108:111], v[8:11]
    ds_read_b64_tr_b16 v[216:217], v238 offset:4096
    v_mfma_f32_16x16x32_bf16 v[8:11], v[200:203], a[104:107], v[8:11]
    ds_read_b64_tr_b16 v[218:219], v238 offset:4352
    v_mfma_f32_16x16x32_bf16 v[8:11], v[196:199], a[100:103], v[8:11]
    ds_read_b64_tr_b16 v[220:221], v238 offset:6144
    v_mfma_f32_16x16x32_bf16 v[8:11], v[192:195], a[96:99], v[8:11]
    ds_read_b64_tr_b16 v[222:223], v238 offset:6400
    v_mfma_f32_16x16x32_bf16 v[16:19], v[192:195], a[160:163], v[16:19]
    buffer_load_dwordx4 v241, s[8:11], s57 offen offset:3072 lds
    v_mfma_f32_16x16x32_bf16 v[16:19], v[196:199], a[164:167], v[16:19]
    s_add_u32 m0, s53, 147456
    s_add_u32 s57, s65, 3145856
    v_mfma_f32_16x16x32_bf16 v[16:19], v[200:203], a[168:171], v[16:19]
    buffer_load_dwordx4 v241, s[8:11], s57 offen offset:0 lds
    v_mfma_f32_16x16x32_bf16 v[16:19], v[204:207], a[172:175], v[16:19]
    s_add_u32 s57, s65, 3275904
    buffer_load_dwordx4 v241, s[8:11], s57 offen offset:1024 lds
    v_mfma_f32_16x16x32_bf16 v[24:27], v[204:207], a[236:239], v[24:27]
    s_add_u32 s57, s65, 3405952
    buffer_load_dwordx4 v241, s[8:11], s57 offen offset:2048 lds
    v_mfma_f32_16x16x32_bf16 v[24:27], v[200:203], a[232:235], v[24:27]
    s_add_u32 s57, s65, 3536000
    buffer_load_dwordx4 v241, s[8:11], s57 offen offset:3072 lds
    v_mfma_f32_16x16x32_bf16 v[24:27], v[196:199], a[228:231], v[24:27]
    v_rcp_f32 v228, v228
    v_mfma_f32_16x16x32_bf16 v[24:27], v[192:195], a[224:227], v[24:27]
    s_waitcnt lgkmcnt(4)
    v_mul_f32 v136, v136, v228
    v_mul_f32 v229, v137, v137
    v_mfma_f32_16x16x32_bf16 v[4:7], v[208:211], a[32:35], v[4:7]
    ds_read_b64_tr_b16 v[192:193], v235 offset:8192
    v_fma_f32 v229, v229, v233, v232
    v_mfma_f32_16x16x32_bf16 v[4:7], v[212:215], a[36:39], v[4:7]
    s_waitcnt lgkmcnt(1)
    ds_read_b64_tr_b16 v[194:195], v235 offset:8448
    v_mul_f32 v229, v229, v137
    v_mfma_f32_16x16x32_bf16 v[4:7], v[216:219], a[40:43], v[4:7]
    ds_read_b64_tr_b16 v[196:197], v235 offset:10240
    v_mfma_f32_16x16x32_bf16 v[4:7], v[220:223], a[44:47], v[4:7]
    ds_read_b64_tr_b16 v[198:199], v235 offset:10496
    v_mfma_f32_16x16x32_bf16 v[12:15], v[220:223], a[108:111], v[12:15]
    ds_read_b64_tr_b16 v[200:201], v235 offset:12288
    v_mfma_f32_16x16x32_bf16 v[12:15], v[216:219], a[104:107], v[12:15]
    ds_read_b64_tr_b16 v[202:203], v235 offset:12544
    v_mfma_f32_16x16x32_bf16 v[12:15], v[212:215], a[100:103], v[12:15]
    ds_read_b64_tr_b16 v[204:205], v235 offset:14336
    v_mfma_f32_16x16x32_bf16 v[12:15], v[208:211], a[96:99], v[12:15]
    ds_read_b64_tr_b16 v[206:207], v235 offset:14592
    v_mfma_f32_16x16x32_bf16 v[20:23], v[208:211], a[160:163], v[20:23]
    v_exp_f32 v225, v225
    v_mfma_f32_16x16x32_bf16 v[20:23], v[212:215], a[164:167], v[20:23]
    v_mul_f32 v129, v129, v161
    v_add_f32 v225, 1.0, v225
    v_mfma_f32_16x16x32_bf16 v[20:23], v[216:219], a[168:171], v[20:23]
    v_exp_f32 v229, v229
    v_mfma_f32_16x16x32_bf16 v[20:23], v[220:223], a[172:175], v[20:23]
    v_mul_f32 v137, v137, v169
    v_add_f32 v229, 1.0, v229
    v_mfma_f32_16x16x32_bf16 v[28:31], v[220:223], a[236:239], v[28:31]
    s_lshl_b32 s59, s29, 10
    v_rcp_f32 v225, v225
    v_mfma_f32_16x16x32_bf16 v[28:31], v[216:219], a[232:235], v[28:31]
    s_add_u32 s59, s59, 0x5010000
    v_mul_f32 v129, v129, v225
    v_mul_f32 v226, v130, v130
    v_mfma_f32_16x16x32_bf16 v[28:31], v[212:215], a[228:231], v[28:31]
    buffer_load_dword v244, v243, s[20:23], s59 offen sc1
    v_mfma_f32_16x16x32_bf16 v[28:31], v[208:211], a[224:227], v[28:31]
    s_waitcnt lgkmcnt(4)
    v_rcp_f32 v229, v229
    v_mfma_f32_16x16x32_bf16 v[32:35], v[192:195], a[32:35], v[32:35]
    ds_read_b64_tr_b16 v[208:209], v238 offset:8192
    v_mul_f32 v137, v137, v229
    v_mfma_f32_16x16x32_bf16 v[32:35], v[196:199], a[36:39], v[32:35]
    s_waitcnt lgkmcnt(1)
    ds_read_b64_tr_b16 v[210:211], v238 offset:8448
    v_fma_f32 v226, v226, v233, v232
    v_mfma_f32_16x16x32_bf16 v[32:35], v[200:203], a[40:43], v[32:35]
    ds_read_b64_tr_b16 v[212:213], v238 offset:10240
    v_mul_f32 v230, v138, v138
    v_mfma_f32_16x16x32_bf16 v[32:35], v[204:207], a[44:47], v[32:35]
    ds_read_b64_tr_b16 v[214:215], v238 offset:10496
    v_mul_f32 v226, v226, v130
    v_mfma_f32_16x16x32_bf16 v[40:43], v[204:207], a[108:111], v[40:43]
    ds_read_b64_tr_b16 v[216:217], v238 offset:12288
    v_fma_f32 v230, v230, v233, v232
    v_mfma_f32_16x16x32_bf16 v[40:43], v[200:203], a[104:107], v[40:43]
    ds_read_b64_tr_b16 v[218:219], v238 offset:12544
    v_mul_f32 v230, v230, v138
    v_mfma_f32_16x16x32_bf16 v[40:43], v[196:199], a[100:103], v[40:43]
    ds_read_b64_tr_b16 v[220:221], v238 offset:14336
    v_mfma_f32_16x16x32_bf16 v[40:43], v[192:195], a[96:99], v[40:43]
    ds_read_b64_tr_b16 v[222:223], v238 offset:14592
    v_mfma_f32_16x16x32_bf16 v[48:51], v[192:195], a[160:163], v[48:51]
    v_exp_f32 v226, v226
    v_mfma_f32_16x16x32_bf16 v[48:51], v[196:199], a[164:167], v[48:51]
    v_mul_f32 v130, v130, v162
    v_add_f32 v226, 1.0, v226
    v_mfma_f32_16x16x32_bf16 v[48:51], v[200:203], a[168:171], v[48:51]
    v_exp_f32 v230, v230
    v_mfma_f32_16x16x32_bf16 v[48:51], v[204:207], a[172:175], v[48:51]
    v_mul_f32 v138, v138, v170
    v_add_f32 v230, 1.0, v230
    v_mfma_f32_16x16x32_bf16 v[56:59], v[204:207], a[236:239], v[56:59]
    v_rcp_f32 v226, v226
    v_mfma_f32_16x16x32_bf16 v[56:59], v[200:203], a[232:235], v[56:59]
    v_mul_f32 v130, v130, v226
    v_mul_f32 v227, v131, v131
    v_mfma_f32_16x16x32_bf16 v[56:59], v[196:199], a[228:231], v[56:59]
    v_rcp_f32 v230, v230
    v_mfma_f32_16x16x32_bf16 v[56:59], v[192:195], a[224:227], v[56:59]
    s_waitcnt lgkmcnt(4)
    v_mul_f32 v138, v138, v230
    v_fma_f32 v227, v227, v233, v232
    v_mfma_f32_16x16x32_bf16 v[36:39], v[208:211], a[32:35], v[36:39]
    ds_read_b64_tr_b16 v[192:193], v235 offset:16384
    v_mul_f32 v231, v139, v139
    v_mfma_f32_16x16x32_bf16 v[36:39], v[212:215], a[36:39], v[36:39]
    s_waitcnt lgkmcnt(1)
    ds_read_b64_tr_b16 v[194:195], v235 offset:16640
    v_mul_f32 v227, v227, v131
    v_mfma_f32_16x16x32_bf16 v[36:39], v[216:219], a[40:43], v[36:39]
    ds_read_b64_tr_b16 v[196:197], v235 offset:18432
    v_fma_f32 v231, v231, v233, v232
    v_mfma_f32_16x16x32_bf16 v[36:39], v[220:223], a[44:47], v[36:39]
    ds_read_b64_tr_b16 v[198:199], v235 offset:18688
    v_mul_f32 v231, v231, v139
    v_mfma_f32_16x16x32_bf16 v[44:47], v[220:223], a[108:111], v[44:47]
    ds_read_b64_tr_b16 v[200:201], v235 offset:20480
    v_mfma_f32_16x16x32_bf16 v[44:47], v[216:219], a[104:107], v[44:47]
    ds_read_b64_tr_b16 v[202:203], v235 offset:20736
    v_mfma_f32_16x16x32_bf16 v[44:47], v[212:215], a[100:103], v[44:47]
    ds_read_b64_tr_b16 v[204:205], v235 offset:22528
    v_mfma_f32_16x16x32_bf16 v[44:47], v[208:211], a[96:99], v[44:47]
    ds_read_b64_tr_b16 v[206:207], v235 offset:22784
    v_mfma_f32_16x16x32_bf16 v[52:55], v[208:211], a[160:163], v[52:55]
    v_exp_f32 v227, v227
    v_mfma_f32_16x16x32_bf16 v[52:55], v[212:215], a[164:167], v[52:55]
    v_mul_f32 v131, v131, v163
    v_add_f32 v227, 1.0, v227
    v_mfma_f32_16x16x32_bf16 v[52:55], v[216:219], a[168:171], v[52:55]
    v_exp_f32 v231, v231
    v_mfma_f32_16x16x32_bf16 v[52:55], v[220:223], a[172:175], v[52:55]
    v_mul_f32 v139, v139, v171
    v_add_f32 v231, 1.0, v231
    v_mfma_f32_16x16x32_bf16 v[60:63], v[220:223], a[236:239], v[60:63]
    v_rcp_f32 v227, v227
    v_mfma_f32_16x16x32_bf16 v[60:63], v[216:219], a[232:235], v[60:63]
    v_mul_f32 v131, v131, v227
    v_mul_f32 v224, v132, v132
    v_mfma_f32_16x16x32_bf16 v[60:63], v[212:215], a[228:231], v[60:63]
    v_rcp_f32 v231, v231
    v_mfma_f32_16x16x32_bf16 v[60:63], v[208:211], a[224:227], v[60:63]
    s_waitcnt lgkmcnt(4)
    v_mul_f32 v139, v139, v231
    v_fma_f32 v224, v224, v233, v232
    v_mfma_f32_16x16x32_bf16 v[0:3], v[192:195], a[48:51], v[0:3]
    ds_read_b64_tr_b16 v[208:209], v238 offset:16384
    v_mul_f32 v228, v140, v140
    v_mfma_f32_16x16x32_bf16 v[0:3], v[196:199], a[52:55], v[0:3]
    s_waitcnt lgkmcnt(1)
    ds_read_b64_tr_b16 v[210:211], v238 offset:16640
    v_mul_f32 v224, v224, v132
    v_mfma_f32_16x16x32_bf16 v[0:3], v[200:203], a[56:59], v[0:3]
    ds_read_b64_tr_b16 v[212:213], v238 offset:18432
    v_fma_f32 v228, v228, v233, v232
    v_mfma_f32_16x16x32_bf16 v[0:3], v[204:207], a[60:63], v[0:3]
    ds_read_b64_tr_b16 v[214:215], v238 offset:18688
    v_mul_f32 v228, v228, v140
    v_mfma_f32_16x16x32_bf16 v[8:11], v[204:207], a[124:127], v[8:11]
    ds_read_b64_tr_b16 v[216:217], v238 offset:20480
    v_mfma_f32_16x16x32_bf16 v[8:11], v[200:203], a[120:123], v[8:11]
    ds_read_b64_tr_b16 v[218:219], v238 offset:20736
    v_mfma_f32_16x16x32_bf16 v[8:11], v[196:199], a[116:119], v[8:11]
    ds_read_b64_tr_b16 v[220:221], v238 offset:22528
    v_mfma_f32_16x16x32_bf16 v[8:11], v[192:195], a[112:115], v[8:11]
    ds_read_b64_tr_b16 v[222:223], v238 offset:22784
    v_mfma_f32_16x16x32_bf16 v[16:19], v[192:195], a[176:179], v[16:19]
    v_exp_f32 v224, v224
    v_mfma_f32_16x16x32_bf16 v[16:19], v[196:199], a[180:183], v[16:19]
    v_mul_f32 v132, v132, v164
    v_add_f32 v224, 1.0, v224
    v_mfma_f32_16x16x32_bf16 v[16:19], v[200:203], a[184:187], v[16:19]
    v_exp_f32 v228, v228
    v_mfma_f32_16x16x32_bf16 v[16:19], v[204:207], a[188:191], v[16:19]
    v_mul_f32 v140, v140, v172
    v_add_f32 v228, 1.0, v228
    v_mfma_f32_16x16x32_bf16 v[24:27], v[204:207], a[252:255], v[24:27]
    v_rcp_f32 v224, v224
    v_mfma_f32_16x16x32_bf16 v[24:27], v[200:203], a[248:251], v[24:27]
    v_mul_f32 v132, v132, v224
    v_mul_f32 v225, v133, v133
    v_mfma_f32_16x16x32_bf16 v[24:27], v[196:199], a[244:247], v[24:27]
    v_rcp_f32 v228, v228
    v_mfma_f32_16x16x32_bf16 v[24:27], v[192:195], a[240:243], v[24:27]
    s_waitcnt lgkmcnt(4)
    v_mul_f32 v140, v140, v228
    v_fma_f32 v225, v225, v233, v232
    v_mfma_f32_16x16x32_bf16 v[4:7], v[208:211], a[48:51], v[4:7]
    ds_read_b64_tr_b16 v[192:193], v235 offset:24576
    v_mul_f32 v229, v141, v141
    v_mfma_f32_16x16x32_bf16 v[4:7], v[212:215], a[52:55], v[4:7]
    s_waitcnt lgkmcnt(1)
    ds_read_b64_tr_b16 v[194:195], v235 offset:24832
    v_mul_f32 v225, v225, v133
    v_mfma_f32_16x16x32_bf16 v[4:7], v[216:219], a[56:59], v[4:7]
    ds_read_b64_tr_b16 v[196:197], v235 offset:26624
    v_fma_f32 v229, v229, v233, v232
    v_mfma_f32_16x16x32_bf16 v[4:7], v[220:223], a[60:63], v[4:7]
    ds_read_b64_tr_b16 v[198:199], v235 offset:26880
    v_mul_f32 v229, v229, v141
    v_mfma_f32_16x16x32_bf16 v[12:15], v[220:223], a[124:127], v[12:15]
    ds_read_b64_tr_b16 v[200:201], v235 offset:28672
    v_mfma_f32_16x16x32_bf16 v[12:15], v[216:219], a[120:123], v[12:15]
    ds_read_b64_tr_b16 v[202:203], v235 offset:28928
    v_mfma_f32_16x16x32_bf16 v[12:15], v[212:215], a[116:119], v[12:15]
    ds_read_b64_tr_b16 v[204:205], v235 offset:30720
    v_mfma_f32_16x16x32_bf16 v[12:15], v[208:211], a[112:115], v[12:15]
    ds_read_b64_tr_b16 v[206:207], v235 offset:30976
    v_mfma_f32_16x16x32_bf16 v[20:23], v[208:211], a[176:179], v[20:23]
    v_exp_f32 v225, v225
    v_mfma_f32_16x16x32_bf16 v[20:23], v[212:215], a[180:183], v[20:23]
    v_mul_f32 v133, v133, v165
    v_add_f32 v225, 1.0, v225
    v_mfma_f32_16x16x32_bf16 v[20:23], v[216:219], a[184:187], v[20:23]
    v_exp_f32 v229, v229
    v_mfma_f32_16x16x32_bf16 v[20:23], v[220:223], a[188:191], v[20:23]
    v_mul_f32 v141, v141, v173
    v_add_f32 v229, 1.0, v229
    v_mfma_f32_16x16x32_bf16 v[28:31], v[220:223], a[252:255], v[28:31]
    v_rcp_f32 v225, v225
    v_mfma_f32_16x16x32_bf16 v[28:31], v[216:219], a[248:251], v[28:31]
    v_mul_f32 v133, v133, v225
    v_mul_f32 v226, v134, v134
    v_mfma_f32_16x16x32_bf16 v[28:31], v[212:215], a[244:247], v[28:31]
    v_rcp_f32 v229, v229
    v_mfma_f32_16x16x32_bf16 v[28:31], v[208:211], a[240:243], v[28:31]
    s_waitcnt lgkmcnt(4)
    v_mul_f32 v141, v141, v229
    v_fma_f32 v226, v226, v233, v232
    v_mfma_f32_16x16x32_bf16 v[32:35], v[192:195], a[48:51], v[32:35]
    ds_read_b64_tr_b16 v[208:209], v238 offset:24576
    v_mul_f32 v230, v142, v142
    v_mfma_f32_16x16x32_bf16 v[32:35], v[196:199], a[52:55], v[32:35]
    s_waitcnt lgkmcnt(1)
    ds_read_b64_tr_b16 v[210:211], v238 offset:24832
    v_mul_f32 v226, v226, v134
    v_mfma_f32_16x16x32_bf16 v[32:35], v[200:203], a[56:59], v[32:35]
    ds_read_b64_tr_b16 v[212:213], v238 offset:26624
    v_fma_f32 v230, v230, v233, v232
    v_mfma_f32_16x16x32_bf16 v[32:35], v[204:207], a[60:63], v[32:35]
    ds_read_b64_tr_b16 v[214:215], v238 offset:26880
    v_mul_f32 v230, v230, v142
    v_mfma_f32_16x16x32_bf16 v[40:43], v[204:207], a[124:127], v[40:43]
    ds_read_b64_tr_b16 v[216:217], v238 offset:28672
    v_mfma_f32_16x16x32_bf16 v[40:43], v[200:203], a[120:123], v[40:43]
    ds_read_b64_tr_b16 v[218:219], v238 offset:28928
    v_mfma_f32_16x16x32_bf16 v[40:43], v[196:199], a[116:119], v[40:43]
    ds_read_b64_tr_b16 v[220:221], v238 offset:30720
    v_mfma_f32_16x16x32_bf16 v[40:43], v[192:195], a[112:115], v[40:43]
    ds_read_b64_tr_b16 v[222:223], v238 offset:30976
    v_mfma_f32_16x16x32_bf16 v[48:51], v[192:195], a[176:179], v[48:51]
    v_exp_f32 v226, v226
    v_mfma_f32_16x16x32_bf16 v[48:51], v[196:199], a[180:183], v[48:51]
    v_mul_f32 v134, v134, v166
    v_add_f32 v226, 1.0, v226
    v_mfma_f32_16x16x32_bf16 v[48:51], v[200:203], a[184:187], v[48:51]
    s_waitcnt lgkmcnt(0)
    v_exp_f32 v230, v230
    v_mfma_f32_16x16x32_bf16 v[48:51], v[204:207], a[188:191], v[48:51]
    v_mul_f32 v142, v142, v174
    v_add_f32 v230, 1.0, v230
    v_mfma_f32_16x16x32_bf16 v[56:59], v[204:207], a[252:255], v[56:59]
    s_waitcnt vmcnt(13)
    s_barrier
    v_mfma_f32_16x16x32_bf16 v[56:59], v[200:203], a[248:251], v[56:59]
    v_rcp_f32 v226, v226
    v_mfma_f32_16x16x32_bf16 v[56:59], v[196:199], a[244:247], v[56:59]
    s_waitcnt vmcnt(0)
    v_cmp_ne_u32 vcc, 1, v244
    v_mul_f32 v134, v134, v226
    v_mfma_f32_16x16x32_bf16 v[56:59], v[192:195], a[240:243], v[56:59]
    s_add_u32 m0, s49, 0
    s_add_u32 s57, s49, 0
    v_mfma_f32_16x16x32_bf16 v[36:39], v[208:211], a[48:51], v[36:39]
    ds_read_b64_tr_b16 v[192:193], v235 offset:32768
    s_cbranch_vccnz L_kvwait
L_kvok:
    v_mfma_f32_16x16x32_bf16 v[36:39], v[212:215], a[52:55], v[36:39]
    ds_read_b64_tr_b16 v[194:195], v235 offset:33024
    v_mul_f32 v227, v135, v135
    v_mfma_f32_16x16x32_bf16 v[36:39], v[216:219], a[56:59], v[36:39]
    ds_read_b64_tr_b16 v[196:197], v235 offset:34816
    v_fma_f32 v227, v227, v233, v232
    v_mfma_f32_16x16x32_bf16 v[36:39], v[220:223], a[60:63], v[36:39]
    ds_read_b64_tr_b16 v[198:199], v235 offset:35072
    v_mul_f32 v227, v227, v135
    v_mfma_f32_16x16x32_bf16 v[44:47], v[220:223], a[124:127], v[44:47]
    ds_read_b64_tr_b16 v[200:201], v235 offset:36864
    v_mfma_f32_16x16x32_bf16 v[44:47], v[216:219], a[120:123], v[44:47]
    ds_read_b64_tr_b16 v[202:203], v235 offset:37120
    v_mfma_f32_16x16x32_bf16 v[44:47], v[212:215], a[116:119], v[44:47]
    ds_read_b64_tr_b16 v[204:205], v235 offset:38912
    v_mfma_f32_16x16x32_bf16 v[44:47], v[208:211], a[112:115], v[44:47]
    ds_read_b64_tr_b16 v[206:207], v235 offset:39168
    v_mfma_f32_16x16x32_bf16 v[52:55], v[208:211], a[176:179], v[52:55]
    buffer_load_dwordx4 v240, s[16:19], s57 offen offset:0 sc1 lds
    v_mfma_f32_16x16x32_bf16 v[52:55], v[212:215], a[180:183], v[52:55]
    buffer_load_dwordx4 v240, s[16:19], s57 offen offset:1024 sc1 lds
    v_mfma_f32_16x16x32_bf16 v[52:55], v[216:219], a[184:187], v[52:55]
    buffer_load_dwordx4 v240, s[16:19], s57 offen offset:2048 sc1 lds
    v_mfma_f32_16x16x32_bf16 v[52:55], v[220:223], a[188:191], v[52:55]
    v_rcp_f32 v230, v230
    v_mfma_f32_16x16x32_bf16 v[60:63], v[220:223], a[252:255], v[60:63]
    v_mul_f32 v142, v142, v230
    v_mul_f32 v231, v143, v143
    v_mfma_f32_16x16x32_bf16 v[60:63], v[216:219], a[248:251], v[60:63]
    v_fma_f32 v231, v231, v233, v232
    v_mul_f32 v231, v231, v143
    v_mfma_f32_16x16x32_bf16 v[60:63], v[212:215], a[244:247], v[60:63]
    buffer_load_dwordx4 v240, s[16:19], s57 offen offset:3072 sc1 lds
    v_mfma_f32_16x16x32_bf16 v[60:63], v[208:211], a[240:243], v[60:63]
    s_waitcnt lgkmcnt(4)
    s_add_u32 m0, s49, 16384
    s_add_u32 s57, s49, 16384
    v_mfma_f32_16x16x32_bf16 v[64:67], v[192:195], a[0:3], 0
    ds_read_b64_tr_b16 v[208:209], v238 offset:32768
    v_mfma_f32_16x16x32_bf16 v[64:67], v[196:199], a[4:7], v[64:67]
    s_waitcnt lgkmcnt(1)
    ds_read_b64_tr_b16 v[210:211], v238 offset:33024
    v_mfma_f32_16x16x32_bf16 v[64:67], v[200:203], a[8:11], v[64:67]
    ds_read_b64_tr_b16 v[212:213], v238 offset:34816
    v_mfma_f32_16x16x32_bf16 v[64:67], v[204:207], a[12:15], v[64:67]
    ds_read_b64_tr_b16 v[214:215], v238 offset:35072
    v_mfma_f32_16x16x32_bf16 v[72:75], v[204:207], a[76:79], 0
    ds_read_b64_tr_b16 v[216:217], v238 offset:36864
    v_mfma_f32_16x16x32_bf16 v[72:75], v[200:203], a[72:75], v[72:75]
    ds_read_b64_tr_b16 v[218:219], v238 offset:37120
    v_mfma_f32_16x16x32_bf16 v[72:75], v[196:199], a[68:71], v[72:75]
    ds_read_b64_tr_b16 v[220:221], v238 offset:38912
    v_cvt_pk_bf16_f32 v0, v0, v1
    v_mfma_f32_16x16x32_bf16 v[72:75], v[192:195], a[64:67], v[72:75]
    ds_read_b64_tr_b16 v[222:223], v238 offset:39168
    v_cvt_pk_bf16_f32 v1, v2, v3
    v_mfma_f32_16x16x32_bf16 v[80:83], v[192:195], a[128:131], 0
    buffer_load_dwordx4 v240, s[16:19], s57 offen offset:0 sc1 lds
    v_mfma_f32_16x16x32_bf16 v[80:83], v[196:199], a[132:135], v[80:83]
    buffer_load_dwordx4 v240, s[16:19], s57 offen offset:1024 sc1 lds
    v_mfma_f32_16x16x32_bf16 v[80:83], v[200:203], a[136:139], v[80:83]
    buffer_load_dwordx4 v240, s[16:19], s57 offen offset:2048 sc1 lds
    v_mfma_f32_16x16x32_bf16 v[80:83], v[204:207], a[140:143], v[80:83]
    v_exp_f32 v227, v227
    v_mfma_f32_16x16x32_bf16 v[88:91], v[204:207], a[204:207], 0
    v_mul_f32 v135, v135, v167
    v_add_f32 v227, 1.0, v227
    v_mfma_f32_16x16x32_bf16 v[88:91], v[200:203], a[200:203], v[88:91]
    v_exp_f32 v231, v231
    v_mfma_f32_16x16x32_bf16 v[88:91], v[196:199], a[196:199], v[88:91]
    buffer_load_dwordx4 v240, s[16:19], s57 offen offset:3072 sc1 lds
    v_mfma_f32_16x16x32_bf16 v[88:91], v[192:195], a[192:195], v[88:91]
    s_waitcnt lgkmcnt(4)
    s_add_u32 m0, s49, 32768
    s_add_u32 s57, s49, 32768
    v_mfma_f32_16x16x32_bf16 v[68:71], v[208:211], a[0:3], 0
    ds_read_b64_tr_b16 v[192:193], v235 offset:40960
    v_mul_f32 v143, v143, v175
    v_mfma_f32_16x16x32_bf16 v[68:71], v[212:215], a[4:7], v[68:71]
    s_waitcnt lgkmcnt(1)
    ds_read_b64_tr_b16 v[194:195], v235 offset:41216
    v_add_f32 v231, 1.0, v231
    v_mfma_f32_16x16x32_bf16 v[68:71], v[216:219], a[8:11], v[68:71]
    ds_read_b64_tr_b16 v[196:197], v235 offset:43008
    v_cvt_pk_bf16_f32 v2, v4, v5
    v_mfma_f32_16x16x32_bf16 v[68:71], v[220:223], a[12:15], v[68:71]
    ds_read_b64_tr_b16 v[198:199], v235 offset:43264
    v_cvt_pk_bf16_f32 v3, v6, v7
    v_mfma_f32_16x16x32_bf16 v[76:79], v[220:223], a[76:79], 0
    ds_read_b64_tr_b16 v[200:201], v235 offset:45056
    v_cvt_pk_bf16_f32 v8, v8, v9
    v_mfma_f32_16x16x32_bf16 v[76:79], v[216:219], a[72:75], v[76:79]
    ds_read_b64_tr_b16 v[202:203], v235 offset:45312
    v_cvt_pk_bf16_f32 v9, v10, v11
    v_mfma_f32_16x16x32_bf16 v[76:79], v[212:215], a[68:71], v[76:79]
    ds_read_b64_tr_b16 v[204:205], v235 offset:47104
    v_cvt_pk_bf16_f32 v10, v12, v13
    v_mfma_f32_16x16x32_bf16 v[76:79], v[208:211], a[64:67], v[76:79]
    ds_read_b64_tr_b16 v[206:207], v235 offset:47360
    v_cvt_pk_bf16_f32 v11, v14, v15
    v_mfma_f32_16x16x32_bf16 v[84:87], v[208:211], a[128:131], 0
    buffer_load_dwordx4 v240, s[16:19], s57 offen offset:0 sc1 lds
    v_mfma_f32_16x16x32_bf16 v[84:87], v[212:215], a[132:135], v[84:87]
    buffer_load_dwordx4 v240, s[16:19], s57 offen offset:1024 sc1 lds
    v_mfma_f32_16x16x32_bf16 v[84:87], v[216:219], a[136:139], v[84:87]
    buffer_load_dwordx4 v240, s[16:19], s57 offen offset:2048 sc1 lds
    v_mfma_f32_16x16x32_bf16 v[84:87], v[220:223], a[140:143], v[84:87]
    v_rcp_f32 v227, v227
    v_mfma_f32_16x16x32_bf16 v[92:95], v[220:223], a[204:207], 0
    v_mul_f32 v135, v135, v227
    v_cvt_pk_bf16_f32 v128, v128, v129
    v_mfma_f32_16x16x32_bf16 v[92:95], v[216:219], a[200:203], v[92:95]
    v_rcp_f32 v231, v231
    v_mfma_f32_16x16x32_bf16 v[92:95], v[212:215], a[196:199], v[92:95]
    buffer_load_dwordx4 v240, s[16:19], s57 offen offset:3072 sc1 lds
    v_mfma_f32_16x16x32_bf16 v[92:95], v[208:211], a[192:195], v[92:95]
    s_waitcnt lgkmcnt(4)
    s_add_u32 m0, s49, 49152
    s_add_u32 s57, s49, 49152
    v_mfma_f32_16x16x32_bf16 v[96:99], v[192:195], a[0:3], 0
    ds_read_b64_tr_b16 v[208:209], v238 offset:40960
    v_mul_f32 v143, v143, v231
    v_mfma_f32_16x16x32_bf16 v[96:99], v[196:199], a[4:7], v[96:99]
    s_waitcnt lgkmcnt(1)
    ds_read_b64_tr_b16 v[210:211], v238 offset:41216
    v_cvt_pk_bf16_f32 v129, v130, v131
    v_mfma_f32_16x16x32_bf16 v[96:99], v[200:203], a[8:11], v[96:99]
    ds_read_b64_tr_b16 v[212:213], v238 offset:43008
    v_cvt_pk_bf16_f32 v136, v136, v137
    v_mfma_f32_16x16x32_bf16 v[96:99], v[204:207], a[12:15], v[96:99]
    ds_read_b64_tr_b16 v[214:215], v238 offset:43264
    v_cvt_pk_bf16_f32 v130, v132, v133
    v_mfma_f32_16x16x32_bf16 v[104:107], v[204:207], a[76:79], 0
    ds_read_b64_tr_b16 v[216:217], v238 offset:45056
    v_cvt_pk_bf16_f32 v137, v138, v139
    v_mfma_f32_16x16x32_bf16 v[104:107], v[200:203], a[72:75], v[104:107]
    ds_read_b64_tr_b16 v[218:219], v238 offset:45312
    v_cvt_pk_bf16_f32 v131, v134, v135
    v_mfma_f32_16x16x32_bf16 v[104:107], v[196:199], a[68:71], v[104:107]
    ds_read_b64_tr_b16 v[220:221], v238 offset:47104
    v_cvt_pk_bf16_f32 v138, v140, v141
    v_mfma_f32_16x16x32_bf16 v[104:107], v[192:195], a[64:67], v[104:107]
    ds_read_b64_tr_b16 v[222:223], v238 offset:47360
    v_mul_f32 v224, v144, v144
    v_mfma_f32_16x16x32_bf16 v[112:115], v[192:195], a[128:131], 0
    buffer_load_dwordx4 v240, s[16:19], s57 offen offset:0 sc1 lds
    v_mfma_f32_16x16x32_bf16 v[112:115], v[196:199], a[132:135], v[112:115]
    buffer_load_dwordx4 v240, s[16:19], s57 offen offset:1024 sc1 lds
    v_mfma_f32_16x16x32_bf16 v[112:115], v[200:203], a[136:139], v[112:115]
    buffer_load_dwordx4 v240, s[16:19], s57 offen offset:2048 sc1 lds
    v_mfma_f32_16x16x32_bf16 v[112:115], v[204:207], a[140:143], v[112:115]
    v_cvt_pk_bf16_f32 v139, v142, v143
    v_fma_f32 v224, v224, v233, v232
    v_mfma_f32_16x16x32_bf16 v[120:123], v[204:207], a[204:207], 0
    v_mul_f32 v228, v152, v152
    v_mul_f32 v224, v224, v144
    v_mfma_f32_16x16x32_bf16 v[120:123], v[200:203], a[200:203], v[120:123]
    v_fma_f32 v228, v228, v233, v232
    v_mul_f32 v228, v228, v152
    v_mfma_f32_16x16x32_bf16 v[120:123], v[196:199], a[196:199], v[120:123]
    buffer_load_dwordx4 v240, s[16:19], s57 offen offset:3072 sc1 lds
    v_mfma_f32_16x16x32_bf16 v[120:123], v[192:195], a[192:195], v[120:123]
    s_waitcnt lgkmcnt(4)
    s_add_u32 m0, s49, 65536
    s_add_u32 s57, s49, 65536
    v_mfma_f32_16x16x32_bf16 v[100:103], v[208:211], a[0:3], 0
    ds_read_b64_tr_b16 v[192:193], v235 offset:49152
    v_cvt_pk_bf16_f32 v16, v16, v17
    v_mfma_f32_16x16x32_bf16 v[100:103], v[212:215], a[4:7], v[100:103]
    s_waitcnt lgkmcnt(1)
    ds_read_b64_tr_b16 v[194:195], v235 offset:49408
    v_cvt_pk_bf16_f32 v17, v18, v19
    v_mfma_f32_16x16x32_bf16 v[100:103], v[216:219], a[8:11], v[100:103]
    ds_read_b64_tr_b16 v[196:197], v235 offset:51200
    v_cvt_pk_bf16_f32 v18, v20, v21
    v_mfma_f32_16x16x32_bf16 v[100:103], v[220:223], a[12:15], v[100:103]
    ds_read_b64_tr_b16 v[198:199], v235 offset:51456
    v_cvt_pk_bf16_f32 v19, v22, v23
    v_mfma_f32_16x16x32_bf16 v[108:111], v[220:223], a[76:79], 0
    ds_read_b64_tr_b16 v[200:201], v235 offset:53248
    v_cvt_pk_bf16_f32 v24, v24, v25
    v_mfma_f32_16x16x32_bf16 v[108:111], v[216:219], a[72:75], v[108:111]
    ds_read_b64_tr_b16 v[202:203], v235 offset:53504
    v_cvt_pk_bf16_f32 v25, v26, v27
    v_mfma_f32_16x16x32_bf16 v[108:111], v[212:215], a[68:71], v[108:111]
    ds_read_b64_tr_b16 v[204:205], v235 offset:55296
    v_cvt_pk_bf16_f32 v26, v28, v29
    v_mfma_f32_16x16x32_bf16 v[108:111], v[208:211], a[64:67], v[108:111]
    ds_read_b64_tr_b16 v[206:207], v235 offset:55552
    v_cvt_pk_bf16_f32 v27, v30, v31
    v_mfma_f32_16x16x32_bf16 v[116:119], v[208:211], a[128:131], 0
    buffer_load_dwordx4 v240, s[16:19], s57 offen offset:0 sc1 lds
    v_mfma_f32_16x16x32_bf16 v[116:119], v[212:215], a[132:135], v[116:119]
    buffer_load_dwordx4 v240, s[16:19], s57 offen offset:1024 sc1 lds
    v_mfma_f32_16x16x32_bf16 v[116:119], v[216:219], a[136:139], v[116:119]
    buffer_load_dwordx4 v240, s[16:19], s57 offen offset:2048 sc1 lds
    v_mfma_f32_16x16x32_bf16 v[116:119], v[220:223], a[140:143], v[116:119]
    v_exp_f32 v224, v224
    v_mfma_f32_16x16x32_bf16 v[124:127], v[220:223], a[204:207], 0
    v_mul_f32 v144, v144, v176
    v_add_f32 v224, 1.0, v224
    v_mfma_f32_16x16x32_bf16 v[124:127], v[216:219], a[200:203], v[124:127]
    v_exp_f32 v228, v228
    v_mfma_f32_16x16x32_bf16 v[124:127], v[212:215], a[196:199], v[124:127]
    buffer_load_dwordx4 v240, s[16:19], s57 offen offset:3072 sc1 lds
    v_mfma_f32_16x16x32_bf16 v[124:127], v[208:211], a[192:195], v[124:127]
    s_waitcnt lgkmcnt(4)
    s_add_u32 m0, s49, 81920
    s_add_u32 s57, s49, 81920
    v_mfma_f32_16x16x32_bf16 v[64:67], v[192:195], a[16:19], v[64:67]
    ds_read_b64_tr_b16 v[208:209], v238 offset:49152
    v_mul_f32 v152, v152, v184
    v_mfma_f32_16x16x32_bf16 v[64:67], v[196:199], a[20:23], v[64:67]
    s_waitcnt lgkmcnt(1)
    ds_read_b64_tr_b16 v[210:211], v238 offset:49408
    v_add_f32 v228, 1.0, v228
    v_mfma_f32_16x16x32_bf16 v[64:67], v[200:203], a[24:27], v[64:67]
    ds_read_b64_tr_b16 v[212:213], v238 offset:51200
    v_cvt_pk_bf16_f32 v32, v32, v33
    v_mfma_f32_16x16x32_bf16 v[64:67], v[204:207], a[28:31], v[64:67]
    ds_read_b64_tr_b16 v[214:215], v238 offset:51456
    v_cvt_pk_bf16_f32 v33, v34, v35
    v_mfma_f32_16x16x32_bf16 v[72:75], v[204:207], a[92:95], v[72:75]
    ds_read_b64_tr_b16 v[216:217], v238 offset:53248
    v_cvt_pk_bf16_f32 v34, v36, v37
    v_mfma_f32_16x16x32_bf16 v[72:75], v[200:203], a[88:91], v[72:75]
    ds_read_b64_tr_b16 v[218:219], v238 offset:53504
    v_cvt_pk_bf16_f32 v35, v38, v39
    v_mfma_f32_16x16x32_bf16 v[72:75], v[196:199], a[84:87], v[72:75]
    ds_read_b64_tr_b16 v[220:221], v238 offset:55296
    v_cvt_pk_bf16_f32 v40, v40, v41
    v_mfma_f32_16x16x32_bf16 v[72:75], v[192:195], a[80:83], v[72:75]
    ds_read_b64_tr_b16 v[222:223], v238 offset:55552
    v_cvt_pk_bf16_f32 v41, v42, v43
    v_mfma_f32_16x16x32_bf16 v[80:83], v[192:195], a[144:147], v[80:83]
    buffer_load_dwordx4 v240, s[16:19], s57 offen offset:0 sc1 lds
    v_mfma_f32_16x16x32_bf16 v[80:83], v[196:199], a[148:151], v[80:83]
    buffer_load_dwordx4 v240, s[16:19], s57 offen offset:1024 sc1 lds
    v_mfma_f32_16x16x32_bf16 v[80:83], v[200:203], a[152:155], v[80:83]
    buffer_load_dwordx4 v240, s[16:19], s57 offen offset:2048 sc1 lds
    v_mfma_f32_16x16x32_bf16 v[80:83], v[204:207], a[156:159], v[80:83]
    v_rcp_f32 v224, v224
    v_mfma_f32_16x16x32_bf16 v[88:91], v[204:207], a[220:223], v[88:91]
    v_mul_f32 v144, v144, v224
    v_mul_f32 v225, v145, v145
    v_mfma_f32_16x16x32_bf16 v[88:91], v[200:203], a[216:219], v[88:91]
    v_rcp_f32 v228, v228
    v_mfma_f32_16x16x32_bf16 v[88:91], v[196:199], a[212:215], v[88:91]
    buffer_load_dwordx4 v240, s[16:19], s57 offen offset:3072 sc1 lds
    v_mfma_f32_16x16x32_bf16 v[88:91], v[192:195], a[208:211], v[88:91]
    s_waitcnt lgkmcnt(4)
    v_mul_f32 v152, v152, v228
    v_fma_f32 v225, v225, v233, v232
    v_mfma_f32_16x16x32_bf16 v[68:71], v[208:211], a[16:19], v[68:71]
    ds_read_b64_tr_b16 v[192:193], v235 offset:57344
    v_mul_f32 v229, v153, v153
    v_mfma_f32_16x16x32_bf16 v[68:71], v[212:215], a[20:23], v[68:71]
    s_waitcnt lgkmcnt(1)
    ds_read_b64_tr_b16 v[194:195], v235 offset:57600
    v_mul_f32 v225, v225, v145
    v_mfma_f32_16x16x32_bf16 v[68:71], v[216:219], a[24:27], v[68:71]
    ds_read_b64_tr_b16 v[196:197], v235 offset:59392
    v_fma_f32 v229, v229, v233, v232
    v_mfma_f32_16x16x32_bf16 v[68:71], v[220:223], a[28:31], v[68:71]
    ds_read_b64_tr_b16 v[198:199], v235 offset:59648
    v_mul_f32 v229, v229, v153
    v_mfma_f32_16x16x32_bf16 v[76:79], v[220:223], a[92:95], v[76:79]
    ds_read_b64_tr_b16 v[200:201], v235 offset:61440
    v_cvt_pk_bf16_f32 v42, v44, v45
    v_mfma_f32_16x16x32_bf16 v[76:79], v[216:219], a[88:91], v[76:79]
    ds_read_b64_tr_b16 v[202:203], v235 offset:61696
    v_cvt_pk_bf16_f32 v43, v46, v47
    v_mfma_f32_16x16x32_bf16 v[76:79], v[212:215], a[84:87], v[76:79]
    ds_read_b64_tr_b16 v[204:205], v235 offset:63488
    v_cvt_pk_bf16_f32 v48, v48, v49
    v_mfma_f32_16x16x32_bf16 v[76:79], v[208:211], a[80:83], v[76:79]
    ds_read_b64_tr_b16 v[206:207], v235 offset:63744
    v_cvt_pk_bf16_f32 v49, v50, v51
    v_mfma_f32_16x16x32_bf16 v[84:87], v[208:211], a[144:147], v[84:87]
    v_exp_f32 v225, v225
    v_mfma_f32_16x16x32_bf16 v[84:87], v[212:215], a[148:151], v[84:87]
    v_mul_f32 v145, v145, v177
    v_add_f32 v225, 1.0, v225
    v_mfma_f32_16x16x32_bf16 v[84:87], v[216:219], a[152:155], v[84:87]
    v_exp_f32 v229, v229
    v_mfma_f32_16x16x32_bf16 v[84:87], v[220:223], a[156:159], v[84:87]
    v_mul_f32 v153, v153, v185
    v_add_f32 v229, 1.0, v229
    v_mfma_f32_16x16x32_bf16 v[92:95], v[220:223], a[220:223], v[92:95]
    v_rcp_f32 v225, v225
    v_mfma_f32_16x16x32_bf16 v[92:95], v[216:219], a[216:219], v[92:95]
    v_mul_f32 v145, v145, v225
    v_mul_f32 v226, v146, v146
    v_mfma_f32_16x16x32_bf16 v[92:95], v[212:215], a[212:215], v[92:95]
    v_rcp_f32 v229, v229
    v_mfma_f32_16x16x32_bf16 v[92:95], v[208:211], a[208:211], v[92:95]
    s_waitcnt lgkmcnt(4)
    v_mul_f32 v153, v153, v229
    v_fma_f32 v226, v226, v233, v232
    v_mfma_f32_16x16x32_bf16 v[96:99], v[192:195], a[16:19], v[96:99]
    ds_read_b64_tr_b16 v[208:209], v238 offset:57344
    v_mul_f32 v230, v154, v154
    v_mfma_f32_16x16x32_bf16 v[96:99], v[196:199], a[20:23], v[96:99]
    s_waitcnt lgkmcnt(1)
    ds_read_b64_tr_b16 v[210:211], v238 offset:57600
    v_mul_f32 v226, v226, v146
    v_mfma_f32_16x16x32_bf16 v[96:99], v[200:203], a[24:27], v[96:99]
    ds_read_b64_tr_b16 v[212:213], v238 offset:59392
    v_fma_f32 v230, v230, v233, v232
    v_mfma_f32_16x16x32_bf16 v[96:99], v[204:207], a[28:31], v[96:99]
    ds_read_b64_tr_b16 v[214:215], v238 offset:59648
    v_mul_f32 v230, v230, v154
    v_mfma_f32_16x16x32_bf16 v[104:107], v[204:207], a[92:95], v[104:107]
    ds_read_b64_tr_b16 v[216:217], v238 offset:61440
    v_cvt_pk_bf16_f32 v50, v52, v53
    v_mfma_f32_16x16x32_bf16 v[104:107], v[200:203], a[88:91], v[104:107]
    ds_read_b64_tr_b16 v[218:219], v238 offset:61696
    v_cvt_pk_bf16_f32 v51, v54, v55
    v_mfma_f32_16x16x32_bf16 v[104:107], v[196:199], a[84:87], v[104:107]
    ds_read_b64_tr_b16 v[220:221], v238 offset:63488
    v_cvt_pk_bf16_f32 v56, v56, v57
    v_mfma_f32_16x16x32_bf16 v[104:107], v[192:195], a[80:83], v[104:107]
    ds_read_b64_tr_b16 v[222:223], v238 offset:63744
    v_cvt_pk_bf16_f32 v57, v58, v59
    v_mfma_f32_16x16x32_bf16 v[112:115], v[192:195], a[144:147], v[112:115]
    v_exp_f32 v226, v226
    v_mfma_f32_16x16x32_bf16 v[112:115], v[196:199], a[148:151], v[112:115]
    v_mul_f32 v146, v146, v178
    v_add_f32 v226, 1.0, v226
    v_mfma_f32_16x16x32_bf16 v[112:115], v[200:203], a[152:155], v[112:115]
    s_waitcnt lgkmcnt(0)
    s_add_u32 m0, s49, 98304
    s_add_u32 s57, s49, 98304
    v_mfma_f32_16x16x32_bf16 v[112:115], v[204:207], a[156:159], v[112:115]
    v_exp_f32 v230, v230
    v_mfma_f32_16x16x32_bf16 v[120:123], v[204:207], a[220:223], v[120:123]
    s_waitcnt vmcnt(20)
    s_barrier
    v_mul_f32 v154, v154, v186
    v_mfma_f32_16x16x32_bf16 v[120:123], v[200:203], a[216:219], v[120:123]
    buffer_load_dwordx4 v240, s[16:19], s57 offen offset:0 sc1 lds
    v_mfma_f32_16x16x32_bf16 v[120:123], v[196:199], a[212:215], v[120:123]
    v_add_f32 v230, 1.0, v230
    v_cvt_pk_bf16_f32 v58, v60, v61
    v_mfma_f32_16x16x32_bf16 v[120:123], v[192:195], a[208:211], v[120:123]
    v_rcp_f32 v226, v226
    v_mfma_f32_16x16x32_bf16 v[100:103], v[208:211], a[16:19], v[100:103]
    ds_read_b64_tr_b16 v[192:193], v236 offset:0
    v_mul_f32 v146, v146, v226
    v_mfma_f32_16x16x32_bf16 v[100:103], v[212:215], a[20:23], v[100:103]
    ds_read_b64_tr_b16 v[194:195], v236 offset:256
    v_mul_f32 v227, v147, v147
    v_mfma_f32_16x16x32_bf16 v[100:103], v[216:219], a[24:27], v[100:103]
    ds_read_b64_tr_b16 v[196:197], v236 offset:2048
    v_fma_f32 v227, v227, v233, v232
    v_mfma_f32_16x16x32_bf16 v[100:103], v[220:223], a[28:31], v[100:103]
    ds_read_b64_tr_b16 v[198:199], v236 offset:2304
    v_mul_f32 v227, v227, v147
    v_mfma_f32_16x16x32_bf16 v[108:111], v[220:223], a[92:95], v[108:111]
    ds_read_b64_tr_b16 v[200:201], v236 offset:4096
    v_cvt_pk_bf16_f32 v59, v62, v63
    v_mfma_f32_16x16x32_bf16 v[108:111], v[216:219], a[88:91], v[108:111]
    ds_read_b64_tr_b16 v[202:203], v236 offset:4352
    ds_read_b128 a[192:195], v240 offset:0
    v_mfma_f32_16x16x32_bf16 v[108:111], v[212:215], a[84:87], v[108:111]
    ds_read_b64_tr_b16 v[204:205], v236 offset:6144
    ds_read_b128 a[196:199], v240 offset:1024
    v_mfma_f32_16x16x32_bf16 v[108:111], v[208:211], a[80:83], v[108:111]
    ds_read_b64_tr_b16 v[206:207], v236 offset:6400
    ds_read_b128 a[200:203], v240 offset:2048
    v_mfma_f32_16x16x32_bf16 v[116:119], v[208:211], a[144:147], v[116:119]
    buffer_load_dwordx4 v240, s[16:19], s57 offen offset:1024 sc1 lds
    v_mfma_f32_16x16x32_bf16 v[116:119], v[212:215], a[148:151], v[116:119]
    buffer_load_dwordx4 v240, s[16:19], s57 offen offset:2048 sc1 lds
    v_mfma_f32_16x16x32_bf16 v[116:119], v[216:219], a[152:155], v[116:119]
    buffer_load_dwordx4 v240, s[16:19], s57 offen offset:3072 sc1 lds
    v_mfma_f32_16x16x32_bf16 v[116:119], v[220:223], a[156:159], v[116:119]
    v_rcp_f32 v230, v230
    v_mfma_f32_16x16x32_bf16 v[124:127], v[220:223], a[220:223], v[124:127]
    v_mul_f32 v154, v154, v230
    v_mul_f32 v231, v155, v155
    v_mfma_f32_16x16x32_bf16 v[124:127], v[216:219], a[216:219], v[124:127]
    v_fma_f32 v231, v231, v233, v232
    v_mul_f32 v231, v231, v155
    v_mfma_f32_16x16x32_bf16 v[124:127], v[212:215], a[212:215], v[124:127]
    v_exp_f32 v227, v227
    v_mfma_f32_16x16x32_bf16 v[124:127], v[208:211], a[208:211], v[124:127]
    s_waitcnt lgkmcnt(7)
    v_mul_f32 v147, v147, v179
    v_add_f32 v227, 1.0, v227
    v_mfma_f32_16x16x32_bf16 v[64:67], v[192:195], a[32:35], v[64:67]
    ds_read_b64_tr_b16 v[208:209], v239 offset:0
    ds_read_b128 a[204:207], v240 offset:3072
    v_mfma_f32_16x16x32_bf16 v[64:67], v[196:199], a[36:39], v[64:67]
    s_waitcnt lgkmcnt(3)
    ds_read_b64_tr_b16 v[210:211], v239 offset:256
    ds_read_b128 a[208:211], v240 offset:4096
    v_mfma_f32_16x16x32_bf16 v[64:67], v[200:203], a[40:43], v[64:67]
    ds_read_b64_tr_b16 v[212:213], v239 offset:2048
    v_accvgpr_write_b32 a0, v0
    v_mfma_f32_16x16x32_bf16 v[64:67], v[204:207], a[44:47], v[64:67]
    ds_read_b64_tr_b16 v[214:215], v239 offset:2304
    v_accvgpr_write_b32 a1, v1
    v_mfma_f32_16x16x32_bf16 v[72:75], v[204:207], a[108:111], v[72:75]
    ds_read_b64_tr_b16 v[216:217], v239 offset:4096
    v_accvgpr_write_b32 a2, v2
    v_mfma_f32_16x16x32_bf16 v[72:75], v[200:203], a[104:107], v[72:75]
    ds_read_b64_tr_b16 v[218:219], v239 offset:4352
    v_accvgpr_write_b32 a3, v3
    v_mfma_f32_16x16x32_bf16 v[72:75], v[196:199], a[100:103], v[72:75]
    ds_read_b64_tr_b16 v[220:221], v239 offset:6144
    v_accvgpr_write_b32 a8, v8
    v_mfma_f32_16x16x32_bf16 v[72:75], v[192:195], a[96:99], v[72:75]
    ds_read_b64_tr_b16 v[222:223], v239 offset:6400
    v_accvgpr_write_b32 a9, v9
    v_mfma_f32_16x16x32_bf16 v[80:83], v[192:195], a[160:163], v[80:83]
    v_exp_f32 v231, v231
    v_mfma_f32_16x16x32_bf16 v[80:83], v[196:199], a[164:167], v[80:83]
    v_mul_f32 v155, v155, v187
    v_add_f32 v231, 1.0, v231
    v_mfma_f32_16x16x32_bf16 v[80:83], v[200:203], a[168:171], v[80:83]
    v_rcp_f32 v227, v227
    v_mfma_f32_16x16x32_bf16 v[80:83], v[204:207], a[172:175], v[80:83]
    v_mul_f32 v147, v147, v227
    v_mul_f32 v224, v148, v148
    v_mfma_f32_16x16x32_bf16 v[88:91], v[204:207], a[236:239], v[88:91]
    v_rcp_f32 v231, v231
    v_mfma_f32_16x16x32_bf16 v[88:91], v[200:203], a[232:235], v[88:91]
    v_mul_f32 v155, v155, v231
    v_fma_f32 v224, v224, v233, v232
    v_mfma_f32_16x16x32_bf16 v[88:91], v[196:199], a[228:231], v[88:91]
    v_mul_f32 v228, v156, v156
    v_mul_f32 v224, v224, v148
    v_mfma_f32_16x16x32_bf16 v[88:91], v[192:195], a[224:227], v[88:91]
    s_waitcnt lgkmcnt(4)
    v_fma_f32 v228, v228, v233, v232
    v_mul_f32 v228, v228, v156
    v_mfma_f32_16x16x32_bf16 v[68:71], v[208:211], a[32:35], v[68:71]
    ds_read_b64_tr_b16 v[192:193], v236 offset:8192
    v_accvgpr_write_b32 a10, v10
    v_mfma_f32_16x16x32_bf16 v[68:71], v[212:215], a[36:39], v[68:71]
    s_waitcnt lgkmcnt(1)
    ds_read_b64_tr_b16 v[194:195], v236 offset:8448
    v_accvgpr_write_b32 a11, v11
    v_mfma_f32_16x16x32_bf16 v[68:71], v[216:219], a[40:43], v[68:71]
    ds_read_b64_tr_b16 v[196:197], v236 offset:10240
    v_accvgpr_write_b32 a16, v16
    v_mfma_f32_16x16x32_bf16 v[68:71], v[220:223], a[44:47], v[68:71]
    ds_read_b64_tr_b16 v[198:199], v236 offset:10496
    v_accvgpr_write_b32 a17, v17
    v_mfma_f32_16x16x32_bf16 v[76:79], v[220:223], a[108:111], v[76:79]
    ds_read_b64_tr_b16 v[200:201], v236 offset:12288
    v_accvgpr_write_b32 a18, v18
    v_mfma_f32_16x16x32_bf16 v[76:79], v[216:219], a[104:107], v[76:79]
    ds_read_b64_tr_b16 v[202:203], v236 offset:12544
    v_accvgpr_write_b32 a19, v19
    v_mfma_f32_16x16x32_bf16 v[76:79], v[212:215], a[100:103], v[76:79]
    ds_read_b64_tr_b16 v[204:205], v236 offset:14336
    v_accvgpr_write_b32 a24, v24
    v_mfma_f32_16x16x32_bf16 v[76:79], v[208:211], a[96:99], v[76:79]
    ds_read_b64_tr_b16 v[206:207], v236 offset:14592
    v_accvgpr_write_b32 a25, v25
    v_mfma_f32_16x16x32_bf16 v[84:87], v[208:211], a[160:163], v[84:87]
    v_exp_f32 v224, v224
    v_mfma_f32_16x16x32_bf16 v[84:87], v[212:215], a[164:167], v[84:87]
    v_mul_f32 v148, v148, v180
    v_add_f32 v224, 1.0, v224
    v_mfma_f32_16x16x32_bf16 v[84:87], v[216:219], a[168:171], v[84:87]
    v_exp_f32 v228, v228
    v_mfma_f32_16x16x32_bf16 v[84:87], v[220:223], a[172:175], v[84:87]
    v_mul_f32 v156, v156, v188
    v_add_f32 v228, 1.0, v228
    v_mfma_f32_16x16x32_bf16 v[92:95], v[220:223], a[236:239], v[92:95]
    v_rcp_f32 v224, v224
    v_mfma_f32_16x16x32_bf16 v[92:95], v[216:219], a[232:235], v[92:95]
    v_mul_f32 v148, v148, v224
    v_mul_f32 v225, v149, v149
    v_mfma_f32_16x16x32_bf16 v[92:95], v[212:215], a[228:231], v[92:95]
    v_rcp_f32 v228, v228
    v_mfma_f32_16x16x32_bf16 v[92:95], v[208:211], a[224:227], v[92:95]
    s_waitcnt lgkmcnt(4)
    v_mul_f32 v156, v156, v228
    v_fma_f32 v225, v225, v233, v232
    v_mfma_f32_16x16x32_bf16 v[96:99], v[192:195], a[32:35], v[96:99]
    ds_read_b64_tr_b16 v[208:209], v239 offset:8192
    v_mul_f32 v229, v157, v157
    v_mfma_f32_16x16x32_bf16 v[96:99], v[196:199], a[36:39], v[96:99]
    s_waitcnt lgkmcnt(1)
    ds_read_b64_tr_b16 v[210:211], v239 offset:8448
    v_mul_f32 v225, v225, v149
    v_mfma_f32_16x16x32_bf16 v[96:99], v[200:203], a[40:43], v[96:99]
    ds_read_b64_tr_b16 v[212:213], v239 offset:10240
    v_fma_f32 v229, v229, v233, v232
    v_mfma_f32_16x16x32_bf16 v[96:99], v[204:207], a[44:47], v[96:99]
    ds_read_b64_tr_b16 v[214:215], v239 offset:10496
    v_mul_f32 v229, v229, v157
    v_mfma_f32_16x16x32_bf16 v[104:107], v[204:207], a[108:111], v[104:107]
    ds_read_b64_tr_b16 v[216:217], v239 offset:12288
    v_accvgpr_write_b32 a26, v26
    v_mfma_f32_16x16x32_bf16 v[104:107], v[200:203], a[104:107], v[104:107]
    ds_read_b64_tr_b16 v[218:219], v239 offset:12544
    v_accvgpr_write_b32 a27, v27
    v_mfma_f32_16x16x32_bf16 v[104:107], v[196:199], a[100:103], v[104:107]
    ds_read_b64_tr_b16 v[220:221], v239 offset:14336
    v_accvgpr_write_b32 a4, v32
    v_mfma_f32_16x16x32_bf16 v[104:107], v[192:195], a[96:99], v[104:107]
    ds_read_b64_tr_b16 v[222:223], v239 offset:14592
    v_accvgpr_write_b32 a5, v33
    v_mfma_f32_16x16x32_bf16 v[112:115], v[192:195], a[160:163], v[112:115]
    v_exp_f32 v225, v225
    v_mfma_f32_16x16x32_bf16 v[112:115], v[196:199], a[164:167], v[112:115]
    v_mul_f32 v149, v149, v181
    v_add_f32 v225, 1.0, v225
    v_mfma_f32_16x16x32_bf16 v[112:115], v[200:203], a[168:171], v[112:115]
    v_exp_f32 v229, v229
    v_mfma_f32_16x16x32_bf16 v[112:115], v[204:207], a[172:175], v[112:115]
    v_mul_f32 v157, v157, v189
    v_add_f32 v229, 1.0, v229
    v_mfma_f32_16x16x32_bf16 v[120:123], v[204:207], a[236:239], v[120:123]
    v_rcp_f32 v225, v225
    v_mfma_f32_16x16x32_bf16 v[120:123], v[200:203], a[232:235], v[120:123]
    v_accvgpr_write_b32 a6, v34
    v_mul_f32 v149, v149, v225
    v_mfma_f32_16x16x32_bf16 v[120:123], v[196:199], a[228:231], v[120:123]
    v_rcp_f32 v229, v229
    v_mfma_f32_16x16x32_bf16 v[120:123], v[192:195], a[224:227], v[120:123]
    s_waitcnt lgkmcnt(4)
    v_accvgpr_write_b32 a7, v35
    v_mul_f32 v226, v150, v150
    v_mfma_f32_16x16x32_bf16 v[100:103], v[208:211], a[32:35], v[100:103]
    ds_read_b64_tr_b16 v[192:193], v236 offset:16384
    v_mul_f32 v157, v157, v229
    v_mfma_f32_16x16x32_bf16 v[100:103], v[212:215], a[36:39], v[100:103]
    s_waitcnt lgkmcnt(1)
    ds_read_b64_tr_b16 v[194:195], v236 offset:16640
    v_accvgpr_write_b32 a12, v40
    v_mfma_f32_16x16x32_bf16 v[100:103], v[216:219], a[40:43], v[100:103]
    ds_read_b64_tr_b16 v[196:197], v236 offset:18432
    v_fma_f32 v226, v226, v233, v232
    v_mfma_f32_16x16x32_bf16 v[100:103], v[220:223], a[44:47], v[100:103]
    ds_read_b64_tr_b16 v[198:199], v236 offset:18688
    v_mul_f32 v230, v158, v158
    v_mfma_f32_16x16x32_bf16 v[108:111], v[220:223], a[108:111], v[108:111]
    ds_read_b64_tr_b16 v[200:201], v236 offset:20480
    v_accvgpr_write_b32 a13, v41
    v_mfma_f32_16x16x32_bf16 v[108:111], v[216:219], a[104:107], v[108:111]
    ds_read_b64_tr_b16 v[202:203], v236 offset:20736
    v_mul_f32 v226, v226, v150
    v_mfma_f32_16x16x32_bf16 v[108:111], v[212:215], a[100:103], v[108:111]
    ds_read_b64_tr_b16 v[204:205], v236 offset:22528
    v_fma_f32 v230, v230, v233, v232
    v_mfma_f32_16x16x32_bf16 v[108:111], v[208:211], a[96:99], v[108:111]
    ds_read_b64_tr_b16 v[206:207], v236 offset:22784
    v_accvgpr_write_b32 a14, v42
    v_mfma_f32_16x16x32_bf16 v[116:119], v[208:211], a[160:163], v[116:119]
    v_mul_f32 v230, v230, v158
    v_accvgpr_write_b32 a15, v43
    v_mfma_f32_16x16x32_bf16 v[116:119], v[212:215], a[164:167], v[116:119]
    v_exp_f32 v226, v226
    v_mfma_f32_16x16x32_bf16 v[116:119], v[216:219], a[168:171], v[116:119]
    v_accvgpr_write_b32 a20, v48
    v_mul_f32 v150, v150, v182
    v_mfma_f32_16x16x32_bf16 v[116:119], v[220:223], a[172:175], v[116:119]
    v_exp_f32 v230, v230
    v_mfma_f32_16x16x32_bf16 v[124:127], v[220:223], a[236:239], v[124:127]
    v_accvgpr_write_b32 a21, v49
    v_add_f32 v226, 1.0, v226
    v_mfma_f32_16x16x32_bf16 v[124:127], v[216:219], a[232:235], v[124:127]
    v_mul_f32 v158, v158, v190
    v_accvgpr_write_b32 a22, v50
    v_mfma_f32_16x16x32_bf16 v[124:127], v[212:215], a[228:231], v[124:127]
    v_add_f32 v230, 1.0, v230
    v_accvgpr_write_b32 a23, v51
    v_mfma_f32_16x16x32_bf16 v[124:127], v[208:211], a[224:227], v[124:127]
    s_waitcnt lgkmcnt(4)
    v_rcp_f32 v226, v226
    v_mfma_f32_16x16x32_bf16 v[64:67], v[192:195], a[48:51], v[64:67]
    ds_read_b64_tr_b16 v[208:209], v239 offset:16384
    v_accvgpr_write_b32 a28, v56
    v_mfma_f32_16x16x32_bf16 v[64:67], v[196:199], a[52:55], v[64:67]
    s_waitcnt lgkmcnt(1)
    ds_read_b64_tr_b16 v[210:211], v239 offset:16640
    v_mul_f32 v150, v150, v226
    v_mfma_f32_16x16x32_bf16 v[64:67], v[200:203], a[56:59], v[64:67]
    ds_read_b64_tr_b16 v[212:213], v239 offset:18432
    v_accvgpr_write_b32 a29, v57
    v_mfma_f32_16x16x32_bf16 v[64:67], v[204:207], a[60:63], v[64:67]
    ds_read_b64_tr_b16 v[214:215], v239 offset:18688
    v_mul_f32 v227, v151, v151
    v_mfma_f32_16x16x32_bf16 v[72:75], v[204:207], a[124:127], v[72:75]
    ds_read_b64_tr_b16 v[216:217], v239 offset:20480
    v_accvgpr_write_b32 a30, v58
    v_mfma_f32_16x16x32_bf16 v[72:75], v[200:203], a[120:123], v[72:75]
    ds_read_b64_tr_b16 v[218:219], v239 offset:20736
    v_fma_f32 v227, v227, v233, v232
    v_mfma_f32_16x16x32_bf16 v[72:75], v[196:199], a[116:119], v[72:75]
    ds_read_b64_tr_b16 v[220:221], v239 offset:22528
    v_accvgpr_write_b32 a31, v59
    v_mfma_f32_16x16x32_bf16 v[72:75], v[192:195], a[112:115], v[72:75]
    ds_read_b64_tr_b16 v[222:223], v239 offset:22784
    v_mul_f32 v227, v227, v151
    v_mfma_f32_16x16x32_bf16 v[80:83], v[192:195], a[176:179], v[80:83]
    v_rcp_f32 v230, v230
    v_mfma_f32_16x16x32_bf16 v[80:83], v[196:199], a[180:183], v[80:83]
    v_mul_f32 v158, v158, v230
    v_mul_f32 v231, v159, v159
    v_mfma_f32_16x16x32_bf16 v[80:83], v[200:203], a[184:187], v[80:83]
    v_fma_f32 v231, v231, v233, v232
    v_mul_f32 v231, v231, v159
    v_mfma_f32_16x16x32_bf16 v[80:83], v[204:207], a[188:191], v[80:83]
    v_exp_f32 v227, v227
    v_mfma_f32_16x16x32_bf16 v[88:91], v[204:207], a[252:255], v[88:91]
    v_mul_f32 v151, v151, v183
    v_add_f32 v227, 1.0, v227
    v_mfma_f32_16x16x32_bf16 v[88:91], v[200:203], a[248:251], v[88:91]
    v_exp_f32 v231, v231
    v_mfma_f32_16x16x32_bf16 v[88:91], v[196:199], a[244:247], v[88:91]
    v_mul_f32 v159, v159, v191
    v_add_f32 v231, 1.0, v231
    v_mfma_f32_16x16x32_bf16 v[88:91], v[192:195], a[240:243], v[88:91]
    s_waitcnt lgkmcnt(4)
    v_rcp_f32 v227, v227
    v_mfma_f32_16x16x32_bf16 v[68:71], v[208:211], a[48:51], v[68:71]
    ds_read_b64_tr_b16 v[192:193], v236 offset:24576
    v_mul_f32 v151, v151, v227
    v_mfma_f32_16x16x32_bf16 v[68:71], v[212:215], a[52:55], v[68:71]
    s_waitcnt lgkmcnt(1)
    ds_read_b64_tr_b16 v[194:195], v236 offset:24832
    v_cvt_pk_bf16_f32 v144, v144, v145
    v_mfma_f32_16x16x32_bf16 v[68:71], v[216:219], a[56:59], v[68:71]
    ds_read_b64_tr_b16 v[196:197], v236 offset:26624
    ds_read_b128 a[212:215], v240 offset:5120
    v_mfma_f32_16x16x32_bf16 v[68:71], v[220:223], a[60:63], v[68:71]
    ds_read_b64_tr_b16 v[198:199], v236 offset:26880
    v_cvt_pk_bf16_f32 v145, v146, v147
    v_mfma_f32_16x16x32_bf16 v[76:79], v[220:223], a[124:127], v[76:79]
    ds_read_b64_tr_b16 v[200:201], v236 offset:28672
    ds_read_b128 a[216:219], v240 offset:6144
    v_mfma_f32_16x16x32_bf16 v[76:79], v[216:219], a[120:123], v[76:79]
    ds_read_b64_tr_b16 v[202:203], v236 offset:28928
    v_cvt_pk_bf16_f32 v146, v148, v149
    v_mfma_f32_16x16x32_bf16 v[76:79], v[212:215], a[116:119], v[76:79]
    ds_read_b64_tr_b16 v[204:205], v236 offset:30720
    ds_read_b128 a[220:223], v240 offset:7168
    v_mfma_f32_16x16x32_bf16 v[76:79], v[208:211], a[112:115], v[76:79]
    ds_read_b64_tr_b16 v[206:207], v236 offset:30976
    v_cvt_pk_bf16_f32 v147, v150, v151
    v_mfma_f32_16x16x32_bf16 v[84:87], v[208:211], a[176:179], v[84:87]
    v_rcp_f32 v231, v231
    v_mfma_f32_16x16x32_bf16 v[84:87], v[212:215], a[180:183], v[84:87]
    v_mul_f32 v159, v159, v231
    v_cvt_pk_bf16_f32 v152, v152, v153
    v_mfma_f32_16x16x32_bf16 v[84:87], v[216:219], a[184:187], v[84:87]
    buffer_store_dwordx4 v[128:131], v240, s[20:23], s98 offen sc1
    v_mfma_f32_16x16x32_bf16 v[84:87], v[220:223], a[188:191], v[84:87]
    v_cvt_pk_bf16_f32 v153, v154, v155
    v_cvt_pk_bf16_f32 v154, v156, v157
    v_mfma_f32_16x16x32_bf16 v[92:95], v[220:223], a[252:255], v[92:95]
    buffer_store_dwordx4 v[136:139], v246, s[20:23], s98 offen sc1
    v_mfma_f32_16x16x32_bf16 v[92:95], v[216:219], a[248:251], v[92:95]
    ds_read_b128 a[224:227], v240 offset:8192
    v_cvt_pk_bf16_f32 v155, v158, v159
    v_mfma_f32_16x16x32_bf16 v[92:95], v[212:215], a[244:247], v[92:95]
    buffer_store_dwordx4 v[144:147], v240, s[20:23], s99 offen sc1
    v_mfma_f32_16x16x32_bf16 v[92:95], v[208:211], a[240:243], v[92:95]
    s_waitcnt lgkmcnt(7)
    ds_read_b128 a[228:231], v240 offset:9216
    ds_read_b128 a[232:235], v240 offset:10240
    v_mfma_f32_16x16x32_bf16 v[96:99], v[192:195], a[48:51], v[96:99]
    ds_read_b64_tr_b16 v[208:209], v239 offset:24576
    ds_read_b128 a[236:239], v240 offset:11264
    v_mfma_f32_16x16x32_bf16 v[96:99], v[196:199], a[52:55], v[96:99]
    s_waitcnt lgkmcnt(5)
    ds_read_b64_tr_b16 v[210:211], v239 offset:24832
    v_mfma_f32_16x16x32_bf16 v[96:99], v[200:203], a[56:59], v[96:99]
    ds_read_b64_tr_b16 v[212:213], v239 offset:26624
    v_mfma_f32_16x16x32_bf16 v[96:99], v[204:207], a[60:63], v[96:99]
    ds_read_b64_tr_b16 v[214:215], v239 offset:26880
    v_mfma_f32_16x16x32_bf16 v[104:107], v[204:207], a[124:127], v[104:107]
    ds_read_b64_tr_b16 v[216:217], v239 offset:28672
    v_mfma_f32_16x16x32_bf16 v[104:107], v[200:203], a[120:123], v[104:107]
    ds_read_b64_tr_b16 v[218:219], v239 offset:28928
    v_cvt_pk_bf16_f32 v64, v64, v65
    v_mfma_f32_16x16x32_bf16 v[104:107], v[196:199], a[116:119], v[104:107]
    ds_read_b64_tr_b16 v[220:221], v239 offset:30720
    v_cvt_pk_bf16_f32 v65, v66, v67
    v_mfma_f32_16x16x32_bf16 v[104:107], v[192:195], a[112:115], v[104:107]
    ds_read_b64_tr_b16 v[222:223], v239 offset:30976
    v_accvgpr_write_b32 a64, v64
    v_mfma_f32_16x16x32_bf16 v[112:115], v[192:195], a[176:179], v[112:115]
    v_cvt_pk_bf16_f32 v66, v68, v69
    v_accvgpr_write_b32 a65, v65
    v_mfma_f32_16x16x32_bf16 v[112:115], v[196:199], a[180:183], v[112:115]
    v_cvt_pk_bf16_f32 v67, v70, v71
    v_accvgpr_write_b32 a66, v66
    v_mfma_f32_16x16x32_bf16 v[112:115], v[200:203], a[184:187], v[112:115]
    v_cvt_pk_bf16_f32 v72, v72, v73
    v_accvgpr_write_b32 a67, v67
    v_mfma_f32_16x16x32_bf16 v[112:115], v[204:207], a[188:191], v[112:115]
    v_cvt_pk_bf16_f32 v73, v74, v75
    v_accvgpr_write_b32 a72, v72
    v_mfma_f32_16x16x32_bf16 v[120:123], v[204:207], a[252:255], v[120:123]
    v_cvt_pk_bf16_f32 v74, v76, v77
    v_accvgpr_write_b32 a73, v73
    v_mfma_f32_16x16x32_bf16 v[120:123], v[200:203], a[248:251], v[120:123]
    v_cvt_pk_bf16_f32 v75, v78, v79
    v_accvgpr_write_b32 a74, v74
    v_mfma_f32_16x16x32_bf16 v[120:123], v[196:199], a[244:247], v[120:123]
    v_cvt_pk_bf16_f32 v80, v80, v81
    v_accvgpr_write_b32 a75, v75
    v_mfma_f32_16x16x32_bf16 v[120:123], v[192:195], a[240:243], v[120:123]
    s_waitcnt lgkmcnt(4)
    v_cvt_pk_bf16_f32 v81, v82, v83
    v_accvgpr_write_b32 a80, v80
    v_mfma_f32_16x16x32_bf16 v[100:103], v[208:211], a[48:51], v[100:103]
    v_cvt_pk_bf16_f32 v82, v84, v85
    v_accvgpr_write_b32 a81, v81
    v_mfma_f32_16x16x32_bf16 v[100:103], v[212:215], a[52:55], v[100:103]
    s_waitcnt lgkmcnt(0)
    v_cvt_pk_bf16_f32 v83, v86, v87
    v_accvgpr_write_b32 a82, v82
    v_mfma_f32_16x16x32_bf16 v[100:103], v[216:219], a[56:59], v[100:103]
    v_cvt_pk_bf16_f32 v88, v88, v89
    v_accvgpr_write_b32 a83, v83
    v_mfma_f32_16x16x32_bf16 v[100:103], v[220:223], a[60:63], v[100:103]
    v_cvt_pk_bf16_f32 v89, v90, v91
    v_accvgpr_write_b32 a88, v88
    v_mfma_f32_16x16x32_bf16 v[108:111], v[220:223], a[124:127], v[108:111]
    v_cvt_pk_bf16_f32 v90, v92, v93
    v_accvgpr_write_b32 a89, v89
    v_mfma_f32_16x16x32_bf16 v[108:111], v[216:219], a[120:123], v[108:111]
    buffer_store_dwordx4 v[152:155], v246, s[20:23], s99 offen sc1
    v_mfma_f32_16x16x32_bf16 v[108:111], v[212:215], a[116:119], v[108:111]
    v_cvt_pk_bf16_f32 v91, v94, v95
    v_accvgpr_write_b32 a90, v90
    v_mfma_f32_16x16x32_bf16 v[108:111], v[208:211], a[112:115], v[108:111]
    v_accvgpr_write_b32 a91, v91
    v_mfma_f32_16x16x32_bf16 v[116:119], v[208:211], a[176:179], v[116:119]
    v_mfma_f32_16x16x32_bf16 v[116:119], v[212:215], a[180:183], v[116:119]
    v_mfma_f32_16x16x32_bf16 v[116:119], v[216:219], a[184:187], v[116:119]
    v_mfma_f32_16x16x32_bf16 v[116:119], v[220:223], a[188:191], v[116:119]
    v_mfma_f32_16x16x32_bf16 v[124:127], v[220:223], a[252:255], v[124:127]
    v_mfma_f32_16x16x32_bf16 v[124:127], v[216:219], a[248:251], v[124:127]
    v_mfma_f32_16x16x32_bf16 v[124:127], v[212:215], a[244:247], v[124:127]
    v_mfma_f32_16x16x32_bf16 v[124:127], v[208:211], a[240:243], v[124:127]
    s_cmp_lg_u32 s30, 0
    s_cbranch_scc1 L_pu
    v_mfma_f32_16x16x32_bf16 v[0:3], a[192:195], a[0:3], 0
    s_mov_b32 s61, 0x5d800000
    ds_read_b128 a[240:243], v240 offset:12288
    v_and_b32 v241, 15, v254
    v_mfma_f32_16x16x32_bf16 v[16:19], a[192:195], a[8:11], 0
    s_lshl_b32 s99, s30, 7
    ds_read_b128 a[244:247], v240 offset:13312
    v_lshl_add_u32 v241, v255, 4, v241
    v_mfma_f32_16x16x32_bf16 v[32:35], a[192:195], a[16:19], 0
    s_add_u32 s99, s99, 0x5020000
    ds_read_b128 a[248:251], v240 offset:14336
    v_lshrrev_b32 v245, 4, v254
    v_mfma_f32_16x16x32_bf16 v[48:51], a[192:195], a[24:27], 0
    ds_read_b128 a[252:255], v240 offset:15360
    v_lshlrev_b32 v245, 2, v245
    v_mfma_f32_16x16x32_bf16 v[0:3], a[196:199], a[4:7], v[0:3]
    v_cvt_pk_bf16_f32 v96, v96, v97
    v_cvt_pk_bf16_f32 v97, v98, v99
    v_cvt_pk_bf16_f32 v98, v100, v101
    v_mfma_f32_16x16x32_bf16 v[16:19], a[196:199], a[12:15], v[16:19]
    v_cvt_pk_bf16_f32 v99, v102, v103
    v_cvt_pk_bf16_f32 v104, v104, v105
    v_accvgpr_write_b32 a68, v96
    v_cvt_pk_bf16_f32 v105, v106, v107
    v_accvgpr_write_b32 a69, v97
    v_cvt_pk_bf16_f32 v106, v108, v109
    v_accvgpr_write_b32 a70, v98
    v_mfma_f32_16x16x32_bf16 v[32:35], a[196:199], a[20:23], v[32:35]
    v_cvt_pk_bf16_f32 v107, v110, v111
    v_accvgpr_write_b32 a71, v99
    v_cvt_pk_bf16_f32 v112, v112, v113
    v_accvgpr_write_b32 a76, v104
    v_cvt_pk_bf16_f32 v113, v114, v115
    v_accvgpr_write_b32 a77, v105
    v_cvt_pk_bf16_f32 v114, v116, v117
    v_accvgpr_write_b32 a78, v106
    v_mfma_f32_16x16x32_bf16 v[48:51], a[196:199], a[28:31], v[48:51]
    v_cvt_pk_bf16_f32 v115, v118, v119
    v_accvgpr_write_b32 a79, v107
    v_cvt_pk_bf16_f32 v120, v120, v121
    v_accvgpr_write_b32 a84, v112
    v_cvt_pk_bf16_f32 v121, v122, v123
    v_accvgpr_write_b32 a85, v113
    v_cvt_pk_bf16_f32 v122, v124, v125
    v_accvgpr_write_b32 a86, v114
    v_mfma_f32_16x16x32_bf16 v[0:3], a[200:203], a[64:67], v[0:3]
    v_cvt_pk_bf16_f32 v123, v126, v127
    v_accvgpr_write_b32 a87, v115
    v_accvgpr_write_b32 a92, v120
    v_accvgpr_write_b32 a93, v121
    v_accvgpr_write_b32 a94, v122
    v_mfma_f32_16x16x32_bf16 v[16:19], a[200:203], a[72:75], v[16:19]
    s_lshl_b32 s98, s29, 10
    v_accvgpr_write_b32 a95, v123
    v_sub_u32 v241, v241, v245
    v_mfma_f32_16x16x32_bf16 v[32:35], a[200:203], a[80:83], v[32:35]
    s_add_u32 s98, s98, s99
    v_cvt_f32_i32 v241, v241
    v_add_f32 v241, 0.5, v241
    v_mfma_f32_16x16x32_bf16 v[48:51], a[200:203], a[88:91], v[48:51]
    s_mov_b32 s52, s49
    v_mul_f32 v199, 0x71800000, v241
    v_mfma_f32_16x16x32_bf16 v[0:3], a[204:207], a[68:71], v[0:3]
    s_add_u32 s53, s49, 114688
    s_add_u32 s54, s49, 131072
    v_mov_b32 v200, v240
    v_mfma_f32_16x16x32_bf16 v[16:19], a[204:207], a[76:79], v[16:19]
    s_add_u32 s55, s49, 114688
    v_add_u32 v201, 0x10000, v240
    v_and_b32 v206, 31, v254
    v_mfma_f32_16x16x32_bf16 v[32:35], a[204:207], a[84:87], v[32:35]
    s_mov_b32 s4, s38
    s_mov_b32 s5, s39
    v_lshlrev_b32 v206, 10, v206
    v_mfma_f32_16x16x32_bf16 v[48:51], a[204:207], a[92:95], v[48:51]
    s_mov_b32 s6, 0x400000
    v_and_b32 v252, 0xfff, v252
    v_mfma_f32_16x16x32_bf16 v[4:7], a[208:211], a[0:3], 0
    s_mov_b32 s7, 0x20000
    v_or_b32 v252, v252, v251
    v_and_b32 v192, 15, v254
    v_mfma_f32_16x16x32_bf16 v[20:23], a[208:211], a[8:11], 0
    s_lshl_b32 s59, s2, 2
    s_add_u32 s59, s59, s28
    v_min_u32 v192, 1, v192
    v_mfma_f32_16x16x32_bf16 v[36:39], a[208:211], a[16:19], 0
    s_lshl_b32 s50, s59, 12
    v_subrev_u32 v192, 1, v192
    v_and_b32 v192, 0x3f803f80, v192
    v_mfma_f32_16x16x32_bf16 v[52:55], a[208:211], a[24:27], 0
    s_mov_b32 s12, s96
    v_subrev_f32 v202, 0x0, v199
    v_mfma_f32_16x16x32_bf16 v[4:7], a[212:215], a[4:7], v[4:7]
    v_min_f32 v32, v32, v202
    v_subrev_f32 v203, 0x71800000, v199
    v_min_f32 v33, v33, v203
    v_subrev_f32 v202, 0x72000000, v199
    v_min_f32 v34, v34, v202
    v_subrev_f32 v203, 0x72400000, v199
    v_min_f32 v35, v35, v203
    v_max3_f32 v128, v0, v1, v2
    v_max_f32 v128, v128, v3
    v_max3_f32 v130, v16, v17, v18
    v_max_f32 v130, v130, v19
    v_max3_f32 v132, v32, v33, v34
    v_max_f32 v132, v132, v35
    v_max3_f32 v134, v48, v49, v50
    v_max_f32 v134, v134, v51
    v_mov_b32 v129, v128
    v_mov_b32 v131, v130
    v_mov_b32 v133, v132
    v_mov_b32 v135, v134
    v_permlane32_swap_b32 v128, v129
    v_permlane32_swap_b32 v130, v131
    v_permlane32_swap_b32 v132, v133
    v_permlane32_swap_b32 v134, v135
    v_max_f32 v128, v128, v129
    v_max_f32 v130, v130, v131
    v_max_f32 v132, v132, v133
    v_mfma_f32_16x16x32_bf16 v[20:23], a[212:215], a[12:15], v[20:23]
    v_max_f32 v134, v134, v135
    v_mov_b32 v129, v128
    v_mov_b32 v131, v130
    v_mov_b32 v133, v132
    v_mfma_f32_16x16x32_bf16 v[36:39], a[212:215], a[20:23], v[36:39]
    v_mov_b32 v135, v134
    v_permlane16_swap_b32 v128, v129
    v_permlane16_swap_b32 v130, v131
    v_permlane16_swap_b32 v132, v133
    v_mfma_f32_16x16x32_bf16 v[52:55], a[212:215], a[28:31], v[52:55]
    v_permlane16_swap_b32 v134, v135
    v_max_f32 v128, v128, v129
    v_max_f32 v130, v130, v131
    v_max_f32 v132, v132, v133
    v_mfma_f32_16x16x32_bf16 v[4:7], a[216:219], a[64:67], v[4:7]
    v_max_f32 v134, v134, v135
    v_add_f32 v128, 0x42800000, v128
    v_add_f32 v130, 0x42800000, v130
    v_add_f32 v132, 0x42800000, v132
    v_mfma_f32_16x16x32_bf16 v[20:23], a[216:219], a[72:75], v[20:23]
    v_add_f32 v134, 0x42800000, v134
    v_sub_f32 v160, 0, v128
    v_sub_f32 v161, 0, v128
    v_sub_f32 v162, 0, v128
    v_mfma_f32_16x16x32_bf16 v[36:39], a[216:219], a[80:83], v[36:39]
    v_sub_f32 v163, 0, v128
    v_sub_f32 v164, 0, v130
    v_sub_f32 v165, 0, v130
    v_sub_f32 v166, 0, v130
    v_mfma_f32_16x16x32_bf16 v[52:55], a[216:219], a[88:91], v[52:55]
    v_sub_f32 v167, 0, v130
    v_sub_f32 v168, 0, v132
    v_sub_f32 v169, 0, v132
    v_sub_f32 v170, 0, v132
    v_mfma_f32_16x16x32_bf16 v[4:7], a[220:223], a[68:71], v[4:7]
    v_sub_f32 v171, 0, v132
    v_sub_f32 v172, 0, v134
    v_sub_f32 v173, 0, v134
    v_sub_f32 v174, 0, v134
    v_mfma_f32_16x16x32_bf16 v[20:23], a[220:223], a[76:79], v[20:23]
    s_mov_b32 s13, s97
    v_sub_f32 v175, 0, v134
    v_sub_f32 v0, v0, v128
    v_mfma_f32_16x16x32_bf16 v[36:39], a[220:223], a[84:87], v[36:39]
    s_mov_b32 s14, 1835008
    v_sub_f32 v1, v1, v128
    v_sub_f32 v2, v2, v128
    v_mfma_f32_16x16x32_bf16 v[52:55], a[220:223], a[92:95], v[52:55]
    v_sub_f32 v3, v3, v128
    v_sub_f32 v16, v16, v130
    v_mfma_f32_16x16x32_bf16 v[8:11], a[224:227], a[0:3], v[160:163]
    s_mov_b32 m0, s52
    v_sub_f32 v17, v17, v130
    v_sub_f32 v18, v18, v130
    v_mfma_f32_16x16x32_bf16 v[24:27], a[224:227], a[8:11], v[164:167]
    v_sub_f32 v19, v19, v130
    v_sub_f32 v32, v32, v132
    v_sub_f32 v33, v33, v132
    v_sub_f32 v34, v34, v132
    v_mfma_f32_16x16x32_bf16 v[40:43], a[224:227], a[16:19], v[168:171]
    v_sub_f32 v35, v35, v132
    v_sub_f32 v48, v48, v134
    v_sub_f32 v49, v49, v134
    v_sub_f32 v50, v50, v134
    v_mfma_f32_16x16x32_bf16 v[56:59], a[224:227], a[24:27], v[172:175]
    v_sub_f32 v51, v51, v134
    v_subrev_f32 v202, 0x73800000, v199
    v_mfma_f32_16x16x32_bf16 v[8:11], a[228:231], a[4:7], v[8:11]
    v_min_f32 v36, v36, v202
    v_subrev_f32 v203, 0x73880000, v199
    v_min_f32 v37, v37, v203
    v_subrev_f32 v202, 0x73900000, v199
    v_min_f32 v38, v38, v202
    v_subrev_f32 v203, 0x73980000, v199
    v_mfma_f32_16x16x32_bf16 v[24:27], a[228:231], a[12:15], v[24:27]
    v_min_f32 v39, v39, v203
    v_sub_f32 v4, v4, v128
    v_sub_f32 v5, v5, v128
    v_sub_f32 v6, v6, v128
    v_mfma_f32_16x16x32_bf16 v[40:43], a[228:231], a[20:23], v[40:43]
    v_sub_f32 v7, v7, v128
    v_sub_f32 v20, v20, v130
    v_sub_f32 v21, v21, v130
    v_sub_f32 v22, v22, v130
    v_mfma_f32_16x16x32_bf16 v[56:59], a[228:231], a[28:31], v[56:59]
    v_sub_f32 v23, v23, v130
    v_sub_f32 v36, v36, v132
    v_sub_f32 v37, v37, v132
    v_sub_f32 v38, v38, v132
    v_mfma_f32_16x16x32_bf16 v[8:11], a[232:235], a[64:67], v[8:11]
    v_sub_f32 v39, v39, v132
    v_sub_f32 v52, v52, v134
    v_sub_f32 v53, v53, v134
    v_sub_f32 v54, v54, v134
    v_mfma_f32_16x16x32_bf16 v[24:27], a[232:235], a[72:75], v[24:27]
    v_sub_f32 v55, v55, v134
    v_subrev_f32 v202, 0x74000000, v199
    v_mfma_f32_16x16x32_bf16 v[40:43], a[232:235], a[80:83], v[40:43]
    v_mov_b32 v193, v192
    v_mov_b32 v194, v192
    v_mfma_f32_16x16x32_bf16 v[56:59], a[232:235], a[88:91], v[56:59]
    v_mov_b32 v195, v192
    v_lshrrev_b32 v244, 4, v254
    v_mfma_f32_16x16x32_bf16 v[8:11], a[236:239], a[68:71], v[8:11]
    v_and_b32 v245, 15, v254
    v_lshlrev_b32 v243, 1, v244
    v_mfma_f32_16x16x32_bf16 v[24:27], a[236:239], a[76:79], v[24:27]
    v_xor_b32 v245, v245, v243
    v_lshlrev_b32 v244, 10, v244
    v_mfma_f32_16x16x32_bf16 v[40:43], a[236:239], a[84:87], v[40:43]
    v_lshl_add_u32 v242, v245, 4, v244
    v_xor_b32 v243, 0x80, v242
    v_mfma_f32_16x16x32_bf16 v[56:59], a[236:239], a[92:95], v[56:59]
    s_waitcnt lgkmcnt(3)
    v_add_u32 v243, 3072, v243
    v_mov_b32 v232, -1
    v_mfma_f32_16x16x32_bf16 v[12:15], a[240:243], a[0:3], v[160:163]
    v_mov_b32 v233, -1
    v_mov_b32 v234, -1
    v_mfma_f32_16x16x32_bf16 v[28:31], a[240:243], a[8:11], v[164:167]
    v_mov_b32 v235, -1
    v_mfma_f32_16x16x32_bf16 v[44:47], a[240:243], a[16:19], v[168:171]
    v_mfma_f32_16x16x32_bf16 v[60:63], a[240:243], a[24:27], v[172:175]
    s_waitcnt lgkmcnt(2)
    v_mfma_f32_16x16x32_bf16 v[12:15], a[244:247], a[4:7], v[12:15]
    v_min_f32 v40, v40, v202
    v_subrev_f32 v203, 0x74040000, v199
    v_min_f32 v41, v41, v203
    v_subrev_f32 v202, 0x74080000, v199
    v_min_f32 v42, v42, v202
    v_subrev_f32 v203, 0x740c0000, v199
    v_min_f32 v43, v43, v203
    v_exp_f32 v0, v0
    v_exp_f32 v1, v1
    v_exp_f32 v2, v2
    v_exp_f32 v3, v3
    v_exp_f32 v16, v16
    v_exp_f32 v17, v17
    v_exp_f32 v18, v18
    v_exp_f32 v19, v19
    v_exp_f32 v32, v32
    v_exp_f32 v33, v33
    v_exp_f32 v34, v34
    v_exp_f32 v35, v35
    v_exp_f32 v48, v48
    v_exp_f32 v49, v49
    v_exp_f32 v50, v50
    v_exp_f32 v51, v51
    v_exp_f32 v4, v4
    v_exp_f32 v5, v5
    v_exp_f32 v6, v6
    v_mfma_f32_16x16x32_bf16 v[28:31], a[244:247], a[12:15], v[28:31]
    v_exp_f32 v7, v7
    v_exp_f32 v20, v20
    v_mfma_f32_16x16x32_bf16 v[44:47], a[244:247], a[20:23], v[44:47]
    v_exp_f32 v21, v21
    v_exp_f32 v22, v22
    v_mfma_f32_16x16x32_bf16 v[60:63], a[244:247], a[28:31], v[60:63]
    s_waitcnt lgkmcnt(1)
    v_exp_f32 v23, v23
    v_exp_f32 v36, v36
    v_mfma_f32_16x16x32_bf16 v[12:15], a[248:251], a[64:67], v[12:15]
    v_exp_f32 v37, v37
    v_exp_f32 v38, v38
    v_mfma_f32_16x16x32_bf16 v[28:31], a[248:251], a[72:75], v[28:31]
    v_exp_f32 v39, v39
    v_exp_f32 v52, v52
    v_mfma_f32_16x16x32_bf16 v[44:47], a[248:251], a[80:83], v[44:47]
    v_exp_f32 v53, v53
    v_exp_f32 v54, v54
    v_mfma_f32_16x16x32_bf16 v[60:63], a[248:251], a[88:91], v[60:63]
    s_waitcnt lgkmcnt(0)
    v_exp_f32 v55, v55
    v_exp_f32 v8, v8
    v_mfma_f32_16x16x32_bf16 v[12:15], a[252:255], a[68:71], v[12:15]
    v_exp_f32 v9, v9
    v_exp_f32 v24, v24
    v_mfma_f32_16x16x32_bf16 v[28:31], a[252:255], a[76:79], v[28:31]
    v_exp_f32 v25, v25
    v_exp_f32 v40, v40
    v_mfma_f32_16x16x32_bf16 v[44:47], a[252:255], a[84:87], v[44:47]
    v_exp_f32 v41, v41
    v_exp_f32 v56, v56
    v_mfma_f32_16x16x32_bf16 v[60:63], a[252:255], a[92:95], v[60:63]
    v_exp_f32 v57, v57
    s_waitcnt vmcnt(20)
    s_barrier
    ds_read_b128 a[192:195], v200 offset:32768
    ds_read_b128 a[196:199], v200 offset:33792
    ds_read_b128 a[200:203], v200 offset:34816
    ds_read_b128 a[204:207], v200 offset:35840
    ds_read_b128 a[208:211], v200 offset:36864
    ds_read_b128 a[212:215], v200 offset:37888
    ds_read_b128 a[216:219], v200 offset:38912
    ds_read_b128 a[220:223], v200 offset:39936
    buffer_load_dword v253, v252, s[4:7], s50 offen
    buffer_load_dword v251, v252, s[12:15], s50 offen
    s_mov_b32 s39, s50
    buffer_load_dwordx4 v240, s[16:19], s54 offen offset:0 sc1 lds
    buffer_load_dwordx4 v240, s[16:19], s54 offen offset:1024 sc1 lds
    buffer_load_dwordx4 v240, s[16:19], s54 offen offset:2048 sc1 lds
    buffer_load_dwordx4 v240, s[16:19], s54 offen offset:3072 sc1 lds
    s_mov_b32 m0, s53
    v_subrev_f32 v202, 0x74400000, v199
    v_min_f32 v44, v44, v202
    v_subrev_f32 v203, 0x74440000, v199
    v_min_f32 v45, v45, v203
    v_subrev_f32 v202, 0x74480000, v199
    v_min_f32 v46, v46, v202
    v_subrev_f32 v203, 0x744c0000, v199
    v_min_f32 v47, v47, v203
    s_waitcnt lgkmcnt(7)
    v_mfma_f32_16x16x32_bf16 v[64:67], a[192:195], a[0:3], v[160:163]
    s_waitcnt lgkmcnt(6)
    v_exp_f32 v10, v10
    v_mfma_f32_16x16x32_bf16 v[64:67], a[196:199], a[4:7], v[64:67]
    s_waitcnt lgkmcnt(5)
    v_exp_f32 v11, v11
    v_mfma_f32_16x16x32_bf16 v[64:67], a[200:203], a[64:67], v[64:67]
    s_waitcnt lgkmcnt(4)
    v_exp_f32 v12, v12
    v_mfma_f32_16x16x32_bf16 v[64:67], a[204:207], a[68:71], v[64:67]
    s_lshr_b32 s35, s34, 1
    v_exp_f32 v13, v13
    v_mfma_f32_16x16x32_bf16 v[80:83], a[204:207], a[76:79], v[164:167]
    s_sub_u32 s31, 15, s30
    ds_read_b128 a[224:227], v200 offset:40960
    ds_read_b128 a[228:231], v200 offset:41984
    v_mfma_f32_16x16x32_bf16 v[80:83], a[200:203], a[72:75], v[80:83]
    s_bitcmp1_b32 s34, 0
    s_cselect_b32 s31, s31, s30
    v_exp_f32 v14, v14
    v_mfma_f32_16x16x32_bf16 v[80:83], a[196:199], a[12:15], v[80:83]
    s_and_b32 s45, s29, 3
    ds_read_b128 a[232:235], v200 offset:43008
    ds_read_b128 a[236:239], v200 offset:44032
    v_mfma_f32_16x16x32_bf16 v[80:83], a[192:195], a[8:11], v[80:83]
    s_lshl_b32 s46, s31, 3
    v_exp_f32 v15, v15
    v_mfma_f32_16x16x32_bf16 v[112:115], a[192:195], a[24:27], v[172:175]
    s_add_u32 s46, s46, s28
    v_exp_f32 v26, v26
    v_mfma_f32_16x16x32_bf16 v[112:115], a[196:199], a[28:31], v[112:115]
    s_mul_i32 s46, s46, 188416
    v_exp_f32 v27, v27
    v_mfma_f32_16x16x32_bf16 v[112:115], a[200:203], a[88:91], v[112:115]
    s_add_u32 s46, s46, 0x2200000
    v_exp_f32 v28, v28
    v_mfma_f32_16x16x32_bf16 v[112:115], a[204:207], a[92:95], v[112:115]
    s_waitcnt lgkmcnt(7)
    v_cvt_pk_bf16_f32 v128, v0, v1
    v_cvt_pk_bf16_f32 v129, v2, v3
    v_mfma_f32_16x16x32_bf16 v[68:71], a[208:211], a[0:3], v[160:163]
    s_waitcnt lgkmcnt(6)
    buffer_load_dwordx4 v240, s[16:19], s55 offen offset:0 sc1 lds
    v_mfma_f32_16x16x32_bf16 v[68:71], a[212:215], a[4:7], v[68:71]
    s_waitcnt lgkmcnt(5)
    v_exp_f32 v29, v29
    v_mfma_f32_16x16x32_bf16 v[68:71], a[216:219], a[64:67], v[68:71]
    s_waitcnt lgkmcnt(4)
    v_cvt_pk_bf16_f32 v130, v4, v5
    v_cvt_pk_bf16_f32 v131, v6, v7
    v_mfma_f32_16x16x32_bf16 v[68:71], a[220:223], a[68:71], v[68:71]
    s_mul_i32 s47, s35, 14336
    ds_read_b128 a[240:243], v200 offset:45056
    v_cvt_pk_bf16_f32 v136, v16, v17
    v_mfma_f32_16x16x32_bf16 v[84:87], a[220:223], a[76:79], v[164:167]
    s_add_u32 s64, s46, s47
    v_exp_f32 v30, v30
    v_mfma_f32_16x16x32_bf16 v[84:87], a[216:219], a[72:75], v[84:87]
    s_add_u32 s64, s64, 131072
    ds_read_b128 a[244:247], v200 offset:46080
    v_cvt_pk_bf16_f32 v137, v18, v19
    v_mfma_f32_16x16x32_bf16 v[84:87], a[212:215], a[12:15], v[84:87]
    s_lshl_b32 s47, s35, 15
    ds_read_b128 a[248:251], v200 offset:47104
    v_cvt_pk_bf16_f32 v138, v20, v21
    v_mfma_f32_16x16x32_bf16 v[84:87], a[208:211], a[8:11], v[84:87]
    s_add_u32 s65, s46, s47
    v_exp_f32 v31, v31
    v_mfma_f32_16x16x32_bf16 v[116:119], a[208:211], a[24:27], v[172:175]
    s_lshl_b32 s46, s45, 8
    ds_read_b128 a[252:255], v200 offset:48128
    v_cvt_pk_bf16_f32 v139, v22, v23
    v_mfma_f32_16x16x32_bf16 v[116:119], a[212:215], a[28:31], v[116:119]
    s_lshl_b32 s47, s28, 13
    v_exp_f32 v42, v42
    v_mfma_f32_16x16x32_bf16 v[116:119], a[216:219], a[88:91], v[116:119]
    s_add_u32 s46, s46, s47
    v_cvt_pk_bf16_f32 v144, v32, v33
    v_cvt_pk_bf16_f32 v145, v34, v35
    v_mfma_f32_16x16x32_bf16 v[116:119], a[220:223], a[92:95], v[116:119]
    s_waitcnt lgkmcnt(7)
    v_exp_f32 v43, v43
    v_mfma_f32_16x16x32_bf16 v[72:75], a[224:227], a[0:3], v[160:163]
    s_waitcnt lgkmcnt(6)
    v_cvt_pk_bf16_f32 v146, v36, v37
    v_cvt_pk_bf16_f32 v147, v38, v39
    v_mfma_f32_16x16x32_bf16 v[72:75], a[228:231], a[4:7], v[72:75]
    s_waitcnt lgkmcnt(5)
    v_exp_f32 v44, v44
    v_mfma_f32_16x16x32_bf16 v[72:75], a[232:235], a[64:67], v[72:75]
    s_waitcnt lgkmcnt(4)
    v_cvt_pk_bf16_f32 v152, v48, v49
    v_cvt_pk_bf16_f32 v153, v50, v51
    v_mfma_f32_16x16x32_bf16 v[72:75], a[236:239], a[68:71], v[72:75]
    s_mul_i32 s47, s35, 458752
    v_exp_f32 v45, v45
    v_mfma_f32_16x16x32_bf16 v[88:91], a[236:239], a[76:79], v[164:167]
    s_add_u32 s48, s46, s47
    v_cvt_pk_bf16_f32 v154, v52, v53
    v_cvt_pk_bf16_f32 v155, v54, v55
    v_mfma_f32_16x16x32_bf16 v[88:91], a[232:235], a[72:75], v[88:91]
    s_lshl_b32 s47, s35, 20
    ds_read_b128 a[192:195], v200 offset:16384
    v_cvt_pk_bf16_f32 v132, v8, v9
    v_mfma_f32_16x16x32_bf16 v[88:91], a[228:231], a[12:15], v[88:91]
    s_add_u32 s49, s46, s47
    v_exp_f32 v46, v46
    v_mfma_f32_16x16x32_bf16 v[88:91], a[224:227], a[8:11], v[88:91]
    s_lshl_b32 s50, s28, 11
    ds_read_b128 a[196:199], v200 offset:24576
    v_cvt_pk_bf16_f32 v133, v10, v11
    v_mfma_f32_16x16x32_bf16 v[120:123], a[224:227], a[24:27], v[172:175]
    s_mov_b32 s8, s4
    v_exp_f32 v47, v47
    v_mfma_f32_16x16x32_bf16 v[120:123], a[228:231], a[28:31], v[120:123]
    s_mov_b32 s9, s5
    v_cvt_pk_bf16_f32 v134, v12, v13
    v_cvt_pk_bf16_f32 v135, v14, v15
    v_mfma_f32_16x16x32_bf16 v[120:123], a[232:235], a[88:91], v[120:123]
    s_mov_b32 s38, 0
    v_exp_f32 v58, v58
    v_mfma_f32_16x16x32_bf16 v[120:123], a[236:239], a[92:95], v[120:123]
    s_waitcnt lgkmcnt(5)
    v_cvt_pk_bf16_f32 v140, v24, v25
    v_cvt_pk_bf16_f32 v141, v26, v27
    v_mfma_f32_16x16x32_bf16 v[76:79], a[240:243], a[0:3], v[160:163]
    s_waitcnt lgkmcnt(4)
    v_exp_f32 v59, v59
    v_mfma_f32_16x16x32_bf16 v[76:79], a[244:247], a[4:7], v[76:79]
    s_waitcnt lgkmcnt(3)
    v_cvt_pk_bf16_f32 v142, v28, v29
    v_cvt_pk_bf16_f32 v143, v30, v31
    v_mfma_f32_16x16x32_bf16 v[76:79], a[248:251], a[64:67], v[76:79]
    s_waitcnt lgkmcnt(2)
    ds_read_b128 a[200:203], v200 offset:17408
    v_cvt_pk_bf16_f32 v148, v40, v41
    v_mfma_f32_16x16x32_bf16 v[76:79], a[252:255], a[68:71], v[76:79]
    s_mov_b32 s12, s96
    buffer_load_dwordx4 v240, s[16:19], s55 offen offset:1024 sc1 lds
    v_mfma_f32_16x16x32_bf16 v[92:95], a[252:255], a[76:79], v[164:167]
    s_mov_b32 s13, s97
    v_exp_f32 v60, v60
    v_mfma_f32_16x16x32_bf16 v[92:95], a[248:251], a[72:75], v[92:95]
    s_mov_b32 s14, 1835008
    ds_read_b128 a[204:207], v200 offset:25600
    v_cvt_pk_bf16_f32 v149, v42, v43
    v_mfma_f32_16x16x32_bf16 v[92:95], a[244:247], a[12:15], v[92:95]
    s_and_b32 s46, s34, 1
    v_exp_f32 v61, v61
    v_mfma_f32_16x16x32_bf16 v[92:95], a[240:243], a[8:11], v[92:95]
    s_lshl_b32 s46, s46, 2
    v_cvt_pk_bf16_f32 v150, v44, v45
    v_cvt_pk_bf16_f32 v151, v46, v47
    v_mfma_f32_16x16x32_bf16 v[124:127], a[240:243], a[24:27], v[172:175]
    s_add_u32 s3, s99, s46
    v_exp_f32 v62, v62
    v_mfma_f32_16x16x32_bf16 v[124:127], a[244:247], a[28:31], v[124:127]
    s_lshl_b32 s46, s35, 13
    v_cvt_pk_bf16_f32 v156, v56, v57
    v_cvt_pk_bf16_f32 v157, v58, v59
    v_mfma_f32_16x16x32_bf16 v[124:127], a[248:251], a[88:91], v[124:127]
    s_add_u32 s3, s3, s46
    v_exp_f32 v63, v63
    v_mfma_f32_16x16x32_bf16 v[124:127], a[252:255], a[92:95], v[124:127]
    s_waitcnt lgkmcnt(3)
    v_cvt_pk_bf16_f32 v158, v60, v61
    v_cvt_pk_bf16_f32 v159, v62, v63
    v_mfma_f32_16x16x32_bf16 a[32:35], a[192:195], v[128:131], 0
    s_waitcnt lgkmcnt(2)
    ds_read_b128 a[208:211], v200 offset:18432
    ds_read_b128 a[212:215], v200 offset:26624
    v_mfma_f32_16x16x32_bf16 a[32:35], a[196:199], v[132:135], a[32:35]
    s_lshl_b32 s51, s31, 2
    v_exp_f32 v64, v64
    v_mfma_f32_16x16x32_bf16 a[96:99], a[192:195], v[136:139], 0
    s_add_u32 s51, s51, s45
    ds_read_b128 a[216:219], v200 offset:19456
    v_subrev_f32 v202, 0x0, v199
    v_mfma_f32_16x16x32_bf16 a[96:99], a[196:199], v[140:143], a[96:99]
    s_lshl_b32 s56, s51, 18
    ds_read_b128 a[220:223], v200 offset:27648
    v_min_f32 v112, v112, v202
    v_mfma_f32_16x16x32_bf16 a[128:131], a[192:195], v[144:147], 0
    s_add_u32 s56, s56, 0x4000000
    v_exp_f32 v65, v65
    v_mfma_f32_16x16x32_bf16 a[128:131], a[196:199], v[148:151], a[128:131]
    s_lshl_b32 s46, s28, 12
    v_exp_f32 v66, v66
    v_mfma_f32_16x16x32_bf16 a[160:163], a[192:195], v[152:155], 0
    s_add_u32 s56, s56, s46
    v_exp_f32 v67, v67
    v_mfma_f32_16x16x32_bf16 a[160:163], a[196:199], v[156:159], a[160:163]
    s_waitcnt lgkmcnt(5)
    buffer_load_dwordx4 v240, s[16:19], s55 offen offset:2048 sc1 lds
    v_mfma_f32_16x16x32_bf16 a[36:39], a[200:203], v[128:131], 0
    s_waitcnt lgkmcnt(4)
    v_exp_f32 v80, v80
    v_mfma_f32_16x16x32_bf16 a[36:39], a[204:207], v[132:135], a[36:39]
    s_lshl_b32 s46, s35, 16
    v_exp_f32 v81, v81
    v_mfma_f32_16x16x32_bf16 a[100:103], a[200:203], v[136:139], 0
    s_add_u32 s40, s56, s46
    ds_read_b128 a[224:227], v200 offset:20480
    v_subrev_f32 v203, 0x71800000, v199
    v_mfma_f32_16x16x32_bf16 a[100:103], a[204:207], v[140:143], a[100:103]
    s_add_u32 s40, s40, 16384
    ds_read_b128 a[228:231], v200 offset:28672
    v_min_f32 v113, v113, v203
    v_mfma_f32_16x16x32_bf16 a[132:135], a[200:203], v[144:147], 0
    s_xor_b32 s46, s35, 1
    v_exp_f32 v82, v82
    v_mfma_f32_16x16x32_bf16 a[132:135], a[204:207], v[148:151], a[132:135]
    s_lshl_b32 s46, s46, 16
    v_exp_f32 v83, v83
    v_mfma_f32_16x16x32_bf16 a[164:167], a[200:203], v[152:155], 0
    s_add_u32 s46, s46, 16384
    v_exp_f32 v112, v112
    v_mfma_f32_16x16x32_bf16 a[164:167], a[204:207], v[156:159], a[164:167]
    s_waitcnt lgkmcnt(5)
    v_exp_f32 v113, v113
    v_mfma_f32_16x16x32_bf16 a[40:43], a[208:211], v[128:131], 0
    s_waitcnt lgkmcnt(4)
    v_subrev_f32 v202, 0x72000000, v199
    v_min_f32 v114, v114, v202
    v_mfma_f32_16x16x32_bf16 a[40:43], a[212:215], v[132:135], a[40:43]
    s_add_u32 s36, s56, s46
    v_exp_f32 v114, v114
    v_mfma_f32_16x16x32_bf16 a[104:107], a[208:211], v[136:139], 0
    s_xor_b32 s46, s35, 2
    ds_read_b128 a[232:235], v200 offset:21504
    v_subrev_f32 v203, 0x72400000, v199
    v_mfma_f32_16x16x32_bf16 a[104:107], a[212:215], v[140:143], a[104:107]
    s_lshl_b32 s46, s46, 16
    ds_read_b128 a[236:239], v200 offset:29696
    v_min_f32 v115, v115, v203
    v_mfma_f32_16x16x32_bf16 a[136:139], a[208:211], v[144:147], 0
    s_add_u32 s46, s46, 32768
    v_exp_f32 v115, v115
    v_mfma_f32_16x16x32_bf16 a[136:139], a[212:215], v[148:151], a[136:139]
    s_add_u32 s37, s56, s46
    v_exp_f32 v68, v68
    v_mfma_f32_16x16x32_bf16 a[168:171], a[208:211], v[152:155], 0
    s_xor_b32 s46, s35, 3
    v_exp_f32 v69, v69
    v_mfma_f32_16x16x32_bf16 a[168:171], a[212:215], v[156:159], a[168:171]
    s_waitcnt lgkmcnt(5)
    v_exp_f32 v70, v70
    v_mfma_f32_16x16x32_bf16 a[44:47], a[216:219], v[128:131], 0
    s_waitcnt lgkmcnt(4)
    buffer_load_dwordx4 v240, s[16:19], s55 offen offset:3072 sc1 lds
    v_mfma_f32_16x16x32_bf16 a[44:47], a[220:223], v[132:135], a[44:47]
    s_add_u32 s54, s54, 0x8000
    v_exp_f32 v71, v71
    v_mfma_f32_16x16x32_bf16 a[108:111], a[216:219], v[136:139], 0
    s_add_u32 s52, s52, 0x8000
    ds_read_b128 a[240:243], v200 offset:22528
    v_subrev_f32 v202, 0x73800000, v199
    v_mfma_f32_16x16x32_bf16 a[108:111], a[220:223], v[140:143], a[108:111]
    s_and_b32 s52, s52, 0x1ffff
    ds_read_b128 a[244:247], v200 offset:30720
    v_min_f32 v116, v116, v202
    v_mfma_f32_16x16x32_bf16 a[140:143], a[216:219], v[144:147], 0
    s_mov_b32 m0, s52
    v_exp_f32 v84, v84
    v_mfma_f32_16x16x32_bf16 a[140:143], a[220:223], v[148:151], a[140:143]
    s_add_u32 s55, s55, 0x8000
    v_exp_f32 v85, v85
    v_mfma_f32_16x16x32_bf16 a[172:175], a[216:219], v[152:155], 0
    s_add_u32 s53, s53, 0x8000
    v_subrev_f32 v203, 0x73880000, v199
    v_min_f32 v117, v117, v203
    v_mfma_f32_16x16x32_bf16 a[172:175], a[220:223], v[156:159], a[172:175]
    s_waitcnt lgkmcnt(5)
    v_exp_f32 v86, v86
    v_mfma_f32_16x16x32_bf16 a[48:51], a[224:227], v[128:131], 0
    s_waitcnt lgkmcnt(4)
    v_subrev_f32 v202, 0x73900000, v199
    v_min_f32 v118, v118, v202
    v_mfma_f32_16x16x32_bf16 a[48:51], a[228:231], v[132:135], a[48:51]
    s_and_b32 s53, s53, 0x1ffff
    v_exp_f32 v87, v87
    v_mfma_f32_16x16x32_bf16 a[112:115], a[224:227], v[136:139], 0
    s_lshl_b32 s46, s46, 16
    ds_read_b128 a[248:251], v200 offset:23552
    v_subrev_f32 v203, 0x73980000, v199
    v_mfma_f32_16x16x32_bf16 a[112:115], a[228:231], v[140:143], a[112:115]
    s_add_u32 s46, s46, 49152
    ds_read_b128 a[252:255], v200 offset:31744
    v_min_f32 v119, v119, v203
    v_mfma_f32_16x16x32_bf16 a[144:147], a[224:227], v[144:147], 0
    s_add_u32 s41, s56, s46
    v_exp_f32 v116, v116
    v_mfma_f32_16x16x32_bf16 a[144:147], a[228:231], v[148:151], a[144:147]
    s_lshl_b32 s94, s51, 9
    v_subrev_f32 v202, 0x74000000, v199
    v_min_f32 v120, v120, v202
    v_mfma_f32_16x16x32_bf16 a[176:179], a[224:227], v[152:155], 0
    s_add_u32 s94, s94, 0x5000000
    v_exp_f32 v117, v117
    v_mfma_f32_16x16x32_bf16 a[176:179], a[228:231], v[156:159], a[176:179]
    s_waitcnt lgkmcnt(5)
    v_subrev_f32 v203, 0x74040000, v199
    v_min_f32 v121, v121, v203
    v_mfma_f32_16x16x32_bf16 a[52:55], a[232:235], v[128:131], 0
    s_waitcnt lgkmcnt(4)
    v_exp_f32 v118, v118
    v_mfma_f32_16x16x32_bf16 a[52:55], a[236:239], v[132:135], a[52:55]
    s_lshl_b32 s46, s35, 7
    v_subrev_f32 v202, 0x74080000, v199
    v_min_f32 v122, v122, v202
    v_mfma_f32_16x16x32_bf16 a[116:119], a[232:235], v[136:139], 0
    s_add_u32 s95, s94, s46
    v_exp_f32 v119, v119
    v_mfma_f32_16x16x32_bf16 a[116:119], a[236:239], v[140:143], a[116:119]
    s_lshl_b32 s46, s31, 17
    v_subrev_f32 v203, 0x740c0000, v199
    v_min_f32 v123, v123, v203
    v_mfma_f32_16x16x32_bf16 a[148:151], a[232:235], v[144:147], 0
    s_lshl_b32 s47, s28, 14
    v_exp_f32 v72, v72
    v_mfma_f32_16x16x32_bf16 a[148:151], a[236:239], v[148:151], a[148:151]
    s_add_u32 s46, s46, s47
    v_subrev_f32 v202, 0x74400000, v199
    v_min_f32 v124, v124, v202
    v_mfma_f32_16x16x32_bf16 a[180:183], a[232:235], v[152:155], 0
    s_lshl_b32 s47, s45, 8
    v_exp_f32 v73, v73
    v_mfma_f32_16x16x32_bf16 a[180:183], a[236:239], v[156:159], a[180:183]
    s_waitcnt lgkmcnt(3)
    v_subrev_f32 v203, 0x74440000, v199
    v_min_f32 v125, v125, v203
    v_mfma_f32_16x16x32_bf16 a[56:59], a[240:243], v[128:131], 0
    s_waitcnt lgkmcnt(2)
    v_exp_f32 v88, v88
    v_mfma_f32_16x16x32_bf16 a[56:59], a[244:247], v[132:135], a[56:59]
    s_add_u32 s46, s46, s47
    v_subrev_f32 v202, 0x74480000, v199
    v_min_f32 v126, v126, v202
    v_mfma_f32_16x16x32_bf16 a[120:123], a[240:243], v[136:139], 0
    s_waitcnt vmcnt(10) lgkmcnt(0)
    v_exp_f32 v89, v89
    v_mfma_f32_16x16x32_bf16 a[120:123], a[244:247], v[140:143], a[120:123]
    s_barrier
    ds_read_b128 a[192:195], v201 offset:0
    ds_read_b128 a[196:199], v201 offset:1024
    v_mfma_f32_16x16x32_bf16 a[152:155], a[240:243], v[144:147], 0
    s_lshr_b32 s47, s35, 1
    buffer_load_dwordx4 v240, s[16:19], s54 offen offset:0 sc1 lds
    v_mfma_f32_16x16x32_bf16 a[152:155], a[244:247], v[148:151], a[152:155]
    s_lshl_b32 s47, s47, 7
    ds_read_b128 a[200:203], v201 offset:2048
    ds_read_b128 a[204:207], v201 offset:3072
    v_mfma_f32_16x16x32_bf16 a[184:187], a[240:243], v[152:155], 0
    s_add_u32 s46, s46, s47
    ds_read_b128 a[208:211], v201 offset:4096
    ds_read_b128 a[212:215], v201 offset:5120
    v_mfma_f32_16x16x32_bf16 a[184:187], a[244:247], v[156:159], a[184:187]
    buffer_load_dwordx4 v240, s[16:19], s54 offen offset:1024 sc1 lds
    v_mfma_f32_16x16x32_bf16 a[60:63], a[248:251], v[128:131], 0
    ds_read_b128 a[216:219], v201 offset:6144
    ds_read_b128 a[220:223], v201 offset:7168
    v_mfma_f32_16x16x32_bf16 a[60:63], a[252:255], v[132:135], a[60:63]
    s_and_b32 s47, s35, 1
    v_subrev_f32 v203, 0x744c0000, v199
    v_min_f32 v127, v127, v203
    v_mfma_f32_16x16x32_bf16 a[124:127], a[248:251], v[136:139], 0
    s_lshl_b32 s47, s47, 16
    v_exp_f32 v120, v120
    v_mfma_f32_16x16x32_bf16 a[124:127], a[252:255], v[140:143], a[124:127]
    s_add_u32 s57, s46, s47
    v_xor_b32 v200, 0x10000, v200
    v_xor_b32 v201, 0x10000, v201
    v_mfma_f32_16x16x32_bf16 a[156:159], a[248:251], v[144:147], 0
    s_lshl_b32 s46, s29, 12
    buffer_load_dwordx4 v240, s[16:19], s54 offen offset:2048 sc1 lds
    v_mfma_f32_16x16x32_bf16 a[156:159], a[252:255], v[148:151], a[156:159]
    s_add_u32 s100, s46, s32
    v_exp_f32 v121, v121
    v_mfma_f32_16x16x32_bf16 a[188:191], a[248:251], v[152:155], 0
    s_add_u32 s101, s46, s33
    v_mfma_f32_16x16x32_bf16 a[188:191], a[252:255], v[156:159], a[188:191]
    s_and_b32 s32, s30, 1
    v_mfma_f32_16x16x32_bf16 v[176:179], v[192:195], v[128:131], 0
    s_lshl_b32 s32, s32, 16
    buffer_load_dwordx4 v240, s[16:19], s54 offen offset:3072 sc1 lds
    v_mfma_f32_16x16x32_bf16 v[176:179], v[192:195], v[132:135], v[176:179]
    s_mov_b32 m0, s53
    v_mfma_f32_16x16x32_bf16 v[180:183], v[192:195], v[136:139], 0
    s_xor_b32 s33, s32, 0x10000
    v_mfma_f32_16x16x32_bf16 v[180:183], v[192:195], v[140:143], v[180:183]
    s_add_u32 s51, s50, s32
    v_mfma_f32_16x16x32_bf16 v[184:187], v[192:195], v[144:147], 0
    s_add_u32 s56, s50, s33
    v_mfma_f32_16x16x32_bf16 v[184:187], v[192:195], v[148:151], v[184:187]
    v_mfma_f32_16x16x32_bf16 v[188:191], v[192:195], v[152:155], 0
    v_mfma_f32_16x16x32_bf16 v[188:191], v[192:195], v[156:159], v[188:191]
    s_waitcnt lgkmcnt(7)
    s_bitcmp1_b32 s35, 0
    s_cselect_b64 vcc, -1, 0
    v_cndmask_b32 v196, v240, v246, vcc
    v_cndmask_b32 v198, v246, v240, vcc
    buffer_store_dword v249, v248, s[20:23], s98 offen sc1
L_uds:
    v_mfma_f32_16x16x32_bf16 v[0:3], a[192:195], a[0:3], v[160:163]
    s_waitcnt lgkmcnt(6)
    v_exp_f32 v74, v74
    v_mfma_f32_16x16x32_bf16 v[0:3], a[196:199], a[4:7], v[0:3]
    s_waitcnt lgkmcnt(5)
    v_exp_f32 v75, v75
    v_mfma_f32_16x16x32_bf16 v[0:3], a[200:203], a[64:67], v[0:3]
    s_waitcnt lgkmcnt(4)
    v_exp_f32 v76, v76
    v_mfma_f32_16x16x32_bf16 v[0:3], a[204:207], a[68:71], v[0:3]
    ds_read_b128 a[224:227], v200 offset:8192
    ds_read_b128 a[228:231], v200 offset:9216
    v_mfma_f32_16x16x32_bf16 v[16:19], a[204:207], a[76:79], v[164:167]
    v_exp_f32 v77, v77
    v_mfma_f32_16x16x32_bf16 v[16:19], a[200:203], a[72:75], v[16:19]
    ds_read_b128 a[232:235], v200 offset:10240
    ds_read_b128 a[236:239], v200 offset:11264
    v_mfma_f32_16x16x32_bf16 v[16:19], a[196:199], a[12:15], v[16:19]
    v_exp_f32 v78, v78
    v_mfma_f32_16x16x32_bf16 v[16:19], a[192:195], a[8:11], v[16:19]
    s_waitcnt lgkmcnt(7)
    v_exp_f32 v79, v79
    v_mfma_f32_16x16x32_bf16 v[4:7], a[208:211], a[0:3], v[160:163]
    s_waitcnt lgkmcnt(6)
    v_exp_f32 v90, v90
    v_mfma_f32_16x16x32_bf16 v[4:7], a[212:215], a[4:7], v[4:7]
    s_waitcnt lgkmcnt(5)
    v_cvt_pk_bf16_f32 v128, v64, v65
    v_cvt_pk_bf16_f32 v129, v66, v67
    v_mfma_f32_16x16x32_bf16 v[4:7], a[216:219], a[64:67], v[4:7]
    s_waitcnt lgkmcnt(4)
    ds_read_b128 a[240:243], v200 offset:12288
    v_cvt_pk_bf16_f32 v130, v68, v69
    v_mfma_f32_16x16x32_bf16 v[4:7], a[220:223], a[68:71], v[4:7]
    v_exp_f32 v91, v91
    v_mfma_f32_16x16x32_bf16 v[20:23], a[220:223], a[76:79], v[164:167]
    ds_read_b128 a[244:247], v200 offset:13312
    v_cvt_pk_bf16_f32 v131, v70, v71
    v_mfma_f32_16x16x32_bf16 v[20:23], a[216:219], a[72:75], v[20:23]
    buffer_load_dwordx4 v240, s[16:19], s55 offen offset:0 sc1 lds
    v_mfma_f32_16x16x32_bf16 v[20:23], a[212:215], a[12:15], v[20:23]
    ds_read_b128 a[248:251], v200 offset:14336
    v_cvt_pk_bf16_f32 v136, v80, v81
    v_mfma_f32_16x16x32_bf16 v[20:23], a[208:211], a[8:11], v[20:23]
    s_waitcnt lgkmcnt(6)
    v_exp_f32 v92, v92
    v_mfma_f32_16x16x32_bf16 v[8:11], a[224:227], a[0:3], v[160:163]
    s_waitcnt lgkmcnt(5)
    ds_read_b128 a[252:255], v200 offset:15360
    v_cvt_pk_bf16_f32 v137, v82, v83
    v_mfma_f32_16x16x32_bf16 v[8:11], a[228:231], a[4:7], v[8:11]
    s_waitcnt lgkmcnt(5)
    v_exp_f32 v93, v93
    v_mfma_f32_16x16x32_bf16 v[8:11], a[232:235], a[64:67], v[8:11]
    s_waitcnt lgkmcnt(4)
    v_cvt_pk_bf16_f32 v138, v84, v85
    v_cvt_pk_bf16_f32 v139, v86, v87
    v_mfma_f32_16x16x32_bf16 v[8:11], a[236:239], a[68:71], v[8:11]
    v_exp_f32 v94, v94
    v_mfma_f32_16x16x32_bf16 v[24:27], a[236:239], a[76:79], v[164:167]
    v_cvt_pk_bf16_f32 v152, v112, v113
    v_cvt_pk_bf16_f32 v153, v114, v115
    v_mfma_f32_16x16x32_bf16 v[24:27], a[232:235], a[72:75], v[24:27]
    ds_read_b128 a[192:195], v201 offset:49152
    v_cvt_pk_bf16_f32 v154, v116, v117
    v_mfma_f32_16x16x32_bf16 v[24:27], a[228:231], a[12:15], v[24:27]
    v_exp_f32 v95, v95
    v_mfma_f32_16x16x32_bf16 v[24:27], a[224:227], a[8:11], v[24:27]
    s_waitcnt lgkmcnt(4)
    ds_read_b128 a[196:199], v201 offset:57344
    v_cvt_pk_bf16_f32 v155, v118, v119
    v_mfma_f32_16x16x32_bf16 v[12:15], a[240:243], a[0:3], v[160:163]
    s_waitcnt lgkmcnt(4)
    v_exp_f32 v122, v122
    v_cvt_pk_bf16_f32 v132, v72, v73
    v_mfma_f32_16x16x32_bf16 v[12:15], a[244:247], a[4:7], v[12:15]
    s_waitcnt lgkmcnt(3)
    v_cvt_pk_bf16_f32 v133, v74, v75
    v_cvt_pk_bf16_f32 v134, v76, v77
    v_mfma_f32_16x16x32_bf16 v[12:15], a[248:251], a[64:67], v[12:15]
    s_waitcnt lgkmcnt(2)
    v_exp_f32 v123, v123
    v_mfma_f32_16x16x32_bf16 v[12:15], a[252:255], a[68:71], v[12:15]
    ds_read_b128 a[200:203], v201 offset:50176
    v_cvt_pk_bf16_f32 v135, v78, v79
    v_mfma_f32_16x16x32_bf16 v[28:31], a[252:255], a[76:79], v[164:167]
    v_exp_f32 v124, v124
    v_cvt_pk_bf16_f32 v140, v88, v89
    v_mfma_f32_16x16x32_bf16 v[28:31], a[248:251], a[72:75], v[28:31]
    ds_read_b128 a[204:207], v201 offset:58368
    buffer_load_dwordx4 v240, s[16:19], s55 offen offset:1024 sc1 lds
    v_cvt_pk_bf16_f32 v141, v90, v91
    v_mfma_f32_16x16x32_bf16 v[28:31], a[244:247], a[12:15], v[28:31]
    v_exp_f32 v125, v125
    v_cvt_pk_bf16_f32 v142, v92, v93
    v_mfma_f32_16x16x32_bf16 v[28:31], a[240:243], a[8:11], v[28:31]
    s_waitcnt lgkmcnt(3)
    v_cvt_pk_bf16_f32 v143, v94, v95
    v_cvt_pk_bf16_f32 v156, v120, v121
    v_mfma_f32_16x16x32_bf16 a[32:35], a[192:195], v[128:131], a[32:35]
    s_waitcnt lgkmcnt(2)
    v_exp_f32 v126, v126
    v_mfma_f32_16x16x32_bf16 a[32:35], a[196:199], v[132:135], a[32:35]
    ds_read_b128 a[208:211], v201 offset:51200
    v_cvt_pk_bf16_f32 v157, v122, v123
    v_mfma_f32_16x16x32_bf16 a[96:99], a[192:195], v[136:139], a[96:99]
    v_exp_f32 v127, v127
    v_cvt_pk_bf16_f32 v158, v124, v125
    v_mfma_f32_16x16x32_bf16 a[96:99], a[196:199], v[140:143], a[96:99]
    ds_read_b128 a[212:215], v201 offset:59392
    v_cvt_pk_bf16_f32 v159, v126, v127
    v_mfma_f32_16x16x32_bf16 a[160:163], a[192:195], v[152:155], a[160:163]
    ds_read_b128 a[216:219], v201 offset:52224
    ds_read_b128 a[220:223], v201 offset:60416
    v_mfma_f32_16x16x32_bf16 a[160:163], a[196:199], v[156:159], a[160:163]
    s_waitcnt lgkmcnt(5)
    buffer_load_dwordx4 v240, s[16:19], s55 offen offset:2048 sc1 lds
    v_mfma_f32_16x16x32_bf16 a[36:39], a[200:203], v[128:131], a[36:39]
    s_waitcnt lgkmcnt(4)
    ds_read_b128 a[224:227], v201 offset:53248
    ds_read_b128 a[228:231], v201 offset:61440
    v_mfma_f32_16x16x32_bf16 a[36:39], a[204:207], v[132:135], a[36:39]
    v_exp_f32 v0, v0
    v_mfma_f32_16x16x32_bf16 a[100:103], a[200:203], v[136:139], a[100:103]
    v_exp_f32 v1, v1
    v_mfma_f32_16x16x32_bf16 a[100:103], a[204:207], v[140:143], a[100:103]
    v_exp_f32 v2, v2
    v_mfma_f32_16x16x32_bf16 a[164:167], a[200:203], v[152:155], a[164:167]
    ds_read_b128 a[232:235], v201 offset:54272
    ds_read_b128 a[236:239], v201 offset:62464
    v_mfma_f32_16x16x32_bf16 a[164:167], a[204:207], v[156:159], a[164:167]
    s_waitcnt lgkmcnt(7)
    v_exp_f32 v3, v3
    v_mfma_f32_16x16x32_bf16 a[40:43], a[208:211], v[128:131], a[40:43]
    s_waitcnt lgkmcnt(6)
    v_exp_f32 v16, v16
    v_mfma_f32_16x16x32_bf16 a[40:43], a[212:215], v[132:135], a[40:43]
    buffer_load_dwordx4 v240, s[16:19], s55 offen offset:3072 sc1 lds
    v_mfma_f32_16x16x32_bf16 a[104:107], a[208:211], v[136:139], a[104:107]
    s_add_u32 s54, s54, 0x8000
    s_add_u32 s52, s52, 0x8000
    ds_read_b128 a[240:243], v201 offset:55296
    v_mfma_f32_16x16x32_bf16 a[104:107], a[212:215], v[140:143], a[104:107]
    s_and_b32 s52, s52, 0x1ffff
    s_mov_b32 m0, s52
    ds_read_b128 a[244:247], v201 offset:63488
    v_mfma_f32_16x16x32_bf16 a[168:171], a[208:211], v[152:155], a[168:171]
    s_add_u32 s55, s55, 0x8000
    v_exp_f32 v17, v17
    v_mfma_f32_16x16x32_bf16 a[168:171], a[212:215], v[156:159], a[168:171]
    s_waitcnt lgkmcnt(7)
    v_exp_f32 v18, v18
    v_mfma_f32_16x16x32_bf16 a[44:47], a[216:219], v[128:131], a[44:47]
    s_waitcnt lgkmcnt(6)
    v_exp_f32 v19, v19
    v_mfma_f32_16x16x32_bf16 a[44:47], a[220:223], v[132:135], a[44:47]
    s_add_u32 s53, s53, 0x8000
    v_exp_f32 v4, v4
    v_mfma_f32_16x16x32_bf16 a[108:111], a[216:219], v[136:139], a[108:111]
    s_and_b32 s53, s53, 0x1ffff
    ds_read_b128 a[248:251], v201 offset:56320
    v_mfma_f32_16x16x32_bf16 a[108:111], a[220:223], v[140:143], a[108:111]
    ds_read_b128 a[252:255], v201 offset:64512
    v_mfma_f32_16x16x32_bf16 a[172:175], a[216:219], v[152:155], a[172:175]
    v_exp_f32 v5, v5
    v_mfma_f32_16x16x32_bf16 a[172:175], a[220:223], v[156:159], a[172:175]
    s_waitcnt lgkmcnt(7)
    v_exp_f32 v6, v6
    v_mfma_f32_16x16x32_bf16 a[48:51], a[224:227], v[128:131], a[48:51]
    s_waitcnt lgkmcnt(6)
    v_exp_f32 v7, v7
    v_mfma_f32_16x16x32_bf16 a[48:51], a[228:231], v[132:135], a[48:51]
    v_exp_f32 v20, v20
    v_mfma_f32_16x16x32_bf16 a[112:115], a[224:227], v[136:139], a[112:115]
    v_exp_f32 v21, v21
    v_mfma_f32_16x16x32_bf16 a[112:115], a[228:231], v[140:143], a[112:115]
    v_exp_f32 v22, v22
    v_mfma_f32_16x16x32_bf16 a[176:179], a[224:227], v[152:155], a[176:179]
    v_exp_f32 v23, v23
    v_mfma_f32_16x16x32_bf16 a[176:179], a[228:231], v[156:159], a[176:179]
    s_waitcnt lgkmcnt(5)
    v_exp_f32 v8, v8
    v_mfma_f32_16x16x32_bf16 a[52:55], a[232:235], v[128:131], a[52:55]
    s_waitcnt lgkmcnt(4)
    v_exp_f32 v9, v9
    v_mfma_f32_16x16x32_bf16 a[52:55], a[236:239], v[132:135], a[52:55]
    v_exp_f32 v24, v24
    v_mfma_f32_16x16x32_bf16 a[116:119], a[232:235], v[136:139], a[116:119]
    s_waitcnt vmcnt(16) lgkmcnt(0)
    v_exp_f32 v25, v25
    v_mfma_f32_16x16x32_bf16 a[116:119], a[236:239], v[140:143], a[116:119]
    s_barrier
    ds_read_b128 a[192:195], v200 offset:32768
    ds_read_b128 a[196:199], v200 offset:33792
    v_mfma_f32_16x16x32_bf16 a[180:183], a[232:235], v[152:155], a[180:183]
    buffer_load_dwordx4 v240, s[16:19], s54 offen offset:0 sc1 lds
    v_mfma_f32_16x16x32_bf16 a[180:183], a[236:239], v[156:159], a[180:183]
    ds_read_b128 a[200:203], v200 offset:34816
    ds_read_b128 a[204:207], v200 offset:35840
    v_mfma_f32_16x16x32_bf16 a[56:59], a[240:243], v[128:131], a[56:59]
    ds_read_b128 a[208:211], v200 offset:36864
    ds_read_b128 a[212:215], v200 offset:37888
    v_mfma_f32_16x16x32_bf16 a[56:59], a[244:247], v[132:135], a[56:59]
    buffer_load_dwordx4 v240, s[16:19], s54 offen offset:1024 sc1 lds
    v_mfma_f32_16x16x32_bf16 a[120:123], a[240:243], v[136:139], a[120:123]
    ds_read_b128 a[216:219], v200 offset:38912
    ds_read_b128 a[220:223], v200 offset:39936
    v_mfma_f32_16x16x32_bf16 a[120:123], a[244:247], v[140:143], a[120:123]
    v_mfma_f32_16x16x32_bf16 a[184:187], a[240:243], v[152:155], a[184:187]
    v_mfma_f32_16x16x32_bf16 a[184:187], a[244:247], v[156:159], a[184:187]
    v_mfma_f32_16x16x32_bf16 a[60:63], a[248:251], v[128:131], a[60:63]
    buffer_load_dwordx4 v240, s[16:19], s54 offen offset:2048 sc1 lds
    v_mfma_f32_16x16x32_bf16 a[60:63], a[252:255], v[132:135], a[60:63]
    v_mfma_f32_16x16x32_bf16 a[124:127], a[248:251], v[136:139], a[124:127]
    v_mfma_f32_16x16x32_bf16 a[124:127], a[252:255], v[140:143], a[124:127]
    v_mfma_f32_16x16x32_bf16 a[188:191], a[248:251], v[152:155], a[188:191]
    buffer_load_dwordx4 v240, s[16:19], s54 offen offset:3072 sc1 lds
    v_mfma_f32_16x16x32_bf16 a[188:191], a[252:255], v[156:159], a[188:191]
    s_mov_b32 m0, s53
    v_mfma_f32_16x16x32_bf16 v[176:179], v[192:195], v[128:131], v[176:179]
    v_mfma_f32_16x16x32_bf16 v[176:179], v[192:195], v[132:135], v[176:179]
    v_mfma_f32_16x16x32_bf16 v[180:183], v[192:195], v[136:139], v[180:183]
    v_mfma_f32_16x16x32_bf16 v[180:183], v[192:195], v[140:143], v[180:183]
    v_mfma_f32_16x16x32_bf16 v[188:191], v[192:195], v[152:155], v[188:191]
    v_mfma_f32_16x16x32_bf16 v[188:191], v[192:195], v[156:159], v[188:191]
    s_waitcnt lgkmcnt(7)
    v_mfma_f32_16x16x32_bf16 v[64:67], a[192:195], a[0:3], v[160:163]
    s_waitcnt lgkmcnt(6)
    v_exp_f32 v10, v10
    v_mfma_f32_16x16x32_bf16 v[64:67], a[196:199], a[4:7], v[64:67]
    s_waitcnt lgkmcnt(5)
    ds_read_b128 a[224:227], v200 offset:40960
    ds_read_b128 a[228:231], v200 offset:41984
    v_mfma_f32_16x16x32_bf16 v[64:67], a[200:203], a[64:67], v[64:67]
    s_waitcnt lgkmcnt(6)
    v_exp_f32 v11, v11
    v_mfma_f32_16x16x32_bf16 v[64:67], a[204:207], a[68:71], v[64:67]
    ds_read_b128 a[232:235], v200 offset:43008
    ds_read_b128 a[236:239], v200 offset:44032
    v_mfma_f32_16x16x32_bf16 v[80:83], a[204:207], a[76:79], v[164:167]
    v_exp_f32 v12, v12
    v_mfma_f32_16x16x32_bf16 v[80:83], a[200:203], a[72:75], v[80:83]
    buffer_load_dword v207, v206, s[20:23], s99 offen sc1
    v_cmp_ngt_f32 vcc, s61, v184
    v_nop
    v_mfma_f32_16x16x32_bf16 v[80:83], a[196:199], a[12:15], v[80:83]
    s_mov_b64 s[62:63], vcc
    v_cmp_ngt_f32 vcc, s61, v188
    v_nop
    v_mfma_f32_16x16x32_bf16 v[80:83], a[192:195], a[8:11], v[80:83]
    s_waitcnt lgkmcnt(7)
    s_or_b64 s[62:63], s[62:63], vcc
    v_mov_b32 v185, v184
    v_accvgpr_read_b32 v32, a128
    v_accvgpr_read_b32 v33, a129
    v_permlane32_swap_b32 v184, v185
    v_mfma_f32_16x16x32_bf16 v[68:71], a[208:211], a[0:3], v[160:163]
    s_waitcnt lgkmcnt(6)
    v_accvgpr_read_b32 v34, a130
    v_add_f32 v184, v184, v185
    v_mov_b32 v185, v184
    v_mfma_f32_16x16x32_bf16 v[68:71], a[212:215], a[4:7], v[68:71]
    s_waitcnt lgkmcnt(5)
    buffer_store_dwordx4 v[232:235], v240, s[20:23], s36 offen offset:2048 sc1
    v_accvgpr_read_b32 v35, a131
    v_accvgpr_read_b32 v36, a132
    v_permlane16_swap_b32 v184, v185
    v_mfma_f32_16x16x32_bf16 v[68:71], a[216:219], a[64:67], v[68:71]
    s_waitcnt lgkmcnt(4)
    v_accvgpr_read_b32 v37, a133
    v_add_f32 v184, v184, v185
    v_rcp_f32 v204, v184
    v_mfma_f32_16x16x32_bf16 v[68:71], a[220:223], a[68:71], v[68:71]
    buffer_load_dwordx4 v240, s[16:19], s55 offen offset:0 sc1 lds
    v_accvgpr_read_b32 v38, a134
    v_exp_f32 v13, v13
    v_mfma_f32_16x16x32_bf16 v[84:87], a[220:223], a[76:79], v[164:167]
    buffer_store_dwordx4 v[232:235], v240, s[20:23], s36 offen offset:3072 sc1
    v_accvgpr_read_b32 v39, a135
    v_mul_f32 v32, v32, v204
    v_mul_f32 v33, v33, v204
    v_mul_f32 v34, v34, v204
    v_mul_f32 v35, v35, v204
    v_mfma_f32_16x16x32_bf16 v[84:87], a[216:219], a[72:75], v[84:87]
    v_mul_f32 v36, v36, v204
    v_mul_f32 v37, v37, v204
    v_mul_f32 v38, v38, v204
    v_mul_f32 v39, v39, v204
    v_exp_f32 v14, v14
    v_mfma_f32_16x16x32_bf16 v[84:87], a[212:215], a[12:15], v[84:87]
    ds_read_b128 a[240:243], v200 offset:45056
    v_cvt_pk_bf16_f32 v32, v32, v33
    v_cvt_pk_bf16_f32 v33, v34, v35
    v_cvt_pk_bf16_f32 v34, v36, v37
    v_mfma_f32_16x16x32_bf16 v[84:87], a[208:211], a[8:11], v[84:87]
    s_waitcnt lgkmcnt(4)
    ds_read_b128 a[244:247], v200 offset:46080
    v_cvt_pk_bf16_f32 v35, v38, v39
    v_exp_f32 v15, v15
    v_mfma_f32_16x16x32_bf16 v[72:75], a[224:227], a[0:3], v[160:163]
    s_waitcnt lgkmcnt(4)
    buffer_store_dwordx4 v[32:35], v240, s[20:23], s101 offen offset:0 sc1
    ds_read_b128 a[248:251], v200 offset:47104
    v_accvgpr_read_b32 v40, a136
    v_accvgpr_read_b32 v41, a137
    v_accvgpr_read_b32 v42, a138
    v_accvgpr_read_b32 v43, a139
    v_accvgpr_read_b32 v44, a140
    v_mfma_f32_16x16x32_bf16 v[72:75], a[228:231], a[4:7], v[72:75]
    s_waitcnt lgkmcnt(4)
    ds_read_b128 a[252:255], v200 offset:48128
    v_accvgpr_read_b32 v45, a141
    v_accvgpr_read_b32 v46, a142
    v_exp_f32 v26, v26
    v_mfma_f32_16x16x32_bf16 v[72:75], a[232:235], a[64:67], v[72:75]
    s_waitcnt lgkmcnt(4)
    buffer_store_dwordx4 v[232:235], v240, s[20:23], s37 offen offset:2048 sc1
    v_accvgpr_read_b32 v47, a143
    v_mul_f32 v40, v40, v204
    v_mul_f32 v41, v41, v204
    v_mul_f32 v42, v42, v204
    v_cvt_pk_bf16_f32 v128, v0, v1
    v_mfma_f32_16x16x32_bf16 v[72:75], a[236:239], a[68:71], v[72:75]
    v_mul_f32 v43, v43, v204
    v_mul_f32 v44, v44, v204
    v_mul_f32 v45, v45, v204
    v_mul_f32 v46, v46, v204
    v_exp_f32 v27, v27
    v_cvt_pk_bf16_f32 v129, v2, v3
    v_mfma_f32_16x16x32_bf16 v[88:91], a[236:239], a[76:79], v[164:167]
    v_mul_f32 v47, v47, v204
    v_cvt_pk_bf16_f32 v40, v40, v41
    v_cvt_pk_bf16_f32 v41, v42, v43
    v_cvt_pk_bf16_f32 v130, v4, v5
    v_mfma_f32_16x16x32_bf16 v[88:91], a[232:235], a[72:75], v[88:91]
    buffer_load_dwordx4 v240, s[16:19], s55 offen offset:1024 sc1 lds
    v_cvt_pk_bf16_f32 v42, v44, v45
    v_cvt_pk_bf16_f32 v43, v46, v47
    v_exp_f32 v28, v28
    v_cvt_pk_bf16_f32 v131, v6, v7
    v_mfma_f32_16x16x32_bf16 v[88:91], a[228:231], a[12:15], v[88:91]
    buffer_store_dwordx4 v[40:43], v240, s[20:23], s101 offen offset:1024 sc1
    ds_read_b128 a[192:195], v200 offset:16384
    v_accvgpr_read_b32 v48, a144
    v_accvgpr_read_b32 v49, a145
    v_accvgpr_read_b32 v50, a146
    v_accvgpr_read_b32 v51, a147
    v_cvt_pk_bf16_f32 v136, v16, v17
    v_mfma_f32_16x16x32_bf16 v[88:91], a[224:227], a[8:11], v[88:91]
    s_waitcnt lgkmcnt(4)
    ds_read_b128 a[196:199], v200 offset:24576
    v_accvgpr_read_b32 v52, a148
    v_accvgpr_read_b32 v53, a149
    v_accvgpr_read_b32 v54, a150
    v_exp_f32 v29, v29
    v_cvt_pk_bf16_f32 v137, v18, v19
    v_mfma_f32_16x16x32_bf16 v[76:79], a[240:243], a[0:3], v[160:163]
    s_waitcnt lgkmcnt(4)
    buffer_store_dwordx4 v[232:235], v240, s[20:23], s37 offen offset:3072 sc1
    v_accvgpr_read_b32 v55, a151
    v_mul_f32 v48, v48, v204
    v_mul_f32 v49, v49, v204
    v_cvt_pk_bf16_f32 v138, v20, v21
    v_mfma_f32_16x16x32_bf16 v[76:79], a[244:247], a[4:7], v[76:79]
    s_waitcnt lgkmcnt(3)
    v_mul_f32 v50, v50, v204
    v_mul_f32 v51, v51, v204
    v_mul_f32 v52, v52, v204
    v_mul_f32 v53, v53, v204
    v_exp_f32 v30, v30
    v_cvt_pk_bf16_f32 v139, v22, v23
    v_mfma_f32_16x16x32_bf16 v[76:79], a[248:251], a[64:67], v[76:79]
    s_waitcnt lgkmcnt(2)
    ds_read_b128 a[200:203], v200 offset:17408
    v_mul_f32 v54, v54, v204
    v_mul_f32 v55, v55, v204
    v_cvt_pk_bf16_f32 v48, v48, v49
    v_cvt_pk_bf16_f32 v132, v8, v9
    v_mfma_f32_16x16x32_bf16 v[76:79], a[252:255], a[68:71], v[76:79]
    ds_read_b128 a[204:207], v200 offset:25600
    v_cvt_pk_bf16_f32 v49, v50, v51
    v_cvt_pk_bf16_f32 v50, v52, v53
    v_cvt_pk_bf16_f32 v51, v54, v55
    v_exp_f32 v31, v31
    v_cvt_pk_bf16_f32 v133, v10, v11
    v_mfma_f32_16x16x32_bf16 v[92:95], a[252:255], a[76:79], v[164:167]
    buffer_store_dwordx4 v[48:51], v240, s[20:23], s101 offen offset:2048 sc1
    v_accvgpr_read_b32 v56, a152
    v_accvgpr_read_b32 v57, a153
    v_accvgpr_read_b32 v58, a154
    v_cvt_pk_bf16_f32 v134, v12, v13
    v_mfma_f32_16x16x32_bf16 v[92:95], a[248:251], a[72:75], v[92:95]
    v_accvgpr_read_b32 v59, a155
    v_accvgpr_read_b32 v60, a156
    v_accvgpr_read_b32 v61, a157
    v_accvgpr_read_b32 v62, a158
    v_exp_f32 v64, v64
    v_cvt_pk_bf16_f32 v135, v14, v15
    v_mfma_f32_16x16x32_bf16 v[92:95], a[244:247], a[12:15], v[92:95]
    buffer_store_dwordx4 v[232:235], v240, s[20:23], s41 offen offset:2048 sc1
    ds_read_b128 a[208:211], v200 offset:18432
    v_accvgpr_read_b32 v63, a159
    v_mul_f32 v56, v56, v204
    v_cvt_pk_bf16_f32 v140, v24, v25
    v_mfma_f32_16x16x32_bf16 v[92:95], a[240:243], a[8:11], v[92:95]
    s_waitcnt lgkmcnt(4)
    ds_read_b128 a[212:215], v200 offset:26624
    buffer_load_dwordx4 v240, s[16:19], s55 offen offset:2048 sc1 lds
    v_mul_f32 v57, v57, v204
    v_mul_f32 v58, v58, v204
    v_mul_f32 v59, v59, v204
    v_mul_f32 v60, v60, v204
    v_exp_f32 v65, v65
    v_cvt_pk_bf16_f32 v141, v26, v27
    v_mfma_f32_16x16x32_bf16 a[32:35], a[192:195], v[128:131], a[32:35]
    s_waitcnt lgkmcnt(4)
    v_mul_f32 v61, v61, v204
    v_mul_f32 v62, v62, v204
    v_mul_f32 v63, v63, v204
    v_cvt_pk_bf16_f32 v142, v28, v29
    v_mfma_f32_16x16x32_bf16 a[32:35], a[196:199], v[132:135], a[32:35]
    v_cvt_pk_bf16_f32 v56, v56, v57
    v_cvt_pk_bf16_f32 v57, v58, v59
    v_cvt_pk_bf16_f32 v58, v60, v61
    v_exp_f32 v66, v66
    v_cvt_pk_bf16_f32 v143, v30, v31
    v_mfma_f32_16x16x32_bf16 a[96:99], a[192:195], v[136:139], a[96:99]
    ds_read_b128 a[216:219], v200 offset:19456
    v_cvt_pk_bf16_f32 v59, v62, v63
    v_mfma_f32_16x16x32_bf16 a[96:99], a[196:199], v[140:143], a[96:99]
    s_waitcnt lgkmcnt(4)
    buffer_store_dwordx4 v[56:59], v240, s[20:23], s101 offen offset:3072 sc1
    ds_read_b128 a[220:223], v200 offset:27648
    v_mov_b32 v189, v188
    v_accvgpr_read_b32 v96, a160
    v_accvgpr_read_b32 v97, a161
    v_permlane32_swap_b32 v188, v189
    v_accvgpr_read_b32 v98, a162
    v_exp_f32 v67, v67
    v_mfma_f32_16x16x32_bf16 a[36:39], a[200:203], v[128:131], a[36:39]
    s_waitcnt lgkmcnt(4)
    ds_read_b128 a[224:227], v200 offset:20480
    v_add_f32 v188, v188, v189
    v_mov_b32 v189, v188
    v_mfma_f32_16x16x32_bf16 a[36:39], a[204:207], v[132:135], a[36:39]
    buffer_store_dwordx4 v[232:235], v240, s[20:23], s41 offen offset:3072 sc1
    ds_read_b128 a[228:231], v200 offset:28672
    v_accvgpr_read_b32 v99, a163
    v_accvgpr_read_b32 v100, a164
    v_permlane16_swap_b32 v188, v189
    v_accvgpr_read_b32 v101, a165
    v_exp_f32 v80, v80
    v_mfma_f32_16x16x32_bf16 a[100:103], a[200:203], v[136:139], a[100:103]
    ds_read_b128 a[232:235], v200 offset:21504
    v_add_f32 v188, v188, v189
    v_rcp_f32 v205, v188
    v_accvgpr_read_b32 v102, a166
    v_accvgpr_read_b32 v103, a167
    v_mfma_f32_16x16x32_bf16 a[100:103], a[204:207], v[140:143], a[100:103]
    s_waitcnt lgkmcnt(6)
    ds_read_b128 a[236:239], v200 offset:29696
    v_mul_f32 v96, v96, v205
    v_mul_f32 v97, v97, v205
    v_mul_f32 v98, v98, v205
    v_exp_f32 v81, v81
    v_mfma_f32_16x16x32_bf16 a[40:43], a[208:211], v[128:131], a[40:43]
    s_waitcnt lgkmcnt(6)
    ds_read_b128 a[240:243], v200 offset:22528
    v_mul_f32 v99, v99, v205
    v_mul_f32 v100, v100, v205
    v_mul_f32 v101, v101, v205
    v_mul_f32 v102, v102, v205
    v_mfma_f32_16x16x32_bf16 a[40:43], a[212:215], v[132:135], a[40:43]
    ds_read_b128 a[244:247], v200 offset:30720
    buffer_load_dwordx4 v240, s[16:19], s55 offen offset:3072 sc1 lds
    v_mul_f32 v103, v103, v205
    v_cvt_pk_bf16_f32 v96, v96, v97
    v_cvt_pk_bf16_f32 v97, v98, v99
    v_exp_f32 v82, v82
    v_mfma_f32_16x16x32_bf16 a[104:107], a[208:211], v[136:139], a[104:107]
    ds_read_b128 a[248:251], v200 offset:23552
    v_cvt_pk_bf16_f32 v98, v100, v101
    v_cvt_pk_bf16_f32 v99, v102, v103
    v_mfma_f32_16x16x32_bf16 a[104:107], a[212:215], v[140:143], a[104:107]
    s_waitcnt lgkmcnt(8)
    buffer_store_dwordx4 v[96:99], v246, s[20:23], s101 offen offset:0 sc1
    ds_read_b128 a[252:255], v200 offset:31744
    v_accvgpr_read_b32 v104, a168
    v_accvgpr_read_b32 v105, a169
    v_accvgpr_read_b32 v106, a170
    v_accvgpr_read_b32 v107, a171
    v_exp_f32 v83, v83
    v_mfma_f32_16x16x32_bf16 a[44:47], a[216:219], v[128:131], a[44:47]
    s_waitcnt lgkmcnt(8)
    v_accvgpr_read_b32 v108, a172
    v_accvgpr_read_b32 v109, a173
    v_accvgpr_read_b32 v110, a174
    v_accvgpr_read_b32 v111, a175
    v_mfma_f32_16x16x32_bf16 a[44:47], a[220:223], v[132:135], a[44:47]
    s_add_u32 s54, s54, 0x8000
    v_mul_f32 v104, v104, v205
    v_mul_f32 v105, v105, v205
    v_mul_f32 v106, v106, v205
    v_exp_f32 v68, v68
    v_mfma_f32_16x16x32_bf16 a[108:111], a[216:219], v[136:139], a[108:111]
    s_add_u32 s52, s52, 0x8000
    v_mul_f32 v107, v107, v205
    v_mul_f32 v108, v108, v205
    v_mul_f32 v109, v109, v205
    v_mul_f32 v110, v110, v205
    v_mfma_f32_16x16x32_bf16 a[108:111], a[220:223], v[140:143], a[108:111]
    s_waitcnt lgkmcnt(7)
    s_and_b32 s52, s52, 0x1ffff
    v_mul_f32 v111, v111, v205
    v_cvt_pk_bf16_f32 v104, v104, v105
    v_cvt_pk_bf16_f32 v105, v106, v107
    v_exp_f32 v69, v69
    v_mfma_f32_16x16x32_bf16 a[48:51], a[224:227], v[128:131], a[48:51]
    s_waitcnt lgkmcnt(6)
    s_waitcnt lgkmcnt(0)
    s_mov_b32 m0, s52
    v_cvt_pk_bf16_f32 v106, v108, v109
    v_cvt_pk_bf16_f32 v107, v110, v111
    v_mfma_f32_16x16x32_bf16 a[48:51], a[228:231], v[132:135], a[48:51]
    s_waitcnt vmcnt(28)
    s_barrier
    buffer_store_dwordx4 v[104:107], v246, s[20:23], s101 offen offset:1024 sc1
    v_accvgpr_read_b32 v112, a176
    v_accvgpr_read_b32 v113, a177
    v_accvgpr_read_b32 v114, a178
    v_accvgpr_read_b32 v115, a179
    v_exp_f32 v70, v70
    v_mfma_f32_16x16x32_bf16 a[112:115], a[224:227], v[136:139], a[112:115]
    s_add_u32 s55, s55, 0x8000
    v_accvgpr_read_b32 v116, a180
    v_accvgpr_read_b32 v117, a181
    v_accvgpr_read_b32 v118, a182
    v_accvgpr_read_b32 v119, a183
    v_mfma_f32_16x16x32_bf16 a[112:115], a[228:231], v[140:143], a[112:115]
    ds_read_b128 a[192:195], v201 offset:0
    v_mul_f32 v112, v112, v205
    v_mul_f32 v113, v113, v205
    v_mul_f32 v114, v114, v205
    v_exp_f32 v71, v71
    v_mfma_f32_16x16x32_bf16 a[52:55], a[232:235], v[128:131], a[52:55]
    v_mul_f32 v115, v115, v205
    v_mul_f32 v116, v116, v205
    v_mul_f32 v117, v117, v205
    v_mul_f32 v118, v118, v205
    v_mfma_f32_16x16x32_bf16 a[52:55], a[236:239], v[132:135], a[52:55]
    s_add_u32 s53, s53, 0x8000
    ds_read_b128 a[196:199], v201 offset:1024
    buffer_load_dwordx4 v240, s[16:19], s54 offen offset:0 sc1 lds
    v_mul_f32 v119, v119, v205
    v_cvt_pk_bf16_f32 v112, v112, v113
    v_cvt_pk_bf16_f32 v113, v114, v115
    v_exp_f32 v84, v84
    v_mfma_f32_16x16x32_bf16 a[116:119], a[232:235], v[136:139], a[116:119]
    s_and_b32 s53, s53, 0x1ffff
    v_cvt_pk_bf16_f32 v114, v116, v117
    v_cvt_pk_bf16_f32 v115, v118, v119
    v_mfma_f32_16x16x32_bf16 a[116:119], a[236:239], v[140:143], a[116:119]
    buffer_store_dwordx4 v[112:115], v246, s[20:23], s101 offen offset:2048 sc1
    ds_read_b128 a[200:203], v201 offset:2048
    v_accvgpr_read_b32 v120, a184
    v_accvgpr_read_b32 v121, a185
    v_accvgpr_read_b32 v122, a186
    v_accvgpr_read_b32 v123, a187
    v_exp_f32 v85, v85
    v_mfma_f32_16x16x32_bf16 a[56:59], a[240:243], v[128:131], a[56:59]
    v_accvgpr_read_b32 v124, a188
    v_accvgpr_read_b32 v125, a189
    v_accvgpr_read_b32 v126, a190
    v_accvgpr_read_b32 v127, a191
    v_mfma_f32_16x16x32_bf16 a[56:59], a[244:247], v[132:135], a[56:59]
    ds_read_b128 a[204:207], v201 offset:3072
    buffer_load_dwordx4 v240, s[16:19], s54 offen offset:1024 sc1 lds
    v_mul_f32 v120, v120, v205
    v_mul_f32 v121, v121, v205
    v_mul_f32 v122, v122, v205
    v_exp_f32 v86, v86
    v_mfma_f32_16x16x32_bf16 a[120:123], a[240:243], v[136:139], a[120:123]
    v_mul_f32 v123, v123, v205
    v_mul_f32 v124, v124, v205
    v_mul_f32 v125, v125, v205
    v_mul_f32 v126, v126, v205
    v_mfma_f32_16x16x32_bf16 a[120:123], a[244:247], v[140:143], a[120:123]
    ds_read_b128 a[208:211], v201 offset:4096
    v_mul_f32 v127, v127, v205
    v_exp_f32 v87, v87
    v_cvt_pk_bf16_f32 v120, v120, v121
    v_mfma_f32_16x16x32_bf16 a[60:63], a[248:251], v[128:131], a[60:63]
    ds_read_b128 a[212:215], v201 offset:5120
    v_cvt_pk_bf16_f32 v121, v122, v123
    v_mfma_f32_16x16x32_bf16 a[60:63], a[252:255], v[132:135], a[60:63]
    buffer_load_dwordx4 v240, s[16:19], s54 offen offset:2048 sc1 lds
    v_exp_f32 v72, v72
    v_cvt_pk_bf16_f32 v122, v124, v125
    v_mfma_f32_16x16x32_bf16 a[124:127], a[248:251], v[136:139], a[124:127]
    ds_read_b128 a[216:219], v201 offset:6144
    v_cvt_pk_bf16_f32 v123, v126, v127
    v_mfma_f32_16x16x32_bf16 a[124:127], a[252:255], v[140:143], a[124:127]
    v_exp_f32 v73, v73
    v_mfma_f32_16x16x32_bf16 v[176:179], v[192:195], v[128:131], v[176:179]
    buffer_store_dwordx4 v[120:123], v246, s[20:23], s101 offen offset:3072 sc1
    v_mfma_f32_16x16x32_bf16 v[176:179], v[192:195], v[132:135], v[176:179]
    ds_read_b128 a[220:223], v201 offset:7168
    buffer_load_dwordx4 v240, s[16:19], s54 offen offset:3072 sc1 lds
    v_exp_f32 v88, v88
    v_mfma_f32_16x16x32_bf16 v[180:183], v[192:195], v[136:139], v[180:183]
    s_mov_b32 m0, s53
    v_xor_b32 v200, 0x10000, v200
    v_xor_b32 v201, 0x10000, v201
    v_mfma_f32_16x16x32_bf16 v[180:183], v[192:195], v[140:143], v[180:183]
    s_waitcnt lgkmcnt(7)
    v_exp_f32 v89, v89
    s_lshl_b32 s47, s30, 1
    s_sub_u32 s47, 12, s47
    s_cmp_eq_u32 s47, 0
    s_cbranch_scc1 L_ussp
.p2align 3
L_uss:
    v_mfma_f32_16x16x32_bf16 v[0:3], a[192:195], a[0:3], v[160:163]
    s_waitcnt lgkmcnt(6)
    v_exp_f32 v74, v74
    v_mfma_f32_16x16x32_bf16 v[0:3], a[196:199], a[4:7], v[0:3]
    s_waitcnt lgkmcnt(5)
    ds_read_b128 a[224:227], v200 offset:8192
    ds_read_b128 a[228:231], v200 offset:9216
    v_mfma_f32_16x16x32_bf16 v[0:3], a[200:203], a[64:67], v[0:3]
    s_waitcnt lgkmcnt(6)
    v_exp_f32 v75, v75
    v_mfma_f32_16x16x32_bf16 v[0:3], a[204:207], a[68:71], v[0:3]
    ds_read_b128 a[232:235], v200 offset:10240
    ds_read_b128 a[236:239], v200 offset:11264
    v_mfma_f32_16x16x32_bf16 v[16:19], a[204:207], a[76:79], v[164:167]
    v_exp_f32 v76, v76
    v_mfma_f32_16x16x32_bf16 v[16:19], a[200:203], a[72:75], v[16:19]
    buffer_load_dwordx4 v240, s[16:19], s55 offen offset:0 sc1 lds
    v_mfma_f32_16x16x32_bf16 v[16:19], a[196:199], a[12:15], v[16:19]
    v_exp_f32 v77, v77
    v_mfma_f32_16x16x32_bf16 v[16:19], a[192:195], a[8:11], v[16:19]
    s_waitcnt lgkmcnt(7)
    v_exp_f32 v78, v78
    v_mfma_f32_16x16x32_bf16 v[4:7], a[208:211], a[0:3], v[160:163]
    s_waitcnt lgkmcnt(6)
    ds_read_b128 a[240:243], v200 offset:12288
    ds_read_b128 a[244:247], v200 offset:13312
    v_mfma_f32_16x16x32_bf16 v[4:7], a[212:215], a[4:7], v[4:7]
    s_waitcnt lgkmcnt(7)
    v_exp_f32 v79, v79
    v_mfma_f32_16x16x32_bf16 v[4:7], a[216:219], a[64:67], v[4:7]
    s_waitcnt lgkmcnt(6)
    ds_read_b128 a[248:251], v200 offset:14336
    ds_read_b128 a[252:255], v200 offset:15360
    v_mfma_f32_16x16x32_bf16 v[4:7], a[220:223], a[68:71], v[4:7]
    v_exp_f32 v90, v90
    v_mfma_f32_16x16x32_bf16 v[20:23], a[220:223], a[76:79], v[164:167]
    v_cvt_pk_bf16_f32 v128, v64, v65
    v_cvt_pk_bf16_f32 v129, v66, v67
    v_mfma_f32_16x16x32_bf16 v[20:23], a[216:219], a[72:75], v[20:23]
    v_exp_f32 v91, v91
    v_mfma_f32_16x16x32_bf16 v[20:23], a[212:215], a[12:15], v[20:23]
    v_cvt_pk_bf16_f32 v130, v68, v69
    v_cvt_pk_bf16_f32 v131, v70, v71
    v_mfma_f32_16x16x32_bf16 v[20:23], a[208:211], a[8:11], v[20:23]
    s_waitcnt lgkmcnt(7)
    buffer_load_dwordx4 v240, s[16:19], s55 offen offset:1024 sc1 lds
    v_mfma_f32_16x16x32_bf16 v[8:11], a[224:227], a[0:3], v[160:163]
    s_waitcnt lgkmcnt(6)
    v_exp_f32 v92, v92
    v_mfma_f32_16x16x32_bf16 v[8:11], a[228:231], a[4:7], v[8:11]
    s_waitcnt lgkmcnt(5)
    ds_read_b128 a[192:195], v201 offset:49152
    v_cvt_pk_bf16_f32 v136, v80, v81
    v_mfma_f32_16x16x32_bf16 v[8:11], a[232:235], a[64:67], v[8:11]
    s_waitcnt lgkmcnt(5)
    ds_read_b128 a[196:199], v201 offset:57344
    v_cvt_pk_bf16_f32 v137, v82, v83
    v_mfma_f32_16x16x32_bf16 v[8:11], a[236:239], a[68:71], v[8:11]
    v_exp_f32 v93, v93
    v_mfma_f32_16x16x32_bf16 v[24:27], a[236:239], a[76:79], v[164:167]
    v_cvt_pk_bf16_f32 v138, v84, v85
    v_cvt_pk_bf16_f32 v139, v86, v87
    v_mfma_f32_16x16x32_bf16 v[24:27], a[232:235], a[72:75], v[24:27]
    v_exp_f32 v94, v94
    v_mfma_f32_16x16x32_bf16 v[24:27], a[228:231], a[12:15], v[24:27]
    ds_read_b128 a[200:203], v201 offset:50176
    v_cvt_pk_bf16_f32 v132, v72, v73
    v_mfma_f32_16x16x32_bf16 v[24:27], a[224:227], a[8:11], v[24:27]
    s_waitcnt lgkmcnt(6)
    ds_read_b128 a[204:207], v201 offset:58368
    v_cvt_pk_bf16_f32 v133, v74, v75
    v_mfma_f32_16x16x32_bf16 v[12:15], a[240:243], a[0:3], v[160:163]
    s_waitcnt lgkmcnt(6)
    v_exp_f32 v95, v95
    v_mfma_f32_16x16x32_bf16 v[12:15], a[244:247], a[4:7], v[12:15]
    s_waitcnt lgkmcnt(5)
    v_cvt_pk_bf16_f32 v134, v76, v77
    v_cvt_pk_bf16_f32 v135, v78, v79
    v_mfma_f32_16x16x32_bf16 v[12:15], a[248:251], a[64:67], v[12:15]
    s_waitcnt lgkmcnt(4)
    v_exp_f32 v0, v0
    v_mfma_f32_16x16x32_bf16 v[12:15], a[252:255], a[68:71], v[12:15]
    ds_read_b128 a[208:211], v201 offset:51200
    v_cvt_pk_bf16_f32 v140, v88, v89
    v_mfma_f32_16x16x32_bf16 v[28:31], a[252:255], a[76:79], v[164:167]
    ds_read_b128 a[212:215], v201 offset:59392
    v_cvt_pk_bf16_f32 v141, v90, v91
    v_mfma_f32_16x16x32_bf16 v[28:31], a[248:251], a[72:75], v[28:31]
    buffer_load_dwordx4 v240, s[16:19], s55 offen offset:2048 sc1 lds
    v_mfma_f32_16x16x32_bf16 v[28:31], a[244:247], a[12:15], v[28:31]
    v_exp_f32 v1, v1
    v_mfma_f32_16x16x32_bf16 v[28:31], a[240:243], a[8:11], v[28:31]
    s_waitcnt lgkmcnt(5)
    v_cvt_pk_bf16_f32 v142, v92, v93
    v_cvt_pk_bf16_f32 v143, v94, v95
    v_mfma_f32_16x16x32_bf16 a[32:35], a[192:195], v[128:131], a[32:35]
    s_waitcnt lgkmcnt(4)
    v_exp_f32 v2, v2
    v_mfma_f32_16x16x32_bf16 a[32:35], a[196:199], v[132:135], a[32:35]
    ds_read_b128 a[216:219], v201 offset:52224
    ds_read_b128 a[220:223], v201 offset:60416
    v_mfma_f32_16x16x32_bf16 a[96:99], a[192:195], v[136:139], a[96:99]
    v_exp_f32 v3, v3
    v_mfma_f32_16x16x32_bf16 a[96:99], a[196:199], v[140:143], a[96:99]
    s_waitcnt lgkmcnt(5)
    ds_read_b128 a[224:227], v201 offset:53248
    ds_read_b128 a[228:231], v201 offset:61440
    v_mfma_f32_16x16x32_bf16 a[36:39], a[200:203], v[128:131], a[36:39]
    s_waitcnt lgkmcnt(6)
    v_exp_f32 v16, v16
    v_mfma_f32_16x16x32_bf16 a[36:39], a[204:207], v[132:135], a[36:39]
    ds_read_b128 a[232:235], v201 offset:54272
    ds_read_b128 a[236:239], v201 offset:62464
    v_mfma_f32_16x16x32_bf16 a[100:103], a[200:203], v[136:139], a[100:103]
    v_exp_f32 v17, v17
    v_mfma_f32_16x16x32_bf16 a[100:103], a[204:207], v[140:143], a[100:103]
    s_waitcnt lgkmcnt(7)
    ds_read_b128 a[240:243], v201 offset:55296
    ds_read_b128 a[244:247], v201 offset:63488
    v_mfma_f32_16x16x32_bf16 a[40:43], a[208:211], v[128:131], a[40:43]
    s_waitcnt lgkmcnt(8)
    buffer_load_dwordx4 v240, s[16:19], s55 offen offset:3072 sc1 lds
    v_mfma_f32_16x16x32_bf16 a[40:43], a[212:215], v[132:135], a[40:43]
    s_add_u32 s54, s54, 0x8000
    v_exp_f32 v18, v18
    v_mfma_f32_16x16x32_bf16 a[104:107], a[208:211], v[136:139], a[104:107]
    s_add_u32 s52, s52, 0x8000
    ds_read_b128 a[248:251], v201 offset:56320
    ds_read_b128 a[252:255], v201 offset:64512
    v_mfma_f32_16x16x32_bf16 a[104:107], a[212:215], v[140:143], a[104:107]
    s_waitcnt lgkmcnt(9)
    v_exp_f32 v19, v19
    v_mfma_f32_16x16x32_bf16 a[44:47], a[216:219], v[128:131], a[44:47]
    s_waitcnt lgkmcnt(8)
    v_exp_f32 v4, v4
    v_mfma_f32_16x16x32_bf16 a[44:47], a[220:223], v[132:135], a[44:47]
    s_and_b32 s52, s52, 0x1ffff
    v_exp_f32 v5, v5
    v_mfma_f32_16x16x32_bf16 a[108:111], a[216:219], v[136:139], a[108:111]
    s_mov_b32 m0, s52
    v_exp_f32 v6, v6
    v_mfma_f32_16x16x32_bf16 a[108:111], a[220:223], v[140:143], a[108:111]
    s_waitcnt lgkmcnt(7)
    v_exp_f32 v7, v7
    v_mfma_f32_16x16x32_bf16 a[48:51], a[224:227], v[128:131], a[48:51]
    s_waitcnt lgkmcnt(6)
    s_waitcnt vmcnt(16) lgkmcnt(0)
    v_mfma_f32_16x16x32_bf16 a[48:51], a[228:231], v[132:135], a[48:51]
    s_barrier
    ds_read_b128 a[192:195], v200 offset:32768
    ds_read_b128 a[196:199], v200 offset:33792
    v_mfma_f32_16x16x32_bf16 a[112:115], a[224:227], v[136:139], a[112:115]
    s_add_u32 s55, s55, 0x8000
    buffer_load_dwordx4 v240, s[16:19], s54 offen offset:0 sc1 lds
    v_mfma_f32_16x16x32_bf16 a[112:115], a[228:231], v[140:143], a[112:115]
    v_exp_f32 v20, v20
    v_mfma_f32_16x16x32_bf16 a[52:55], a[232:235], v[128:131], a[52:55]
    ds_read_b128 a[200:203], v200 offset:34816
    ds_read_b128 a[204:207], v200 offset:35840
    v_mfma_f32_16x16x32_bf16 a[52:55], a[236:239], v[132:135], a[52:55]
    s_add_u32 s53, s53, 0x8000
    v_exp_f32 v21, v21
    v_mfma_f32_16x16x32_bf16 a[116:119], a[232:235], v[136:139], a[116:119]
    s_and_b32 s53, s53, 0x1ffff
    buffer_load_dwordx4 v240, s[16:19], s54 offen offset:1024 sc1 lds
    v_mfma_f32_16x16x32_bf16 a[116:119], a[236:239], v[140:143], a[116:119]
    v_exp_f32 v22, v22
    v_mfma_f32_16x16x32_bf16 a[56:59], a[240:243], v[128:131], a[56:59]
    ds_read_b128 a[208:211], v200 offset:36864
    ds_read_b128 a[212:215], v200 offset:37888
    v_mfma_f32_16x16x32_bf16 a[56:59], a[244:247], v[132:135], a[56:59]
    v_exp_f32 v23, v23
    v_mfma_f32_16x16x32_bf16 a[120:123], a[240:243], v[136:139], a[120:123]
    buffer_load_dwordx4 v240, s[16:19], s54 offen offset:2048 sc1 lds
    v_mfma_f32_16x16x32_bf16 a[120:123], a[244:247], v[140:143], a[120:123]
    v_exp_f32 v8, v8
    v_mfma_f32_16x16x32_bf16 a[60:63], a[248:251], v[128:131], a[60:63]
    ds_read_b128 a[216:219], v200 offset:38912
    ds_read_b128 a[220:223], v200 offset:39936
    v_mfma_f32_16x16x32_bf16 a[60:63], a[252:255], v[132:135], a[60:63]
    v_exp_f32 v9, v9
    v_mfma_f32_16x16x32_bf16 a[124:127], a[248:251], v[136:139], a[124:127]
    buffer_load_dwordx4 v240, s[16:19], s54 offen offset:3072 sc1 lds
    v_mfma_f32_16x16x32_bf16 a[124:127], a[252:255], v[140:143], a[124:127]
    s_mov_b32 m0, s53
    v_exp_f32 v24, v24
    v_mfma_f32_16x16x32_bf16 v[176:179], v[192:195], v[128:131], v[176:179]
    v_exp_f32 v25, v25
    v_mfma_f32_16x16x32_bf16 v[176:179], v[192:195], v[132:135], v[176:179]
    v_mfma_f32_16x16x32_bf16 v[180:183], v[192:195], v[136:139], v[180:183]
    v_mfma_f32_16x16x32_bf16 v[180:183], v[192:195], v[140:143], v[180:183]
    s_waitcnt lgkmcnt(7)
    v_mfma_f32_16x16x32_bf16 v[64:67], a[192:195], a[0:3], v[160:163]
    s_waitcnt lgkmcnt(6)
    v_exp_f32 v10, v10
    v_mfma_f32_16x16x32_bf16 v[64:67], a[196:199], a[4:7], v[64:67]
    s_waitcnt lgkmcnt(5)
    ds_read_b128 a[224:227], v200 offset:40960
    ds_read_b128 a[228:231], v200 offset:41984
    v_mfma_f32_16x16x32_bf16 v[64:67], a[200:203], a[64:67], v[64:67]
    s_waitcnt lgkmcnt(6)
    v_exp_f32 v11, v11
    v_mfma_f32_16x16x32_bf16 v[64:67], a[204:207], a[68:71], v[64:67]
    ds_read_b128 a[232:235], v200 offset:43008
    ds_read_b128 a[236:239], v200 offset:44032
    v_mfma_f32_16x16x32_bf16 v[80:83], a[204:207], a[76:79], v[164:167]
    v_exp_f32 v12, v12
    v_mfma_f32_16x16x32_bf16 v[80:83], a[200:203], a[72:75], v[80:83]
    buffer_load_dwordx4 v240, s[16:19], s55 offen offset:0 sc1 lds
    v_mfma_f32_16x16x32_bf16 v[80:83], a[196:199], a[12:15], v[80:83]
    v_exp_f32 v13, v13
    v_mfma_f32_16x16x32_bf16 v[80:83], a[192:195], a[8:11], v[80:83]
    s_waitcnt lgkmcnt(7)
    v_exp_f32 v14, v14
    v_mfma_f32_16x16x32_bf16 v[68:71], a[208:211], a[0:3], v[160:163]
    s_waitcnt lgkmcnt(6)
    ds_read_b128 a[240:243], v200 offset:45056
    ds_read_b128 a[244:247], v200 offset:46080
    v_mfma_f32_16x16x32_bf16 v[68:71], a[212:215], a[4:7], v[68:71]
    s_waitcnt lgkmcnt(7)
    v_exp_f32 v15, v15
    v_mfma_f32_16x16x32_bf16 v[68:71], a[216:219], a[64:67], v[68:71]
    s_waitcnt lgkmcnt(6)
    ds_read_b128 a[248:251], v200 offset:47104
    ds_read_b128 a[252:255], v200 offset:48128
    v_mfma_f32_16x16x32_bf16 v[68:71], a[220:223], a[68:71], v[68:71]
    v_exp_f32 v26, v26
    v_mfma_f32_16x16x32_bf16 v[84:87], a[220:223], a[76:79], v[164:167]
    v_cvt_pk_bf16_f32 v128, v0, v1
    v_cvt_pk_bf16_f32 v129, v2, v3
    v_mfma_f32_16x16x32_bf16 v[84:87], a[216:219], a[72:75], v[84:87]
    v_exp_f32 v27, v27
    v_mfma_f32_16x16x32_bf16 v[84:87], a[212:215], a[12:15], v[84:87]
    v_cvt_pk_bf16_f32 v130, v4, v5
    v_cvt_pk_bf16_f32 v131, v6, v7
    v_mfma_f32_16x16x32_bf16 v[84:87], a[208:211], a[8:11], v[84:87]
    s_waitcnt lgkmcnt(7)
    buffer_load_dwordx4 v240, s[16:19], s55 offen offset:1024 sc1 lds
    v_mfma_f32_16x16x32_bf16 v[72:75], a[224:227], a[0:3], v[160:163]
    s_waitcnt lgkmcnt(6)
    v_exp_f32 v28, v28
    v_mfma_f32_16x16x32_bf16 v[72:75], a[228:231], a[4:7], v[72:75]
    s_waitcnt lgkmcnt(5)
    ds_read_b128 a[192:195], v200 offset:16384
    v_cvt_pk_bf16_f32 v136, v16, v17
    v_mfma_f32_16x16x32_bf16 v[72:75], a[232:235], a[64:67], v[72:75]
    s_waitcnt lgkmcnt(5)
    ds_read_b128 a[196:199], v200 offset:24576
    v_cvt_pk_bf16_f32 v137, v18, v19
    v_mfma_f32_16x16x32_bf16 v[72:75], a[236:239], a[68:71], v[72:75]
    v_exp_f32 v29, v29
    v_mfma_f32_16x16x32_bf16 v[88:91], a[236:239], a[76:79], v[164:167]
    v_cvt_pk_bf16_f32 v138, v20, v21
    v_cvt_pk_bf16_f32 v139, v22, v23
    v_mfma_f32_16x16x32_bf16 v[88:91], a[232:235], a[72:75], v[88:91]
    v_exp_f32 v30, v30
    v_mfma_f32_16x16x32_bf16 v[88:91], a[228:231], a[12:15], v[88:91]
    ds_read_b128 a[200:203], v200 offset:17408
    v_cvt_pk_bf16_f32 v132, v8, v9
    v_mfma_f32_16x16x32_bf16 v[88:91], a[224:227], a[8:11], v[88:91]
    s_waitcnt lgkmcnt(6)
    ds_read_b128 a[204:207], v200 offset:25600
    v_cvt_pk_bf16_f32 v133, v10, v11
    v_mfma_f32_16x16x32_bf16 v[76:79], a[240:243], a[0:3], v[160:163]
    s_waitcnt lgkmcnt(6)
    v_exp_f32 v31, v31
    v_mfma_f32_16x16x32_bf16 v[76:79], a[244:247], a[4:7], v[76:79]
    s_waitcnt lgkmcnt(5)
    v_cvt_pk_bf16_f32 v134, v12, v13
    v_cvt_pk_bf16_f32 v135, v14, v15
    v_mfma_f32_16x16x32_bf16 v[76:79], a[248:251], a[64:67], v[76:79]
    s_waitcnt lgkmcnt(4)
    v_exp_f32 v64, v64
    v_mfma_f32_16x16x32_bf16 v[76:79], a[252:255], a[68:71], v[76:79]
    ds_read_b128 a[208:211], v200 offset:18432
    v_cvt_pk_bf16_f32 v140, v24, v25
    v_mfma_f32_16x16x32_bf16 v[92:95], a[252:255], a[76:79], v[164:167]
    ds_read_b128 a[212:215], v200 offset:26624
    v_cvt_pk_bf16_f32 v141, v26, v27
    v_mfma_f32_16x16x32_bf16 v[92:95], a[248:251], a[72:75], v[92:95]
    buffer_load_dwordx4 v240, s[16:19], s55 offen offset:2048 sc1 lds
    v_mfma_f32_16x16x32_bf16 v[92:95], a[244:247], a[12:15], v[92:95]
    v_exp_f32 v65, v65
    v_mfma_f32_16x16x32_bf16 v[92:95], a[240:243], a[8:11], v[92:95]
    s_waitcnt lgkmcnt(5)
    v_cvt_pk_bf16_f32 v142, v28, v29
    v_cvt_pk_bf16_f32 v143, v30, v31
    v_mfma_f32_16x16x32_bf16 a[32:35], a[192:195], v[128:131], a[32:35]
    s_waitcnt lgkmcnt(4)
    v_exp_f32 v66, v66
    v_mfma_f32_16x16x32_bf16 a[32:35], a[196:199], v[132:135], a[32:35]
    ds_read_b128 a[216:219], v200 offset:19456
    ds_read_b128 a[220:223], v200 offset:27648
    v_mfma_f32_16x16x32_bf16 a[96:99], a[192:195], v[136:139], a[96:99]
    v_exp_f32 v67, v67
    v_mfma_f32_16x16x32_bf16 a[96:99], a[196:199], v[140:143], a[96:99]
    s_waitcnt lgkmcnt(5)
    ds_read_b128 a[224:227], v200 offset:20480
    ds_read_b128 a[228:231], v200 offset:28672
    v_mfma_f32_16x16x32_bf16 a[36:39], a[200:203], v[128:131], a[36:39]
    s_waitcnt lgkmcnt(6)
    v_exp_f32 v80, v80
    v_mfma_f32_16x16x32_bf16 a[36:39], a[204:207], v[132:135], a[36:39]
    ds_read_b128 a[232:235], v200 offset:21504
    ds_read_b128 a[236:239], v200 offset:29696
    v_mfma_f32_16x16x32_bf16 a[100:103], a[200:203], v[136:139], a[100:103]
    v_exp_f32 v81, v81
    v_mfma_f32_16x16x32_bf16 a[100:103], a[204:207], v[140:143], a[100:103]
    s_waitcnt lgkmcnt(7)
    ds_read_b128 a[240:243], v200 offset:22528
    ds_read_b128 a[244:247], v200 offset:30720
    v_mfma_f32_16x16x32_bf16 a[40:43], a[208:211], v[128:131], a[40:43]
    s_waitcnt lgkmcnt(8)
    buffer_load_dwordx4 v240, s[16:19], s55 offen offset:3072 sc1 lds
    v_mfma_f32_16x16x32_bf16 a[40:43], a[212:215], v[132:135], a[40:43]
    s_add_u32 s54, s54, 0x8000
    v_exp_f32 v82, v82
    v_mfma_f32_16x16x32_bf16 a[104:107], a[208:211], v[136:139], a[104:107]
    s_add_u32 s52, s52, 0x8000
    ds_read_b128 a[248:251], v200 offset:23552
    ds_read_b128 a[252:255], v200 offset:31744
    v_mfma_f32_16x16x32_bf16 a[104:107], a[212:215], v[140:143], a[104:107]
    s_waitcnt lgkmcnt(9)
    v_exp_f32 v83, v83
    v_mfma_f32_16x16x32_bf16 a[44:47], a[216:219], v[128:131], a[44:47]
    s_waitcnt lgkmcnt(8)
    v_exp_f32 v68, v68
    v_mfma_f32_16x16x32_bf16 a[44:47], a[220:223], v[132:135], a[44:47]
    s_and_b32 s52, s52, 0x1ffff
    v_exp_f32 v69, v69
    v_mfma_f32_16x16x32_bf16 a[108:111], a[216:219], v[136:139], a[108:111]
    s_mov_b32 m0, s52
    v_exp_f32 v70, v70
    v_mfma_f32_16x16x32_bf16 a[108:111], a[220:223], v[140:143], a[108:111]
    s_waitcnt lgkmcnt(7)
    v_exp_f32 v71, v71
    v_mfma_f32_16x16x32_bf16 a[48:51], a[224:227], v[128:131], a[48:51]
    s_waitcnt lgkmcnt(6)
    s_waitcnt vmcnt(16) lgkmcnt(0)
    v_xor_b32 v200, 0x10000, v200
    v_mfma_f32_16x16x32_bf16 a[48:51], a[228:231], v[132:135], a[48:51]
    s_barrier
    ds_read_b128 a[192:195], v201 offset:0
    ds_read_b128 a[196:199], v201 offset:1024
    v_mfma_f32_16x16x32_bf16 a[112:115], a[224:227], v[136:139], a[112:115]
    s_add_u32 s55, s55, 0x8000
    buffer_load_dwordx4 v240, s[16:19], s54 offen offset:0 sc1 lds
    v_mfma_f32_16x16x32_bf16 a[112:115], a[228:231], v[140:143], a[112:115]
    v_exp_f32 v84, v84
    v_mfma_f32_16x16x32_bf16 a[52:55], a[232:235], v[128:131], a[52:55]
    ds_read_b128 a[200:203], v201 offset:2048
    ds_read_b128 a[204:207], v201 offset:3072
    v_mfma_f32_16x16x32_bf16 a[52:55], a[236:239], v[132:135], a[52:55]
    s_add_u32 s53, s53, 0x8000
    v_exp_f32 v85, v85
    v_mfma_f32_16x16x32_bf16 a[116:119], a[232:235], v[136:139], a[116:119]
    s_and_b32 s53, s53, 0x1ffff
    buffer_load_dwordx4 v240, s[16:19], s54 offen offset:1024 sc1 lds
    v_mfma_f32_16x16x32_bf16 a[116:119], a[236:239], v[140:143], a[116:119]
    v_exp_f32 v86, v86
    v_mfma_f32_16x16x32_bf16 a[56:59], a[240:243], v[128:131], a[56:59]
    ds_read_b128 a[208:211], v201 offset:4096
    ds_read_b128 a[212:215], v201 offset:5120
    v_mfma_f32_16x16x32_bf16 a[56:59], a[244:247], v[132:135], a[56:59]
    s_sub_u32 s47, s47, 1
    v_exp_f32 v87, v87
    v_mfma_f32_16x16x32_bf16 a[120:123], a[240:243], v[136:139], a[120:123]
    s_cmp_lg_u32 s47, 0
    buffer_load_dwordx4 v240, s[16:19], s54 offen offset:2048 sc1 lds
    v_mfma_f32_16x16x32_bf16 a[120:123], a[244:247], v[140:143], a[120:123]
    v_exp_f32 v72, v72
    v_mfma_f32_16x16x32_bf16 a[60:63], a[248:251], v[128:131], a[60:63]
    ds_read_b128 a[216:219], v201 offset:6144
    ds_read_b128 a[220:223], v201 offset:7168
    v_mfma_f32_16x16x32_bf16 a[60:63], a[252:255], v[132:135], a[60:63]
    v_exp_f32 v73, v73
    v_mfma_f32_16x16x32_bf16 a[124:127], a[248:251], v[136:139], a[124:127]
    buffer_load_dwordx4 v240, s[16:19], s54 offen offset:3072 sc1 lds
    v_mfma_f32_16x16x32_bf16 a[124:127], a[252:255], v[140:143], a[124:127]
    s_mov_b32 m0, s53
    v_exp_f32 v88, v88
    v_mfma_f32_16x16x32_bf16 v[176:179], v[192:195], v[128:131], v[176:179]
    v_exp_f32 v89, v89
    v_mfma_f32_16x16x32_bf16 v[176:179], v[192:195], v[132:135], v[176:179]
    v_xor_b32 v201, 0x10000, v201
    v_mfma_f32_16x16x32_bf16 v[180:183], v[192:195], v[136:139], v[180:183]
    v_mfma_f32_16x16x32_bf16 v[180:183], v[192:195], v[140:143], v[180:183]
    s_waitcnt lgkmcnt(7)
    s_cbranch_scc1 L_uss
L_ussp:
    s_waitcnt vmcnt(18)
    v_cmp_ne_u32 vcc, 1, v207
    s_nop 0
    s_cbranch_vccnz L_hwait
L_hok:
    v_mfma_f32_16x16x32_bf16 v[0:3], a[192:195], a[0:3], v[160:163]
    s_waitcnt lgkmcnt(6)
    s_mov_b32 m0, s53
    ds_read_b128 a[224:227], v200 offset:8192
    v_mfma_f32_16x16x32_bf16 v[0:3], a[196:199], a[4:7], v[0:3]
    s_waitcnt lgkmcnt(6)
    buffer_load_dwordx4 v240, s[16:19], s55 offen offset:0 sc1 lds
    v_mfma_f32_16x16x32_bf16 v[0:3], a[200:203], a[64:67], v[0:3]
    s_waitcnt lgkmcnt(5)
    ds_read_b128 a[228:231], v200 offset:9216
    ds_read_b128 a[232:235], v200 offset:10240
    v_mfma_f32_16x16x32_bf16 v[0:3], a[204:207], a[68:71], v[0:3]
    ds_read_b128 a[236:239], v200 offset:11264
    ds_read_b128 a[240:243], v200 offset:12288
    v_mfma_f32_16x16x32_bf16 v[16:19], a[204:207], a[76:79], v[164:167]
    buffer_load_dwordx4 v240, s[16:19], s55 offen offset:1024 sc1 lds
    v_mfma_f32_16x16x32_bf16 v[16:19], a[200:203], a[72:75], v[16:19]
    ds_read_b128 a[244:247], v200 offset:13312
    ds_read_b128 a[248:251], v200 offset:14336
    v_mfma_f32_16x16x32_bf16 v[16:19], a[196:199], a[12:15], v[16:19]
    ds_read_b128 a[252:255], v200 offset:15360
    v_cvt_pk_bf16_f32 v128, v64, v65
    v_mfma_f32_16x16x32_bf16 v[16:19], a[192:195], a[8:11], v[16:19]
    s_waitcnt lgkmcnt(11)
    v_exp_f32 v74, v74
    v_mfma_f32_16x16x32_bf16 v[4:7], a[208:211], a[0:3], v[160:163]
    s_waitcnt lgkmcnt(10)
    buffer_load_dwordx4 v240, s[16:19], s55 offen offset:2048 sc1 lds
    v_mfma_f32_16x16x32_bf16 v[4:7], a[212:215], a[4:7], v[4:7]
    s_waitcnt lgkmcnt(9)
    v_exp_f32 v75, v75
    v_mfma_f32_16x16x32_bf16 v[4:7], a[216:219], a[64:67], v[4:7]
    s_waitcnt lgkmcnt(8)
    ds_read_b128 a[192:195], v201 offset:49152
    v_cvt_pk_bf16_f32 v129, v66, v67
    v_mfma_f32_16x16x32_bf16 v[4:7], a[220:223], a[68:71], v[4:7]
    ds_read_b128 a[196:199], v201 offset:57344
    v_cvt_pk_bf16_f32 v130, v68, v69
    v_mfma_f32_16x16x32_bf16 v[20:23], a[220:223], a[76:79], v[164:167]
    buffer_load_dwordx4 v240, s[16:19], s55 offen offset:3072 sc1 lds
    v_mfma_f32_16x16x32_bf16 v[20:23], a[216:219], a[72:75], v[20:23]
    s_add_u32 s55, s55, 0x8000
    s_add_u32 s53, s53, 0x8000
    s_and_b32 s53, s53, 0x1ffff
    v_mfma_f32_16x16x32_bf16 v[20:23], a[212:215], a[12:15], v[20:23]
    s_add_u32 m0, s50, 131072
    s_add_u32 s58, s48, 0
    ds_read_b128 a[200:203], v201 offset:50176
    v_mfma_f32_16x16x32_bf16 v[20:23], a[208:211], a[8:11], v[20:23]
    s_waitcnt lgkmcnt(10)
    v_exp_f32 v76, v76
    v_mfma_f32_16x16x32_bf16 v[8:11], a[224:227], a[0:3], v[160:163]
    s_waitcnt lgkmcnt(9)
    buffer_load_dwordx4 v242, s[12:15], s58 offen lds
    v_mfma_f32_16x16x32_bf16 v[8:11], a[228:231], a[4:7], v[8:11]
    s_waitcnt lgkmcnt(8)
    v_exp_f32 v77, v77
    v_mfma_f32_16x16x32_bf16 v[8:11], a[232:235], a[64:67], v[8:11]
    s_waitcnt lgkmcnt(7)
    v_exp_f32 v78, v78
    v_mfma_f32_16x16x32_bf16 v[8:11], a[236:239], a[68:71], v[8:11]
    v_exp_f32 v79, v79
    v_mfma_f32_16x16x32_bf16 v[24:27], a[236:239], a[76:79], v[164:167]
    buffer_load_dwordx4 v243, s[12:15], s58 offen offset:1024 lds
    v_mfma_f32_16x16x32_bf16 v[24:27], a[232:235], a[72:75], v[24:27]
    s_add_u32 m0, s50, 139264
    ds_read_b128 a[204:207], v201 offset:58368
    v_cvt_pk_bf16_f32 v131, v70, v71
    v_mfma_f32_16x16x32_bf16 v[24:27], a[228:231], a[12:15], v[24:27]
    s_add_u32 s58, s48, 32768
    v_exp_f32 v90, v90
    v_mfma_f32_16x16x32_bf16 v[24:27], a[224:227], a[8:11], v[24:27]
    s_waitcnt lgkmcnt(7)
    v_cvt_pk_bf16_f32 v136, v80, v81
    v_cvt_pk_bf16_f32 v137, v82, v83
    v_mfma_f32_16x16x32_bf16 v[12:15], a[240:243], a[0:3], v[160:163]
    s_waitcnt lgkmcnt(6)
    v_exp_f32 v91, v91
    v_mfma_f32_16x16x32_bf16 v[12:15], a[244:247], a[4:7], v[12:15]
    s_waitcnt lgkmcnt(5)
    v_cvt_pk_bf16_f32 v138, v84, v85
    v_cvt_pk_bf16_f32 v139, v86, v87
    v_mfma_f32_16x16x32_bf16 v[12:15], a[248:251], a[64:67], v[12:15]
    s_waitcnt lgkmcnt(4)
    v_exp_f32 v92, v92
    v_mfma_f32_16x16x32_bf16 v[12:15], a[252:255], a[68:71], v[12:15]
    ds_read_b128 a[208:211], v201 offset:51200
    v_cvt_pk_bf16_f32 v132, v72, v73
    v_mfma_f32_16x16x32_bf16 v[28:31], a[252:255], a[76:79], v[164:167]
    buffer_load_dwordx4 v242, s[12:15], s58 offen lds
    v_mfma_f32_16x16x32_bf16 v[28:31], a[248:251], a[72:75], v[28:31]
    v_exp_f32 v93, v93
    v_mfma_f32_16x16x32_bf16 v[28:31], a[244:247], a[12:15], v[28:31]
    v_cvt_pk_bf16_f32 v133, v74, v75
    v_cvt_pk_bf16_f32 v134, v76, v77
    v_mfma_f32_16x16x32_bf16 v[28:31], a[240:243], a[8:11], v[28:31]
    s_waitcnt lgkmcnt(4)
    ds_read_b128 a[212:215], v201 offset:59392
    v_exp_f32 v94, v94
    v_cvt_pk_bf16_f32 v135, v78, v79
    v_cvt_pk_bf16_f32 v140, v88, v89
    v_mfma_f32_16x16x32_bf16 a[32:35], a[192:195], v[128:131], a[32:35]
    s_waitcnt lgkmcnt(4)
    v_exp_f32 v95, v95
    v_cvt_pk_bf16_f32 v141, v90, v91
    v_cvt_pk_bf16_f32 v142, v92, v93
    v_mfma_f32_16x16x32_bf16 a[32:35], a[196:199], v[132:135], a[32:35]
    ds_read_b128 a[216:219], v201 offset:52224
    v_cvt_pk_bf16_f32 v143, v94, v95
    v_mfma_f32_16x16x32_bf16 a[96:99], a[192:195], v[136:139], a[96:99]
    buffer_load_dwordx4 v243, s[12:15], s58 offen offset:1024 lds
    v_mfma_f32_16x16x32_bf16 a[96:99], a[196:199], v[140:143], a[96:99]
    s_waitcnt lgkmcnt(4)
    ds_read_b128 a[220:223], v201 offset:60416
    ds_read_b128 a[224:227], v201 offset:53248
    v_mfma_f32_16x16x32_bf16 a[36:39], a[200:203], v[128:131], a[36:39]
    s_waitcnt lgkmcnt(5)
    s_add_u32 s59, s64, 0
    ds_read_b128 a[228:231], v201 offset:61440
    v_mfma_f32_16x16x32_bf16 a[36:39], a[204:207], v[132:135], a[36:39]
    buffer_load_dwordx4 a[128:131], v196, s[20:23], s59 offen offset:0 sc1
    v_mfma_f32_16x16x32_bf16 a[100:103], a[200:203], v[136:139], a[100:103]
    ds_read_b128 a[232:235], v201 offset:54272
    ds_read_b128 a[236:239], v201 offset:62464
    v_mfma_f32_16x16x32_bf16 a[100:103], a[204:207], v[140:143], a[100:103]
    s_waitcnt lgkmcnt(7)
    ds_read_b128 a[240:243], v201 offset:55296
    ds_read_b128 a[244:247], v201 offset:63488
    v_mfma_f32_16x16x32_bf16 a[40:43], a[208:211], v[128:131], a[40:43]
    s_waitcnt lgkmcnt(8)
    buffer_load_dwordx4 a[132:135], v198, s[20:23], s59 offen offset:0 sc1
    v_mfma_f32_16x16x32_bf16 a[40:43], a[212:215], v[132:135], a[40:43]
    ds_read_b128 a[248:251], v201 offset:56320
    ds_read_b128 a[252:255], v201 offset:64512
    v_mfma_f32_16x16x32_bf16 a[104:107], a[208:211], v[136:139], a[104:107]
    buffer_load_dwordx4 a[136:139], v196, s[20:23], s59 offen offset:1024 sc1
    v_mfma_f32_16x16x32_bf16 a[104:107], a[212:215], v[140:143], a[104:107]
    s_waitcnt lgkmcnt(9)
    v_exp_f32 v0, v0
    v_mfma_f32_16x16x32_bf16 a[44:47], a[216:219], v[128:131], a[44:47]
    s_waitcnt lgkmcnt(8)
    buffer_load_dwordx4 a[140:143], v198, s[20:23], s59 offen offset:1024 sc1
    v_mfma_f32_16x16x32_bf16 a[44:47], a[220:223], v[132:135], a[44:47]
    s_add_u32 m0, s50, 147456
    v_exp_f32 v1, v1
    v_mfma_f32_16x16x32_bf16 a[108:111], a[216:219], v[136:139], a[108:111]
    s_add_u32 s58, s48, 65536
    v_exp_f32 v2, v2
    v_mfma_f32_16x16x32_bf16 a[108:111], a[220:223], v[140:143], a[108:111]
    s_waitcnt lgkmcnt(7)
    v_exp_f32 v3, v3
    v_mfma_f32_16x16x32_bf16 a[48:51], a[224:227], v[128:131], a[48:51]
    s_waitcnt lgkmcnt(6)
    s_waitcnt lgkmcnt(0)
    v_mfma_f32_16x16x32_bf16 a[48:51], a[228:231], v[132:135], a[48:51]
    s_waitcnt vmcnt(24)
    s_barrier
    ds_read_b128 a[192:195], v200 offset:32768
    v_mfma_f32_16x16x32_bf16 a[112:115], a[224:227], v[136:139], a[112:115]
    v_exp_f32 v16, v16
    v_mfma_f32_16x16x32_bf16 a[112:115], a[228:231], v[140:143], a[112:115]
    ds_read_b128 a[196:199], v200 offset:33792
    ds_read_b128 a[200:203], v200 offset:34816
    v_mfma_f32_16x16x32_bf16 a[52:55], a[232:235], v[128:131], a[52:55]
    buffer_load_dwordx4 v242, s[12:15], s58 offen lds
    v_mfma_f32_16x16x32_bf16 a[52:55], a[236:239], v[132:135], a[52:55]
    v_exp_f32 v17, v17
    v_mfma_f32_16x16x32_bf16 a[116:119], a[232:235], v[136:139], a[116:119]
    v_exp_f32 v18, v18
    v_mfma_f32_16x16x32_bf16 a[116:119], a[236:239], v[140:143], a[116:119]
    v_exp_f32 v19, v19
    v_mfma_f32_16x16x32_bf16 a[56:59], a[240:243], v[128:131], a[56:59]
    v_exp_f32 v4, v4
    v_mfma_f32_16x16x32_bf16 a[56:59], a[244:247], v[132:135], a[56:59]
    ds_read_b128 a[204:207], v200 offset:35840
    buffer_load_dwordx4 v243, s[12:15], s58 offen offset:1024 lds
    v_exp_f32 v5, v5
    v_mfma_f32_16x16x32_bf16 a[120:123], a[240:243], v[136:139], a[120:123]
    s_add_u32 m0, s50, 155648
    v_exp_f32 v6, v6
    v_mfma_f32_16x16x32_bf16 a[120:123], a[244:247], v[140:143], a[120:123]
    ds_read_b128 a[208:211], v200 offset:36864
    v_exp_f32 v7, v7
    v_mfma_f32_16x16x32_bf16 a[60:63], a[248:251], v[128:131], a[60:63]
    s_add_u32 s58, s48, 98304
    v_exp_f32 v20, v20
    v_mfma_f32_16x16x32_bf16 a[60:63], a[252:255], v[132:135], a[60:63]
    ds_read_b128 a[212:215], v200 offset:37888
    buffer_load_dwordx4 v242, s[12:15], s58 offen lds
    v_exp_f32 v21, v21
    v_mfma_f32_16x16x32_bf16 a[124:127], a[248:251], v[136:139], a[124:127]
    v_exp_f32 v22, v22
    v_mfma_f32_16x16x32_bf16 a[124:127], a[252:255], v[140:143], a[124:127]
    ds_read_b128 a[216:219], v200 offset:38912
    v_exp_f32 v23, v23
    v_mfma_f32_16x16x32_bf16 v[176:179], v[192:195], v[128:131], v[176:179]
    v_exp_f32 v8, v8
    v_mfma_f32_16x16x32_bf16 v[176:179], v[192:195], v[132:135], v[176:179]
    ds_read_b128 a[220:223], v200 offset:39936
    buffer_load_dwordx4 v243, s[12:15], s58 offen offset:1024 lds
    v_exp_f32 v9, v9
    v_mfma_f32_16x16x32_bf16 v[180:183], v[192:195], v[136:139], v[180:183]
    v_exp_f32 v24, v24
    v_mfma_f32_16x16x32_bf16 v[180:183], v[192:195], v[140:143], v[180:183]
    s_waitcnt lgkmcnt(7)
    v_exp_f32 v25, v25
    v_mfma_f32_16x16x32_bf16 v[64:67], a[192:195], a[0:3], v[160:163]
    s_waitcnt lgkmcnt(6)
    s_mov_b32 m0, s53
    ds_read_b128 a[224:227], v200 offset:40960
    v_mfma_f32_16x16x32_bf16 v[64:67], a[196:199], a[4:7], v[64:67]
    s_waitcnt lgkmcnt(6)
    buffer_load_dwordx4 v240, s[16:19], s55 offen offset:0 sc1 lds
    v_mfma_f32_16x16x32_bf16 v[64:67], a[200:203], a[64:67], v[64:67]
    s_waitcnt lgkmcnt(5)
    ds_read_b128 a[228:231], v200 offset:41984
    ds_read_b128 a[232:235], v200 offset:43008
    v_mfma_f32_16x16x32_bf16 v[64:67], a[204:207], a[68:71], v[64:67]
    ds_read_b128 a[236:239], v200 offset:44032
    ds_read_b128 a[240:243], v200 offset:45056
    v_mfma_f32_16x16x32_bf16 v[80:83], a[204:207], a[76:79], v[164:167]
    buffer_load_dwordx4 v240, s[16:19], s55 offen offset:1024 sc1 lds
    v_mfma_f32_16x16x32_bf16 v[80:83], a[200:203], a[72:75], v[80:83]
    ds_read_b128 a[244:247], v200 offset:46080
    ds_read_b128 a[248:251], v200 offset:47104
    v_mfma_f32_16x16x32_bf16 v[80:83], a[196:199], a[12:15], v[80:83]
    ds_read_b128 a[252:255], v200 offset:48128
    v_cvt_pk_bf16_f32 v128, v0, v1
    v_mfma_f32_16x16x32_bf16 v[80:83], a[192:195], a[8:11], v[80:83]
    s_waitcnt lgkmcnt(11)
    v_exp_f32 v10, v10
    v_mfma_f32_16x16x32_bf16 v[68:71], a[208:211], a[0:3], v[160:163]
    s_waitcnt lgkmcnt(10)
    buffer_load_dwordx4 v240, s[16:19], s55 offen offset:2048 sc1 lds
    v_mfma_f32_16x16x32_bf16 v[68:71], a[212:215], a[4:7], v[68:71]
    s_waitcnt lgkmcnt(9)
    v_exp_f32 v11, v11
    v_mfma_f32_16x16x32_bf16 v[68:71], a[216:219], a[64:67], v[68:71]
    s_waitcnt lgkmcnt(8)
    ds_read_b128 a[192:195], v200 offset:16384
    v_cvt_pk_bf16_f32 v129, v2, v3
    v_mfma_f32_16x16x32_bf16 v[68:71], a[220:223], a[68:71], v[68:71]
    ds_read_b128 a[196:199], v200 offset:24576
    v_cvt_pk_bf16_f32 v130, v4, v5
    v_mfma_f32_16x16x32_bf16 v[84:87], a[220:223], a[76:79], v[164:167]
    buffer_load_dwordx4 v240, s[16:19], s55 offen offset:3072 sc1 lds
    v_mfma_f32_16x16x32_bf16 v[84:87], a[216:219], a[72:75], v[84:87]
    s_add_u32 s59, s64, 2048
    v_exp_f32 v12, v12
    v_mfma_f32_16x16x32_bf16 v[84:87], a[212:215], a[12:15], v[84:87]
    v_exp_f32 v13, v13
    v_mfma_f32_16x16x32_bf16 v[84:87], a[208:211], a[8:11], v[84:87]
    s_waitcnt lgkmcnt(9)
    v_exp_f32 v14, v14
    v_mfma_f32_16x16x32_bf16 v[72:75], a[224:227], a[0:3], v[160:163]
    s_waitcnt lgkmcnt(8)
    buffer_load_dwordx4 a[144:147], v196, s[20:23], s59 offen offset:0 sc1
    v_mfma_f32_16x16x32_bf16 v[72:75], a[228:231], a[4:7], v[72:75]
    s_waitcnt lgkmcnt(7)
    ds_read_b128 a[200:203], v200 offset:17408
    ds_read_b128 a[204:207], v200 offset:25600
    v_mfma_f32_16x16x32_bf16 v[72:75], a[232:235], a[64:67], v[72:75]
    s_waitcnt lgkmcnt(8)
    v_exp_f32 v15, v15
    v_mfma_f32_16x16x32_bf16 v[72:75], a[236:239], a[68:71], v[72:75]
    v_exp_f32 v26, v26
    v_mfma_f32_16x16x32_bf16 v[88:91], a[236:239], a[76:79], v[164:167]
    buffer_load_dwordx4 a[148:151], v198, s[20:23], s59 offen offset:0 sc1
    v_mfma_f32_16x16x32_bf16 v[88:91], a[232:235], a[72:75], v[88:91]
    v_cvt_pk_bf16_f32 v131, v6, v7
    v_cvt_pk_bf16_f32 v136, v16, v17
    v_mfma_f32_16x16x32_bf16 v[88:91], a[228:231], a[12:15], v[88:91]
    v_exp_f32 v27, v27
    v_mfma_f32_16x16x32_bf16 v[88:91], a[224:227], a[8:11], v[88:91]
    s_waitcnt lgkmcnt(7)
    v_cvt_pk_bf16_f32 v137, v18, v19
    v_cvt_pk_bf16_f32 v138, v20, v21
    v_mfma_f32_16x16x32_bf16 v[76:79], a[240:243], a[0:3], v[160:163]
    s_waitcnt lgkmcnt(6)
    v_exp_f32 v28, v28
    v_mfma_f32_16x16x32_bf16 v[76:79], a[244:247], a[4:7], v[76:79]
    s_waitcnt lgkmcnt(5)
    v_cvt_pk_bf16_f32 v139, v22, v23
    v_cvt_pk_bf16_f32 v132, v8, v9
    v_mfma_f32_16x16x32_bf16 v[76:79], a[248:251], a[64:67], v[76:79]
    s_waitcnt lgkmcnt(4)
    ds_read_b128 a[208:211], v200 offset:18432
    v_cvt_pk_bf16_f32 v133, v10, v11
    v_mfma_f32_16x16x32_bf16 v[76:79], a[252:255], a[68:71], v[76:79]
    buffer_load_dwordx4 a[152:155], v196, s[20:23], s59 offen offset:1024 sc1
    v_mfma_f32_16x16x32_bf16 v[92:95], a[252:255], a[76:79], v[164:167]
    v_exp_f32 v29, v29
    v_mfma_f32_16x16x32_bf16 v[92:95], a[248:251], a[72:75], v[92:95]
    ds_read_b128 a[212:215], v200 offset:26624
    v_cvt_pk_bf16_f32 v134, v12, v13
    v_mfma_f32_16x16x32_bf16 v[92:95], a[244:247], a[12:15], v[92:95]
    v_exp_f32 v30, v30
    v_mfma_f32_16x16x32_bf16 v[92:95], a[240:243], a[8:11], v[92:95]
    s_waitcnt lgkmcnt(5)
    v_cvt_pk_bf16_f32 v135, v14, v15
    v_cvt_pk_bf16_f32 v140, v24, v25
    v_mfma_f32_16x16x32_bf16 a[32:35], a[192:195], v[128:131], a[32:35]
    s_waitcnt lgkmcnt(4)
    v_exp_f32 v31, v31
    v_cvt_pk_bf16_f32 v141, v26, v27
    v_cvt_pk_bf16_f32 v142, v28, v29
    v_mfma_f32_16x16x32_bf16 a[32:35], a[196:199], v[132:135], a[32:35]
    ds_read_b128 a[216:219], v200 offset:19456
    v_cvt_pk_bf16_f32 v143, v30, v31
    v_mfma_f32_16x16x32_bf16 a[96:99], a[192:195], v[136:139], a[96:99]
    buffer_load_dwordx4 a[156:159], v198, s[20:23], s59 offen offset:1024 sc1
    v_mfma_f32_16x16x32_bf16 a[96:99], a[196:199], v[140:143], a[96:99]
    s_waitcnt lgkmcnt(4)
    ds_read_b128 a[220:223], v200 offset:27648
    ds_read_b128 a[224:227], v200 offset:20480
    v_mfma_f32_16x16x32_bf16 a[36:39], a[200:203], v[128:131], a[36:39]
    s_waitcnt lgkmcnt(5)
    s_add_u32 s59, s64, 4096
    ds_read_b128 a[228:231], v200 offset:28672
    v_mfma_f32_16x16x32_bf16 a[36:39], a[204:207], v[132:135], a[36:39]
    buffer_load_dwordx4 a[160:163], v196, s[20:23], s59 offen offset:0 sc1
    v_mfma_f32_16x16x32_bf16 a[100:103], a[200:203], v[136:139], a[100:103]
    ds_read_b128 a[232:235], v200 offset:21504
    ds_read_b128 a[236:239], v200 offset:29696
    v_mfma_f32_16x16x32_bf16 a[100:103], a[204:207], v[140:143], a[100:103]
    s_waitcnt lgkmcnt(7)
    ds_read_b128 a[240:243], v200 offset:22528
    ds_read_b128 a[244:247], v200 offset:30720
    v_mfma_f32_16x16x32_bf16 a[40:43], a[208:211], v[128:131], a[40:43]
    s_waitcnt lgkmcnt(8)
    buffer_load_dwordx4 a[164:167], v198, s[20:23], s59 offen offset:0 sc1
    v_mfma_f32_16x16x32_bf16 a[40:43], a[212:215], v[132:135], a[40:43]
    ds_read_b128 a[248:251], v200 offset:23552
    ds_read_b128 a[252:255], v200 offset:31744
    v_mfma_f32_16x16x32_bf16 a[104:107], a[208:211], v[136:139], a[104:107]
    buffer_load_dwordx4 a[168:171], v196, s[20:23], s59 offen offset:1024 sc1
    v_mfma_f32_16x16x32_bf16 a[104:107], a[212:215], v[140:143], a[104:107]
    s_waitcnt lgkmcnt(9)
    v_exp_f32 v64, v64
    v_mfma_f32_16x16x32_bf16 a[44:47], a[216:219], v[128:131], a[44:47]
    s_waitcnt lgkmcnt(8)
    buffer_load_dwordx4 a[172:175], v198, s[20:23], s59 offen offset:1024 sc1
    v_mfma_f32_16x16x32_bf16 a[44:47], a[220:223], v[132:135], a[44:47]
    s_add_u32 s59, s64, 6144
    v_exp_f32 v65, v65
    v_mfma_f32_16x16x32_bf16 a[108:111], a[216:219], v[136:139], a[108:111]
    v_exp_f32 v66, v66
    v_mfma_f32_16x16x32_bf16 a[108:111], a[220:223], v[140:143], a[108:111]
    s_waitcnt lgkmcnt(7)
    v_exp_f32 v67, v67
    v_mfma_f32_16x16x32_bf16 a[48:51], a[224:227], v[128:131], a[48:51]
    s_waitcnt lgkmcnt(6)
    s_waitcnt lgkmcnt(0)
    v_xor_b32 v200, 0x10000, v200
    v_mfma_f32_16x16x32_bf16 a[48:51], a[228:231], v[132:135], a[48:51]
    s_waitcnt vmcnt(32)
    s_barrier
    ds_read_b128 a[192:195], v201 offset:0
    v_mfma_f32_16x16x32_bf16 a[112:115], a[224:227], v[136:139], a[112:115]
    v_exp_f32 v80, v80
    v_mfma_f32_16x16x32_bf16 a[112:115], a[228:231], v[140:143], a[112:115]
    ds_read_b128 a[196:199], v201 offset:1024
    ds_read_b128 a[200:203], v201 offset:2048
    v_mfma_f32_16x16x32_bf16 a[52:55], a[232:235], v[128:131], a[52:55]
    buffer_load_dwordx4 a[176:179], v196, s[20:23], s59 offen offset:0 sc1
    v_mfma_f32_16x16x32_bf16 a[52:55], a[236:239], v[132:135], a[52:55]
    v_exp_f32 v81, v81
    v_mfma_f32_16x16x32_bf16 a[116:119], a[232:235], v[136:139], a[116:119]
    v_exp_f32 v82, v82
    v_mfma_f32_16x16x32_bf16 a[116:119], a[236:239], v[140:143], a[116:119]
    v_exp_f32 v83, v83
    v_mfma_f32_16x16x32_bf16 a[56:59], a[240:243], v[128:131], a[56:59]
    v_exp_f32 v68, v68
    v_mfma_f32_16x16x32_bf16 a[56:59], a[244:247], v[132:135], a[56:59]
    ds_read_b128 a[204:207], v201 offset:3072
    buffer_load_dwordx4 a[180:183], v198, s[20:23], s59 offen offset:0 sc1
    v_exp_f32 v69, v69
    v_mfma_f32_16x16x32_bf16 a[120:123], a[240:243], v[136:139], a[120:123]
    v_exp_f32 v70, v70
    v_mfma_f32_16x16x32_bf16 a[120:123], a[244:247], v[140:143], a[120:123]
    ds_read_b128 a[208:211], v201 offset:4096
    v_exp_f32 v71, v71
    v_mfma_f32_16x16x32_bf16 a[60:63], a[248:251], v[128:131], a[60:63]
    v_exp_f32 v84, v84
    v_mfma_f32_16x16x32_bf16 a[60:63], a[252:255], v[132:135], a[60:63]
    ds_read_b128 a[212:215], v201 offset:5120
    buffer_load_dwordx4 a[184:187], v196, s[20:23], s59 offen offset:1024 sc1
    v_exp_f32 v85, v85
    v_mfma_f32_16x16x32_bf16 a[124:127], a[248:251], v[136:139], a[124:127]
    v_exp_f32 v86, v86
    v_mfma_f32_16x16x32_bf16 a[124:127], a[252:255], v[140:143], a[124:127]
    ds_read_b128 a[216:219], v201 offset:6144
    v_exp_f32 v87, v87
    v_mfma_f32_16x16x32_bf16 v[176:179], v[192:195], v[128:131], v[176:179]
    v_exp_f32 v72, v72
    v_mfma_f32_16x16x32_bf16 v[176:179], v[192:195], v[132:135], v[176:179]
    ds_read_b128 a[220:223], v201 offset:7168
    buffer_load_dwordx4 a[188:191], v198, s[20:23], s59 offen offset:1024 sc1
    v_exp_f32 v73, v73
    v_mfma_f32_16x16x32_bf16 v[180:183], v[192:195], v[136:139], v[180:183]
    v_exp_f32 v88, v88
    v_mfma_f32_16x16x32_bf16 v[180:183], v[192:195], v[140:143], v[180:183]
    s_waitcnt lgkmcnt(7)
    v_exp_f32 v89, v89
    v_xor_b32 v201, 0x10000, v201
    v_mfma_f32_16x16x32_bf16 v[0:3], a[192:195], a[0:3], v[160:163]
    s_waitcnt lgkmcnt(6)
    s_add_u32 s59, s64, 8192
    ds_read_b128 a[224:227], v200 offset:8192
    v_mfma_f32_16x16x32_bf16 v[0:3], a[196:199], a[4:7], v[0:3]
    s_waitcnt lgkmcnt(6)
    buffer_load_dwordx4 v[96:99], v196, s[20:23], s59 offen offset:0 sc1
    v_mfma_f32_16x16x32_bf16 v[0:3], a[200:203], a[64:67], v[0:3]
    s_waitcnt lgkmcnt(5)
    ds_read_b128 a[228:231], v200 offset:9216
    ds_read_b128 a[232:235], v200 offset:10240
    v_mfma_f32_16x16x32_bf16 v[0:3], a[204:207], a[68:71], v[0:3]
    ds_read_b128 a[236:239], v200 offset:11264
    ds_read_b128 a[240:243], v200 offset:12288
    v_mfma_f32_16x16x32_bf16 v[16:19], a[204:207], a[76:79], v[164:167]
    buffer_load_dwordx4 v[100:103], v198, s[20:23], s59 offen offset:0 sc1
    v_mfma_f32_16x16x32_bf16 v[16:19], a[200:203], a[72:75], v[16:19]
    ds_read_b128 a[244:247], v200 offset:13312
    ds_read_b128 a[248:251], v200 offset:14336
    v_mfma_f32_16x16x32_bf16 v[16:19], a[196:199], a[12:15], v[16:19]
    ds_read_b128 a[252:255], v200 offset:15360
    v_cvt_pk_bf16_f32 v128, v64, v65
    v_mfma_f32_16x16x32_bf16 v[16:19], a[192:195], a[8:11], v[16:19]
    s_waitcnt lgkmcnt(11)
    v_exp_f32 v74, v74
    v_mfma_f32_16x16x32_bf16 v[4:7], a[208:211], a[0:3], v[160:163]
    s_waitcnt lgkmcnt(10)
    buffer_load_dwordx4 v[104:107], v196, s[20:23], s59 offen offset:1024 sc1
    v_mfma_f32_16x16x32_bf16 v[4:7], a[212:215], a[4:7], v[4:7]
    s_waitcnt lgkmcnt(9)
    v_exp_f32 v75, v75
    v_mfma_f32_16x16x32_bf16 v[4:7], a[216:219], a[64:67], v[4:7]
    s_waitcnt lgkmcnt(8)
    ds_read_b128 a[192:195], v201 offset:49152
    v_cvt_pk_bf16_f32 v129, v66, v67
    v_mfma_f32_16x16x32_bf16 v[4:7], a[220:223], a[68:71], v[4:7]
    ds_read_b128 a[196:199], v201 offset:57344
    v_cvt_pk_bf16_f32 v130, v68, v69
    v_mfma_f32_16x16x32_bf16 v[20:23], a[220:223], a[76:79], v[164:167]
    buffer_load_dwordx4 v[108:111], v198, s[20:23], s59 offen offset:1024 sc1
    v_mfma_f32_16x16x32_bf16 v[20:23], a[216:219], a[72:75], v[20:23]
    s_add_u32 m0, s51, 0
    s_add_u32 s58, s48, 131072
    v_cvt_pk_bf16_f32 v131, v70, v71
    v_mfma_f32_16x16x32_bf16 v[20:23], a[212:215], a[12:15], v[20:23]
    v_exp_f32 v76, v76
    v_mfma_f32_16x16x32_bf16 v[20:23], a[208:211], a[8:11], v[20:23]
    s_waitcnt lgkmcnt(9)
    v_exp_f32 v77, v77
    v_mfma_f32_16x16x32_bf16 v[8:11], a[224:227], a[0:3], v[160:163]
    s_waitcnt lgkmcnt(8)
    buffer_load_dwordx4 v242, s[12:15], s58 offen lds
    v_mfma_f32_16x16x32_bf16 v[8:11], a[228:231], a[4:7], v[8:11]
    s_waitcnt lgkmcnt(7)
    ds_read_b128 a[200:203], v201 offset:50176
    ds_read_b128 a[204:207], v201 offset:58368
    v_mfma_f32_16x16x32_bf16 v[8:11], a[232:235], a[64:67], v[8:11]
    s_waitcnt lgkmcnt(8)
    v_exp_f32 v78, v78
    v_mfma_f32_16x16x32_bf16 v[8:11], a[236:239], a[68:71], v[8:11]
    v_exp_f32 v79, v79
    v_mfma_f32_16x16x32_bf16 v[24:27], a[236:239], a[76:79], v[164:167]
    buffer_load_dwordx4 v243, s[12:15], s58 offen offset:1024 lds
    v_mfma_f32_16x16x32_bf16 v[24:27], a[232:235], a[72:75], v[24:27]
    s_add_u32 m0, s51, 8192
    v_exp_f32 v90, v90
    v_mfma_f32_16x16x32_bf16 v[24:27], a[228:231], a[12:15], v[24:27]
    s_add_u32 s58, s48, 163840
    v_cvt_pk_bf16_f32 v136, v80, v81
    v_cvt_pk_bf16_f32 v137, v82, v83
    v_mfma_f32_16x16x32_bf16 v[24:27], a[224:227], a[8:11], v[24:27]
    s_waitcnt lgkmcnt(7)
    v_exp_f32 v91, v91
    v_mfma_f32_16x16x32_bf16 v[12:15], a[240:243], a[0:3], v[160:163]
    s_waitcnt lgkmcnt(6)
    v_cvt_pk_bf16_f32 v138, v84, v85
    v_cvt_pk_bf16_f32 v139, v86, v87
    v_mfma_f32_16x16x32_bf16 v[12:15], a[244:247], a[4:7], v[12:15]
    s_waitcnt lgkmcnt(5)
    v_exp_f32 v92, v92
    v_mfma_f32_16x16x32_bf16 v[12:15], a[248:251], a[64:67], v[12:15]
    s_waitcnt lgkmcnt(4)
    ds_read_b128 a[208:211], v201 offset:51200
    v_cvt_pk_bf16_f32 v132, v72, v73
    v_mfma_f32_16x16x32_bf16 v[12:15], a[252:255], a[68:71], v[12:15]
    buffer_load_dwordx4 v242, s[12:15], s58 offen lds
    v_mfma_f32_16x16x32_bf16 v[28:31], a[252:255], a[76:79], v[164:167]
    v_cvt_pk_bf16_f32 v133, v74, v75
    v_cvt_pk_bf16_f32 v134, v76, v77
    v_mfma_f32_16x16x32_bf16 v[28:31], a[248:251], a[72:75], v[28:31]
    v_exp_f32 v93, v93
    v_mfma_f32_16x16x32_bf16 v[28:31], a[244:247], a[12:15], v[28:31]
    ds_read_b128 a[212:215], v201 offset:59392
    v_cvt_pk_bf16_f32 v135, v78, v79
    v_mfma_f32_16x16x32_bf16 v[28:31], a[240:243], a[8:11], v[28:31]
    s_waitcnt lgkmcnt(5)
    v_exp_f32 v94, v94
    v_cvt_pk_bf16_f32 v140, v88, v89
    v_mfma_f32_16x16x32_bf16 a[32:35], a[192:195], v[128:131], a[32:35]
    s_waitcnt lgkmcnt(4)
    v_exp_f32 v95, v95
    v_cvt_pk_bf16_f32 v141, v90, v91
    v_cvt_pk_bf16_f32 v142, v92, v93
    v_mfma_f32_16x16x32_bf16 a[32:35], a[196:199], v[132:135], a[32:35]
    ds_read_b128 a[216:219], v201 offset:52224
    v_cvt_pk_bf16_f32 v143, v94, v95
    v_mfma_f32_16x16x32_bf16 a[96:99], a[192:195], v[136:139], a[96:99]
    buffer_load_dwordx4 v243, s[12:15], s58 offen offset:1024 lds
    v_mfma_f32_16x16x32_bf16 a[96:99], a[196:199], v[140:143], a[96:99]
    s_waitcnt lgkmcnt(4)
    s_add_u32 m0, s51, 16384
    ds_read_b128 a[220:223], v201 offset:60416
    v_mfma_f32_16x16x32_bf16 a[36:39], a[200:203], v[128:131], a[36:39]
    s_waitcnt lgkmcnt(4)
    s_add_u32 s58, s48, 196608
    ds_read_b128 a[224:227], v201 offset:53248
    v_mfma_f32_16x16x32_bf16 a[36:39], a[204:207], v[132:135], a[36:39]
    ds_read_b128 a[228:231], v201 offset:61440
    buffer_load_dwordx4 v242, s[12:15], s58 offen lds
    v_mfma_f32_16x16x32_bf16 a[100:103], a[200:203], v[136:139], a[100:103]
    ds_read_b128 a[232:235], v201 offset:54272
    ds_read_b128 a[236:239], v201 offset:62464
    v_mfma_f32_16x16x32_bf16 a[100:103], a[204:207], v[140:143], a[100:103]
    s_waitcnt lgkmcnt(7)
    ds_read_b128 a[240:243], v201 offset:55296
    ds_read_b128 a[244:247], v201 offset:63488
    v_mfma_f32_16x16x32_bf16 a[40:43], a[208:211], v[128:131], a[40:43]
    s_waitcnt lgkmcnt(8)
    buffer_load_dwordx4 v243, s[12:15], s58 offen offset:1024 lds
    v_mfma_f32_16x16x32_bf16 a[40:43], a[212:215], v[132:135], a[40:43]
    s_add_u32 m0, s51, 24576
    ds_read_b128 a[248:251], v201 offset:56320
    ds_read_b128 a[252:255], v201 offset:64512
    v_mfma_f32_16x16x32_bf16 a[104:107], a[208:211], v[136:139], a[104:107]
    s_add_u32 s58, s48, 229376
    v_subrev_f32 v202, 0x0, v199
    v_min_f32 v0, v0, v202
    v_mfma_f32_16x16x32_bf16 a[104:107], a[212:215], v[140:143], a[104:107]
    s_waitcnt lgkmcnt(9)
    buffer_load_dwordx4 v242, s[12:15], s58 offen lds
    v_mfma_f32_16x16x32_bf16 a[44:47], a[216:219], v[128:131], a[44:47]
    s_waitcnt lgkmcnt(8)
    buffer_load_dwordx4 v243, s[12:15], s58 offen offset:1024 lds
    v_mfma_f32_16x16x32_bf16 a[44:47], a[220:223], v[132:135], a[44:47]
    s_add_u32 m0, s51, 32768
    v_subrev_f32 v203, 0x71800000, v199
    v_min_f32 v1, v1, v203
    v_mfma_f32_16x16x32_bf16 a[108:111], a[216:219], v[136:139], a[108:111]
    s_add_u32 s58, s48, 262144
    v_exp_f32 v0, v0
    v_mfma_f32_16x16x32_bf16 a[108:111], a[220:223], v[140:143], a[108:111]
    s_waitcnt lgkmcnt(7)
    v_subrev_f32 v202, 0x72000000, v199
    v_min_f32 v2, v2, v202
    v_mfma_f32_16x16x32_bf16 a[48:51], a[224:227], v[128:131], a[48:51]
    s_waitcnt lgkmcnt(6)
    s_waitcnt lgkmcnt(0)
    v_subrev_f32 v203, 0x72400000, v199
    v_mfma_f32_16x16x32_bf16 a[48:51], a[228:231], v[132:135], a[48:51]
    s_waitcnt vmcnt(40)
    s_barrier
    ds_read_b128 a[192:195], v200 offset:32768
    v_mfma_f32_16x16x32_bf16 a[112:115], a[224:227], v[136:139], a[112:115]
    v_exp_f32 v1, v1
    v_mfma_f32_16x16x32_bf16 a[112:115], a[228:231], v[140:143], a[112:115]
    ds_read_b128 a[196:199], v200 offset:33792
    v_min_f32 v3, v3, v203
    v_mfma_f32_16x16x32_bf16 a[52:55], a[232:235], v[128:131], a[52:55]
    buffer_load_dwordx4 v242, s[12:15], s58 offen lds
    v_mfma_f32_16x16x32_bf16 a[52:55], a[236:239], v[132:135], a[52:55]
    v_exp_f32 v2, v2
    v_mfma_f32_16x16x32_bf16 a[116:119], a[232:235], v[136:139], a[116:119]
    v_exp_f32 v3, v3
    v_mfma_f32_16x16x32_bf16 a[116:119], a[236:239], v[140:143], a[116:119]
    ds_read_b128 a[200:203], v200 offset:34816
    v_exp_f32 v16, v16
    v_subrev_f32 v202, 0x73800000, v199
    v_exp_f32 v17, v17
    v_mfma_f32_16x16x32_bf16 a[56:59], a[240:243], v[128:131], a[56:59]
    v_min_f32 v4, v4, v202
    v_subrev_f32 v203, 0x73880000, v199
    v_exp_f32 v18, v18
    v_mfma_f32_16x16x32_bf16 a[56:59], a[244:247], v[132:135], a[56:59]
    ds_read_b128 a[204:207], v200 offset:35840
    buffer_load_dwordx4 v243, s[12:15], s58 offen offset:1024 lds
    v_min_f32 v5, v5, v203
    v_subrev_f32 v202, 0x73900000, v199
    v_exp_f32 v19, v19
    v_min_f32 v6, v6, v202
    v_mfma_f32_16x16x32_bf16 a[120:123], a[240:243], v[136:139], a[120:123]
    v_subrev_f32 v203, 0x73980000, v199
    v_exp_f32 v4, v4
    v_min_f32 v7, v7, v203
    v_mfma_f32_16x16x32_bf16 a[120:123], a[244:247], v[140:143], a[120:123]
    s_add_u32 m0, s51, 40960
    ds_read_b128 a[208:211], v200 offset:36864
    v_subrev_f32 v202, 0x74000000, v199
    v_exp_f32 v5, v5
    v_min_f32 v8, v8, v202
    v_subrev_f32 v203, 0x74040000, v199
    v_exp_f32 v6, v6
    v_mfma_f32_16x16x32_bf16 a[60:63], a[248:251], v[128:131], a[60:63]
    s_add_u32 s58, s48, 294912
    v_min_f32 v9, v9, v203
    v_subrev_f32 v202, 0x74080000, v199
    v_exp_f32 v7, v7
    v_mfma_f32_16x16x32_bf16 a[60:63], a[252:255], v[132:135], a[60:63]
    ds_read_b128 a[212:215], v200 offset:37888
    buffer_load_dwordx4 v242, s[12:15], s58 offen lds
    v_min_f32 v10, v10, v202
    v_subrev_f32 v203, 0x740c0000, v199
    v_exp_f32 v20, v20
    v_min_f32 v11, v11, v203
    v_mfma_f32_16x16x32_bf16 a[124:127], a[248:251], v[136:139], a[124:127]
    v_subrev_f32 v202, 0x74400000, v199
    v_exp_f32 v21, v21
    v_min_f32 v12, v12, v202
    v_subrev_f32 v203, 0x74440000, v199
    v_mfma_f32_16x16x32_bf16 a[124:127], a[252:255], v[140:143], a[124:127]
    ds_read_b128 a[216:219], v200 offset:38912
    v_exp_f32 v22, v22
    v_min_f32 v13, v13, v203
    v_subrev_f32 v202, 0x74480000, v199
    v_exp_f32 v23, v23
    v_mfma_f32_16x16x32_bf16 v[176:179], v[192:195], v[128:131], v[176:179]
    v_min_f32 v14, v14, v202
    v_subrev_f32 v203, 0x744c0000, v199
    v_exp_f32 v8, v8
    v_mfma_f32_16x16x32_bf16 v[176:179], v[192:195], v[132:135], v[176:179]
    ds_read_b128 a[220:223], v200 offset:39936
    buffer_load_dwordx4 v243, s[12:15], s58 offen offset:1024 lds
    v_min_f32 v15, v15, v203
    v_exp_f32 v9, v9
    v_mfma_f32_16x16x32_bf16 v[180:183], v[192:195], v[136:139], v[180:183]
    v_exp_f32 v24, v24
    v_mfma_f32_16x16x32_bf16 v[180:183], v[192:195], v[140:143], v[180:183]
    s_waitcnt lgkmcnt(7)
    v_exp_f32 v25, v25
    v_mfma_f32_16x16x32_bf16 v[80:83], a[192:195], a[8:11], v[164:167]
    s_waitcnt lgkmcnt(6)
    ds_read_b128 a[224:227], v200 offset:40960
    ds_read_b128 a[228:231], v200 offset:41984
    ds_read_b128 a[232:235], v200 offset:43008
    v_mfma_f32_16x16x32_bf16 v[80:83], a[196:199], a[12:15], v[80:83]
    s_waitcnt lgkmcnt(8)
    ds_read_b128 a[236:239], v200 offset:44032
    ds_read_b128 a[240:243], v200 offset:45056
    v_mfma_f32_16x16x32_bf16 v[80:83], a[200:203], a[72:75], v[80:83]
    s_waitcnt lgkmcnt(9)
    ds_read_b128 a[244:247], v200 offset:46080
    ds_read_b128 a[248:251], v200 offset:47104
    v_mfma_f32_16x16x32_bf16 v[80:83], a[204:207], a[76:79], v[80:83]
    s_waitcnt lgkmcnt(10)
    s_add_u32 s59, s64, 10240
    ds_read_b128 a[252:255], v200 offset:48128
    v_mfma_f32_16x16x32_bf16 v[84:87], a[208:211], a[8:11], v[164:167]
    s_waitcnt lgkmcnt(10)
    v_exp_f32 v10, v10
    v_mfma_f32_16x16x32_bf16 v[84:87], a[212:215], a[12:15], v[84:87]
    s_waitcnt lgkmcnt(9)
    ds_read_b128 a[192:195], v200 offset:16384
    ds_read_b128 a[196:199], v200 offset:24576
    v_mfma_f32_16x16x32_bf16 v[84:87], a[216:219], a[72:75], v[84:87]
    s_waitcnt lgkmcnt(10)
    buffer_load_dwordx4 v[112:115], v196, s[20:23], s59 offen offset:0 sc1
    v_exp_f32 v11, v11
    v_mfma_f32_16x16x32_bf16 v[84:87], a[220:223], a[76:79], v[84:87]
    s_waitcnt lgkmcnt(9)
    v_exp_f32 v12, v12
    v_mfma_f32_16x16x32_bf16 v[88:91], a[224:227], a[8:11], v[164:167]
    s_waitcnt lgkmcnt(8)
    v_exp_f32 v13, v13
    v_mfma_f32_16x16x32_bf16 v[88:91], a[228:231], a[12:15], v[88:91]
    s_waitcnt lgkmcnt(7)
    v_exp_f32 v14, v14
    v_cvt_pk_bf16_f32 v128, v0, v1
    v_mfma_f32_16x16x32_bf16 v[88:91], a[232:235], a[72:75], v[88:91]
    s_waitcnt lgkmcnt(6)
    ds_read_b128 a[200:203], v200 offset:17408
    buffer_load_dwordx4 v[116:119], v198, s[20:23], s59 offen offset:0 sc1
    v_exp_f32 v15, v15
    v_cvt_pk_bf16_f32 v129, v2, v3
    v_cvt_pk_bf16_f32 v130, v4, v5
    v_mfma_f32_16x16x32_bf16 v[88:91], a[236:239], a[76:79], v[88:91]
    s_waitcnt lgkmcnt(6)
    ds_read_b128 a[204:207], v200 offset:25600
    v_exp_f32 v26, v26
    v_cvt_pk_bf16_f32 v131, v6, v7
    v_cvt_pk_bf16_f32 v136, v16, v17
    v_mfma_f32_16x16x32_bf16 v[92:95], a[240:243], a[8:11], v[164:167]
    s_waitcnt lgkmcnt(6)
    v_exp_f32 v27, v27
    v_cvt_pk_bf16_f32 v137, v18, v19
    v_cvt_pk_bf16_f32 v138, v20, v21
    v_mfma_f32_16x16x32_bf16 v[92:95], a[244:247], a[12:15], v[92:95]
    s_waitcnt lgkmcnt(5)
    v_exp_f32 v28, v28
    v_cvt_pk_bf16_f32 v139, v22, v23
    v_cvt_pk_bf16_f32 v132, v8, v9
    v_mfma_f32_16x16x32_bf16 v[92:95], a[248:251], a[72:75], v[92:95]
    s_waitcnt lgkmcnt(4)
    ds_read_b128 a[208:211], v200 offset:18432
    buffer_load_dwordx4 v[120:123], v196, s[20:23], s59 offen offset:1024 sc1
    v_exp_f32 v29, v29
    v_cvt_pk_bf16_f32 v133, v10, v11
    v_cvt_pk_bf16_f32 v134, v12, v13
    v_mfma_f32_16x16x32_bf16 v[92:95], a[252:255], a[76:79], v[92:95]
    s_waitcnt lgkmcnt(4)
    ds_read_b128 a[212:215], v200 offset:26624
    v_exp_f32 v30, v30
    v_cvt_pk_bf16_f32 v135, v14, v15
    v_cvt_pk_bf16_f32 v140, v24, v25
    v_mfma_f32_16x16x32_bf16 a[32:35], a[192:195], v[128:131], a[32:35]
    s_waitcnt lgkmcnt(4)
    v_exp_f32 v31, v31
    v_cvt_pk_bf16_f32 v141, v26, v27
    v_cvt_pk_bf16_f32 v142, v28, v29
    v_mfma_f32_16x16x32_bf16 a[32:35], a[196:199], v[132:135], a[32:35]
    ds_read_b128 a[216:219], v200 offset:19456
    v_cvt_pk_bf16_f32 v143, v30, v31
    v_mfma_f32_16x16x32_bf16 a[96:99], a[192:195], v[136:139], a[96:99]
    buffer_load_dwordx4 v[124:127], v198, s[20:23], s59 offen offset:1024 sc1
    v_mfma_f32_16x16x32_bf16 a[96:99], a[196:199], v[140:143], a[96:99]
    s_waitcnt lgkmcnt(4)
    ds_read_b128 a[220:223], v200 offset:27648
    ds_read_b128 a[224:227], v200 offset:20480
    v_mfma_f32_16x16x32_bf16 a[36:39], a[200:203], v[128:131], a[36:39]
    s_waitcnt lgkmcnt(5)
    s_add_u32 m0, s51, 49152
    ds_read_b128 a[228:231], v200 offset:28672
    v_mfma_f32_16x16x32_bf16 a[36:39], a[204:207], v[132:135], a[36:39]
    s_add_u32 s58, s48, 327680
    ds_read_b128 a[232:235], v200 offset:21504
    ds_read_b128 a[236:239], v200 offset:29696
    v_mfma_f32_16x16x32_bf16 a[100:103], a[200:203], v[136:139], a[100:103]
    buffer_load_dwordx4 v242, s[12:15], s58 offen lds
    v_mfma_f32_16x16x32_bf16 a[100:103], a[204:207], v[140:143], a[100:103]
    s_waitcnt lgkmcnt(7)
    ds_read_b128 a[240:243], v200 offset:22528
    ds_read_b128 a[244:247], v200 offset:30720
    v_mfma_f32_16x16x32_bf16 a[40:43], a[208:211], v[128:131], a[40:43]
    s_waitcnt lgkmcnt(8)
    ds_read_b128 a[248:251], v200 offset:23552
    ds_read_b128 a[252:255], v200 offset:31744
    v_mfma_f32_16x16x32_bf16 a[40:43], a[212:215], v[132:135], a[40:43]
    buffer_load_dwordx4 v243, s[12:15], s58 offen offset:1024 lds
    v_mfma_f32_16x16x32_bf16 a[104:107], a[208:211], v[136:139], a[104:107]
    s_add_u32 m0, s51, 57344
    s_add_u32 s58, s48, 360448
    v_subrev_f32 v202, 0x0, v199
    v_mfma_f32_16x16x32_bf16 a[104:107], a[212:215], v[140:143], a[104:107]
    s_waitcnt lgkmcnt(9)
    buffer_load_dwordx4 v242, s[12:15], s58 offen lds
    v_mfma_f32_16x16x32_bf16 a[44:47], a[216:219], v[128:131], a[44:47]
    s_waitcnt lgkmcnt(8)
    buffer_load_dwordx4 v243, s[12:15], s58 offen offset:1024 lds
    v_mfma_f32_16x16x32_bf16 a[44:47], a[220:223], v[132:135], a[44:47]
    s_add_u32 m0, s56, 0
    v_min_f32 v80, v80, v202
    v_subrev_f32 v203, 0x71800000, v199
    v_mfma_f32_16x16x32_bf16 a[108:111], a[216:219], v[136:139], a[108:111]
    s_add_u32 s58, s48, 393216
    v_min_f32 v81, v81, v203
    v_subrev_f32 v202, 0x72000000, v199
    v_mfma_f32_16x16x32_bf16 a[108:111], a[220:223], v[140:143], a[108:111]
    s_waitcnt lgkmcnt(7)
    v_min_f32 v82, v82, v202
    v_subrev_f32 v203, 0x72400000, v199
    v_mfma_f32_16x16x32_bf16 a[48:51], a[224:227], v[128:131], a[48:51]
    s_waitcnt lgkmcnt(6)
    s_waitcnt lgkmcnt(0)
    v_min_f32 v83, v83, v203
    v_mfma_f32_16x16x32_bf16 a[48:51], a[228:231], v[132:135], a[48:51]
    s_waitcnt vmcnt(36)
    s_barrier
    ds_read_b128 a[192:195], v200 offset:49152
    v_mfma_f32_16x16x32_bf16 a[112:115], a[224:227], v[136:139], a[112:115]
    ds_read_b128 a[196:199], v200 offset:57344
    v_subrev_f32 v202, 0x73800000, v199
    v_mfma_f32_16x16x32_bf16 a[112:115], a[228:231], v[140:143], a[112:115]
    buffer_load_dwordx4 v242, s[12:15], s58 offen lds
    v_mfma_f32_16x16x32_bf16 a[52:55], a[232:235], v[128:131], a[52:55]
    v_min_f32 v84, v84, v202
    v_subrev_f32 v203, 0x73880000, v199
    v_mfma_f32_16x16x32_bf16 a[52:55], a[236:239], v[132:135], a[52:55]
    ds_read_b128 a[200:203], v200 offset:50176
    v_min_f32 v85, v85, v203
    v_mfma_f32_16x16x32_bf16 a[116:119], a[232:235], v[136:139], a[116:119]
    v_subrev_f32 v202, 0x73900000, v199
    v_min_f32 v86, v86, v202
    v_mfma_f32_16x16x32_bf16 a[116:119], a[236:239], v[140:143], a[116:119]
    ds_read_b128 a[204:207], v200 offset:58368
    v_subrev_f32 v203, 0x73980000, v199
    v_mfma_f32_16x16x32_bf16 a[56:59], a[240:243], v[128:131], a[56:59]
    buffer_load_dwordx4 v243, s[12:15], s58 offen offset:1024 lds
    v_mfma_f32_16x16x32_bf16 a[56:59], a[244:247], v[132:135], a[56:59]
    s_add_u32 m0, s56, 8192
    v_min_f32 v87, v87, v203
    v_subrev_f32 v202, 0x74000000, v199
    v_mfma_f32_16x16x32_bf16 a[120:123], a[240:243], v[136:139], a[120:123]
    v_exp_f32 v80, v80
    v_min_f32 v88, v88, v202
    v_subrev_f32 v203, 0x74040000, v199
    v_mfma_f32_16x16x32_bf16 a[120:123], a[244:247], v[140:143], a[120:123]
    ds_read_b128 a[208:211], v200 offset:51200
    v_exp_f32 v81, v81
    v_min_f32 v89, v89, v203
    v_subrev_f32 v202, 0x74080000, v199
    v_mfma_f32_16x16x32_bf16 a[60:63], a[248:251], v[128:131], a[60:63]
    s_add_u32 s58, s48, 425984
    v_exp_f32 v82, v82
    v_min_f32 v90, v90, v202
    v_subrev_f32 v203, 0x740c0000, v199
    v_mfma_f32_16x16x32_bf16 a[60:63], a[252:255], v[132:135], a[60:63]
    ds_read_b128 a[212:215], v200 offset:59392
    buffer_load_dwordx4 v242, s[12:15], s58 offen lds
    v_exp_f32 v83, v83
    v_min_f32 v91, v91, v203
    v_subrev_f32 v202, 0x74400000, v199
    v_mfma_f32_16x16x32_bf16 a[124:127], a[248:251], v[136:139], a[124:127]
    v_exp_f32 v84, v84
    v_min_f32 v92, v92, v202
    v_subrev_f32 v203, 0x74440000, v199
    v_mfma_f32_16x16x32_bf16 a[124:127], a[252:255], v[140:143], a[124:127]
    ds_read_b128 a[216:219], v200 offset:52224
    v_exp_f32 v85, v85
    v_min_f32 v93, v93, v203
    v_subrev_f32 v202, 0x74480000, v199
    v_mfma_f32_16x16x32_bf16 v[176:179], v[192:195], v[128:131], v[176:179]
    v_exp_f32 v86, v86
    v_min_f32 v94, v94, v202
    v_subrev_f32 v203, 0x744c0000, v199
    v_mfma_f32_16x16x32_bf16 v[176:179], v[192:195], v[132:135], v[176:179]
    ds_read_b128 a[220:223], v200 offset:60416
    buffer_load_dwordx4 v243, s[12:15], s58 offen offset:1024 lds
    v_exp_f32 v87, v87
    v_min_f32 v95, v95, v203
    v_mfma_f32_16x16x32_bf16 v[180:183], v[192:195], v[136:139], v[180:183]
    v_exp_f32 v88, v88
    v_mfma_f32_16x16x32_bf16 v[180:183], v[192:195], v[140:143], v[180:183]
    s_waitcnt lgkmcnt(7)
    v_exp_f32 v89, v89
L_fin:
    ds_read_b128 a[224:227], v200 offset:53248
    ds_read_b128 a[228:231], v200 offset:61440
    ds_read_b128 a[232:235], v200 offset:54272
    ds_read_b128 a[236:239], v200 offset:62464
    ds_read_b128 a[240:243], v200 offset:55296
    ds_read_b128 a[244:247], v200 offset:63488
    ds_read_b128 a[248:251], v200 offset:56320
    ds_read_b128 a[252:255], v200 offset:64512
    v_exp_f32 v90, v90
    v_exp_f32 v91, v91
    v_exp_f32 v92, v92
    v_exp_f32 v93, v93
    v_exp_f32 v94, v94
    v_exp_f32 v95, v95
    v_cvt_pk_bf16_f32 v136, v80, v81
    v_cvt_pk_bf16_f32 v137, v82, v83
    v_cvt_pk_bf16_f32 v138, v84, v85
    v_cvt_pk_bf16_f32 v139, v86, v87
    v_cvt_pk_bf16_f32 v140, v88, v89
    v_cvt_pk_bf16_f32 v141, v90, v91
    v_cvt_pk_bf16_f32 v142, v92, v93
    v_cvt_pk_bf16_f32 v143, v94, v95
    v_and_b32 v206, 0x1c00, v206
    s_waitcnt vmcnt(40)
    s_waitcnt lgkmcnt(0)
    s_barrier
    s_mov_b32 s4, s42
    s_mov_b32 s5, s43
    s_mov_b32 s6, 0x200000
    s_mov_b32 s7, 0x20000
    v_mfma_f32_16x16x32_bf16 v[180:183], v[192:195], v[136:139], v[180:183]
    v_mov_b32 v177, v176
    v_accvgpr_read_b32 v0, a32
    v_mfma_f32_16x16x32_bf16 v[180:183], v[192:195], v[140:143], v[180:183]
    v_accvgpr_read_b32 v1, a33
    v_permlane32_swap_b32 v176, v177
    v_mfma_f32_16x16x32_bf16 a[96:99], a[192:195], v[136:139], a[96:99]
    v_accvgpr_read_b32 v2, a34
    v_mov_b32 v177, v176
    v_mfma_f32_16x16x32_bf16 a[96:99], a[196:199], v[140:143], a[96:99]
    v_accvgpr_read_b32 v3, a35
    v_accvgpr_read_b32 v4, a36
    v_mfma_f32_16x16x32_bf16 a[100:103], a[200:203], v[136:139], a[100:103]
    v_permlane16_swap_b32 v176, v177
    v_accvgpr_read_b32 v5, a37
    v_mfma_f32_16x16x32_bf16 a[100:103], a[204:207], v[140:143], a[100:103]
    s_add_u32 m0, s56, 16384
    s_add_u32 s58, s49, 0
    v_mfma_f32_16x16x32_bf16 a[104:107], a[208:211], v[136:139], a[104:107]
    buffer_load_dwordx4 v242, s[8:11], s58 offen lds
    v_mfma_f32_16x16x32_bf16 a[104:107], a[212:215], v[140:143], a[104:107]
    v_accvgpr_read_b32 v6, a38
    v_mfma_f32_16x16x32_bf16 a[108:111], a[216:219], v[136:139], a[108:111]
    v_rcp_f32 v202, v176
    v_mfma_f32_16x16x32_bf16 a[108:111], a[220:223], v[140:143], a[108:111]
    v_accvgpr_read_b32 v7, a39
    v_mul_f32 v0, v0, v202
    v_mfma_f32_16x16x32_bf16 a[112:115], a[224:227], v[136:139], a[112:115]
    v_mul_f32 v1, v1, v202
    v_mul_f32 v2, v2, v202
    v_mfma_f32_16x16x32_bf16 a[112:115], a[228:231], v[140:143], a[112:115]
    v_mul_f32 v3, v3, v202
    v_mul_f32 v4, v4, v202
    v_mfma_f32_16x16x32_bf16 a[116:119], a[232:235], v[136:139], a[116:119]
    v_mul_f32 v5, v5, v202
    v_mul_f32 v6, v6, v202
    v_mfma_f32_16x16x32_bf16 a[116:119], a[236:239], v[140:143], a[116:119]
    v_mul_f32 v7, v7, v202
    v_cvt_pk_bf16_f32 v64, v0, v1
    v_mfma_f32_16x16x32_bf16 a[120:123], a[240:243], v[136:139], a[120:123]
    v_cvt_pk_bf16_f32 v65, v2, v3
    v_cvt_pk_bf16_f32 v66, v4, v5
    v_mfma_f32_16x16x32_bf16 a[120:123], a[244:247], v[140:143], a[120:123]
    v_cvt_pk_bf16_f32 v67, v6, v7
    v_mfma_f32_16x16x32_bf16 a[124:127], a[248:251], v[136:139], a[124:127]
    buffer_store_dwordx4 v[64:67], v240, s[20:23], s100 offen offset:0 sc1
    v_mfma_f32_16x16x32_bf16 a[124:127], a[252:255], v[140:143], a[124:127]
    v_accvgpr_read_b32 v8, a40
    v_accvgpr_read_b32 v9, a41
    v_accvgpr_read_b32 v10, a42
    v_accvgpr_read_b32 v11, a43
    v_accvgpr_read_b32 v12, a44
    v_accvgpr_read_b32 v13, a45
    v_accvgpr_read_b32 v14, a46
    v_accvgpr_read_b32 v15, a47
    v_mul_f32 v8, v8, v202
    v_mul_f32 v9, v9, v202
    buffer_load_dwordx4 v243, s[8:11], s58 offen offset:1024 lds
    v_mul_f32 v10, v10, v202
    v_mul_f32 v11, v11, v202
    v_mul_f32 v12, v12, v202
    v_mul_f32 v13, v13, v202
    v_mul_f32 v14, v14, v202
    v_mul_f32 v15, v15, v202
    v_cvt_pk_bf16_f32 v68, v8, v9
    v_cvt_pk_bf16_f32 v69, v10, v11
    v_cvt_pk_bf16_f32 v70, v12, v13
    v_cvt_pk_bf16_f32 v71, v14, v15
    buffer_store_dwordx4 v[68:71], v240, s[20:23], s100 offen offset:1024 sc1
    v_accvgpr_read_b32 v16, a48
    v_accvgpr_read_b32 v17, a49
    v_accvgpr_read_b32 v18, a50
    v_accvgpr_read_b32 v19, a51
    v_accvgpr_read_b32 v20, a52
    v_accvgpr_read_b32 v21, a53
    v_accvgpr_read_b32 v22, a54
    v_accvgpr_read_b32 v23, a55
    v_mul_f32 v16, v16, v202
    v_mul_f32 v17, v17, v202
    s_add_u32 m0, s56, 24576
    s_add_u32 s58, s49, 32768
    buffer_load_dwordx4 v242, s[8:11], s58 offen lds
    v_mul_f32 v18, v18, v202
    v_mul_f32 v19, v19, v202
    v_mul_f32 v20, v20, v202
    v_mul_f32 v21, v21, v202
    v_mul_f32 v22, v22, v202
    v_mul_f32 v23, v23, v202
    v_cvt_pk_bf16_f32 v72, v16, v17
    v_cvt_pk_bf16_f32 v73, v18, v19
    v_cvt_pk_bf16_f32 v74, v20, v21
    v_cvt_pk_bf16_f32 v75, v22, v23
    buffer_store_dwordx4 v[72:75], v240, s[20:23], s100 offen offset:2048 sc1
    v_accvgpr_read_b32 v24, a56
    v_accvgpr_read_b32 v25, a57
    v_accvgpr_read_b32 v26, a58
    v_accvgpr_read_b32 v27, a59
    v_accvgpr_read_b32 v28, a60
    v_accvgpr_read_b32 v29, a61
    v_accvgpr_read_b32 v30, a62
    v_accvgpr_read_b32 v31, a63
    v_mul_f32 v24, v24, v202
    v_mul_f32 v25, v25, v202
    buffer_load_dwordx4 v243, s[8:11], s58 offen offset:1024 lds
    v_mul_f32 v26, v26, v202
    v_mul_f32 v27, v27, v202
    v_mul_f32 v28, v28, v202
    v_mul_f32 v29, v29, v202
    v_mul_f32 v30, v30, v202
    v_mul_f32 v31, v31, v202
    v_cvt_pk_bf16_f32 v76, v24, v25
    v_cvt_pk_bf16_f32 v77, v26, v27
    v_cvt_pk_bf16_f32 v78, v28, v29
    v_cvt_pk_bf16_f32 v79, v30, v31
    buffer_store_dwordx4 v[76:79], v240, s[20:23], s100 offen offset:3072 sc1
    v_mov_b32 v181, v180
    v_accvgpr_read_b32 v32, a96
    v_accvgpr_read_b32 v33, a97
    v_permlane32_swap_b32 v180, v181
    v_accvgpr_read_b32 v34, a98
    v_mov_b32 v181, v180
    v_accvgpr_read_b32 v35, a99
    v_accvgpr_read_b32 v36, a100
    v_permlane16_swap_b32 v180, v181
    v_accvgpr_read_b32 v37, a101
    v_accvgpr_read_b32 v38, a102
    v_rcp_f32 v203, v180
    v_accvgpr_read_b32 v39, a103
    v_mul_f32 v32, v32, v203
    v_mul_f32 v33, v33, v203
    v_mul_f32 v34, v34, v203
    v_mul_f32 v35, v35, v203
    v_mul_f32 v36, v36, v203
    v_mul_f32 v37, v37, v203
    v_mul_f32 v38, v38, v203
    v_mul_f32 v39, v39, v203
    v_cvt_pk_bf16_f32 v80, v32, v33
    v_cvt_pk_bf16_f32 v81, v34, v35
    v_cvt_pk_bf16_f32 v82, v36, v37
    v_cvt_pk_bf16_f32 v83, v38, v39
    buffer_store_dwordx4 v[80:83], v246, s[20:23], s100 offen offset:0 sc1
    v_accvgpr_read_b32 v40, a104
    v_accvgpr_read_b32 v41, a105
    v_accvgpr_read_b32 v42, a106
    v_accvgpr_read_b32 v43, a107
    v_accvgpr_read_b32 v44, a108
    v_accvgpr_read_b32 v45, a109
    v_accvgpr_read_b32 v46, a110
    v_accvgpr_read_b32 v47, a111
    v_mul_f32 v40, v40, v203
    v_mul_f32 v41, v41, v203
    v_mul_f32 v42, v42, v203
    v_mul_f32 v43, v43, v203
    v_mul_f32 v44, v44, v203
    v_mul_f32 v45, v45, v203
    v_mul_f32 v46, v46, v203
    v_mul_f32 v47, v47, v203
    v_cvt_pk_bf16_f32 v84, v40, v41
    v_cvt_pk_bf16_f32 v85, v42, v43
    v_cvt_pk_bf16_f32 v86, v44, v45
    v_cvt_pk_bf16_f32 v87, v46, v47
    buffer_store_dwordx4 v[84:87], v246, s[20:23], s100 offen offset:1024 sc1
    v_accvgpr_read_b32 v48, a112
    v_accvgpr_read_b32 v49, a113
    v_accvgpr_read_b32 v50, a114
    v_accvgpr_read_b32 v51, a115
    v_accvgpr_read_b32 v52, a116
    v_accvgpr_read_b32 v53, a117
    v_accvgpr_read_b32 v54, a118
    v_accvgpr_read_b32 v55, a119
    v_mul_f32 v48, v48, v203
    v_mul_f32 v49, v49, v203
    v_mul_f32 v50, v50, v203
    v_mul_f32 v51, v51, v203
    v_mul_f32 v52, v52, v203
    v_mul_f32 v53, v53, v203
    v_mul_f32 v54, v54, v203
    v_mul_f32 v55, v55, v203
    v_cvt_pk_bf16_f32 v88, v48, v49
    v_cvt_pk_bf16_f32 v89, v50, v51
    v_cvt_pk_bf16_f32 v90, v52, v53
    v_cvt_pk_bf16_f32 v91, v54, v55
    buffer_store_dwordx4 v[88:91], v246, s[20:23], s100 offen offset:2048 sc1
    v_accvgpr_read_b32 v56, a120
    v_accvgpr_read_b32 v57, a121
    v_accvgpr_read_b32 v58, a122
    v_accvgpr_read_b32 v59, a123
    v_accvgpr_read_b32 v60, a124
    v_accvgpr_read_b32 v61, a125
    v_accvgpr_read_b32 v62, a126
    v_accvgpr_read_b32 v63, a127
    v_mul_f32 v56, v56, v203
    v_mul_f32 v57, v57, v203
    v_mul_f32 v58, v58, v203
    v_mul_f32 v59, v59, v203
    v_mul_f32 v60, v60, v203
    v_mul_f32 v61, v61, v203
    v_mul_f32 v62, v62, v203
    v_mul_f32 v63, v63, v203
    v_cvt_pk_bf16_f32 v92, v56, v57
    v_cvt_pk_bf16_f32 v93, v58, v59
    v_cvt_pk_bf16_f32 v94, v60, v61
    v_cvt_pk_bf16_f32 v95, v62, v63
    buffer_store_dwordx4 v[92:95], v246, s[20:23], s100 offen offset:3072 sc1
    v_lshrrev_b32 v244, 2, v254
    v_and_b32 v245, 7, v244
    v_lshlrev_b32 v244, 8, v244
    v_and_b32 v241, 3, v254
    s_add_u32 s59, s64, 12288
    buffer_load_dwordx4 a[224:227], v196, s[20:23], s59 offen offset:0 sc1
    v_lshl_add_u32 v244, v241, 3, v244
    v_add_u32 v244, s32, v244
    s_sub_u32 s46, 0x20000, s32
    s_lshl_b32 s60, s35, 1
    buffer_load_dwordx4 a[228:231], v198, s[20:23], s59 offen offset:0 sc1
    s_and_b32 s60, s60, 4
    v_xor_b32 v245, s60, v245
    v_xor_b32 v241, 0, v245
    v_lshl_add_u32 v208, v241, 5, v244
    buffer_load_dwordx4 a[232:235], v196, s[20:23], s59 offen offset:1024 sc1
    v_xor_b32 v216, 0x10000, v208
    v_add_u32 v224, s46, v208
    v_xor_b32 v241, 1, v245
    v_lshl_add_u32 v209, v241, 5, v244
    buffer_load_dwordx4 a[236:239], v198, s[20:23], s59 offen offset:1024 sc1
    v_xor_b32 v217, 0x10000, v209
    v_add_u32 v225, s46, v209
    v_xor_b32 v241, 2, v245
    v_lshl_add_u32 v210, v241, 5, v244
    v_xor_b32 v218, 0x10000, v210
    v_add_u32 v226, s46, v210
    v_xor_b32 v241, 3, v245
    v_lshl_add_u32 v211, v241, 5, v244
    v_xor_b32 v219, 0x10000, v211
    v_add_u32 v227, s46, v211
    v_xor_b32 v241, 4, v245
    v_lshl_add_u32 v212, v241, 5, v244
    v_xor_b32 v220, 0x10000, v212
    v_add_u32 v228, s46, v212
    v_xor_b32 v241, 5, v245
    v_lshl_add_u32 v213, v241, 5, v244
    v_xor_b32 v221, 0x10000, v213
    v_add_u32 v229, s46, v213
    v_xor_b32 v241, 6, v245
    v_lshl_add_u32 v214, v241, 5, v244
    v_xor_b32 v222, 0x10000, v214
    v_add_u32 v230, s46, v214
    v_xor_b32 v241, 7, v245
    v_lshl_add_u32 v215, v241, 5, v244
    v_xor_b32 v223, 0x10000, v215
    v_add_u32 v231, s46, v215
    v_add_u32 v236, 0x4000, v240
    v_add_u32 v237, 0x8000, v240
    v_and_b32 v247, 3, v254
    v_lshlrev_b32 v247, 7, v247
    v_and_b32 v244, 15, v254
    v_lshlrev_b32 v244, 10, v244
    v_lshrrev_b32 v245, 4, v254
    v_lshl_add_u32 v238, v245, 3, v244
    v_add_u32 v239, 64, v238
    v_cmp_ngt_f32 vcc, s61, v176
    v_nop
    s_or_b64 s[62:63], s[62:63], vcc
    v_cmp_ngt_f32 vcc, s61, v180
    v_nop
    s_or_b64 s[62:63], s[62:63], vcc
    s_or_b32 s62, s62, s63
    v_mov_b32 v244, s62
    v_lshlrev_b32 v245, 2, v255
    s_add_u32 s46, s33, 49152
    v_add_u32 v245, s46, v245
    ds_write_b32 v245, v244
    v_mov_b32 v245, s46
    ds_read_b64_tr_b16 v[128:129], v224 offset:0
    ds_read_b64_tr_b16 v[130:131], v224 offset:4096
    ds_read_b64_tr_b16 v[132:133], v224 offset:8192
    ds_read_b64_tr_b16 v[134:135], v224 offset:12288
    ds_read_b64_tr_b16 v[136:137], v225 offset:0
    ds_read_b64_tr_b16 v[138:139], v225 offset:4096
    ds_read_b64_tr_b16 v[140:141], v225 offset:8192
    ds_read_b64_tr_b16 v[142:143], v225 offset:12288
    ds_read_b64_tr_b16 v[144:145], v226 offset:0
    ds_read_b64_tr_b16 v[146:147], v226 offset:4096
    ds_read_b64_tr_b16 v[148:149], v226 offset:8192
    ds_read_b64_tr_b16 v[150:151], v226 offset:12288
    ds_read_b64_tr_b16 v[152:153], v227 offset:0
    ds_read_b64_tr_b16 v[154:155], v227 offset:4096
    ds_read_b64_tr_b16 v[156:157], v227 offset:8192
    ds_read_b64_tr_b16 v[158:159], v227 offset:12288
    s_waitcnt vmcnt(44)
    s_waitcnt lgkmcnt(12)
    v_mfma_f32_16x16x32_bf16 v[0:3], v[128:131], a[128:131], 0
    s_add_u32 m0, s56, 32768
    ds_read_b64_tr_b16 v[160:161], v228 offset:0
    ds_read_b64_tr_b16 v[162:163], v228 offset:4096
    v_mfma_f32_16x16x32_bf16 v[0:3], v[132:135], a[136:139], v[0:3]
    s_add_u32 s58, s49, 65536
    v_mfma_f32_16x16x32_bf16 v[32:35], v[128:131], a[132:135], 0
    ds_read_b64_tr_b16 v[164:165], v228 offset:8192
    ds_read_b64_tr_b16 v[166:167], v228 offset:12288
    v_mfma_f32_16x16x32_bf16 v[32:35], v[132:135], a[140:143], v[32:35]
    s_waitcnt lgkmcnt(12)
    buffer_load_dwordx4 v242, s[8:11], s58 offen lds
    v_mfma_f32_16x16x32_bf16 v[4:7], v[136:139], a[128:131], 0
    ds_read_b64_tr_b16 v[168:169], v229 offset:0
    ds_read_b64_tr_b16 v[170:171], v229 offset:4096
    v_mfma_f32_16x16x32_bf16 v[4:7], v[140:143], a[136:139], v[4:7]
    buffer_load_dwordx4 v243, s[8:11], s58 offen offset:1024 lds
    v_mfma_f32_16x16x32_bf16 v[36:39], v[136:139], a[132:135], 0
    s_add_u32 m0, s56, 40960
    ds_read_b64_tr_b16 v[172:173], v229 offset:8192
    ds_read_b64_tr_b16 v[174:175], v229 offset:12288
    v_mfma_f32_16x16x32_bf16 v[36:39], v[140:143], a[140:143], v[36:39]
    s_waitcnt lgkmcnt(12)
    ds_read_b64_tr_b16 v[176:177], v230 offset:0
    ds_read_b64_tr_b16 v[178:179], v230 offset:4096
    v_mfma_f32_16x16x32_bf16 v[8:11], v[144:147], a[128:131], 0
    s_add_u32 s58, s49, 98304
    ds_read_b64_tr_b16 v[180:181], v230 offset:8192
    ds_read_b64_tr_b16 v[182:183], v230 offset:12288
    v_mfma_f32_16x16x32_bf16 v[8:11], v[148:151], a[136:139], v[8:11]
    ds_read_b64_tr_b16 v[184:185], v231 offset:0
    ds_read_b64_tr_b16 v[186:187], v231 offset:4096
    v_mfma_f32_16x16x32_bf16 v[40:43], v[144:147], a[132:135], 0
    ds_read_b64_tr_b16 v[188:189], v231 offset:8192
    ds_read_b64_tr_b16 v[190:191], v231 offset:12288
    v_mfma_f32_16x16x32_bf16 v[40:43], v[148:151], a[140:143], v[40:43]
    s_waitcnt lgkmcnt(15)
    buffer_load_dwordx4 v242, s[8:11], s58 offen lds
    v_mfma_f32_16x16x32_bf16 v[12:15], v[152:155], a[128:131], 0
    buffer_load_dwordx4 v243, s[8:11], s58 offen offset:1024 lds
    v_mfma_f32_16x16x32_bf16 v[12:15], v[156:159], a[136:139], v[12:15]
    v_mfma_f32_16x16x32_bf16 v[44:47], v[152:155], a[132:135], 0
    s_waitcnt lgkmcnt(0)
    v_mfma_f32_16x16x32_bf16 v[44:47], v[156:159], a[140:143], v[44:47]
    s_add_u32 m0, s50, 131072
    s_add_u32 s58, s49, 196608
    v_mfma_f32_16x16x32_bf16 v[16:19], v[160:163], a[128:131], 0
    s_waitcnt vmcnt(40)
    s_barrier
    ds_read_b64_tr_b16 v[128:129], v224 offset:16384
    ds_read_b64_tr_b16 v[130:131], v224 offset:20480
    v_mfma_f32_16x16x32_bf16 v[16:19], v[164:167], a[136:139], v[16:19]
    ds_read_b128 v[200:203], v245
    v_mfma_f32_16x16x32_bf16 v[48:51], v[160:163], a[132:135], 0
    ds_read_b64_tr_b16 v[132:133], v224 offset:24576
    ds_read_b64_tr_b16 v[134:135], v224 offset:28672
    v_mfma_f32_16x16x32_bf16 v[48:51], v[164:167], a[140:143], v[48:51]
    buffer_load_dwordx4 v242, s[8:11], s58 offen lds
    v_mfma_f32_16x16x32_bf16 v[20:23], v[168:171], a[128:131], 0
    ds_read_b64_tr_b16 v[136:137], v225 offset:16384
    ds_read_b64_tr_b16 v[138:139], v225 offset:20480
    v_mfma_f32_16x16x32_bf16 v[20:23], v[172:175], a[136:139], v[20:23]
    buffer_load_dwordx4 v243, s[8:11], s58 offen offset:1024 lds
    v_mfma_f32_16x16x32_bf16 v[52:55], v[168:171], a[132:135], 0
    s_add_u32 m0, s50, 139264
    ds_read_b64_tr_b16 v[140:141], v225 offset:24576
    ds_read_b64_tr_b16 v[142:143], v225 offset:28672
    v_mfma_f32_16x16x32_bf16 v[52:55], v[172:175], a[140:143], v[52:55]
    s_add_u32 s58, s49, 229376
    v_mfma_f32_16x16x32_bf16 v[24:27], v[176:179], a[128:131], 0
    ds_read_b64_tr_b16 v[144:145], v226 offset:16384
    ds_read_b64_tr_b16 v[146:147], v226 offset:20480
    v_mfma_f32_16x16x32_bf16 v[24:27], v[180:183], a[136:139], v[24:27]
    buffer_load_dwordx4 v242, s[8:11], s58 offen lds
    v_mfma_f32_16x16x32_bf16 v[56:59], v[176:179], a[132:135], 0
    s_waitcnt lgkmcnt(8)
    ds_read_b64_tr_b16 v[148:149], v226 offset:24576
    ds_read_b64_tr_b16 v[150:151], v226 offset:28672
    v_mfma_f32_16x16x32_bf16 v[56:59], v[180:183], a[140:143], v[56:59]
    v_or3_b32 v200, v200, v201, v202
    v_or_b32 v200, v200, v203
    v_mfma_f32_16x16x32_bf16 v[28:31], v[184:187], a[128:131], 0
    ds_read_b64_tr_b16 v[152:153], v227 offset:16384
    ds_read_b64_tr_b16 v[154:155], v227 offset:20480
    v_mfma_f32_16x16x32_bf16 v[28:31], v[188:191], a[136:139], v[28:31]
    v_cmp_ne_u32 vcc, 0, v200
    v_mfma_f32_16x16x32_bf16 v[60:63], v[184:187], a[132:135], 0
    ds_read_b64_tr_b16 v[156:157], v227 offset:24576
    ds_read_b64_tr_b16 v[158:159], v227 offset:28672
    v_mfma_f32_16x16x32_bf16 v[60:63], v[188:191], a[140:143], v[60:63]
    s_waitcnt lgkmcnt(12)
    s_cbranch_vccnz L_safe
L_safe_ret:
    v_mfma_f32_16x16x32_bf16 v[0:3], v[128:131], a[144:147], v[0:3]
    ds_read_b64_tr_b16 v[160:161], v228 offset:16384
    ds_read_b64_tr_b16 v[162:163], v228 offset:20480
    v_mfma_f32_16x16x32_bf16 v[0:3], v[132:135], a[152:155], v[0:3]
    buffer_load_dwordx4 v243, s[8:11], s58 offen offset:1024 lds
    v_mfma_f32_16x16x32_bf16 v[32:35], v[128:131], a[148:151], v[32:35]
    ds_read_b64_tr_b16 v[164:165], v228 offset:24576
    ds_read_b64_tr_b16 v[166:167], v228 offset:28672
    v_mfma_f32_16x16x32_bf16 v[32:35], v[132:135], a[156:159], v[32:35]
    s_waitcnt lgkmcnt(12)
    v_mfma_f32_16x16x32_bf16 v[4:7], v[136:139], a[144:147], v[4:7]
    ds_read_b64_tr_b16 v[168:169], v229 offset:16384
    ds_read_b64_tr_b16 v[170:171], v229 offset:20480
    v_mfma_f32_16x16x32_bf16 v[4:7], v[140:143], a[152:155], v[4:7]
    v_mfma_f32_16x16x32_bf16 v[36:39], v[136:139], a[148:151], v[36:39]
    ds_read_b64_tr_b16 v[172:173], v229 offset:24576
    ds_read_b64_tr_b16 v[174:175], v229 offset:28672
    v_mfma_f32_16x16x32_bf16 v[36:39], v[140:143], a[156:159], v[36:39]
    s_waitcnt lgkmcnt(12)
    v_mfma_f32_16x16x32_bf16 v[8:11], v[144:147], a[144:147], v[8:11]
    ds_read_b64_tr_b16 v[176:177], v230 offset:16384
    ds_read_b64_tr_b16 v[178:179], v230 offset:20480
    v_mfma_f32_16x16x32_bf16 v[8:11], v[148:151], a[152:155], v[8:11]
    buffer_load_dwordx2 v[192:193], v238, s[24:27], s57 offen offset:0
    v_mfma_f32_16x16x32_bf16 v[40:43], v[144:147], a[148:151], v[40:43]
    ds_read_b64_tr_b16 v[180:181], v230 offset:24576
    ds_read_b64_tr_b16 v[182:183], v230 offset:28672
    v_mfma_f32_16x16x32_bf16 v[40:43], v[148:151], a[156:159], v[40:43]
    s_waitcnt lgkmcnt(12)
    v_mfma_f32_16x16x32_bf16 v[12:15], v[152:155], a[144:147], v[12:15]
    ds_read_b64_tr_b16 v[184:185], v231 offset:16384
    ds_read_b64_tr_b16 v[186:187], v231 offset:20480
    v_mfma_f32_16x16x32_bf16 v[12:15], v[156:159], a[152:155], v[12:15]
    v_mfma_f32_16x16x32_bf16 v[44:47], v[152:155], a[148:151], v[44:47]
    ds_read_b64_tr_b16 v[188:189], v231 offset:24576
    ds_read_b64_tr_b16 v[190:191], v231 offset:28672
    v_mfma_f32_16x16x32_bf16 v[44:47], v[156:159], a[156:159], v[44:47]
    s_waitcnt lgkmcnt(12)
    v_mfma_f32_16x16x32_bf16 v[16:19], v[160:163], a[144:147], v[16:19]
    ds_read_b64_tr_b16 v[128:129], v208 offset:0
    ds_read_b64_tr_b16 v[130:131], v208 offset:4096
    v_mfma_f32_16x16x32_bf16 v[16:19], v[164:167], a[152:155], v[16:19]
    buffer_load_dwordx2 v[194:195], v238, s[24:27], s57 offen offset:32
    v_mfma_f32_16x16x32_bf16 v[48:51], v[160:163], a[148:151], v[48:51]
    ds_read_b64_tr_b16 v[132:133], v208 offset:8192
    ds_read_b64_tr_b16 v[134:135], v208 offset:12288
    v_mfma_f32_16x16x32_bf16 v[48:51], v[164:167], a[156:159], v[48:51]
    s_waitcnt lgkmcnt(12)
    v_mfma_f32_16x16x32_bf16 v[20:23], v[168:171], a[144:147], v[20:23]
    ds_read_b64_tr_b16 v[136:137], v209 offset:0
    ds_read_b64_tr_b16 v[138:139], v209 offset:4096
    v_mfma_f32_16x16x32_bf16 v[20:23], v[172:175], a[152:155], v[20:23]
    v_mfma_f32_16x16x32_bf16 v[52:55], v[168:171], a[148:151], v[52:55]
    ds_read_b64_tr_b16 v[140:141], v209 offset:8192
    ds_read_b64_tr_b16 v[142:143], v209 offset:12288
    v_mfma_f32_16x16x32_bf16 v[52:55], v[172:175], a[156:159], v[52:55]
    s_waitcnt lgkmcnt(12)
    v_mfma_f32_16x16x32_bf16 v[24:27], v[176:179], a[144:147], v[24:27]
    ds_read_b64_tr_b16 v[144:145], v210 offset:0
    ds_read_b64_tr_b16 v[146:147], v210 offset:4096
    v_mfma_f32_16x16x32_bf16 v[24:27], v[180:183], a[152:155], v[24:27]
    buffer_load_dwordx2 v[200:201], v239, s[24:27], s57 offen offset:0
    v_mfma_f32_16x16x32_bf16 v[56:59], v[176:179], a[148:151], v[56:59]
    ds_read_b64_tr_b16 v[148:149], v210 offset:8192
    ds_read_b64_tr_b16 v[150:151], v210 offset:12288
    v_mfma_f32_16x16x32_bf16 v[56:59], v[180:183], a[156:159], v[56:59]
    s_waitcnt lgkmcnt(12)
    v_mfma_f32_16x16x32_bf16 v[28:31], v[184:187], a[144:147], v[28:31]
    ds_read_b64_tr_b16 v[152:153], v211 offset:0
    ds_read_b64_tr_b16 v[154:155], v211 offset:4096
    v_mfma_f32_16x16x32_bf16 v[28:31], v[188:191], a[152:155], v[28:31]
    v_mfma_f32_16x16x32_bf16 v[60:63], v[184:187], a[148:151], v[60:63]
    s_waitcnt vmcnt(31)
    ds_read_b64_tr_b16 v[156:157], v211 offset:8192
    ds_read_b64_tr_b16 v[158:159], v211 offset:12288
    v_mfma_f32_16x16x32_bf16 v[60:63], v[188:191], a[156:159], v[60:63]
    s_waitcnt lgkmcnt(12)
    v_mfma_f32_16x16x32_bf16 v[0:3], v[128:131], a[160:163], v[0:3]
    ds_read_b64_tr_b16 v[160:161], v212 offset:0
    ds_read_b64_tr_b16 v[162:163], v212 offset:4096
    v_mfma_f32_16x16x32_bf16 v[0:3], v[132:135], a[168:171], v[0:3]
    buffer_load_dwordx2 v[202:203], v239, s[24:27], s57 offen offset:32
    v_mfma_f32_16x16x32_bf16 v[32:35], v[128:131], a[164:167], v[32:35]
    ds_read_b64_tr_b16 v[164:165], v212 offset:8192
    ds_read_b64_tr_b16 v[166:167], v212 offset:12288
    v_mfma_f32_16x16x32_bf16 v[32:35], v[132:135], a[172:175], v[32:35]
    s_waitcnt lgkmcnt(12)
    v_mfma_f32_16x16x32_bf16 v[4:7], v[136:139], a[160:163], v[4:7]
    ds_read_b64_tr_b16 v[168:169], v213 offset:0
    ds_read_b64_tr_b16 v[170:171], v213 offset:4096
    v_mfma_f32_16x16x32_bf16 v[4:7], v[140:143], a[168:171], v[4:7]
    v_mfma_f32_16x16x32_bf16 v[36:39], v[136:139], a[164:167], v[36:39]
    ds_read_b64_tr_b16 v[172:173], v213 offset:8192
    ds_read_b64_tr_b16 v[174:175], v213 offset:12288
    v_mfma_f32_16x16x32_bf16 v[36:39], v[140:143], a[172:175], v[36:39]
    s_waitcnt lgkmcnt(12)
    ds_read_b64_tr_b16 v[176:177], v214 offset:0
    ds_read_b64_tr_b16 v[178:179], v214 offset:4096
    v_mfma_f32_16x16x32_bf16 v[8:11], v[144:147], a[160:163], v[8:11]
    ds_read_b64_tr_b16 v[180:181], v214 offset:8192
    ds_read_b64_tr_b16 v[182:183], v214 offset:12288
    v_mfma_f32_16x16x32_bf16 v[8:11], v[148:151], a[168:171], v[8:11]
    ds_read_b64_tr_b16 v[184:185], v215 offset:0
    ds_read_b64_tr_b16 v[186:187], v215 offset:4096
    v_mfma_f32_16x16x32_bf16 v[40:43], v[144:147], a[164:167], v[40:43]
    ds_read_b64_tr_b16 v[188:189], v215 offset:8192
    ds_read_b64_tr_b16 v[190:191], v215 offset:12288
    v_mfma_f32_16x16x32_bf16 v[40:43], v[148:151], a[172:175], v[40:43]
    s_waitcnt lgkmcnt(15)
    v_mfma_f32_16x16x32_bf16 v[12:15], v[152:155], a[160:163], v[12:15]
    v_mfma_f32_16x16x32_bf16 v[12:15], v[156:159], a[168:171], v[12:15]
    v_mfma_f32_16x16x32_bf16 v[44:47], v[152:155], a[164:167], v[44:47]
    s_waitcnt lgkmcnt(0)
    v_mfma_f32_16x16x32_bf16 v[44:47], v[156:159], a[172:175], v[44:47]
    s_add_u32 m0, s56, 49152
    s_add_u32 s58, s49, 131072
    v_mfma_f32_16x16x32_bf16 v[16:19], v[160:163], a[160:163], v[16:19]
    s_waitcnt vmcnt(16)
    s_barrier
    ds_read_b64_tr_b16 v[128:129], v208 offset:16384
    ds_read_b64_tr_b16 v[130:131], v208 offset:20480
    v_mfma_f32_16x16x32_bf16 v[16:19], v[164:167], a[168:171], v[16:19]
    buffer_store_dword v249, v248, s[20:23], s98 offen offset:8 sc1
    v_mfma_f32_16x16x32_bf16 v[48:51], v[160:163], a[164:167], v[48:51]
    ds_read_b64_tr_b16 v[132:133], v208 offset:24576
    ds_read_b64_tr_b16 v[134:135], v208 offset:28672
    v_mfma_f32_16x16x32_bf16 v[48:51], v[164:167], a[172:175], v[48:51]
    buffer_store_dword v249, v248, s[20:23], s98 offen offset:4 sc1
    v_mfma_f32_16x16x32_bf16 v[20:23], v[168:171], a[160:163], v[20:23]
    ds_read_b64_tr_b16 v[136:137], v209 offset:16384
    ds_read_b64_tr_b16 v[138:139], v209 offset:20480
    v_mfma_f32_16x16x32_bf16 v[20:23], v[172:175], a[168:171], v[20:23]
    buffer_load_dwordx4 v242, s[8:11], s58 offen lds
    v_mfma_f32_16x16x32_bf16 v[52:55], v[168:171], a[164:167], v[52:55]
    ds_read_b64_tr_b16 v[140:141], v209 offset:24576
    ds_read_b64_tr_b16 v[142:143], v209 offset:28672
    v_mfma_f32_16x16x32_bf16 v[52:55], v[172:175], a[172:175], v[52:55]
    buffer_load_dwordx4 v243, s[8:11], s58 offen offset:1024 lds
    v_mfma_f32_16x16x32_bf16 v[24:27], v[176:179], a[160:163], v[24:27]
    s_add_u32 m0, s56, 57344
    ds_read_b64_tr_b16 v[144:145], v210 offset:16384
    ds_read_b64_tr_b16 v[146:147], v210 offset:20480
    v_mfma_f32_16x16x32_bf16 v[24:27], v[180:183], a[168:171], v[24:27]
    s_add_u32 s58, s49, 163840
    v_mfma_f32_16x16x32_bf16 v[56:59], v[176:179], a[164:167], v[56:59]
    ds_read_b64_tr_b16 v[148:149], v210 offset:24576
    ds_read_b64_tr_b16 v[150:151], v210 offset:28672
    v_mfma_f32_16x16x32_bf16 v[56:59], v[180:183], a[172:175], v[56:59]
    buffer_load_dwordx4 v242, s[8:11], s58 offen lds
    v_mfma_f32_16x16x32_bf16 v[28:31], v[184:187], a[160:163], v[28:31]
    ds_read_b64_tr_b16 v[152:153], v211 offset:16384
    ds_read_b64_tr_b16 v[154:155], v211 offset:20480
    v_mfma_f32_16x16x32_bf16 v[28:31], v[188:191], a[168:171], v[28:31]
    buffer_load_dwordx4 v243, s[8:11], s58 offen offset:1024 lds
    v_mfma_f32_16x16x32_bf16 v[60:63], v[184:187], a[164:167], v[60:63]
    ds_read_b64_tr_b16 v[156:157], v211 offset:24576
    ds_read_b64_tr_b16 v[158:159], v211 offset:28672
    v_mfma_f32_16x16x32_bf16 v[60:63], v[188:191], a[172:175], v[60:63]
    s_waitcnt lgkmcnt(12)
    s_add_u32 m0, s50, 147456
    s_add_u32 s58, s49, 262144
    v_mfma_f32_16x16x32_bf16 v[0:3], v[128:131], a[176:179], v[0:3]
    ds_read_b64_tr_b16 v[160:161], v212 offset:16384
    ds_read_b64_tr_b16 v[162:163], v212 offset:20480
    v_mfma_f32_16x16x32_bf16 v[0:3], v[132:135], a[184:187], v[0:3]
    buffer_load_dwordx4 v242, s[8:11], s58 offen lds
    v_mfma_f32_16x16x32_bf16 v[32:35], v[128:131], a[180:183], v[32:35]
    ds_read_b64_tr_b16 v[164:165], v212 offset:24576
    ds_read_b64_tr_b16 v[166:167], v212 offset:28672
    v_mfma_f32_16x16x32_bf16 v[32:35], v[132:135], a[188:191], v[32:35]
    s_waitcnt lgkmcnt(12)
    buffer_load_dwordx4 v243, s[8:11], s58 offen offset:1024 lds
    v_mfma_f32_16x16x32_bf16 v[4:7], v[136:139], a[176:179], v[4:7]
    ds_read_b64_tr_b16 v[168:169], v213 offset:16384
    ds_read_b64_tr_b16 v[170:171], v213 offset:20480
    buffer_load_dword v207, v206, s[20:23], s3 offen offset:4 sc1
    v_mfma_f32_16x16x32_bf16 v[4:7], v[140:143], a[184:187], v[4:7]
    s_add_u32 m0, s50, 155648
    s_add_u32 s58, s49, 294912
    v_mfma_f32_16x16x32_bf16 v[36:39], v[136:139], a[180:183], v[36:39]
    ds_read_b64_tr_b16 v[172:173], v213 offset:24576
    ds_read_b64_tr_b16 v[174:175], v213 offset:28672
    v_mfma_f32_16x16x32_bf16 v[36:39], v[140:143], a[188:191], v[36:39]
    s_waitcnt lgkmcnt(12)
    buffer_load_dwordx4 v242, s[8:11], s58 offen lds
    v_mfma_f32_16x16x32_bf16 v[8:11], v[144:147], a[176:179], v[8:11]
    ds_read_b64_tr_b16 v[176:177], v214 offset:16384
    ds_read_b64_tr_b16 v[178:179], v214 offset:20480
    v_mfma_f32_16x16x32_bf16 v[8:11], v[148:151], a[184:187], v[8:11]
    buffer_load_dwordx4 v243, s[8:11], s58 offen offset:1024 lds
    v_mfma_f32_16x16x32_bf16 v[40:43], v[144:147], a[180:183], v[40:43]
    s_add_u32 m0, s51, 0
    ds_read_b64_tr_b16 v[180:181], v214 offset:24576
    ds_read_b64_tr_b16 v[182:183], v214 offset:28672
    v_mfma_f32_16x16x32_bf16 v[40:43], v[148:151], a[188:191], v[40:43]
    s_waitcnt lgkmcnt(12)
    s_add_u32 s58, s49, 327680
    v_mfma_f32_16x16x32_bf16 v[12:15], v[152:155], a[176:179], v[12:15]
    ds_read_b64_tr_b16 v[184:185], v215 offset:16384
    ds_read_b64_tr_b16 v[186:187], v215 offset:20480
    v_mfma_f32_16x16x32_bf16 v[12:15], v[156:159], a[184:187], v[12:15]
    buffer_load_dwordx4 v242, s[8:11], s58 offen lds
    v_mfma_f32_16x16x32_bf16 v[44:47], v[152:155], a[180:183], v[44:47]
    ds_read_b64_tr_b16 v[188:189], v215 offset:24576
    ds_read_b64_tr_b16 v[190:191], v215 offset:28672
    v_mfma_f32_16x16x32_bf16 v[44:47], v[156:159], a[188:191], v[44:47]
    s_waitcnt lgkmcnt(12)
    buffer_load_dwordx4 v243, s[8:11], s58 offen offset:1024 lds
    v_mfma_f32_16x16x32_bf16 v[16:19], v[160:163], a[176:179], v[16:19]
    s_add_u32 m0, s51, 8192
    ds_read_b64_tr_b16 v[128:129], v208 offset:32768
    ds_read_b64_tr_b16 v[130:131], v208 offset:36864
    v_mfma_f32_16x16x32_bf16 v[16:19], v[164:167], a[184:187], v[16:19]
    s_add_u32 s58, s49, 360448
    v_mfma_f32_16x16x32_bf16 v[48:51], v[160:163], a[180:183], v[48:51]
    ds_read_b64_tr_b16 v[132:133], v208 offset:40960
    ds_read_b64_tr_b16 v[134:135], v208 offset:45056
    v_mfma_f32_16x16x32_bf16 v[48:51], v[164:167], a[188:191], v[48:51]
    s_waitcnt lgkmcnt(12)
    buffer_load_dwordx4 v242, s[8:11], s58 offen lds
    v_mfma_f32_16x16x32_bf16 v[20:23], v[168:171], a[176:179], v[20:23]
    ds_read_b64_tr_b16 v[136:137], v209 offset:32768
    ds_read_b64_tr_b16 v[138:139], v209 offset:36864
    v_mfma_f32_16x16x32_bf16 v[20:23], v[172:175], a[184:187], v[20:23]
    buffer_load_dwordx4 v243, s[8:11], s58 offen offset:1024 lds
    v_mfma_f32_16x16x32_bf16 v[52:55], v[168:171], a[180:183], v[52:55]
    ds_read_b64_tr_b16 v[140:141], v209 offset:40960
    ds_read_b64_tr_b16 v[142:143], v209 offset:45056
    v_mfma_f32_16x16x32_bf16 v[52:55], v[172:175], a[188:191], v[52:55]
    s_waitcnt lgkmcnt(12)
    v_mfma_f32_16x16x32_bf16 v[24:27], v[176:179], a[176:179], v[24:27]
    ds_read_b64_tr_b16 v[144:145], v210 offset:32768
    ds_read_b64_tr_b16 v[146:147], v210 offset:36864
    v_mfma_f32_16x16x32_bf16 v[24:27], v[180:183], a[184:187], v[24:27]
    v_mfma_f32_16x16x32_bf16 v[56:59], v[176:179], a[180:183], v[56:59]
    ds_read_b64_tr_b16 v[148:149], v210 offset:40960
    ds_read_b64_tr_b16 v[150:151], v210 offset:45056
    v_mfma_f32_16x16x32_bf16 v[56:59], v[180:183], a[188:191], v[56:59]
    s_waitcnt lgkmcnt(12)
    v_mfma_f32_16x16x32_bf16 v[28:31], v[184:187], a[176:179], v[28:31]
    ds_read_b64_tr_b16 v[152:153], v211 offset:32768
    ds_read_b64_tr_b16 v[154:155], v211 offset:36864
    v_mfma_f32_16x16x32_bf16 v[28:31], v[188:191], a[184:187], v[28:31]
    v_mfma_f32_16x16x32_bf16 v[60:63], v[184:187], a[180:183], v[60:63]
    ds_read_b64_tr_b16 v[156:157], v211 offset:40960
    ds_read_b64_tr_b16 v[158:159], v211 offset:45056
    v_mfma_f32_16x16x32_bf16 v[60:63], v[188:191], a[188:191], v[60:63]
    s_waitcnt lgkmcnt(12)
    v_mfma_f32_16x16x32_bf16 v[0:3], v[128:131], v[96:99], v[0:3]
    ds_read_b64_tr_b16 v[160:161], v212 offset:32768
    ds_read_b64_tr_b16 v[162:163], v212 offset:36864
    v_mfma_f32_16x16x32_bf16 v[0:3], v[132:135], v[104:107], v[0:3]
    v_mfma_f32_16x16x32_bf16 v[32:35], v[128:131], v[100:103], v[32:35]
    ds_read_b64_tr_b16 v[164:165], v212 offset:40960
    ds_read_b64_tr_b16 v[166:167], v212 offset:45056
    v_mfma_f32_16x16x32_bf16 v[32:35], v[132:135], v[108:111], v[32:35]
    s_waitcnt lgkmcnt(12)
    v_mfma_f32_16x16x32_bf16 v[4:7], v[136:139], v[96:99], v[4:7]
    ds_read_b64_tr_b16 v[168:169], v213 offset:32768
    ds_read_b64_tr_b16 v[170:171], v213 offset:36864
    v_mfma_f32_16x16x32_bf16 v[4:7], v[140:143], v[104:107], v[4:7]
    v_mfma_f32_16x16x32_bf16 v[36:39], v[136:139], v[100:103], v[36:39]
    ds_read_b64_tr_b16 v[172:173], v213 offset:40960
    ds_read_b64_tr_b16 v[174:175], v213 offset:45056
    v_mfma_f32_16x16x32_bf16 v[36:39], v[140:143], v[108:111], v[36:39]
    s_waitcnt lgkmcnt(12)
    ds_read_b64_tr_b16 v[176:177], v214 offset:32768
    ds_read_b64_tr_b16 v[178:179], v214 offset:36864
    v_mfma_f32_16x16x32_bf16 v[8:11], v[144:147], v[96:99], v[8:11]
    s_waitcnt vmcnt(6)
    ds_read_b64_tr_b16 v[180:181], v214 offset:40960
    ds_read_b64_tr_b16 v[182:183], v214 offset:45056
    v_cmp_ne_u32 vcc, 1, v207
    v_mfma_f32_16x16x32_bf16 v[8:11], v[148:151], v[104:107], v[8:11]
    ds_read_b64_tr_b16 v[184:185], v215 offset:32768
    ds_read_b64_tr_b16 v[186:187], v215 offset:36864
    s_cbranch_vccnz L_cwait
L_cok:
    v_mfma_f32_16x16x32_bf16 v[40:43], v[144:147], v[100:103], v[40:43]
    s_add_u32 s59, s65, 0
    ds_read_b64_tr_b16 v[188:189], v215 offset:40960
    ds_read_b64_tr_b16 v[190:191], v215 offset:45056
    v_mfma_f32_16x16x32_bf16 v[40:43], v[148:151], v[108:111], v[40:43]
    s_waitcnt lgkmcnt(15)
    buffer_load_dwordx4 a[240:243], v196, s[20:23], s59 offen offset:0 sc1
    v_mfma_f32_16x16x32_bf16 v[12:15], v[152:155], v[96:99], v[12:15]
    v_mfma_f32_16x16x32_bf16 v[12:15], v[156:159], v[104:107], v[12:15]
    v_mfma_f32_16x16x32_bf16 v[44:47], v[152:155], v[100:103], v[44:47]
    s_waitcnt lgkmcnt(0)
    buffer_load_dwordx4 a[244:247], v198, s[20:23], s59 offen offset:0 sc1
    v_mfma_f32_16x16x32_bf16 v[44:47], v[156:159], v[108:111], v[44:47]
    v_mfma_f32_16x16x32_bf16 v[16:19], v[160:163], v[96:99], v[16:19]
    s_barrier
    ds_read_b64_tr_b16 v[128:129], v208 offset:49152
    ds_read_b64_tr_b16 v[130:131], v208 offset:53248
    v_mfma_f32_16x16x32_bf16 v[16:19], v[164:167], v[104:107], v[16:19]
    v_mfma_f32_16x16x32_bf16 v[48:51], v[160:163], v[100:103], v[48:51]
    ds_read_b64_tr_b16 v[132:133], v208 offset:57344
    ds_read_b64_tr_b16 v[134:135], v208 offset:61440
    v_mfma_f32_16x16x32_bf16 v[48:51], v[164:167], v[108:111], v[48:51]
    buffer_load_dwordx4 a[248:251], v196, s[20:23], s59 offen offset:1024 sc1
    v_mfma_f32_16x16x32_bf16 v[20:23], v[168:171], v[96:99], v[20:23]
    ds_read_b64_tr_b16 v[136:137], v209 offset:49152
    ds_read_b64_tr_b16 v[138:139], v209 offset:53248
    v_mfma_f32_16x16x32_bf16 v[20:23], v[172:175], v[104:107], v[20:23]
    v_mfma_f32_16x16x32_bf16 v[52:55], v[168:171], v[100:103], v[52:55]
    ds_read_b64_tr_b16 v[140:141], v209 offset:57344
    ds_read_b64_tr_b16 v[142:143], v209 offset:61440
    v_mfma_f32_16x16x32_bf16 v[52:55], v[172:175], v[108:111], v[52:55]
    buffer_load_dwordx4 a[252:255], v198, s[20:23], s59 offen offset:1024 sc1
    v_mfma_f32_16x16x32_bf16 v[24:27], v[176:179], v[96:99], v[24:27]
    s_add_u32 s59, s65, 2048
    ds_read_b64_tr_b16 v[144:145], v210 offset:49152
    ds_read_b64_tr_b16 v[146:147], v210 offset:53248
    v_mfma_f32_16x16x32_bf16 v[24:27], v[180:183], v[104:107], v[24:27]
    v_mfma_f32_16x16x32_bf16 v[56:59], v[176:179], v[100:103], v[56:59]
    ds_read_b64_tr_b16 v[148:149], v210 offset:57344
    ds_read_b64_tr_b16 v[150:151], v210 offset:61440
    v_mfma_f32_16x16x32_bf16 v[56:59], v[180:183], v[108:111], v[56:59]
    buffer_load_dwordx4 a[128:131], v196, s[20:23], s59 offen offset:0 sc1
    v_mfma_f32_16x16x32_bf16 v[28:31], v[184:187], v[96:99], v[28:31]
    ds_read_b64_tr_b16 v[152:153], v211 offset:49152
    ds_read_b64_tr_b16 v[154:155], v211 offset:53248
    v_mfma_f32_16x16x32_bf16 v[28:31], v[188:191], v[104:107], v[28:31]
    v_mfma_f32_16x16x32_bf16 v[60:63], v[184:187], v[100:103], v[60:63]
    ds_read_b64_tr_b16 v[156:157], v211 offset:57344
    ds_read_b64_tr_b16 v[158:159], v211 offset:61440
    v_mfma_f32_16x16x32_bf16 v[60:63], v[188:191], v[108:111], v[60:63]
    s_waitcnt lgkmcnt(12)
    buffer_load_dwordx4 a[132:135], v198, s[20:23], s59 offen offset:0 sc1
    v_mfma_f32_16x16x32_bf16 v[0:3], v[128:131], v[112:115], v[0:3]
    ds_read_b64_tr_b16 v[160:161], v212 offset:49152
    ds_read_b64_tr_b16 v[162:163], v212 offset:53248
    v_mfma_f32_16x16x32_bf16 v[0:3], v[132:135], v[120:123], v[0:3]
    v_mfma_f32_16x16x32_bf16 v[32:35], v[128:131], v[116:119], v[32:35]
    ds_read_b64_tr_b16 v[164:165], v212 offset:57344
    ds_read_b64_tr_b16 v[166:167], v212 offset:61440
    v_mfma_f32_16x16x32_bf16 v[32:35], v[132:135], v[124:127], v[32:35]
    s_waitcnt lgkmcnt(12)
    buffer_load_dwordx4 a[136:139], v196, s[20:23], s59 offen offset:1024 sc1
    v_mfma_f32_16x16x32_bf16 v[4:7], v[136:139], v[112:115], v[4:7]
    ds_read_b64_tr_b16 v[168:169], v213 offset:49152
    ds_read_b64_tr_b16 v[170:171], v213 offset:53248
    v_mfma_f32_16x16x32_bf16 v[4:7], v[140:143], v[120:123], v[4:7]
    v_mfma_f32_16x16x32_bf16 v[36:39], v[136:139], v[116:119], v[36:39]
    ds_read_b64_tr_b16 v[172:173], v213 offset:57344
    ds_read_b64_tr_b16 v[174:175], v213 offset:61440
    v_mfma_f32_16x16x32_bf16 v[36:39], v[140:143], v[124:127], v[36:39]
    s_waitcnt lgkmcnt(12)
    buffer_load_dwordx4 a[140:143], v198, s[20:23], s59 offen offset:1024 sc1
    v_mfma_f32_16x16x32_bf16 v[8:11], v[144:147], v[112:115], v[8:11]
    s_add_u32 s59, s65, 4096
    ds_read_b64_tr_b16 v[176:177], v214 offset:49152
    ds_read_b64_tr_b16 v[178:179], v214 offset:53248
    v_mfma_f32_16x16x32_bf16 v[8:11], v[148:151], v[120:123], v[8:11]
    v_mfma_f32_16x16x32_bf16 v[40:43], v[144:147], v[116:119], v[40:43]
    ds_read_b64_tr_b16 v[180:181], v214 offset:57344
    ds_read_b64_tr_b16 v[182:183], v214 offset:61440
    v_mfma_f32_16x16x32_bf16 v[40:43], v[148:151], v[124:127], v[40:43]
    s_waitcnt lgkmcnt(12)
    buffer_load_dwordx4 a[144:147], v196, s[20:23], s59 offen offset:0 sc1
    v_mfma_f32_16x16x32_bf16 v[12:15], v[152:155], v[112:115], v[12:15]
    ds_read_b64_tr_b16 v[184:185], v215 offset:49152
    ds_read_b64_tr_b16 v[186:187], v215 offset:53248
    v_mfma_f32_16x16x32_bf16 v[12:15], v[156:159], v[120:123], v[12:15]
    v_mfma_f32_16x16x32_bf16 v[44:47], v[152:155], v[116:119], v[44:47]
    ds_read_b64_tr_b16 v[188:189], v215 offset:57344
    ds_read_b64_tr_b16 v[190:191], v215 offset:61440
    v_mfma_f32_16x16x32_bf16 v[44:47], v[156:159], v[124:127], v[44:47]
    s_waitcnt lgkmcnt(12)
    buffer_load_dwordx4 a[148:151], v198, s[20:23], s59 offen offset:0 sc1
    v_mfma_f32_16x16x32_bf16 v[16:19], v[160:163], v[112:115], v[16:19]
    ds_read_b64_tr_b16 v[128:129], v216 offset:0
    ds_read_b64_tr_b16 v[130:131], v216 offset:4096
    v_mfma_f32_16x16x32_bf16 v[16:19], v[164:167], v[120:123], v[16:19]
    v_mfma_f32_16x16x32_bf16 v[48:51], v[160:163], v[116:119], v[48:51]
    ds_read_b64_tr_b16 v[132:133], v216 offset:8192
    ds_read_b64_tr_b16 v[134:135], v216 offset:12288
    v_mfma_f32_16x16x32_bf16 v[48:51], v[164:167], v[124:127], v[48:51]
    s_waitcnt lgkmcnt(12)
    buffer_load_dwordx4 a[152:155], v196, s[20:23], s59 offen offset:1024 sc1
    v_mfma_f32_16x16x32_bf16 v[20:23], v[168:171], v[112:115], v[20:23]
    ds_read_b64_tr_b16 v[136:137], v217 offset:0
    ds_read_b64_tr_b16 v[138:139], v217 offset:4096
    v_mfma_f32_16x16x32_bf16 v[20:23], v[172:175], v[120:123], v[20:23]
    v_mfma_f32_16x16x32_bf16 v[52:55], v[168:171], v[116:119], v[52:55]
    ds_read_b64_tr_b16 v[140:141], v217 offset:8192
    ds_read_b64_tr_b16 v[142:143], v217 offset:12288
    v_mfma_f32_16x16x32_bf16 v[52:55], v[172:175], v[124:127], v[52:55]
    s_waitcnt lgkmcnt(12)
    buffer_load_dwordx4 a[156:159], v198, s[20:23], s59 offen offset:1024 sc1
    v_mfma_f32_16x16x32_bf16 v[24:27], v[176:179], v[112:115], v[24:27]
    s_add_u32 s59, s65, 6144
    ds_read_b64_tr_b16 v[144:145], v218 offset:0
    ds_read_b64_tr_b16 v[146:147], v218 offset:4096
    v_mfma_f32_16x16x32_bf16 v[24:27], v[180:183], v[120:123], v[24:27]
    v_mfma_f32_16x16x32_bf16 v[56:59], v[176:179], v[116:119], v[56:59]
    ds_read_b64_tr_b16 v[148:149], v218 offset:8192
    ds_read_b64_tr_b16 v[150:151], v218 offset:12288
    v_mfma_f32_16x16x32_bf16 v[56:59], v[180:183], v[124:127], v[56:59]
    s_waitcnt lgkmcnt(12)
    buffer_load_dwordx4 a[160:163], v196, s[20:23], s59 offen offset:0 sc1
    v_mfma_f32_16x16x32_bf16 v[28:31], v[184:187], v[112:115], v[28:31]
    ds_read_b64_tr_b16 v[152:153], v219 offset:0
    ds_read_b64_tr_b16 v[154:155], v219 offset:4096
    v_mfma_f32_16x16x32_bf16 v[28:31], v[188:191], v[120:123], v[28:31]
    v_mfma_f32_16x16x32_bf16 v[60:63], v[184:187], v[116:119], v[60:63]
    ds_read_b64_tr_b16 v[156:157], v219 offset:8192
    ds_read_b64_tr_b16 v[158:159], v219 offset:12288
    v_mfma_f32_16x16x32_bf16 v[60:63], v[188:191], v[124:127], v[60:63]
    s_waitcnt lgkmcnt(12)
    buffer_load_dwordx4 a[164:167], v198, s[20:23], s59 offen offset:0 sc1
    v_mfma_f32_16x16x32_bf16 v[0:3], v[128:131], a[224:227], v[0:3]
    ds_read_b64_tr_b16 v[160:161], v220 offset:0
    ds_read_b64_tr_b16 v[162:163], v220 offset:4096
    v_mfma_f32_16x16x32_bf16 v[0:3], v[132:135], a[232:235], v[0:3]
    v_mfma_f32_16x16x32_bf16 v[32:35], v[128:131], a[228:231], v[32:35]
    ds_read_b64_tr_b16 v[164:165], v220 offset:8192
    ds_read_b64_tr_b16 v[166:167], v220 offset:12288
    v_mfma_f32_16x16x32_bf16 v[32:35], v[132:135], a[236:239], v[32:35]
    s_waitcnt lgkmcnt(12)
    buffer_load_dwordx4 a[168:171], v196, s[20:23], s59 offen offset:1024 sc1
    v_mfma_f32_16x16x32_bf16 v[4:7], v[136:139], a[224:227], v[4:7]
    ds_read_b64_tr_b16 v[168:169], v221 offset:0
    ds_read_b64_tr_b16 v[170:171], v221 offset:4096
    v_mfma_f32_16x16x32_bf16 v[4:7], v[140:143], a[232:235], v[4:7]
    v_mfma_f32_16x16x32_bf16 v[36:39], v[136:139], a[228:231], v[36:39]
    ds_read_b64_tr_b16 v[172:173], v221 offset:8192
    ds_read_b64_tr_b16 v[174:175], v221 offset:12288
    v_mfma_f32_16x16x32_bf16 v[36:39], v[140:143], a[236:239], v[36:39]
    s_waitcnt lgkmcnt(12)
    ds_read_b64_tr_b16 v[176:177], v222 offset:0
    ds_read_b64_tr_b16 v[178:179], v222 offset:4096
    v_mfma_f32_16x16x32_bf16 v[8:11], v[144:147], a[224:227], v[8:11]
    ds_read_b64_tr_b16 v[180:181], v222 offset:8192
    ds_read_b64_tr_b16 v[182:183], v222 offset:12288
    v_mfma_f32_16x16x32_bf16 v[8:11], v[148:151], a[232:235], v[8:11]
    ds_read_b64_tr_b16 v[184:185], v223 offset:0
    ds_read_b64_tr_b16 v[186:187], v223 offset:4096
    v_mfma_f32_16x16x32_bf16 v[40:43], v[144:147], a[228:231], v[40:43]
    ds_read_b64_tr_b16 v[188:189], v223 offset:8192
    ds_read_b64_tr_b16 v[190:191], v223 offset:12288
    v_mfma_f32_16x16x32_bf16 v[40:43], v[148:151], a[236:239], v[40:43]
    s_waitcnt lgkmcnt(15)
    buffer_load_dwordx4 a[172:175], v198, s[20:23], s59 offen offset:1024 sc1
    v_mfma_f32_16x16x32_bf16 v[12:15], v[152:155], a[224:227], v[12:15]
    s_add_u32 s59, s65, 8192
    v_mfma_f32_16x16x32_bf16 v[12:15], v[156:159], a[232:235], v[12:15]
    buffer_load_dwordx4 a[176:179], v196, s[20:23], s59 offen offset:0 sc1
    v_mfma_f32_16x16x32_bf16 v[44:47], v[152:155], a[228:231], v[44:47]
    s_waitcnt lgkmcnt(0)
    v_mfma_f32_16x16x32_bf16 v[44:47], v[156:159], a[236:239], v[44:47]
    buffer_load_dwordx4 a[180:183], v198, s[20:23], s59 offen offset:0 sc1
    v_mfma_f32_16x16x32_bf16 v[16:19], v[160:163], a[224:227], v[16:19]
    s_barrier
    ds_read_b64_tr_b16 v[128:129], v216 offset:16384
    ds_read_b64_tr_b16 v[130:131], v216 offset:20480
    v_mfma_f32_16x16x32_bf16 v[16:19], v[164:167], a[232:235], v[16:19]
    v_mfma_f32_16x16x32_bf16 v[48:51], v[160:163], a[228:231], v[48:51]
    ds_read_b64_tr_b16 v[132:133], v216 offset:24576
    ds_read_b64_tr_b16 v[134:135], v216 offset:28672
    v_mfma_f32_16x16x32_bf16 v[48:51], v[164:167], a[236:239], v[48:51]
    buffer_load_dwordx4 a[184:187], v196, s[20:23], s59 offen offset:1024 sc1
    v_mfma_f32_16x16x32_bf16 v[20:23], v[168:171], a[224:227], v[20:23]
    ds_read_b64_tr_b16 v[136:137], v217 offset:16384
    ds_read_b64_tr_b16 v[138:139], v217 offset:20480
    v_mfma_f32_16x16x32_bf16 v[20:23], v[172:175], a[232:235], v[20:23]
    v_mfma_f32_16x16x32_bf16 v[52:55], v[168:171], a[228:231], v[52:55]
    ds_read_b64_tr_b16 v[140:141], v217 offset:24576
    ds_read_b64_tr_b16 v[142:143], v217 offset:28672
    v_mfma_f32_16x16x32_bf16 v[52:55], v[172:175], a[236:239], v[52:55]
    v_mfma_f32_16x16x32_bf16 v[24:27], v[176:179], a[224:227], v[24:27]
    ds_read_b64_tr_b16 v[144:145], v218 offset:16384
    ds_read_b64_tr_b16 v[146:147], v218 offset:20480
    v_mfma_f32_16x16x32_bf16 v[24:27], v[180:183], a[232:235], v[24:27]
    buffer_load_dwordx4 a[188:191], v198, s[20:23], s59 offen offset:1024 sc1
    v_mfma_f32_16x16x32_bf16 v[56:59], v[176:179], a[228:231], v[56:59]
    s_add_u32 s59, s65, 10240
    ds_read_b64_tr_b16 v[148:149], v218 offset:24576
    ds_read_b64_tr_b16 v[150:151], v218 offset:28672
    v_mfma_f32_16x16x32_bf16 v[56:59], v[180:183], a[236:239], v[56:59]
    v_mfma_f32_16x16x32_bf16 v[28:31], v[184:187], a[224:227], v[28:31]
    ds_read_b64_tr_b16 v[152:153], v219 offset:16384
    ds_read_b64_tr_b16 v[154:155], v219 offset:20480
    v_mfma_f32_16x16x32_bf16 v[28:31], v[188:191], a[232:235], v[28:31]
    buffer_load_dwordx4 a[192:195], v196, s[20:23], s59 offen offset:0 sc1
    v_mfma_f32_16x16x32_bf16 v[60:63], v[184:187], a[228:231], v[60:63]
    s_waitcnt vmcnt(17)
    ds_read_b64_tr_b16 v[156:157], v219 offset:24576
    ds_read_b64_tr_b16 v[158:159], v219 offset:28672
    v_mfma_f32_16x16x32_bf16 v[60:63], v[188:191], a[236:239], v[60:63]
    s_waitcnt lgkmcnt(12)
    v_mfma_f32_16x16x32_bf16 v[64:67], v[128:131], a[240:243], 0
    ds_read_b64_tr_b16 v[160:161], v220 offset:16384
    ds_read_b64_tr_b16 v[162:163], v220 offset:20480
    v_mfma_f32_16x16x32_bf16 v[64:67], v[132:135], a[248:251], v[64:67]
    buffer_load_dwordx4 a[196:199], v198, s[20:23], s59 offen offset:0 sc1
    v_mfma_f32_16x16x32_bf16 v[96:99], v[128:131], a[244:247], 0
    ds_read_b64_tr_b16 v[164:165], v220 offset:24576
    ds_read_b64_tr_b16 v[166:167], v220 offset:28672
    v_mfma_f32_16x16x32_bf16 v[96:99], v[132:135], a[252:255], v[96:99]
    s_waitcnt lgkmcnt(12)
    v_mfma_f32_16x16x32_bf16 v[68:71], v[136:139], a[240:243], 0
    ds_read_b64_tr_b16 v[168:169], v221 offset:16384
    ds_read_b64_tr_b16 v[170:171], v221 offset:20480
    v_mfma_f32_16x16x32_bf16 v[68:71], v[140:143], a[248:251], v[68:71]
    buffer_load_dwordx4 a[200:203], v196, s[20:23], s59 offen offset:1024 sc1
    v_mfma_f32_16x16x32_bf16 v[100:103], v[136:139], a[244:247], 0
    ds_read_b64_tr_b16 v[172:173], v221 offset:24576
    ds_read_b64_tr_b16 v[174:175], v221 offset:28672
    v_mfma_f32_16x16x32_bf16 v[100:103], v[140:143], a[252:255], v[100:103]
    s_waitcnt lgkmcnt(12)
    v_mfma_f32_16x16x32_bf16 v[72:75], v[144:147], a[240:243], 0
    ds_read_b64_tr_b16 v[176:177], v222 offset:16384
    ds_read_b64_tr_b16 v[178:179], v222 offset:20480
    v_mfma_f32_16x16x32_bf16 v[72:75], v[148:151], a[248:251], v[72:75]
    buffer_load_dwordx4 a[204:207], v198, s[20:23], s59 offen offset:1024 sc1
    v_mfma_f32_16x16x32_bf16 v[104:107], v[144:147], a[244:247], 0
    ds_read_b64_tr_b16 v[180:181], v222 offset:24576
    ds_read_b64_tr_b16 v[182:183], v222 offset:28672
    v_mfma_f32_16x16x32_bf16 v[104:107], v[148:151], a[252:255], v[104:107]
    s_waitcnt lgkmcnt(12)
    s_add_u32 m0, s51, 16384
    s_add_u32 s58, s49, 393216
    v_mfma_f32_16x16x32_bf16 v[76:79], v[152:155], a[240:243], 0
    ds_read_b64_tr_b16 v[184:185], v223 offset:16384
    ds_read_b64_tr_b16 v[186:187], v223 offset:20480
    v_mfma_f32_16x16x32_bf16 v[76:79], v[156:159], a[248:251], v[76:79]
    buffer_load_dwordx4 v242, s[8:11], s58 offen lds
    v_mfma_f32_16x16x32_bf16 v[108:111], v[152:155], a[244:247], 0
    ds_read_b64_tr_b16 v[188:189], v223 offset:24576
    ds_read_b64_tr_b16 v[190:191], v223 offset:28672
    v_mfma_f32_16x16x32_bf16 v[108:111], v[156:159], a[252:255], v[108:111]
    s_waitcnt lgkmcnt(12)
    v_cvt_pk_bf16_f32 v32, v32, v33
    v_cvt_pk_bf16_f32 v33, v34, v35
    v_mfma_f32_16x16x32_bf16 v[80:83], v[160:163], a[240:243], 0
    ds_read_b64_tr_b16 v[128:129], v216 offset:32768
    ds_read_b64_tr_b16 v[130:131], v216 offset:36864
    v_mfma_f32_16x16x32_bf16 v[80:83], v[164:167], a[248:251], v[80:83]
    buffer_load_dwordx4 v243, s[8:11], s58 offen offset:1024 lds
    v_mfma_f32_16x16x32_bf16 v[112:115], v[160:163], a[244:247], 0
    ds_read_b64_tr_b16 v[132:133], v216 offset:40960
    ds_read_b64_tr_b16 v[134:135], v216 offset:45056
    v_mfma_f32_16x16x32_bf16 v[112:115], v[164:167], a[252:255], v[112:115]
    s_waitcnt lgkmcnt(12)
    s_add_u32 m0, s51, 24576
    s_add_u32 s58, s49, 425984
    v_mfma_f32_16x16x32_bf16 v[84:87], v[168:171], a[240:243], 0
    ds_read_b64_tr_b16 v[136:137], v217 offset:32768
    ds_read_b64_tr_b16 v[138:139], v217 offset:36864
    v_mfma_f32_16x16x32_bf16 v[84:87], v[172:175], a[248:251], v[84:87]
    buffer_load_dwordx4 v242, s[8:11], s58 offen lds
    v_mfma_f32_16x16x32_bf16 v[116:119], v[168:171], a[244:247], 0
    ds_read_b64_tr_b16 v[140:141], v217 offset:40960
    ds_read_b64_tr_b16 v[142:143], v217 offset:45056
    v_mfma_f32_16x16x32_bf16 v[116:119], v[172:175], a[252:255], v[116:119]
    s_waitcnt lgkmcnt(12)
    v_cvt_pk_bf16_f32 v34, v36, v37
    v_cvt_pk_bf16_f32 v35, v38, v39
    v_mfma_f32_16x16x32_bf16 v[88:91], v[176:179], a[240:243], 0
    ds_read_b64_tr_b16 v[144:145], v218 offset:32768
    ds_read_b64_tr_b16 v[146:147], v218 offset:36864
    v_mfma_f32_16x16x32_bf16 v[88:91], v[180:183], a[248:251], v[88:91]
    buffer_load_dwordx4 v243, s[8:11], s58 offen offset:1024 lds
    v_mfma_f32_16x16x32_bf16 v[120:123], v[176:179], a[244:247], 0
    ds_read_b64_tr_b16 v[148:149], v218 offset:40960
    ds_read_b64_tr_b16 v[150:151], v218 offset:45056
    v_mfma_f32_16x16x32_bf16 v[120:123], v[180:183], a[252:255], v[120:123]
    s_waitcnt lgkmcnt(12)
    s_add_u32 s59, s65, 12288
    v_mfma_f32_16x16x32_bf16 v[92:95], v[184:187], a[240:243], 0
    ds_read_b64_tr_b16 v[152:153], v219 offset:32768
    ds_read_b64_tr_b16 v[154:155], v219 offset:36864
    v_mfma_f32_16x16x32_bf16 v[92:95], v[188:191], a[248:251], v[92:95]
    buffer_load_dwordx4 a[208:211], v196, s[20:23], s59 offen offset:0 sc1
    v_mfma_f32_16x16x32_bf16 v[124:127], v[184:187], a[244:247], 0
    s_waitcnt vmcnt(21)
    ds_read_b64_tr_b16 v[156:157], v219 offset:40960
    ds_read_b64_tr_b16 v[158:159], v219 offset:45056
    v_mfma_f32_16x16x32_bf16 v[124:127], v[188:191], a[252:255], v[124:127]
    s_waitcnt lgkmcnt(12)
    buffer_store_dwordx4 v[32:35], v240, s[20:23], s36 offen offset:0 sc1
    v_mfma_f32_16x16x32_bf16 v[64:67], v[128:131], a[128:131], v[64:67]
    ds_read_b64_tr_b16 v[160:161], v220 offset:32768
    ds_read_b64_tr_b16 v[162:163], v220 offset:36864
    v_mfma_f32_16x16x32_bf16 v[64:67], v[132:135], a[136:139], v[64:67]
    v_cvt_pk_bf16_f32 v40, v40, v41
    v_cvt_pk_bf16_f32 v41, v42, v43
    v_mfma_f32_16x16x32_bf16 v[96:99], v[128:131], a[132:135], v[96:99]
    ds_read_b64_tr_b16 v[164:165], v220 offset:40960
    ds_read_b64_tr_b16 v[166:167], v220 offset:45056
    v_mfma_f32_16x16x32_bf16 v[96:99], v[132:135], a[140:143], v[96:99]
    s_waitcnt lgkmcnt(12)
    buffer_load_dwordx4 a[212:215], v198, s[20:23], s59 offen offset:0 sc1
    v_mfma_f32_16x16x32_bf16 v[68:71], v[136:139], a[128:131], v[68:71]
    ds_read_b64_tr_b16 v[168:169], v221 offset:32768
    ds_read_b64_tr_b16 v[170:171], v221 offset:36864
    v_mfma_f32_16x16x32_bf16 v[68:71], v[140:143], a[136:139], v[68:71]
    v_cvt_pk_bf16_f32 v42, v44, v45
    v_cvt_pk_bf16_f32 v43, v46, v47
    v_mfma_f32_16x16x32_bf16 v[100:103], v[136:139], a[132:135], v[100:103]
    ds_read_b64_tr_b16 v[172:173], v221 offset:40960
    ds_read_b64_tr_b16 v[174:175], v221 offset:45056
    v_mfma_f32_16x16x32_bf16 v[100:103], v[140:143], a[140:143], v[100:103]
    s_waitcnt lgkmcnt(12)
    ds_read_b64_tr_b16 v[176:177], v222 offset:32768
    ds_read_b64_tr_b16 v[178:179], v222 offset:36864
    v_mfma_f32_16x16x32_bf16 v[72:75], v[144:147], a[128:131], v[72:75]
    ds_read_b64_tr_b16 v[180:181], v222 offset:40960
    ds_read_b64_tr_b16 v[182:183], v222 offset:45056
    v_mfma_f32_16x16x32_bf16 v[72:75], v[148:151], a[136:139], v[72:75]
    ds_read_b64_tr_b16 v[184:185], v223 offset:32768
    ds_read_b64_tr_b16 v[186:187], v223 offset:36864
    v_mfma_f32_16x16x32_bf16 v[104:107], v[144:147], a[132:135], v[104:107]
    ds_read_b64_tr_b16 v[188:189], v223 offset:40960
    ds_read_b64_tr_b16 v[190:191], v223 offset:45056
    v_mfma_f32_16x16x32_bf16 v[104:107], v[148:151], a[140:143], v[104:107]
    s_waitcnt lgkmcnt(15)
    buffer_load_dwordx4 a[216:219], v196, s[20:23], s59 offen offset:1024 sc1
    v_mfma_f32_16x16x32_bf16 v[76:79], v[152:155], a[128:131], v[76:79]
    buffer_load_dwordx4 a[220:223], v198, s[20:23], s59 offen offset:1024 sc1
    v_mfma_f32_16x16x32_bf16 v[76:79], v[156:159], a[136:139], v[76:79]
    s_add_u32 m0, s51, 32768
    s_add_u32 s58, s49, 458752
    v_mfma_f32_16x16x32_bf16 v[108:111], v[152:155], a[132:135], v[108:111]
    s_waitcnt lgkmcnt(0)
    buffer_load_dwordx4 v242, s[8:11], s58 offen lds
    v_mfma_f32_16x16x32_bf16 v[108:111], v[156:159], a[140:143], v[108:111]
    buffer_store_dwordx4 v[40:43], v240, s[20:23], s36 offen offset:1024 sc1
    v_mfma_f32_16x16x32_bf16 v[80:83], v[160:163], a[128:131], v[80:83]
    s_barrier
    ds_read_b64_tr_b16 v[128:129], v216 offset:49152
    ds_read_b64_tr_b16 v[130:131], v216 offset:53248
    v_mfma_f32_16x16x32_bf16 v[80:83], v[164:167], a[136:139], v[80:83]
    v_cvt_pk_bf16_f32 v16, v16, v17
    v_cvt_pk_bf16_f32 v17, v18, v19
    v_mfma_f32_16x16x32_bf16 v[112:115], v[160:163], a[132:135], v[112:115]
    ds_read_b64_tr_b16 v[132:133], v216 offset:57344
    ds_read_b64_tr_b16 v[134:135], v216 offset:61440
    v_mfma_f32_16x16x32_bf16 v[112:115], v[164:167], a[140:143], v[112:115]
    buffer_load_dwordx4 v243, s[8:11], s58 offen offset:1024 lds
    v_mfma_f32_16x16x32_bf16 v[84:87], v[168:171], a[128:131], v[84:87]
    ds_read_b64_tr_b16 v[136:137], v217 offset:49152
    ds_read_b64_tr_b16 v[138:139], v217 offset:53248
    v_mfma_f32_16x16x32_bf16 v[84:87], v[172:175], a[136:139], v[84:87]
    s_add_u32 m0, s51, 40960
    s_add_u32 s58, s49, 491520
    v_cvt_pk_bf16_f32 v18, v20, v21
    v_mfma_f32_16x16x32_bf16 v[116:119], v[168:171], a[132:135], v[116:119]
    ds_read_b64_tr_b16 v[140:141], v217 offset:57344
    ds_read_b64_tr_b16 v[142:143], v217 offset:61440
    v_mfma_f32_16x16x32_bf16 v[116:119], v[172:175], a[140:143], v[116:119]
    buffer_load_dwordx4 v242, s[8:11], s58 offen lds
    v_mfma_f32_16x16x32_bf16 v[88:91], v[176:179], a[128:131], v[88:91]
    ds_read_b64_tr_b16 v[144:145], v218 offset:49152
    ds_read_b64_tr_b16 v[146:147], v218 offset:53248
    v_mfma_f32_16x16x32_bf16 v[88:91], v[180:183], a[136:139], v[88:91]
    v_cvt_pk_bf16_f32 v19, v22, v23
    v_mfma_f32_16x16x32_bf16 v[120:123], v[176:179], a[132:135], v[120:123]
    ds_read_b64_tr_b16 v[148:149], v218 offset:57344
    ds_read_b64_tr_b16 v[150:151], v218 offset:61440
    v_mfma_f32_16x16x32_bf16 v[120:123], v[180:183], a[140:143], v[120:123]
    buffer_load_dwordx4 v243, s[8:11], s58 offen offset:1024 lds
    v_mfma_f32_16x16x32_bf16 v[92:95], v[184:187], a[128:131], v[92:95]
    ds_read_b64_tr_b16 v[152:153], v219 offset:49152
    ds_read_b64_tr_b16 v[154:155], v219 offset:53248
    v_mfma_f32_16x16x32_bf16 v[92:95], v[188:191], a[136:139], v[92:95]
    s_add_u32 s59, s65, 14336
    buffer_store_dwordx4 v[16:19], v240, s[20:23], s37 offen offset:0 sc1
    v_mfma_f32_16x16x32_bf16 v[124:127], v[184:187], a[132:135], v[124:127]
    s_waitcnt vmcnt(27)
    ds_read_b64_tr_b16 v[156:157], v219 offset:57344
    ds_read_b64_tr_b16 v[158:159], v219 offset:61440
    v_mfma_f32_16x16x32_bf16 v[124:127], v[188:191], a[140:143], v[124:127]
    s_waitcnt lgkmcnt(12)
    buffer_load_dwordx4 a[224:227], v196, s[20:23], s59 offen offset:0 sc1
    v_mfma_f32_16x16x32_bf16 v[64:67], v[128:131], a[144:147], v[64:67]
    ds_read_b64_tr_b16 v[160:161], v220 offset:49152
    ds_read_b64_tr_b16 v[162:163], v220 offset:53248
    v_mfma_f32_16x16x32_bf16 v[64:67], v[132:135], a[152:155], v[64:67]
    v_cvt_pk_bf16_f32 v24, v24, v25
    v_cvt_pk_bf16_f32 v25, v26, v27
    v_mfma_f32_16x16x32_bf16 v[96:99], v[128:131], a[148:151], v[96:99]
    ds_read_b64_tr_b16 v[164:165], v220 offset:57344
    ds_read_b64_tr_b16 v[166:167], v220 offset:61440
    v_mfma_f32_16x16x32_bf16 v[96:99], v[132:135], a[156:159], v[96:99]
    s_waitcnt lgkmcnt(12)
    buffer_load_dwordx4 a[228:231], v198, s[20:23], s59 offen offset:0 sc1
    v_mfma_f32_16x16x32_bf16 v[68:71], v[136:139], a[144:147], v[68:71]
    ds_read_b64_tr_b16 v[168:169], v221 offset:49152
    ds_read_b64_tr_b16 v[170:171], v221 offset:53248
    v_mfma_f32_16x16x32_bf16 v[68:71], v[140:143], a[152:155], v[68:71]
    v_cvt_pk_bf16_f32 v26, v28, v29
    v_cvt_pk_bf16_f32 v27, v30, v31
    v_mfma_f32_16x16x32_bf16 v[100:103], v[136:139], a[148:151], v[100:103]
    ds_read_b64_tr_b16 v[172:173], v221 offset:57344
    ds_read_b64_tr_b16 v[174:175], v221 offset:61440
    v_mfma_f32_16x16x32_bf16 v[100:103], v[140:143], a[156:159], v[100:103]
    s_waitcnt lgkmcnt(12)
    buffer_load_dwordx4 a[232:235], v196, s[20:23], s59 offen offset:1024 sc1
    v_mfma_f32_16x16x32_bf16 v[72:75], v[144:147], a[144:147], v[72:75]
    ds_read_b64_tr_b16 v[176:177], v222 offset:49152
    ds_read_b64_tr_b16 v[178:179], v222 offset:53248
    v_mfma_f32_16x16x32_bf16 v[72:75], v[148:151], a[152:155], v[72:75]
    buffer_store_dwordx4 v[24:27], v240, s[20:23], s37 offen offset:1024 sc1
    v_mfma_f32_16x16x32_bf16 v[104:107], v[144:147], a[148:151], v[104:107]
    ds_read_b64_tr_b16 v[180:181], v222 offset:57344
    ds_read_b64_tr_b16 v[182:183], v222 offset:61440
    v_mfma_f32_16x16x32_bf16 v[104:107], v[148:151], a[156:159], v[104:107]
    s_waitcnt lgkmcnt(12)
    v_cvt_pk_bf16_f32 v48, v48, v49
    v_cvt_pk_bf16_f32 v49, v50, v51
    v_mfma_f32_16x16x32_bf16 v[76:79], v[152:155], a[144:147], v[76:79]
    ds_read_b64_tr_b16 v[184:185], v223 offset:49152
    ds_read_b64_tr_b16 v[186:187], v223 offset:53248
    v_mfma_f32_16x16x32_bf16 v[76:79], v[156:159], a[152:155], v[76:79]
    buffer_load_dwordx4 a[236:239], v198, s[20:23], s59 offen offset:1024 sc1
    v_mfma_f32_16x16x32_bf16 v[108:111], v[152:155], a[148:151], v[108:111]
    s_add_u32 m0, s51, 49152
    ds_read_b64_tr_b16 v[188:189], v223 offset:57344
    ds_read_b64_tr_b16 v[190:191], v223 offset:61440
    v_mfma_f32_16x16x32_bf16 v[108:111], v[156:159], a[156:159], v[108:111]
    s_waitcnt lgkmcnt(12)
    s_add_u32 s58, s49, 524288
    v_cvt_pk_bf16_f32 v50, v52, v53
    v_mfma_f32_16x16x32_bf16 v[80:83], v[160:163], a[144:147], v[80:83]
    ds_read_b64_tr_b16 v[128:129], v224 offset:0
    ds_read_b64_tr_b16 v[130:131], v224 offset:4096
    v_mfma_f32_16x16x32_bf16 v[80:83], v[164:167], a[152:155], v[80:83]
    buffer_load_dwordx4 v242, s[8:11], s58 offen lds
    v_mfma_f32_16x16x32_bf16 v[112:115], v[160:163], a[148:151], v[112:115]
    ds_read_b64_tr_b16 v[132:133], v224 offset:8192
    ds_read_b64_tr_b16 v[134:135], v224 offset:12288
    v_mfma_f32_16x16x32_bf16 v[112:115], v[164:167], a[156:159], v[112:115]
    s_waitcnt lgkmcnt(12)
    v_cvt_pk_bf16_f32 v51, v54, v55
    v_mfma_f32_16x16x32_bf16 v[84:87], v[168:171], a[144:147], v[84:87]
    ds_read_b64_tr_b16 v[136:137], v225 offset:0
    ds_read_b64_tr_b16 v[138:139], v225 offset:4096
    v_mfma_f32_16x16x32_bf16 v[84:87], v[172:175], a[152:155], v[84:87]
    buffer_load_dwordx4 v243, s[8:11], s58 offen offset:1024 lds
    v_mfma_f32_16x16x32_bf16 v[116:119], v[168:171], a[148:151], v[116:119]
    s_add_u32 m0, s51, 57344
    ds_read_b64_tr_b16 v[140:141], v225 offset:8192
    ds_read_b64_tr_b16 v[142:143], v225 offset:12288
    v_mfma_f32_16x16x32_bf16 v[116:119], v[172:175], a[156:159], v[116:119]
    s_waitcnt lgkmcnt(12)
    s_add_u32 s58, s49, 557056
    v_mfma_f32_16x16x32_bf16 v[88:91], v[176:179], a[144:147], v[88:91]
    ds_read_b64_tr_b16 v[144:145], v226 offset:0
    ds_read_b64_tr_b16 v[146:147], v226 offset:4096
    v_mfma_f32_16x16x32_bf16 v[88:91], v[180:183], a[152:155], v[88:91]
    buffer_load_dwordx4 v242, s[8:11], s58 offen lds
    v_mfma_f32_16x16x32_bf16 v[120:123], v[176:179], a[148:151], v[120:123]
    ds_read_b64_tr_b16 v[148:149], v226 offset:8192
    ds_read_b64_tr_b16 v[150:151], v226 offset:12288
    v_mfma_f32_16x16x32_bf16 v[120:123], v[180:183], a[156:159], v[120:123]
    s_waitcnt lgkmcnt(12)
    buffer_store_dwordx4 v[48:51], v240, s[20:23], s41 offen offset:0 sc1
    v_mfma_f32_16x16x32_bf16 v[92:95], v[184:187], a[144:147], v[92:95]
    ds_read_b64_tr_b16 v[152:153], v227 offset:0
    ds_read_b64_tr_b16 v[154:155], v227 offset:4096
    v_mfma_f32_16x16x32_bf16 v[92:95], v[188:191], a[152:155], v[92:95]
    buffer_load_dwordx4 v243, s[8:11], s58 offen offset:1024 lds
    v_mfma_f32_16x16x32_bf16 v[124:127], v[184:187], a[148:151], v[124:127]
    s_waitcnt vmcnt(33)
    ds_read_b64_tr_b16 v[156:157], v227 offset:8192
    ds_read_b64_tr_b16 v[158:159], v227 offset:12288
    v_mfma_f32_16x16x32_bf16 v[124:127], v[188:191], a[156:159], v[124:127]
    s_waitcnt lgkmcnt(12)
    s_add_u32 s59, s65, 16384
    v_cvt_pk_bf16_f32 v56, v56, v57
    v_mfma_f32_16x16x32_bf16 v[64:67], v[128:131], a[160:163], v[64:67]
    ds_read_b64_tr_b16 v[160:161], v228 offset:0
    ds_read_b64_tr_b16 v[162:163], v228 offset:4096
    v_mfma_f32_16x16x32_bf16 v[64:67], v[132:135], a[168:171], v[64:67]
    buffer_load_dwordx4 a[240:243], v196, s[20:23], s59 offen offset:0 sc1
    v_mfma_f32_16x16x32_bf16 v[96:99], v[128:131], a[164:167], v[96:99]
    ds_read_b64_tr_b16 v[164:165], v228 offset:8192
    ds_read_b64_tr_b16 v[166:167], v228 offset:12288
    v_mfma_f32_16x16x32_bf16 v[96:99], v[132:135], a[172:175], v[96:99]
    s_waitcnt lgkmcnt(12)
    v_cvt_pk_bf16_f32 v57, v58, v59
    v_cvt_pk_bf16_f32 v58, v60, v61
    v_mfma_f32_16x16x32_bf16 v[68:71], v[136:139], a[160:163], v[68:71]
    ds_read_b64_tr_b16 v[168:169], v229 offset:0
    ds_read_b64_tr_b16 v[170:171], v229 offset:4096
    v_mfma_f32_16x16x32_bf16 v[68:71], v[140:143], a[168:171], v[68:71]
    buffer_load_dwordx4 a[244:247], v198, s[20:23], s59 offen offset:0 sc1
    v_mfma_f32_16x16x32_bf16 v[100:103], v[136:139], a[164:167], v[100:103]
    ds_read_b64_tr_b16 v[172:173], v229 offset:8192
    ds_read_b64_tr_b16 v[174:175], v229 offset:12288
    v_mfma_f32_16x16x32_bf16 v[100:103], v[140:143], a[172:175], v[100:103]
    s_waitcnt lgkmcnt(12)
    ds_read_b64_tr_b16 v[176:177], v230 offset:0
    ds_read_b64_tr_b16 v[178:179], v230 offset:4096
    v_mfma_f32_16x16x32_bf16 v[72:75], v[144:147], a[160:163], v[72:75]
    ds_read_b64_tr_b16 v[180:181], v230 offset:8192
    ds_read_b64_tr_b16 v[182:183], v230 offset:12288
    v_mfma_f32_16x16x32_bf16 v[72:75], v[148:151], a[168:171], v[72:75]
    ds_read_b64_tr_b16 v[184:185], v231 offset:0
    ds_read_b64_tr_b16 v[186:187], v231 offset:4096
    v_mfma_f32_16x16x32_bf16 v[104:107], v[144:147], a[164:167], v[104:107]
    ds_read_b64_tr_b16 v[188:189], v231 offset:8192
    ds_read_b64_tr_b16 v[190:191], v231 offset:12288
    v_mfma_f32_16x16x32_bf16 v[104:107], v[148:151], a[172:175], v[104:107]
    s_waitcnt lgkmcnt(15)
    buffer_load_dwordx4 a[248:251], v196, s[20:23], s59 offen offset:1024 sc1
    v_mfma_f32_16x16x32_bf16 v[76:79], v[152:155], a[160:163], v[76:79]
    v_cvt_pk_bf16_f32 v59, v62, v63
    v_mfma_f32_16x16x32_bf16 v[76:79], v[156:159], a[168:171], v[76:79]
    buffer_load_dwordx4 a[252:255], v198, s[20:23], s59 offen offset:1024 sc1
    v_mfma_f32_16x16x32_bf16 v[108:111], v[152:155], a[164:167], v[108:111]
    s_waitcnt lgkmcnt(0)
    buffer_store_dwordx4 v[56:59], v240, s[20:23], s41 offen offset:1024 sc1
    v_mfma_f32_16x16x32_bf16 v[108:111], v[156:159], a[172:175], v[108:111]
    s_add_u32 m0, s56, 0
    s_add_u32 s58, s49, 589824
    v_mfma_f32_16x16x32_bf16 v[80:83], v[160:163], a[160:163], v[80:83]
    s_barrier
    ds_read_b64_tr_b16 v[128:129], v224 offset:16384
    ds_read_b64_tr_b16 v[130:131], v224 offset:20480
    v_mfma_f32_16x16x32_bf16 v[80:83], v[164:167], a[168:171], v[80:83]
    buffer_load_dwordx4 v242, s[8:11], s58 offen lds
    v_mfma_f32_16x16x32_bf16 v[112:115], v[160:163], a[164:167], v[112:115]
    ds_read_b64_tr_b16 v[132:133], v224 offset:24576
    ds_read_b64_tr_b16 v[134:135], v224 offset:28672
    v_mfma_f32_16x16x32_bf16 v[112:115], v[164:167], a[172:175], v[112:115]
    v_mfma_f32_16x16x32_bf16 v[84:87], v[168:171], a[160:163], v[84:87]
    ds_read_b64_tr_b16 v[136:137], v225 offset:16384
    ds_read_b64_tr_b16 v[138:139], v225 offset:20480
    v_mfma_f32_16x16x32_bf16 v[84:87], v[172:175], a[168:171], v[84:87]
    v_mfma_f32_16x16x32_bf16 v[116:119], v[168:171], a[164:167], v[116:119]
    ds_read_b64_tr_b16 v[140:141], v225 offset:24576
    ds_read_b64_tr_b16 v[142:143], v225 offset:28672
    v_mfma_f32_16x16x32_bf16 v[116:119], v[172:175], a[172:175], v[116:119]
    buffer_load_dwordx4 v243, s[8:11], s58 offen offset:1024 lds
    v_mfma_f32_16x16x32_bf16 v[88:91], v[176:179], a[160:163], v[88:91]
    s_add_u32 m0, s56, 8192
    ds_read_b64_tr_b16 v[144:145], v226 offset:16384
    ds_read_b64_tr_b16 v[146:147], v226 offset:20480
    v_mfma_f32_16x16x32_bf16 v[88:91], v[180:183], a[168:171], v[88:91]
    s_add_u32 s58, s49, 622592
    v_mfma_f32_16x16x32_bf16 v[120:123], v[176:179], a[164:167], v[120:123]
    ds_read_b64_tr_b16 v[148:149], v226 offset:24576
    ds_read_b64_tr_b16 v[150:151], v226 offset:28672
    v_mfma_f32_16x16x32_bf16 v[120:123], v[180:183], a[172:175], v[120:123]
    buffer_load_dwordx4 v242, s[8:11], s58 offen lds
    v_mfma_f32_16x16x32_bf16 v[92:95], v[184:187], a[160:163], v[92:95]
    ds_read_b64_tr_b16 v[152:153], v227 offset:16384
    ds_read_b64_tr_b16 v[154:155], v227 offset:20480
    v_mfma_f32_16x16x32_bf16 v[92:95], v[188:191], a[168:171], v[92:95]
    v_mfma_f32_16x16x32_bf16 v[124:127], v[184:187], a[164:167], v[124:127]
    s_waitcnt vmcnt(37)
    ds_read_b64_tr_b16 v[156:157], v227 offset:24576
    ds_read_b64_tr_b16 v[158:159], v227 offset:28672
    v_mfma_f32_16x16x32_bf16 v[124:127], v[188:191], a[172:175], v[124:127]
    s_waitcnt lgkmcnt(12)
    buffer_load_dwordx4 v243, s[8:11], s58 offen offset:1024 lds
    v_mfma_f32_16x16x32_bf16 v[64:67], v[128:131], a[176:179], v[64:67]
    s_add_u32 s59, s65, 18432
    ds_read_b64_tr_b16 v[160:161], v228 offset:16384
    ds_read_b64_tr_b16 v[162:163], v228 offset:20480
    v_mfma_f32_16x16x32_bf16 v[64:67], v[132:135], a[184:187], v[64:67]
    v_mfma_f32_16x16x32_bf16 v[96:99], v[128:131], a[180:183], v[96:99]
    ds_read_b64_tr_b16 v[164:165], v228 offset:24576
    ds_read_b64_tr_b16 v[166:167], v228 offset:28672
    v_mfma_f32_16x16x32_bf16 v[96:99], v[132:135], a[188:191], v[96:99]
    s_waitcnt lgkmcnt(12)
    buffer_load_dwordx4 a[128:131], v196, s[20:23], s59 offen offset:0 sc1
    v_mfma_f32_16x16x32_bf16 v[68:71], v[136:139], a[176:179], v[68:71]
    ds_read_b64_tr_b16 v[168:169], v229 offset:16384
    ds_read_b64_tr_b16 v[170:171], v229 offset:20480
    v_mfma_f32_16x16x32_bf16 v[68:71], v[140:143], a[184:187], v[68:71]
    v_mfma_f32_16x16x32_bf16 v[100:103], v[136:139], a[180:183], v[100:103]
    ds_read_b64_tr_b16 v[172:173], v229 offset:24576
    ds_read_b64_tr_b16 v[174:175], v229 offset:28672
    v_mfma_f32_16x16x32_bf16 v[100:103], v[140:143], a[188:191], v[100:103]
    s_waitcnt lgkmcnt(12)
    buffer_load_dwordx4 a[132:135], v198, s[20:23], s59 offen offset:0 sc1
    v_mfma_f32_16x16x32_bf16 v[72:75], v[144:147], a[176:179], v[72:75]
    ds_read_b64_tr_b16 v[176:177], v230 offset:16384
    ds_read_b64_tr_b16 v[178:179], v230 offset:20480
    v_mfma_f32_16x16x32_bf16 v[72:75], v[148:151], a[184:187], v[72:75]
    v_mfma_f32_16x16x32_bf16 v[104:107], v[144:147], a[180:183], v[104:107]
    ds_read_b64_tr_b16 v[180:181], v230 offset:24576
    ds_read_b64_tr_b16 v[182:183], v230 offset:28672
    v_mfma_f32_16x16x32_bf16 v[104:107], v[148:151], a[188:191], v[104:107]
    s_waitcnt lgkmcnt(12)
    buffer_load_dwordx4 a[136:139], v196, s[20:23], s59 offen offset:1024 sc1
    v_mfma_f32_16x16x32_bf16 v[76:79], v[152:155], a[176:179], v[76:79]
    ds_read_b64_tr_b16 v[184:185], v231 offset:16384
    ds_read_b64_tr_b16 v[186:187], v231 offset:20480
    v_mfma_f32_16x16x32_bf16 v[76:79], v[156:159], a[184:187], v[76:79]
    v_mfma_f32_16x16x32_bf16 v[108:111], v[152:155], a[180:183], v[108:111]
    ds_read_b64_tr_b16 v[188:189], v231 offset:24576
    ds_read_b64_tr_b16 v[190:191], v231 offset:28672
    v_mfma_f32_16x16x32_bf16 v[108:111], v[156:159], a[188:191], v[108:111]
    s_waitcnt lgkmcnt(12)
    buffer_load_dwordx4 a[140:143], v198, s[20:23], s59 offen offset:1024 sc1
    v_mfma_f32_16x16x32_bf16 v[80:83], v[160:163], a[176:179], v[80:83]
    ds_read_b64_tr_b16 v[128:129], v208 offset:0
    ds_read_b64_tr_b16 v[130:131], v208 offset:4096
    v_mfma_f32_16x16x32_bf16 v[80:83], v[164:167], a[184:187], v[80:83]
    s_add_u32 m0, s56, 16384
    s_add_u32 s58, s49, 655360
    v_mfma_f32_16x16x32_bf16 v[112:115], v[160:163], a[180:183], v[112:115]
    ds_read_b64_tr_b16 v[132:133], v208 offset:8192
    ds_read_b64_tr_b16 v[134:135], v208 offset:12288
    v_mfma_f32_16x16x32_bf16 v[112:115], v[164:167], a[188:191], v[112:115]
    s_waitcnt lgkmcnt(12)
    buffer_load_dwordx4 v242, s[8:11], s58 offen lds
    v_mfma_f32_16x16x32_bf16 v[84:87], v[168:171], a[176:179], v[84:87]
    ds_read_b64_tr_b16 v[136:137], v209 offset:0
    ds_read_b64_tr_b16 v[138:139], v209 offset:4096
    v_mfma_f32_16x16x32_bf16 v[84:87], v[172:175], a[184:187], v[84:87]
    v_mfma_f32_16x16x32_bf16 v[116:119], v[168:171], a[180:183], v[116:119]
    ds_read_b64_tr_b16 v[140:141], v209 offset:8192
    ds_read_b64_tr_b16 v[142:143], v209 offset:12288
    v_mfma_f32_16x16x32_bf16 v[116:119], v[172:175], a[188:191], v[116:119]
    s_waitcnt lgkmcnt(12)
    buffer_load_dwordx4 v243, s[8:11], s58 offen offset:1024 lds
    v_mfma_f32_16x16x32_bf16 v[88:91], v[176:179], a[176:179], v[88:91]
    ds_read_b64_tr_b16 v[144:145], v210 offset:0
    ds_read_b64_tr_b16 v[146:147], v210 offset:4096
    v_mfma_f32_16x16x32_bf16 v[88:91], v[180:183], a[184:187], v[88:91]
    s_add_u32 m0, s56, 24576
    s_add_u32 s58, s49, 688128
    v_mfma_f32_16x16x32_bf16 v[120:123], v[176:179], a[180:183], v[120:123]
    ds_read_b64_tr_b16 v[148:149], v210 offset:8192
    ds_read_b64_tr_b16 v[150:151], v210 offset:12288
    v_mfma_f32_16x16x32_bf16 v[120:123], v[180:183], a[188:191], v[120:123]
    s_waitcnt lgkmcnt(12)
    buffer_load_dwordx4 v242, s[8:11], s58 offen lds
    v_mfma_f32_16x16x32_bf16 v[92:95], v[184:187], a[176:179], v[92:95]
    ds_read_b64_tr_b16 v[152:153], v211 offset:0
    ds_read_b64_tr_b16 v[154:155], v211 offset:4096
    v_mfma_f32_16x16x32_bf16 v[92:95], v[188:191], a[184:187], v[92:95]
    v_mfma_f32_16x16x32_bf16 v[124:127], v[184:187], a[180:183], v[124:127]
    s_waitcnt vmcnt(41)
    ds_read_b64_tr_b16 v[156:157], v211 offset:8192
    ds_read_b64_tr_b16 v[158:159], v211 offset:12288
    v_mfma_f32_16x16x32_bf16 v[124:127], v[188:191], a[188:191], v[124:127]
    s_waitcnt lgkmcnt(12)
    v_mfma_f32_16x16x32_bf16 v[64:67], v[128:131], a[192:195], v[64:67]
    ds_read_b64_tr_b16 v[160:161], v212 offset:0
    ds_read_b64_tr_b16 v[162:163], v212 offset:4096
    v_mfma_f32_16x16x32_bf16 v[64:67], v[132:135], a[200:203], v[64:67]
    buffer_load_dwordx4 v243, s[8:11], s58 offen offset:1024 lds
    v_mfma_f32_16x16x32_bf16 v[96:99], v[128:131], a[196:199], v[96:99]
    s_add_u32 s59, s65, 20480
    ds_read_b64_tr_b16 v[164:165], v212 offset:8192
    ds_read_b64_tr_b16 v[166:167], v212 offset:12288
    v_mfma_f32_16x16x32_bf16 v[96:99], v[132:135], a[204:207], v[96:99]
    s_waitcnt lgkmcnt(12)
    v_mfma_f32_16x16x32_bf16 v[68:71], v[136:139], a[192:195], v[68:71]
    ds_read_b64_tr_b16 v[168:169], v213 offset:0
    ds_read_b64_tr_b16 v[170:171], v213 offset:4096
    v_mfma_f32_16x16x32_bf16 v[68:71], v[140:143], a[200:203], v[68:71]
    buffer_load_dwordx4 a[144:147], v196, s[20:23], s59 offen offset:0 sc1
    v_mfma_f32_16x16x32_bf16 v[100:103], v[136:139], a[196:199], v[100:103]
    ds_read_b64_tr_b16 v[172:173], v213 offset:8192
    ds_read_b64_tr_b16 v[174:175], v213 offset:12288
    v_mfma_f32_16x16x32_bf16 v[100:103], v[140:143], a[204:207], v[100:103]
    s_waitcnt lgkmcnt(12)
    ds_read_b64_tr_b16 v[176:177], v214 offset:0
    ds_read_b64_tr_b16 v[178:179], v214 offset:4096
    v_mfma_f32_16x16x32_bf16 v[72:75], v[144:147], a[192:195], v[72:75]
    ds_read_b64_tr_b16 v[180:181], v214 offset:8192
    ds_read_b64_tr_b16 v[182:183], v214 offset:12288
    v_mfma_f32_16x16x32_bf16 v[72:75], v[148:151], a[200:203], v[72:75]
    ds_read_b64_tr_b16 v[184:185], v215 offset:0
    ds_read_b64_tr_b16 v[186:187], v215 offset:4096
    v_mfma_f32_16x16x32_bf16 v[104:107], v[144:147], a[196:199], v[104:107]
    ds_read_b64_tr_b16 v[188:189], v215 offset:8192
    ds_read_b64_tr_b16 v[190:191], v215 offset:12288
    v_mfma_f32_16x16x32_bf16 v[104:107], v[148:151], a[204:207], v[104:107]
    s_waitcnt lgkmcnt(15)
    buffer_load_dwordx4 a[148:151], v198, s[20:23], s59 offen offset:0 sc1
    v_mfma_f32_16x16x32_bf16 v[76:79], v[152:155], a[192:195], v[76:79]
    buffer_load_dwordx4 a[152:155], v196, s[20:23], s59 offen offset:1024 sc1
    v_mfma_f32_16x16x32_bf16 v[76:79], v[156:159], a[200:203], v[76:79]
    v_mfma_f32_16x16x32_bf16 v[108:111], v[152:155], a[196:199], v[108:111]
    s_waitcnt lgkmcnt(0)
    v_mfma_f32_16x16x32_bf16 v[108:111], v[156:159], a[204:207], v[108:111]
    v_mfma_f32_16x16x32_bf16 v[80:83], v[160:163], a[192:195], v[80:83]
    s_waitcnt vmcnt(31)
    s_barrier
    ds_read_b64_tr_b16 v[128:129], v208 offset:16384
    ds_read_b64_tr_b16 v[130:131], v208 offset:20480
    v_mfma_f32_16x16x32_bf16 v[80:83], v[164:167], a[200:203], v[80:83]
    buffer_load_dwordx4 a[156:159], v198, s[20:23], s59 offen offset:1024 sc1
    v_mfma_f32_16x16x32_bf16 v[112:115], v[160:163], a[196:199], v[112:115]
    ds_read_b64_tr_b16 v[132:133], v208 offset:24576
    ds_read_b64_tr_b16 v[134:135], v208 offset:28672
    v_mfma_f32_16x16x32_bf16 v[112:115], v[164:167], a[204:207], v[112:115]
    s_add_u32 m0, s56, 32768
    s_add_u32 s58, s49, 720896
    v_mfma_f32_16x16x32_bf16 v[84:87], v[168:171], a[192:195], v[84:87]
    ds_read_b64_tr_b16 v[136:137], v209 offset:16384
    ds_read_b64_tr_b16 v[138:139], v209 offset:20480
    v_mfma_f32_16x16x32_bf16 v[84:87], v[172:175], a[200:203], v[84:87]
    buffer_load_dwordx4 v242, s[8:11], s58 offen lds
    v_mfma_f32_16x16x32_bf16 v[116:119], v[168:171], a[196:199], v[116:119]
    ds_read_b64_tr_b16 v[140:141], v209 offset:24576
    ds_read_b64_tr_b16 v[142:143], v209 offset:28672
    v_mfma_f32_16x16x32_bf16 v[116:119], v[172:175], a[204:207], v[116:119]
    v_mfma_f32_16x16x32_bf16 v[88:91], v[176:179], a[192:195], v[88:91]
    ds_read_b64_tr_b16 v[144:145], v210 offset:16384
    ds_read_b64_tr_b16 v[146:147], v210 offset:20480
    v_mfma_f32_16x16x32_bf16 v[88:91], v[180:183], a[200:203], v[88:91]
    buffer_load_dwordx4 v243, s[8:11], s58 offen offset:1024 lds
    v_mfma_f32_16x16x32_bf16 v[120:123], v[176:179], a[196:199], v[120:123]
    ds_read_b64_tr_b16 v[148:149], v210 offset:24576
    ds_read_b64_tr_b16 v[150:151], v210 offset:28672
    v_mfma_f32_16x16x32_bf16 v[120:123], v[180:183], a[204:207], v[120:123]
    s_add_u32 m0, s56, 40960
    s_add_u32 s58, s49, 753664
    v_mfma_f32_16x16x32_bf16 v[92:95], v[184:187], a[192:195], v[92:95]
    ds_read_b64_tr_b16 v[152:153], v211 offset:16384
    ds_read_b64_tr_b16 v[154:155], v211 offset:20480
    v_mfma_f32_16x16x32_bf16 v[92:95], v[188:191], a[200:203], v[92:95]
    buffer_load_dwordx4 v242, s[8:11], s58 offen lds
    v_mfma_f32_16x16x32_bf16 v[124:127], v[184:187], a[196:199], v[124:127]
    ds_read_b64_tr_b16 v[156:157], v211 offset:24576
    ds_read_b64_tr_b16 v[158:159], v211 offset:28672
    v_mfma_f32_16x16x32_bf16 v[124:127], v[188:191], a[204:207], v[124:127]
    s_waitcnt lgkmcnt(12)
    v_mfma_f32_16x16x32_bf16 v[64:67], v[128:131], a[208:211], v[64:67]
    ds_read_b64_tr_b16 v[160:161], v212 offset:16384
    ds_read_b64_tr_b16 v[162:163], v212 offset:20480
    v_mfma_f32_16x16x32_bf16 v[64:67], v[132:135], a[216:219], v[64:67]
    buffer_load_dwordx4 v243, s[8:11], s58 offen offset:1024 lds
    v_mfma_f32_16x16x32_bf16 v[96:99], v[128:131], a[212:215], v[96:99]
    ds_read_b64_tr_b16 v[164:165], v212 offset:24576
    ds_read_b64_tr_b16 v[166:167], v212 offset:28672
    v_mfma_f32_16x16x32_bf16 v[96:99], v[132:135], a[220:223], v[96:99]
    s_waitcnt lgkmcnt(12)
    s_add_u32 s59, s65, 22528
    v_mfma_f32_16x16x32_bf16 v[68:71], v[136:139], a[208:211], v[68:71]
    ds_read_b64_tr_b16 v[168:169], v213 offset:16384
    ds_read_b64_tr_b16 v[170:171], v213 offset:20480
    v_mfma_f32_16x16x32_bf16 v[68:71], v[140:143], a[216:219], v[68:71]
    buffer_load_dwordx4 a[160:163], v196, s[20:23], s59 offen offset:0 sc1
    v_mfma_f32_16x16x32_bf16 v[100:103], v[136:139], a[212:215], v[100:103]
    ds_read_b64_tr_b16 v[172:173], v213 offset:24576
    ds_read_b64_tr_b16 v[174:175], v213 offset:28672
    v_mfma_f32_16x16x32_bf16 v[100:103], v[140:143], a[220:223], v[100:103]
    s_waitcnt lgkmcnt(12)
    v_mfma_f32_16x16x32_bf16 v[72:75], v[144:147], a[208:211], v[72:75]
    ds_read_b64_tr_b16 v[176:177], v214 offset:16384
    ds_read_b64_tr_b16 v[178:179], v214 offset:20480
    v_mfma_f32_16x16x32_bf16 v[72:75], v[148:151], a[216:219], v[72:75]
    v_mfma_f32_16x16x32_bf16 v[104:107], v[144:147], a[212:215], v[104:107]
    ds_read_b64_tr_b16 v[180:181], v214 offset:24576
    ds_read_b64_tr_b16 v[182:183], v214 offset:28672
    v_mfma_f32_16x16x32_bf16 v[104:107], v[148:151], a[220:223], v[104:107]
    s_waitcnt lgkmcnt(12)
    buffer_load_dwordx4 a[164:167], v198, s[20:23], s59 offen offset:0 sc1
    v_mfma_f32_16x16x32_bf16 v[76:79], v[152:155], a[208:211], v[76:79]
    ds_read_b64_tr_b16 v[184:185], v215 offset:16384
    ds_read_b64_tr_b16 v[186:187], v215 offset:20480
    v_mfma_f32_16x16x32_bf16 v[76:79], v[156:159], a[216:219], v[76:79]
    v_mfma_f32_16x16x32_bf16 v[108:111], v[152:155], a[212:215], v[108:111]
    ds_read_b64_tr_b16 v[188:189], v215 offset:24576
    ds_read_b64_tr_b16 v[190:191], v215 offset:28672
    v_mfma_f32_16x16x32_bf16 v[108:111], v[156:159], a[220:223], v[108:111]
    s_waitcnt lgkmcnt(12)
    buffer_load_dwordx4 a[168:171], v196, s[20:23], s59 offen offset:1024 sc1
    v_mfma_f32_16x16x32_bf16 v[80:83], v[160:163], a[208:211], v[80:83]
    ds_read_b64_tr_b16 v[128:129], v208 offset:32768
    ds_read_b64_tr_b16 v[130:131], v208 offset:36864
    v_mfma_f32_16x16x32_bf16 v[80:83], v[164:167], a[216:219], v[80:83]
    v_mfma_f32_16x16x32_bf16 v[112:115], v[160:163], a[212:215], v[112:115]
    ds_read_b64_tr_b16 v[132:133], v208 offset:40960
    ds_read_b64_tr_b16 v[134:135], v208 offset:45056
    v_mfma_f32_16x16x32_bf16 v[112:115], v[164:167], a[220:223], v[112:115]
    s_waitcnt lgkmcnt(12)
    buffer_load_dwordx4 a[172:175], v198, s[20:23], s59 offen offset:1024 sc1
    v_mfma_f32_16x16x32_bf16 v[84:87], v[168:171], a[208:211], v[84:87]
    s_add_u32 m0, s56, 49152
    ds_read_b64_tr_b16 v[136:137], v209 offset:32768
    ds_read_b64_tr_b16 v[138:139], v209 offset:36864
    v_mfma_f32_16x16x32_bf16 v[84:87], v[172:175], a[216:219], v[84:87]
    s_add_u32 s58, s49, 786432
    v_mfma_f32_16x16x32_bf16 v[116:119], v[168:171], a[212:215], v[116:119]
    ds_read_b64_tr_b16 v[140:141], v209 offset:40960
    ds_read_b64_tr_b16 v[142:143], v209 offset:45056
    v_mfma_f32_16x16x32_bf16 v[116:119], v[172:175], a[220:223], v[116:119]
    s_waitcnt lgkmcnt(12)
    buffer_load_dwordx4 v242, s[8:11], s58 offen lds
    v_mfma_f32_16x16x32_bf16 v[88:91], v[176:179], a[208:211], v[88:91]
    ds_read_b64_tr_b16 v[144:145], v210 offset:32768
    ds_read_b64_tr_b16 v[146:147], v210 offset:36864
    v_mfma_f32_16x16x32_bf16 v[88:91], v[180:183], a[216:219], v[88:91]
    v_mfma_f32_16x16x32_bf16 v[120:123], v[176:179], a[212:215], v[120:123]
    ds_read_b64_tr_b16 v[148:149], v210 offset:40960
    ds_read_b64_tr_b16 v[150:151], v210 offset:45056
    v_mfma_f32_16x16x32_bf16 v[120:123], v[180:183], a[220:223], v[120:123]
    s_waitcnt lgkmcnt(12)
    buffer_load_dwordx4 v243, s[8:11], s58 offen offset:1024 lds
    v_mfma_f32_16x16x32_bf16 v[92:95], v[184:187], a[208:211], v[92:95]
    ds_read_b64_tr_b16 v[152:153], v211 offset:32768
    ds_read_b64_tr_b16 v[154:155], v211 offset:36864
    v_mfma_f32_16x16x32_bf16 v[92:95], v[188:191], a[216:219], v[92:95]
    s_add_u32 m0, s56, 57344
    s_add_u32 s58, s49, 819200
    v_mfma_f32_16x16x32_bf16 v[124:127], v[184:187], a[212:215], v[124:127]
    s_waitcnt vmcnt(36)
    ds_read_b64_tr_b16 v[156:157], v211 offset:40960
    ds_read_b64_tr_b16 v[158:159], v211 offset:45056
    v_mfma_f32_16x16x32_bf16 v[124:127], v[188:191], a[220:223], v[124:127]
    s_waitcnt lgkmcnt(12)
    buffer_load_dwordx4 v242, s[8:11], s58 offen lds
    v_mfma_f32_16x16x32_bf16 v[64:67], v[128:131], a[224:227], v[64:67]
    ds_read_b64_tr_b16 v[160:161], v212 offset:32768
    ds_read_b64_tr_b16 v[162:163], v212 offset:36864
    v_mfma_f32_16x16x32_bf16 v[64:67], v[132:135], a[232:235], v[64:67]
    v_mfma_f32_16x16x32_bf16 v[96:99], v[128:131], a[228:231], v[96:99]
    ds_read_b64_tr_b16 v[164:165], v212 offset:40960
    ds_read_b64_tr_b16 v[166:167], v212 offset:45056
    v_mfma_f32_16x16x32_bf16 v[96:99], v[132:135], a[236:239], v[96:99]
    s_waitcnt lgkmcnt(12)
    buffer_load_dwordx4 v243, s[8:11], s58 offen offset:1024 lds
    v_mfma_f32_16x16x32_bf16 v[68:71], v[136:139], a[224:227], v[68:71]
    ds_read_b64_tr_b16 v[168:169], v213 offset:32768
    ds_read_b64_tr_b16 v[170:171], v213 offset:36864
    v_mfma_f32_16x16x32_bf16 v[68:71], v[140:143], a[232:235], v[68:71]
    s_add_u32 s59, s65, 24576
    v_mfma_f32_16x16x32_bf16 v[100:103], v[136:139], a[228:231], v[100:103]
    ds_read_b64_tr_b16 v[172:173], v213 offset:40960
    ds_read_b64_tr_b16 v[174:175], v213 offset:45056
    v_mfma_f32_16x16x32_bf16 v[100:103], v[140:143], a[236:239], v[100:103]
    s_waitcnt lgkmcnt(12)
    buffer_load_dwordx4 a[176:179], v196, s[20:23], s59 offen offset:0 sc1
    v_mfma_f32_16x16x32_bf16 v[72:75], v[144:147], a[224:227], v[72:75]
    ds_read_b64_tr_b16 v[176:177], v214 offset:32768
    ds_read_b64_tr_b16 v[178:179], v214 offset:36864
    v_mfma_f32_16x16x32_bf16 v[72:75], v[148:151], a[232:235], v[72:75]
    v_mfma_f32_16x16x32_bf16 v[104:107], v[144:147], a[228:231], v[104:107]
    ds_read_b64_tr_b16 v[180:181], v214 offset:40960
    ds_read_b64_tr_b16 v[182:183], v214 offset:45056
    v_mfma_f32_16x16x32_bf16 v[104:107], v[148:151], a[236:239], v[104:107]
    s_waitcnt lgkmcnt(12)
    buffer_load_dwordx4 a[180:183], v198, s[20:23], s59 offen offset:0 sc1
    v_mfma_f32_16x16x32_bf16 v[76:79], v[152:155], a[224:227], v[76:79]
    ds_read_b64_tr_b16 v[184:185], v215 offset:32768
    ds_read_b64_tr_b16 v[186:187], v215 offset:36864
    v_mfma_f32_16x16x32_bf16 v[76:79], v[156:159], a[232:235], v[76:79]
    v_mfma_f32_16x16x32_bf16 v[108:111], v[152:155], a[228:231], v[108:111]
    ds_read_b64_tr_b16 v[188:189], v215 offset:40960
    ds_read_b64_tr_b16 v[190:191], v215 offset:45056
    v_mfma_f32_16x16x32_bf16 v[108:111], v[156:159], a[236:239], v[108:111]
    s_waitcnt lgkmcnt(12)
    buffer_load_dwordx4 a[184:187], v196, s[20:23], s59 offen offset:1024 sc1
    v_mfma_f32_16x16x32_bf16 v[80:83], v[160:163], a[224:227], v[80:83]
    s_waitcnt vmcnt(27)
    s_barrier
    ds_read_b64_tr_b16 v[128:129], v208 offset:49152
    ds_read_b64_tr_b16 v[130:131], v208 offset:53248
    v_mfma_f32_16x16x32_bf16 v[80:83], v[164:167], a[232:235], v[80:83]
    buffer_store_dword v249, v248, s[20:23], s95 offen offset:4 sc1
    v_mfma_f32_16x16x32_bf16 v[112:115], v[160:163], a[228:231], v[112:115]
    ds_read_b64_tr_b16 v[132:133], v208 offset:57344
    ds_read_b64_tr_b16 v[134:135], v208 offset:61440
    v_mfma_f32_16x16x32_bf16 v[112:115], v[164:167], a[236:239], v[112:115]
    s_waitcnt lgkmcnt(12)
    v_mfma_f32_16x16x32_bf16 v[84:87], v[168:171], a[224:227], v[84:87]
    ds_read_b64_tr_b16 v[136:137], v209 offset:49152
    ds_read_b64_tr_b16 v[138:139], v209 offset:53248
    v_mfma_f32_16x16x32_bf16 v[84:87], v[172:175], a[232:235], v[84:87]
    buffer_load_dwordx4 a[188:191], v198, s[20:23], s59 offen offset:1024 sc1
    v_mfma_f32_16x16x32_bf16 v[116:119], v[168:171], a[228:231], v[116:119]
    s_add_u32 m0, s50, 131072
    ds_read_b64_tr_b16 v[140:141], v209 offset:57344
    ds_read_b64_tr_b16 v[142:143], v209 offset:61440
    v_mfma_f32_16x16x32_bf16 v[116:119], v[172:175], a[236:239], v[116:119]
    s_waitcnt lgkmcnt(12)
    s_add_u32 s58, s49, 851968
    v_mfma_f32_16x16x32_bf16 v[88:91], v[176:179], a[224:227], v[88:91]
    ds_read_b64_tr_b16 v[144:145], v210 offset:49152
    ds_read_b64_tr_b16 v[146:147], v210 offset:53248
    v_mfma_f32_16x16x32_bf16 v[88:91], v[180:183], a[232:235], v[88:91]
    buffer_load_dwordx4 v242, s[8:11], s58 offen lds
    v_mfma_f32_16x16x32_bf16 v[120:123], v[176:179], a[228:231], v[120:123]
    ds_read_b64_tr_b16 v[148:149], v210 offset:57344
    ds_read_b64_tr_b16 v[150:151], v210 offset:61440
    v_mfma_f32_16x16x32_bf16 v[120:123], v[180:183], a[236:239], v[120:123]
    s_waitcnt lgkmcnt(12)
    v_mfma_f32_16x16x32_bf16 v[92:95], v[184:187], a[224:227], v[92:95]
    ds_read_b64_tr_b16 v[152:153], v211 offset:49152
    ds_read_b64_tr_b16 v[154:155], v211 offset:53248
    v_mfma_f32_16x16x32_bf16 v[92:95], v[188:191], a[232:235], v[92:95]
    buffer_load_dwordx4 v243, s[8:11], s58 offen offset:1024 lds
    v_mfma_f32_16x16x32_bf16 v[124:127], v[184:187], a[228:231], v[124:127]
    ds_read_b64_tr_b16 v[156:157], v211 offset:57344
    ds_read_b64_tr_b16 v[158:159], v211 offset:61440
    v_mfma_f32_16x16x32_bf16 v[124:127], v[188:191], a[236:239], v[124:127]
    s_waitcnt lgkmcnt(12)
    s_add_u32 m0, s50, 139264
    s_add_u32 s58, s49, 884736
    v_mfma_f32_16x16x32_bf16 v[64:67], v[128:131], a[240:243], v[64:67]
    ds_read_b64_tr_b16 v[160:161], v212 offset:49152
    ds_read_b64_tr_b16 v[162:163], v212 offset:53248
    v_mfma_f32_16x16x32_bf16 v[64:67], v[132:135], a[248:251], v[64:67]
    buffer_load_dwordx4 v242, s[8:11], s58 offen lds
    v_mfma_f32_16x16x32_bf16 v[96:99], v[128:131], a[244:247], v[96:99]
    ds_read_b64_tr_b16 v[164:165], v212 offset:57344
    ds_read_b64_tr_b16 v[166:167], v212 offset:61440
    v_mfma_f32_16x16x32_bf16 v[96:99], v[132:135], a[252:255], v[96:99]
    s_waitcnt lgkmcnt(12)
    v_mfma_f32_16x16x32_bf16 v[68:71], v[136:139], a[240:243], v[68:71]
    ds_read_b64_tr_b16 v[168:169], v213 offset:49152
    ds_read_b64_tr_b16 v[170:171], v213 offset:53248
    v_mfma_f32_16x16x32_bf16 v[68:71], v[140:143], a[248:251], v[68:71]
    buffer_load_dwordx4 v243, s[8:11], s58 offen offset:1024 lds
    v_mfma_f32_16x16x32_bf16 v[100:103], v[136:139], a[244:247], v[100:103]
    ds_read_b64_tr_b16 v[172:173], v213 offset:57344
    ds_read_b64_tr_b16 v[174:175], v213 offset:61440
    v_mfma_f32_16x16x32_bf16 v[100:103], v[140:143], a[252:255], v[100:103]
    s_waitcnt lgkmcnt(12)
    s_add_u32 s59, s65, 26624
    v_mfma_f32_16x16x32_bf16 v[72:75], v[144:147], a[240:243], v[72:75]
    ds_read_b64_tr_b16 v[176:177], v214 offset:49152
    ds_read_b64_tr_b16 v[178:179], v214 offset:53248
    v_mfma_f32_16x16x32_bf16 v[72:75], v[148:151], a[248:251], v[72:75]
    buffer_load_dwordx4 a[192:195], v196, s[20:23], s59 offen offset:0 sc1
    v_mfma_f32_16x16x32_bf16 v[104:107], v[144:147], a[244:247], v[104:107]
    ds_read_b64_tr_b16 v[180:181], v214 offset:57344
    ds_read_b64_tr_b16 v[182:183], v214 offset:61440
    v_mfma_f32_16x16x32_bf16 v[104:107], v[148:151], a[252:255], v[104:107]
    s_waitcnt lgkmcnt(12)
    v_mfma_f32_16x16x32_bf16 v[76:79], v[152:155], a[240:243], v[76:79]
    ds_read_b64_tr_b16 v[184:185], v215 offset:49152
    ds_read_b64_tr_b16 v[186:187], v215 offset:53248
    v_mfma_f32_16x16x32_bf16 v[76:79], v[156:159], a[248:251], v[76:79]
    buffer_load_dwordx4 a[196:199], v198, s[20:23], s59 offen offset:0 sc1
    v_mfma_f32_16x16x32_bf16 v[108:111], v[152:155], a[244:247], v[108:111]
    ds_read_b64_tr_b16 v[188:189], v215 offset:57344
    ds_read_b64_tr_b16 v[190:191], v215 offset:61440
    v_mfma_f32_16x16x32_bf16 v[108:111], v[156:159], a[252:255], v[108:111]
    s_waitcnt lgkmcnt(12)
    v_mfma_f32_16x16x32_bf16 v[80:83], v[160:163], a[240:243], v[80:83]
    ds_read_b64_tr_b16 v[128:129], v216 offset:0
    ds_read_b64_tr_b16 v[130:131], v216 offset:4096
    v_mfma_f32_16x16x32_bf16 v[80:83], v[164:167], a[248:251], v[80:83]
    buffer_load_dwordx4 a[200:203], v196, s[20:23], s59 offen offset:1024 sc1
    v_mfma_f32_16x16x32_bf16 v[112:115], v[160:163], a[244:247], v[112:115]
    ds_read_b64_tr_b16 v[132:133], v216 offset:8192
    ds_read_b64_tr_b16 v[134:135], v216 offset:12288
    v_mfma_f32_16x16x32_bf16 v[112:115], v[164:167], a[252:255], v[112:115]
    s_waitcnt lgkmcnt(12)
    v_mfma_f32_16x16x32_bf16 v[84:87], v[168:171], a[240:243], v[84:87]
    ds_read_b64_tr_b16 v[136:137], v217 offset:0
    ds_read_b64_tr_b16 v[138:139], v217 offset:4096
    v_mfma_f32_16x16x32_bf16 v[84:87], v[172:175], a[248:251], v[84:87]
    buffer_load_dwordx4 a[204:207], v198, s[20:23], s59 offen offset:1024 sc1
    v_mfma_f32_16x16x32_bf16 v[116:119], v[168:171], a[244:247], v[116:119]
    ds_read_b64_tr_b16 v[140:141], v217 offset:8192
    ds_read_b64_tr_b16 v[142:143], v217 offset:12288
    v_mfma_f32_16x16x32_bf16 v[116:119], v[172:175], a[252:255], v[116:119]
    s_waitcnt lgkmcnt(12)
    s_add_u32 m0, s50, 147456
    s_add_u32 s58, s49, 917504
    v_mfma_f32_16x16x32_bf16 v[88:91], v[176:179], a[240:243], v[88:91]
    ds_read_b64_tr_b16 v[144:145], v218 offset:0
    ds_read_b64_tr_b16 v[146:147], v218 offset:4096
    v_mfma_f32_16x16x32_bf16 v[88:91], v[180:183], a[248:251], v[88:91]
    buffer_load_dwordx4 v242, s[8:11], s58 offen lds
    v_mfma_f32_16x16x32_bf16 v[120:123], v[176:179], a[244:247], v[120:123]
    ds_read_b64_tr_b16 v[148:149], v218 offset:8192
    ds_read_b64_tr_b16 v[150:151], v218 offset:12288
    v_mfma_f32_16x16x32_bf16 v[120:123], v[180:183], a[252:255], v[120:123]
    s_waitcnt lgkmcnt(12)
    v_mfma_f32_16x16x32_bf16 v[92:95], v[184:187], a[240:243], v[92:95]
    ds_read_b64_tr_b16 v[152:153], v219 offset:0
    ds_read_b64_tr_b16 v[154:155], v219 offset:4096
    v_mfma_f32_16x16x32_bf16 v[92:95], v[188:191], a[248:251], v[92:95]
    v_mfma_f32_16x16x32_bf16 v[124:127], v[184:187], a[244:247], v[124:127]
    s_waitcnt vmcnt(34)
    ds_read_b64_tr_b16 v[156:157], v219 offset:8192
    ds_read_b64_tr_b16 v[158:159], v219 offset:12288
    v_mfma_f32_16x16x32_bf16 v[124:127], v[188:191], a[252:255], v[124:127]
    s_waitcnt lgkmcnt(12)
    buffer_load_dwordx4 v243, s[8:11], s58 offen offset:1024 lds
    v_mfma_f32_16x16x32_bf16 v[64:67], v[128:131], a[128:131], v[64:67]
    s_add_u32 m0, s50, 155648
    ds_read_b64_tr_b16 v[160:161], v220 offset:0
    ds_read_b64_tr_b16 v[162:163], v220 offset:4096
    v_mfma_f32_16x16x32_bf16 v[64:67], v[132:135], a[136:139], v[64:67]
    s_add_u32 s58, s49, 950272
    v_mfma_f32_16x16x32_bf16 v[96:99], v[128:131], a[132:135], v[96:99]
    ds_read_b64_tr_b16 v[164:165], v220 offset:8192
    ds_read_b64_tr_b16 v[166:167], v220 offset:12288
    v_mfma_f32_16x16x32_bf16 v[96:99], v[132:135], a[140:143], v[96:99]
    s_waitcnt lgkmcnt(12)
    buffer_load_dwordx4 v242, s[8:11], s58 offen lds
    v_mfma_f32_16x16x32_bf16 v[68:71], v[136:139], a[128:131], v[68:71]
    ds_read_b64_tr_b16 v[168:169], v221 offset:0
    ds_read_b64_tr_b16 v[170:171], v221 offset:4096
    v_mfma_f32_16x16x32_bf16 v[68:71], v[140:143], a[136:139], v[68:71]
    v_mfma_f32_16x16x32_bf16 v[100:103], v[136:139], a[132:135], v[100:103]
    ds_read_b64_tr_b16 v[172:173], v221 offset:8192
    ds_read_b64_tr_b16 v[174:175], v221 offset:12288
    v_mfma_f32_16x16x32_bf16 v[100:103], v[140:143], a[140:143], v[100:103]
    s_waitcnt lgkmcnt(12)
    buffer_load_dwordx4 v243, s[8:11], s58 offen offset:1024 lds
    v_mfma_f32_16x16x32_bf16 v[72:75], v[144:147], a[128:131], v[72:75]
    s_add_u32 s59, s65, 28672
    ds_read_b64_tr_b16 v[176:177], v222 offset:0
    ds_read_b64_tr_b16 v[178:179], v222 offset:4096
    v_mfma_f32_16x16x32_bf16 v[72:75], v[148:151], a[136:139], v[72:75]
    v_mfma_f32_16x16x32_bf16 v[104:107], v[144:147], a[132:135], v[104:107]
    ds_read_b64_tr_b16 v[180:181], v222 offset:8192
    ds_read_b64_tr_b16 v[182:183], v222 offset:12288
    v_mfma_f32_16x16x32_bf16 v[104:107], v[148:151], a[140:143], v[104:107]
    s_waitcnt lgkmcnt(12)
    buffer_load_dwordx4 a[208:211], v196, s[20:23], s59 offen offset:0 sc1
    v_mfma_f32_16x16x32_bf16 v[76:79], v[152:155], a[128:131], v[76:79]
    ds_read_b64_tr_b16 v[184:185], v223 offset:0
    ds_read_b64_tr_b16 v[186:187], v223 offset:4096
    v_mfma_f32_16x16x32_bf16 v[76:79], v[156:159], a[136:139], v[76:79]
    v_mfma_f32_16x16x32_bf16 v[108:111], v[152:155], a[132:135], v[108:111]
    ds_read_b64_tr_b16 v[188:189], v223 offset:8192
    ds_read_b64_tr_b16 v[190:191], v223 offset:12288
    v_mfma_f32_16x16x32_bf16 v[108:111], v[156:159], a[140:143], v[108:111]
    s_waitcnt lgkmcnt(12)
    buffer_load_dwordx4 a[212:215], v198, s[20:23], s59 offen offset:0 sc1
    v_mfma_f32_16x16x32_bf16 v[80:83], v[160:163], a[128:131], v[80:83]
    s_waitcnt vmcnt(27)
    s_barrier
    ds_read_b64_tr_b16 v[128:129], v216 offset:16384
    ds_read_b64_tr_b16 v[130:131], v216 offset:20480
    v_mfma_f32_16x16x32_bf16 v[80:83], v[164:167], a[136:139], v[80:83]
    ds_read_b64_tr_b16 v[132:133], v216 offset:24576
    ds_read_b64_tr_b16 v[134:135], v216 offset:28672
    v_mfma_f32_16x16x32_bf16 v[112:115], v[160:163], a[132:135], v[112:115]
    ds_read_b64_tr_b16 v[136:137], v217 offset:16384
    ds_read_b64_tr_b16 v[138:139], v217 offset:20480
    v_mfma_f32_16x16x32_bf16 v[112:115], v[164:167], a[140:143], v[112:115]
    s_waitcnt lgkmcnt(14)
    ds_read_b64_tr_b16 v[140:141], v217 offset:24576
    ds_read_b64_tr_b16 v[142:143], v217 offset:28672
    v_mfma_f32_16x16x32_bf16 v[84:87], v[168:171], a[128:131], v[84:87]
    ds_read_b64_tr_b16 v[144:145], v218 offset:16384
    ds_read_b64_tr_b16 v[146:147], v218 offset:20480
    v_mfma_f32_16x16x32_bf16 v[84:87], v[172:175], a[136:139], v[84:87]
    ds_read_b64_tr_b16 v[148:149], v218 offset:24576
    ds_read_b64_tr_b16 v[150:151], v218 offset:28672
    v_mfma_f32_16x16x32_bf16 v[116:119], v[168:171], a[132:135], v[116:119]
    ds_read_b64_tr_b16 v[152:153], v219 offset:16384
    ds_read_b64_tr_b16 v[154:155], v219 offset:20480
    v_mfma_f32_16x16x32_bf16 v[116:119], v[172:175], a[140:143], v[116:119]
    s_waitcnt lgkmcnt(15)
    ds_read_b64_tr_b16 v[156:157], v219 offset:24576
    ds_read_b64_tr_b16 v[158:159], v219 offset:28672
    v_mfma_f32_16x16x32_bf16 v[88:91], v[176:179], a[128:131], v[88:91]
    ds_read_b64_tr_b16 v[160:161], v220 offset:16384
    ds_read_b64_tr_b16 v[162:163], v220 offset:20480
    v_mfma_f32_16x16x32_bf16 v[88:91], v[180:183], a[136:139], v[88:91]
    buffer_load_dwordx4 a[216:219], v196, s[20:23], s59 offen offset:1024 sc1
    v_mfma_f32_16x16x32_bf16 v[120:123], v[176:179], a[132:135], v[120:123]
    ds_read_b64_tr_b16 v[164:165], v220 offset:24576
    ds_read_b64_tr_b16 v[166:167], v220 offset:28672
    v_mfma_f32_16x16x32_bf16 v[120:123], v[180:183], a[140:143], v[120:123]
    s_waitcnt lgkmcnt(15)
    buffer_load_dwordx4 a[220:223], v198, s[20:23], s59 offen offset:1024 sc1
    v_mfma_f32_16x16x32_bf16 v[92:95], v[184:187], a[128:131], v[92:95]
    s_add_u32 m0, s51, 0
    ds_read_b64_tr_b16 v[168:169], v221 offset:16384
    ds_read_b64_tr_b16 v[170:171], v221 offset:20480
    v_mfma_f32_16x16x32_bf16 v[92:95], v[188:191], a[136:139], v[92:95]
    s_add_u32 s58, s49, 983040
    v_mfma_f32_16x16x32_bf16 v[124:127], v[184:187], a[132:135], v[124:127]
    ds_read_b64_tr_b16 v[172:173], v221 offset:24576
    ds_read_b64_tr_b16 v[174:175], v221 offset:28672
    v_mfma_f32_16x16x32_bf16 v[124:127], v[188:191], a[140:143], v[124:127]
    buffer_load_dwordx4 v242, s[8:11], s58 offen lds
    v_mfma_f32_16x16x32_bf16 v[96:99], v[128:131], a[148:151], v[96:99]
    ds_read_b64_tr_b16 v[176:177], v222 offset:16384
    ds_read_b64_tr_b16 v[178:179], v222 offset:20480
    v_mfma_f32_16x16x32_bf16 v[96:99], v[132:135], a[156:159], v[96:99]
    s_waitcnt lgkmcnt(15)
    buffer_load_dwordx4 v243, s[8:11], s58 offen offset:1024 lds
    v_mfma_f32_16x16x32_bf16 v[100:103], v[136:139], a[148:151], v[100:103]
    s_add_u32 m0, s51, 8192
    ds_read_b64_tr_b16 v[180:181], v222 offset:24576
    ds_read_b64_tr_b16 v[182:183], v222 offset:28672
    v_mfma_f32_16x16x32_bf16 v[100:103], v[140:143], a[156:159], v[100:103]
    s_waitcnt lgkmcnt(15)
    s_add_u32 s58, s49, 1015808
    v_mfma_f32_16x16x32_bf16 v[104:107], v[144:147], a[148:151], v[104:107]
    ds_read_b64_tr_b16 v[184:185], v223 offset:16384
    ds_read_b64_tr_b16 v[186:187], v223 offset:20480
    v_mfma_f32_16x16x32_bf16 v[104:107], v[148:151], a[156:159], v[104:107]
    s_waitcnt lgkmcnt(14)
    buffer_load_dwordx4 v242, s[8:11], s58 offen lds
    v_mfma_f32_16x16x32_bf16 v[108:111], v[152:155], a[148:151], v[108:111]
    ds_read_b64_tr_b16 v[188:189], v223 offset:24576
    ds_read_b64_tr_b16 v[190:191], v223 offset:28672
    v_mfma_f32_16x16x32_bf16 v[108:111], v[156:159], a[156:159], v[108:111]
    s_waitcnt lgkmcnt(12)
    v_mfma_f32_16x16x32_bf16 v[80:83], v[160:163], a[144:147], v[80:83]
    ds_read_b64_tr_b16 v[128:129], v216 offset:32768
    ds_read_b64_tr_b16 v[130:131], v216 offset:36864
    v_mfma_f32_16x16x32_bf16 v[80:83], v[164:167], a[152:155], v[80:83]
    ds_read_b64_tr_b16 v[132:133], v216 offset:40960
    ds_read_b64_tr_b16 v[134:135], v216 offset:45056
    v_mfma_f32_16x16x32_bf16 v[112:115], v[160:163], a[148:151], v[112:115]
    ds_read_b64_tr_b16 v[136:137], v217 offset:32768
    ds_read_b64_tr_b16 v[138:139], v217 offset:36864
    v_mfma_f32_16x16x32_bf16 v[112:115], v[164:167], a[156:159], v[112:115]
    s_waitcnt lgkmcnt(14)
    ds_read_b64_tr_b16 v[140:141], v217 offset:40960
    ds_read_b64_tr_b16 v[142:143], v217 offset:45056
    v_mfma_f32_16x16x32_bf16 v[84:87], v[168:171], a[144:147], v[84:87]
    ds_read_b64_tr_b16 v[144:145], v218 offset:32768
    ds_read_b64_tr_b16 v[146:147], v218 offset:36864
    v_mfma_f32_16x16x32_bf16 v[84:87], v[172:175], a[152:155], v[84:87]
    ds_read_b64_tr_b16 v[148:149], v218 offset:40960
    ds_read_b64_tr_b16 v[150:151], v218 offset:45056
    v_mfma_f32_16x16x32_bf16 v[116:119], v[168:171], a[148:151], v[116:119]
    ds_read_b64_tr_b16 v[152:153], v219 offset:32768
    ds_read_b64_tr_b16 v[154:155], v219 offset:36864
    v_mfma_f32_16x16x32_bf16 v[116:119], v[172:175], a[156:159], v[116:119]
    s_waitcnt lgkmcnt(15)
    ds_read_b64_tr_b16 v[156:157], v219 offset:40960
    ds_read_b64_tr_b16 v[158:159], v219 offset:45056
    v_mfma_f32_16x16x32_bf16 v[88:91], v[176:179], a[144:147], v[88:91]
    ds_read_b64_tr_b16 v[160:161], v220 offset:32768
    ds_read_b64_tr_b16 v[162:163], v220 offset:36864
    v_mfma_f32_16x16x32_bf16 v[88:91], v[180:183], a[152:155], v[88:91]
    buffer_load_dwordx4 v243, s[8:11], s58 offen offset:1024 lds
    v_mfma_f32_16x16x32_bf16 v[120:123], v[176:179], a[148:151], v[120:123]
    s_add_u32 s59, s65, 30720
    ds_read_b64_tr_b16 v[164:165], v220 offset:40960
    ds_read_b64_tr_b16 v[166:167], v220 offset:45056
    v_mfma_f32_16x16x32_bf16 v[120:123], v[180:183], a[156:159], v[120:123]
    s_waitcnt lgkmcnt(15)
    buffer_load_dwordx4 a[224:227], v196, s[20:23], s59 offen offset:0 sc1
    v_mfma_f32_16x16x32_bf16 v[92:95], v[184:187], a[144:147], v[92:95]
    ds_read_b64_tr_b16 v[168:169], v221 offset:32768
    ds_read_b64_tr_b16 v[170:171], v221 offset:36864
    v_mfma_f32_16x16x32_bf16 v[92:95], v[188:191], a[152:155], v[92:95]
    buffer_load_dwordx4 a[228:231], v198, s[20:23], s59 offen offset:0 sc1
    v_mfma_f32_16x16x32_bf16 v[124:127], v[184:187], a[148:151], v[124:127]
    s_waitcnt vmcnt(31)
    ds_read_b64_tr_b16 v[172:173], v221 offset:40960
    ds_read_b64_tr_b16 v[174:175], v221 offset:45056
    v_mfma_f32_16x16x32_bf16 v[124:127], v[188:191], a[156:159], v[124:127]
    buffer_load_dwordx4 a[232:235], v196, s[20:23], s59 offen offset:1024 sc1
    v_mfma_f32_16x16x32_bf16 v[96:99], v[128:131], a[164:167], v[96:99]
    ds_read_b64_tr_b16 v[176:177], v222 offset:32768
    ds_read_b64_tr_b16 v[178:179], v222 offset:36864
    v_mfma_f32_16x16x32_bf16 v[96:99], v[132:135], a[172:175], v[96:99]
    s_waitcnt lgkmcnt(15)
    buffer_load_dwordx4 a[236:239], v198, s[20:23], s59 offen offset:1024 sc1
    v_mfma_f32_16x16x32_bf16 v[100:103], v[136:139], a[164:167], v[100:103]
    ds_read_b64_tr_b16 v[180:181], v222 offset:40960
    ds_read_b64_tr_b16 v[182:183], v222 offset:45056
    v_mfma_f32_16x16x32_bf16 v[100:103], v[140:143], a[172:175], v[100:103]
    s_waitcnt lgkmcnt(15)
    v_mfma_f32_16x16x32_bf16 v[104:107], v[144:147], a[164:167], v[104:107]
    ds_read_b64_tr_b16 v[184:185], v223 offset:32768
    ds_read_b64_tr_b16 v[186:187], v223 offset:36864
    v_mfma_f32_16x16x32_bf16 v[104:107], v[148:151], a[172:175], v[104:107]
    s_waitcnt lgkmcnt(14)
    v_mfma_f32_16x16x32_bf16 v[108:111], v[152:155], a[164:167], v[108:111]
    ds_read_b64_tr_b16 v[188:189], v223 offset:40960
    ds_read_b64_tr_b16 v[190:191], v223 offset:45056
    v_mfma_f32_16x16x32_bf16 v[108:111], v[156:159], a[172:175], v[108:111]
    s_waitcnt lgkmcnt(12)
    v_mfma_f32_16x16x32_bf16 v[80:83], v[160:163], a[160:163], v[80:83]
    s_waitcnt vmcnt(20)
    s_barrier
    ds_read_b64_tr_b16 v[128:129], v216 offset:49152
    ds_read_b64_tr_b16 v[130:131], v216 offset:53248
    v_mfma_f32_16x16x32_bf16 v[80:83], v[164:167], a[168:171], v[80:83]
    ds_read_b64_tr_b16 v[132:133], v216 offset:57344
    ds_read_b64_tr_b16 v[134:135], v216 offset:61440
    v_mfma_f32_16x16x32_bf16 v[112:115], v[160:163], a[164:167], v[112:115]
    ds_read_b64_tr_b16 v[136:137], v217 offset:49152
    ds_read_b64_tr_b16 v[138:139], v217 offset:53248
    v_mfma_f32_16x16x32_bf16 v[112:115], v[164:167], a[172:175], v[112:115]
    s_waitcnt lgkmcnt(14)
    ds_read_b64_tr_b16 v[140:141], v217 offset:57344
    ds_read_b64_tr_b16 v[142:143], v217 offset:61440
    v_mfma_f32_16x16x32_bf16 v[84:87], v[168:171], a[160:163], v[84:87]
    ds_read_b64_tr_b16 v[144:145], v218 offset:49152
    ds_read_b64_tr_b16 v[146:147], v218 offset:53248
    v_mfma_f32_16x16x32_bf16 v[84:87], v[172:175], a[168:171], v[84:87]
    ds_read_b64_tr_b16 v[148:149], v218 offset:57344
    ds_read_b64_tr_b16 v[150:151], v218 offset:61440
    v_mfma_f32_16x16x32_bf16 v[116:119], v[168:171], a[164:167], v[116:119]
    ds_read_b64_tr_b16 v[152:153], v219 offset:49152
    ds_read_b64_tr_b16 v[154:155], v219 offset:53248
    v_mfma_f32_16x16x32_bf16 v[116:119], v[172:175], a[172:175], v[116:119]
    s_waitcnt lgkmcnt(15)
    ds_read_b64_tr_b16 v[156:157], v219 offset:57344
    ds_read_b64_tr_b16 v[158:159], v219 offset:61440
    v_mfma_f32_16x16x32_bf16 v[88:91], v[176:179], a[160:163], v[88:91]
    ds_read_b64_tr_b16 v[160:161], v220 offset:49152
    ds_read_b64_tr_b16 v[162:163], v220 offset:53248
    v_mfma_f32_16x16x32_bf16 v[88:91], v[180:183], a[168:171], v[88:91]
    v_mfma_f32_16x16x32_bf16 v[120:123], v[176:179], a[164:167], v[120:123]
    ds_read_b64_tr_b16 v[164:165], v220 offset:57344
    ds_read_b64_tr_b16 v[166:167], v220 offset:61440
    v_mfma_f32_16x16x32_bf16 v[120:123], v[180:183], a[172:175], v[120:123]
    s_waitcnt lgkmcnt(15)
    v_mfma_f32_16x16x32_bf16 v[92:95], v[184:187], a[160:163], v[92:95]
    ds_read_b64_tr_b16 v[168:169], v221 offset:49152
    ds_read_b64_tr_b16 v[170:171], v221 offset:53248
    v_mfma_f32_16x16x32_bf16 v[92:95], v[188:191], a[168:171], v[92:95]
    v_mfma_f32_16x16x32_bf16 v[124:127], v[184:187], a[164:167], v[124:127]
    ds_read_b64_tr_b16 v[172:173], v221 offset:57344
    ds_read_b64_tr_b16 v[174:175], v221 offset:61440
    v_mfma_f32_16x16x32_bf16 v[124:127], v[188:191], a[172:175], v[124:127]
    v_mfma_f32_16x16x32_bf16 v[96:99], v[128:131], a[180:183], v[96:99]
    ds_read_b64_tr_b16 v[176:177], v222 offset:49152
    ds_read_b64_tr_b16 v[178:179], v222 offset:53248
    v_mfma_f32_16x16x32_bf16 v[96:99], v[132:135], a[188:191], v[96:99]
    s_waitcnt lgkmcnt(15)
    buffer_load_dword v250, v247, s[20:23], s94 offen offset:4 sc1
    v_mfma_f32_16x16x32_bf16 v[100:103], v[136:139], a[180:183], v[100:103]
    ds_read_b64_tr_b16 v[180:181], v222 offset:57344
    ds_read_b64_tr_b16 v[182:183], v222 offset:61440
    v_mfma_f32_16x16x32_bf16 v[100:103], v[140:143], a[188:191], v[100:103]
    s_waitcnt lgkmcnt(15)
    v_mfma_f32_16x16x32_bf16 v[104:107], v[144:147], a[180:183], v[104:107]
    ds_read_b64_tr_b16 v[184:185], v223 offset:49152
    ds_read_b64_tr_b16 v[186:187], v223 offset:53248
    v_mfma_f32_16x16x32_bf16 v[104:107], v[148:151], a[188:191], v[104:107]
    s_waitcnt lgkmcnt(14)
    v_mfma_f32_16x16x32_bf16 v[108:111], v[152:155], a[180:183], v[108:111]
    ds_read_b64_tr_b16 v[188:189], v223 offset:57344
    ds_read_b64_tr_b16 v[190:191], v223 offset:61440
    v_mfma_f32_16x16x32_bf16 v[108:111], v[156:159], a[188:191], v[108:111]
    s_waitcnt lgkmcnt(12)
    v_mfma_f32_16x16x32_bf16 v[80:83], v[160:163], a[176:179], v[80:83]
    ds_read_b64_tr_b16 v[128:129], v224 offset:0
    ds_read_b64_tr_b16 v[130:131], v224 offset:4096
    v_mfma_f32_16x16x32_bf16 v[80:83], v[164:167], a[184:187], v[80:83]
    ds_read_b64_tr_b16 v[132:133], v224 offset:8192
    ds_read_b64_tr_b16 v[134:135], v224 offset:12288
    v_mfma_f32_16x16x32_bf16 v[112:115], v[160:163], a[180:183], v[112:115]
    ds_read_b64_tr_b16 v[136:137], v225 offset:0
    ds_read_b64_tr_b16 v[138:139], v225 offset:4096
    v_mfma_f32_16x16x32_bf16 v[112:115], v[164:167], a[188:191], v[112:115]
    s_waitcnt lgkmcnt(14)
    ds_read_b64_tr_b16 v[140:141], v225 offset:8192
    ds_read_b64_tr_b16 v[142:143], v225 offset:12288
    v_mfma_f32_16x16x32_bf16 v[84:87], v[168:171], a[176:179], v[84:87]
    ds_read_b64_tr_b16 v[144:145], v226 offset:0
    ds_read_b64_tr_b16 v[146:147], v226 offset:4096
    v_mfma_f32_16x16x32_bf16 v[84:87], v[172:175], a[184:187], v[84:87]
    ds_read_b64_tr_b16 v[148:149], v226 offset:8192
    ds_read_b64_tr_b16 v[150:151], v226 offset:12288
    v_mfma_f32_16x16x32_bf16 v[116:119], v[168:171], a[180:183], v[116:119]
    ds_read_b64_tr_b16 v[152:153], v227 offset:0
    ds_read_b64_tr_b16 v[154:155], v227 offset:4096
    v_mfma_f32_16x16x32_bf16 v[116:119], v[172:175], a[188:191], v[116:119]
    s_waitcnt lgkmcnt(15)
    ds_read_b64_tr_b16 v[156:157], v227 offset:8192
    ds_read_b64_tr_b16 v[158:159], v227 offset:12288
    v_mfma_f32_16x16x32_bf16 v[88:91], v[176:179], a[176:179], v[88:91]
    ds_read_b64_tr_b16 v[160:161], v228 offset:0
    ds_read_b64_tr_b16 v[162:163], v228 offset:4096
    v_mfma_f32_16x16x32_bf16 v[88:91], v[180:183], a[184:187], v[88:91]
    v_mfma_f32_16x16x32_bf16 v[120:123], v[176:179], a[180:183], v[120:123]
    ds_read_b64_tr_b16 v[164:165], v228 offset:8192
    ds_read_b64_tr_b16 v[166:167], v228 offset:12288
    v_mfma_f32_16x16x32_bf16 v[120:123], v[180:183], a[188:191], v[120:123]
    s_waitcnt lgkmcnt(15)
    v_mfma_f32_16x16x32_bf16 v[92:95], v[184:187], a[176:179], v[92:95]
    ds_read_b64_tr_b16 v[168:169], v229 offset:0
    ds_read_b64_tr_b16 v[170:171], v229 offset:4096
    v_mfma_f32_16x16x32_bf16 v[92:95], v[188:191], a[184:187], v[92:95]
    v_mfma_f32_16x16x32_bf16 v[124:127], v[184:187], a[180:183], v[124:127]
    s_waitcnt vmcnt(17)
    ds_read_b64_tr_b16 v[172:173], v229 offset:8192
    ds_read_b64_tr_b16 v[174:175], v229 offset:12288
    v_mfma_f32_16x16x32_bf16 v[124:127], v[188:191], a[188:191], v[124:127]
    v_mfma_f32_16x16x32_bf16 v[96:99], v[128:131], a[196:199], v[96:99]
    ds_read_b64_tr_b16 v[176:177], v230 offset:0
    ds_read_b64_tr_b16 v[178:179], v230 offset:4096
    v_mfma_f32_16x16x32_bf16 v[96:99], v[132:135], a[204:207], v[96:99]
    s_waitcnt lgkmcnt(15)
    v_mfma_f32_16x16x32_bf16 v[100:103], v[136:139], a[196:199], v[100:103]
    ds_read_b64_tr_b16 v[180:181], v230 offset:8192
    ds_read_b64_tr_b16 v[182:183], v230 offset:12288
    v_mfma_f32_16x16x32_bf16 v[100:103], v[140:143], a[204:207], v[100:103]
    s_waitcnt lgkmcnt(15)
    v_mfma_f32_16x16x32_bf16 v[104:107], v[144:147], a[196:199], v[104:107]
    ds_read_b64_tr_b16 v[184:185], v231 offset:0
    ds_read_b64_tr_b16 v[186:187], v231 offset:4096
    v_mfma_f32_16x16x32_bf16 v[104:107], v[148:151], a[204:207], v[104:107]
    s_waitcnt lgkmcnt(14)
    v_mfma_f32_16x16x32_bf16 v[108:111], v[152:155], a[196:199], v[108:111]
    ds_read_b64_tr_b16 v[188:189], v231 offset:8192
    ds_read_b64_tr_b16 v[190:191], v231 offset:12288
    v_mfma_f32_16x16x32_bf16 v[108:111], v[156:159], a[204:207], v[108:111]
    s_waitcnt lgkmcnt(12)
    v_mfma_f32_16x16x32_bf16 v[80:83], v[160:163], a[192:195], v[80:83]
    s_waitcnt vmcnt(5)
    s_barrier
    ds_read_b64_tr_b16 v[128:129], v224 offset:16384
    ds_read_b64_tr_b16 v[130:131], v224 offset:20480
    v_mfma_f32_16x16x32_bf16 v[80:83], v[164:167], a[200:203], v[80:83]
    ds_read_b64_tr_b16 v[132:133], v224 offset:24576
    ds_read_b64_tr_b16 v[134:135], v224 offset:28672
    v_mfma_f32_16x16x32_bf16 v[112:115], v[160:163], a[196:199], v[112:115]
    s_waitcnt vmcnt(0)
    ds_read_b64_tr_b16 v[136:137], v225 offset:16384
    ds_read_b64_tr_b16 v[138:139], v225 offset:20480
    v_cmp_ne_u32 vcc, 1, v250
    v_mfma_f32_16x16x32_bf16 v[112:115], v[164:167], a[204:207], v[112:115]
    s_waitcnt lgkmcnt(14)
    ds_read_b64_tr_b16 v[140:141], v225 offset:24576
    ds_read_b64_tr_b16 v[142:143], v225 offset:28672
    s_cbranch_vccnz L_gwait
L_gok:
    v_mfma_f32_16x16x32_bf16 v[84:87], v[168:171], a[192:195], v[84:87]
    ds_read_b64_tr_b16 v[144:145], v226 offset:16384
    ds_read_b64_tr_b16 v[146:147], v226 offset:20480
    v_mfma_f32_16x16x32_bf16 v[84:87], v[172:175], a[200:203], v[84:87]
    ds_read_b64_tr_b16 v[148:149], v226 offset:24576
    ds_read_b64_tr_b16 v[150:151], v226 offset:28672
    buffer_load_dwordx4 v[16:19], v240, s[20:23], s40 offen offset:0 sc1
    v_mfma_f32_16x16x32_bf16 v[116:119], v[168:171], a[196:199], v[116:119]
    ds_read_b64_tr_b16 v[152:153], v227 offset:16384
    ds_read_b64_tr_b16 v[154:155], v227 offset:20480
    v_mfma_f32_16x16x32_bf16 v[116:119], v[172:175], a[204:207], v[116:119]
    s_waitcnt lgkmcnt(15)
    ds_read_b64_tr_b16 v[156:157], v227 offset:24576
    ds_read_b64_tr_b16 v[158:159], v227 offset:28672
    buffer_load_dwordx4 v[20:23], v240, s[20:23], s40 offen offset:1024 sc1
    v_mfma_f32_16x16x32_bf16 v[88:91], v[176:179], a[192:195], v[88:91]
    ds_read_b64_tr_b16 v[160:161], v228 offset:16384
    ds_read_b64_tr_b16 v[162:163], v228 offset:20480
    v_mfma_f32_16x16x32_bf16 v[88:91], v[180:183], a[200:203], v[88:91]
    buffer_load_dwordx4 v[24:27], v236, s[20:23], s40 offen offset:0 sc1
    v_mfma_f32_16x16x32_bf16 v[120:123], v[176:179], a[196:199], v[120:123]
    ds_read_b64_tr_b16 v[164:165], v228 offset:24576
    ds_read_b64_tr_b16 v[166:167], v228 offset:28672
    v_mfma_f32_16x16x32_bf16 v[120:123], v[180:183], a[204:207], v[120:123]
    s_waitcnt lgkmcnt(15)
    buffer_load_dwordx4 v[28:31], v236, s[20:23], s40 offen offset:1024 sc1
    v_mfma_f32_16x16x32_bf16 v[92:95], v[184:187], a[192:195], v[92:95]
    ds_read_b64_tr_b16 v[168:169], v229 offset:16384
    ds_read_b64_tr_b16 v[170:171], v229 offset:20480
    v_mfma_f32_16x16x32_bf16 v[92:95], v[188:191], a[200:203], v[92:95]
    buffer_load_dwordx4 v[32:35], v237, s[20:23], s40 offen offset:0 sc1
    v_mfma_f32_16x16x32_bf16 v[124:127], v[184:187], a[196:199], v[124:127]
    ds_read_b64_tr_b16 v[172:173], v229 offset:24576
    ds_read_b64_tr_b16 v[174:175], v229 offset:28672
    v_mfma_f32_16x16x32_bf16 v[124:127], v[188:191], a[204:207], v[124:127]
    buffer_load_dwordx4 v[36:39], v237, s[20:23], s40 offen offset:1024 sc1
    v_mfma_f32_16x16x32_bf16 v[96:99], v[128:131], a[212:215], v[96:99]
    ds_read_b64_tr_b16 v[176:177], v230 offset:16384
    ds_read_b64_tr_b16 v[178:179], v230 offset:20480
    v_mfma_f32_16x16x32_bf16 v[96:99], v[132:135], a[220:223], v[96:99]
    s_waitcnt lgkmcnt(15)
    v_mfma_f32_16x16x32_bf16 v[100:103], v[136:139], a[212:215], v[100:103]
    ds_read_b64_tr_b16 v[180:181], v230 offset:24576
    ds_read_b64_tr_b16 v[182:183], v230 offset:28672
    v_mfma_f32_16x16x32_bf16 v[100:103], v[140:143], a[220:223], v[100:103]
    s_waitcnt lgkmcnt(15)
    v_mfma_f32_16x16x32_bf16 v[104:107], v[144:147], a[212:215], v[104:107]
    ds_read_b64_tr_b16 v[184:185], v231 offset:16384
    ds_read_b64_tr_b16 v[186:187], v231 offset:20480
    v_mfma_f32_16x16x32_bf16 v[104:107], v[148:151], a[220:223], v[104:107]
    s_waitcnt lgkmcnt(14)
    v_mfma_f32_16x16x32_bf16 v[108:111], v[152:155], a[212:215], v[108:111]
    ds_read_b64_tr_b16 v[188:189], v231 offset:24576
    ds_read_b64_tr_b16 v[190:191], v231 offset:28672
    v_mfma_f32_16x16x32_bf16 v[108:111], v[156:159], a[220:223], v[108:111]
    s_waitcnt lgkmcnt(12)
    v_mfma_f32_16x16x32_bf16 v[80:83], v[160:163], a[208:211], v[80:83]
    ds_read_b64_tr_b16 v[128:129], v208 offset:0
    ds_read_b64_tr_b16 v[130:131], v208 offset:4096
    v_mfma_f32_16x16x32_bf16 v[80:83], v[164:167], a[216:219], v[80:83]
    ds_read_b64_tr_b16 v[132:133], v208 offset:8192
    ds_read_b64_tr_b16 v[134:135], v208 offset:12288
    v_mfma_f32_16x16x32_bf16 v[112:115], v[160:163], a[212:215], v[112:115]
    ds_read_b64_tr_b16 v[136:137], v209 offset:0
    ds_read_b64_tr_b16 v[138:139], v209 offset:4096
    v_mfma_f32_16x16x32_bf16 v[112:115], v[164:167], a[220:223], v[112:115]
    s_waitcnt lgkmcnt(14)
    ds_read_b64_tr_b16 v[140:141], v209 offset:8192
    ds_read_b64_tr_b16 v[142:143], v209 offset:12288
    v_mfma_f32_16x16x32_bf16 v[84:87], v[168:171], a[208:211], v[84:87]
    ds_read_b64_tr_b16 v[144:145], v210 offset:0
    ds_read_b64_tr_b16 v[146:147], v210 offset:4096
    v_mfma_f32_16x16x32_bf16 v[84:87], v[172:175], a[216:219], v[84:87]
    ds_read_b64_tr_b16 v[148:149], v210 offset:8192
    ds_read_b64_tr_b16 v[150:151], v210 offset:12288
    v_mfma_f32_16x16x32_bf16 v[116:119], v[168:171], a[212:215], v[116:119]
    ds_read_b64_tr_b16 v[152:153], v211 offset:0
    ds_read_b64_tr_b16 v[154:155], v211 offset:4096
    v_mfma_f32_16x16x32_bf16 v[116:119], v[172:175], a[220:223], v[116:119]
    s_waitcnt lgkmcnt(15)
    ds_read_b64_tr_b16 v[156:157], v211 offset:8192
    ds_read_b64_tr_b16 v[158:159], v211 offset:12288
    v_mfma_f32_16x16x32_bf16 v[88:91], v[176:179], a[208:211], v[88:91]
    ds_read_b64_tr_b16 v[160:161], v212 offset:0
    ds_read_b64_tr_b16 v[162:163], v212 offset:4096
    v_mfma_f32_16x16x32_bf16 v[88:91], v[180:183], a[216:219], v[88:91]
    v_mfma_f32_16x16x32_bf16 v[120:123], v[176:179], a[212:215], v[120:123]
    ds_read_b64_tr_b16 v[164:165], v212 offset:8192
    ds_read_b64_tr_b16 v[166:167], v212 offset:12288
    v_mfma_f32_16x16x32_bf16 v[120:123], v[180:183], a[220:223], v[120:123]
    s_waitcnt lgkmcnt(15)
    v_mfma_f32_16x16x32_bf16 v[92:95], v[184:187], a[208:211], v[92:95]
    ds_read_b64_tr_b16 v[168:169], v213 offset:0
    ds_read_b64_tr_b16 v[170:171], v213 offset:4096
    v_mfma_f32_16x16x32_bf16 v[92:95], v[188:191], a[216:219], v[92:95]
    v_mfma_f32_16x16x32_bf16 v[124:127], v[184:187], a[212:215], v[124:127]
    ds_read_b64_tr_b16 v[172:173], v213 offset:8192
    ds_read_b64_tr_b16 v[174:175], v213 offset:12288
    v_mfma_f32_16x16x32_bf16 v[124:127], v[188:191], a[220:223], v[124:127]
    v_mfma_f32_16x16x32_bf16 v[96:99], v[128:131], a[228:231], v[96:99]
    ds_read_b64_tr_b16 v[176:177], v214 offset:0
    ds_read_b64_tr_b16 v[178:179], v214 offset:4096
    v_mfma_f32_16x16x32_bf16 v[96:99], v[132:135], a[236:239], v[96:99]
    s_waitcnt lgkmcnt(15)
    v_mfma_f32_16x16x32_bf16 v[100:103], v[136:139], a[228:231], v[100:103]
    ds_read_b64_tr_b16 v[180:181], v214 offset:8192
    ds_read_b64_tr_b16 v[182:183], v214 offset:12288
    v_mfma_f32_16x16x32_bf16 v[100:103], v[140:143], a[236:239], v[100:103]
    s_waitcnt lgkmcnt(15)
    v_mfma_f32_16x16x32_bf16 v[104:107], v[144:147], a[228:231], v[104:107]
    ds_read_b64_tr_b16 v[184:185], v215 offset:0
    ds_read_b64_tr_b16 v[186:187], v215 offset:4096
    v_mfma_f32_16x16x32_bf16 v[104:107], v[148:151], a[236:239], v[104:107]
    s_waitcnt lgkmcnt(14)
    v_mfma_f32_16x16x32_bf16 v[108:111], v[152:155], a[228:231], v[108:111]
    ds_read_b64_tr_b16 v[188:189], v215 offset:8192
    ds_read_b64_tr_b16 v[190:191], v215 offset:12288
    v_mfma_f32_16x16x32_bf16 v[108:111], v[156:159], a[236:239], v[108:111]
    s_waitcnt lgkmcnt(12)
    v_mfma_f32_16x16x32_bf16 v[80:83], v[160:163], a[224:227], v[80:83]
    ds_read_b64_tr_b16 v[128:129], v216 offset:16384
    ds_read_b64_tr_b16 v[130:131], v216 offset:20480
    v_mfma_f32_16x16x32_bf16 v[80:83], v[164:167], a[232:235], v[80:83]
    ds_read_b64_tr_b16 v[132:133], v216 offset:24576
    ds_read_b64_tr_b16 v[134:135], v216 offset:28672
    v_cvt_pk_bf16_f32 v96, v96, v97
    v_cvt_pk_bf16_f32 v97, v98, v99
    v_mfma_f32_16x16x32_bf16 v[112:115], v[160:163], a[228:231], v[112:115]
    ds_read_b64_tr_b16 v[136:137], v216 offset:32768
    ds_read_b64_tr_b16 v[138:139], v216 offset:36864
    v_cvt_pk_bf16_f32 v98, v100, v101
    v_cvt_pk_bf16_f32 v99, v102, v103
    v_mfma_f32_16x16x32_bf16 v[112:115], v[164:167], a[236:239], v[112:115]
    s_waitcnt lgkmcnt(14)
    ds_read_b64_tr_b16 v[140:141], v216 offset:40960
    ds_read_b64_tr_b16 v[142:143], v216 offset:45056
    buffer_store_dwordx4 v[96:99], v240, s[20:23], s36 offen offset:2048 sc1
    v_mfma_f32_16x16x32_bf16 v[84:87], v[168:171], a[224:227], v[84:87]
    ds_read_b64_tr_b16 v[144:145], v216 offset:49152
    ds_read_b64_tr_b16 v[146:147], v216 offset:53248
    v_mfma_f32_16x16x32_bf16 v[84:87], v[172:175], a[232:235], v[84:87]
    ds_read_b64_tr_b16 v[148:149], v216 offset:57344
    ds_read_b64_tr_b16 v[150:151], v216 offset:61440
    v_cvt_pk_bf16_f32 v104, v104, v105
    v_cvt_pk_bf16_f32 v105, v106, v107
    v_mfma_f32_16x16x32_bf16 v[116:119], v[168:171], a[228:231], v[116:119]
    ds_read_b64_tr_b16 v[152:153], v224 offset:0
    ds_read_b64_tr_b16 v[154:155], v224 offset:4096
    v_cvt_pk_bf16_f32 v106, v108, v109
    v_cvt_pk_bf16_f32 v107, v110, v111
    v_mfma_f32_16x16x32_bf16 v[116:119], v[172:175], a[236:239], v[116:119]
    s_waitcnt lgkmcnt(15)
    ds_read_b64_tr_b16 v[156:157], v224 offset:8192
    ds_read_b64_tr_b16 v[158:159], v224 offset:12288
    buffer_store_dwordx4 v[104:107], v240, s[20:23], s36 offen offset:3072 sc1
    v_mfma_f32_16x16x32_bf16 v[88:91], v[176:179], a[224:227], v[88:91]
    ds_read_b64_tr_b16 v[160:161], v224 offset:16384
    ds_read_b64_tr_b16 v[162:163], v224 offset:20480
    v_mfma_f32_16x16x32_bf16 v[88:91], v[180:183], a[232:235], v[88:91]
    ds_read_b64_tr_b16 v[164:165], v224 offset:24576
    ds_read_b64_tr_b16 v[166:167], v224 offset:28672
    v_mfma_f32_16x16x32_bf16 v[120:123], v[176:179], a[228:231], v[120:123]
    ds_read_b64_tr_b16 v[168:169], v208 offset:0
    ds_read_b64_tr_b16 v[170:171], v208 offset:4096
    v_mfma_f32_16x16x32_bf16 v[120:123], v[180:183], a[236:239], v[120:123]
    s_waitcnt lgkmcnt(15)
    ds_read_b64_tr_b16 v[172:173], v208 offset:8192
    ds_read_b64_tr_b16 v[174:175], v208 offset:12288
    v_cvt_pk_bf16_f32 v80, v80, v81
    v_cvt_pk_bf16_f32 v81, v82, v83
    v_mfma_f32_16x16x32_bf16 v[92:95], v[184:187], a[224:227], v[92:95]
    ds_read_b64_tr_b16 v[176:177], v217 offset:16384
    ds_read_b64_tr_b16 v[178:179], v217 offset:20480
    v_cvt_pk_bf16_f32 v82, v84, v85
    v_cvt_pk_bf16_f32 v83, v86, v87
    v_mfma_f32_16x16x32_bf16 v[92:95], v[188:191], a[232:235], v[92:95]
    ds_read_b64_tr_b16 v[180:181], v217 offset:24576
    ds_read_b64_tr_b16 v[182:183], v217 offset:28672
    buffer_store_dwordx4 v[80:83], v240, s[20:23], s37 offen offset:2048 sc1
    v_mfma_f32_16x16x32_bf16 v[124:127], v[184:187], a[228:231], v[124:127]
    ds_read_b64_tr_b16 v[184:185], v217 offset:32768
    ds_read_b64_tr_b16 v[186:187], v217 offset:36864
    v_cvt_pk_bf16_f32 v112, v112, v113
    v_cvt_pk_bf16_f32 v113, v114, v115
    v_mfma_f32_16x16x32_bf16 v[124:127], v[188:191], a[236:239], v[124:127]
    ds_read_b64_tr_b16 v[188:189], v217 offset:40960
    ds_read_b64_tr_b16 v[190:191], v217 offset:45056
    v_cvt_pk_bf16_f32 v114, v116, v117
    v_cvt_pk_bf16_f32 v115, v118, v119
    v_mfma_f32_16x16x32_bf16 v[64:67], v[128:131], a[144:147], v[64:67]
    ds_read_b64_tr_b16 v[128:129], v217 offset:49152
    ds_read_b64_tr_b16 v[130:131], v217 offset:53248
    buffer_store_dwordx4 v[112:115], v240, s[20:23], s41 offen offset:2048 sc1
    v_mfma_f32_16x16x32_bf16 v[64:67], v[132:135], a[152:155], v[64:67]
    s_waitcnt lgkmcnt(15)
    ds_read_b64_tr_b16 v[132:133], v217 offset:57344
    ds_read_b64_tr_b16 v[134:135], v217 offset:61440
    v_mfma_f32_16x16x32_bf16 v[64:67], v[136:139], a[160:163], v[64:67]
    ds_read_b64_tr_b16 v[136:137], v225 offset:0
    ds_read_b64_tr_b16 v[138:139], v225 offset:4096
    v_mfma_f32_16x16x32_bf16 v[64:67], v[140:143], a[168:171], v[64:67]
    ds_read_b64_tr_b16 v[140:141], v225 offset:8192
    ds_read_b64_tr_b16 v[142:143], v225 offset:12288
    v_cvt_pk_bf16_f32 v88, v88, v89
    v_cvt_pk_bf16_f32 v89, v90, v91
    v_mfma_f32_16x16x32_bf16 v[64:67], v[144:147], a[176:179], v[64:67]
    ds_read_b64_tr_b16 v[144:145], v225 offset:16384
    ds_read_b64_tr_b16 v[146:147], v225 offset:20480
    v_cvt_pk_bf16_f32 v90, v92, v93
    v_cvt_pk_bf16_f32 v91, v94, v95
    v_mfma_f32_16x16x32_bf16 v[64:67], v[148:151], a[184:187], v[64:67]
    ds_read_b64_tr_b16 v[148:149], v225 offset:24576
    ds_read_b64_tr_b16 v[150:151], v225 offset:28672
    buffer_store_dwordx4 v[88:91], v240, s[20:23], s37 offen offset:3072 sc1
    v_mfma_f32_16x16x32_bf16 v[64:67], v[152:155], a[192:195], v[64:67]
    ds_read_b64_tr_b16 v[152:153], v209 offset:0
    ds_read_b64_tr_b16 v[154:155], v209 offset:4096
    v_cvt_pk_bf16_f32 v120, v120, v121
    v_cvt_pk_bf16_f32 v121, v122, v123
    v_mfma_f32_16x16x32_bf16 v[64:67], v[156:159], a[200:203], v[64:67]
    s_waitcnt lgkmcnt(15)
    ds_read_b64_tr_b16 v[156:157], v209 offset:8192
    ds_read_b64_tr_b16 v[158:159], v209 offset:12288
    v_cvt_pk_bf16_f32 v122, v124, v125
    v_cvt_pk_bf16_f32 v123, v126, v127
    v_mfma_f32_16x16x32_bf16 v[64:67], v[160:163], a[208:211], v[64:67]
    ds_read_b64_tr_b16 v[160:161], v218 offset:16384
    ds_read_b64_tr_b16 v[162:163], v218 offset:20480
    buffer_store_dwordx4 v[120:123], v240, s[20:23], s41 offen offset:3072 sc1
    v_mfma_f32_16x16x32_bf16 v[64:67], v[164:167], a[216:219], v[64:67]
    ds_read_b64_tr_b16 v[164:165], v218 offset:24576
    ds_read_b64_tr_b16 v[166:167], v218 offset:28672
    v_mfma_f32_16x16x32_bf16 v[64:67], v[168:171], a[224:227], v[64:67]
    ds_read_b64_tr_b16 v[168:169], v218 offset:32768
    ds_read_b64_tr_b16 v[170:171], v218 offset:36864
    v_mfma_f32_16x16x32_bf16 v[64:67], v[172:175], a[232:235], v[64:67]
    ds_read_b64_tr_b16 v[172:173], v218 offset:40960
    ds_read_b64_tr_b16 v[174:175], v218 offset:45056
    v_mfma_f32_16x16x32_bf16 v[68:71], v[176:179], a[144:147], v[68:71]
    ds_read_b64_tr_b16 v[176:177], v218 offset:49152
    ds_read_b64_tr_b16 v[178:179], v218 offset:53248
    v_mfma_f32_16x16x32_bf16 v[68:71], v[180:183], a[152:155], v[68:71]
    s_waitcnt lgkmcnt(15)
    ds_read_b64_tr_b16 v[180:181], v218 offset:57344
    ds_read_b64_tr_b16 v[182:183], v218 offset:61440
    v_mfma_f32_16x16x32_bf16 v[68:71], v[184:187], a[160:163], v[68:71]
    ds_read_b64_tr_b16 v[184:185], v226 offset:0
    ds_read_b64_tr_b16 v[186:187], v226 offset:4096
    v_mfma_f32_16x16x32_bf16 v[68:71], v[188:191], a[168:171], v[68:71]
    ds_read_b64_tr_b16 v[188:189], v226 offset:8192
    ds_read_b64_tr_b16 v[190:191], v226 offset:12288
    v_mfma_f32_16x16x32_bf16 v[68:71], v[128:131], a[176:179], v[68:71]
    ds_read_b64_tr_b16 v[128:129], v226 offset:16384
    ds_read_b64_tr_b16 v[130:131], v226 offset:20480
    v_mfma_f32_16x16x32_bf16 v[68:71], v[132:135], a[184:187], v[68:71]
    ds_read_b64_tr_b16 v[132:133], v226 offset:24576
    ds_read_b64_tr_b16 v[134:135], v226 offset:28672
    v_mfma_f32_16x16x32_bf16 v[68:71], v[136:139], a[192:195], v[68:71]
    ds_read_b64_tr_b16 v[136:137], v210 offset:0
    ds_read_b64_tr_b16 v[138:139], v210 offset:4096
    v_mfma_f32_16x16x32_bf16 v[68:71], v[140:143], a[200:203], v[68:71]
    s_waitcnt lgkmcnt(15)
    ds_read_b64_tr_b16 v[140:141], v210 offset:8192
    ds_read_b64_tr_b16 v[142:143], v210 offset:12288
    v_mfma_f32_16x16x32_bf16 v[68:71], v[144:147], a[208:211], v[68:71]
    ds_read_b64_tr_b16 v[144:145], v219 offset:16384
    ds_read_b64_tr_b16 v[146:147], v219 offset:20480
    v_mfma_f32_16x16x32_bf16 v[68:71], v[148:151], a[216:219], v[68:71]
    ds_read_b64_tr_b16 v[148:149], v219 offset:24576
    ds_read_b64_tr_b16 v[150:151], v219 offset:28672
    v_mfma_f32_16x16x32_bf16 v[68:71], v[152:155], a[224:227], v[68:71]
    ds_read_b64_tr_b16 v[152:153], v219 offset:32768
    ds_read_b64_tr_b16 v[154:155], v219 offset:36864
    v_mfma_f32_16x16x32_bf16 v[68:71], v[156:159], a[232:235], v[68:71]
    ds_read_b64_tr_b16 v[156:157], v219 offset:40960
    ds_read_b64_tr_b16 v[158:159], v219 offset:45056
    v_mfma_f32_16x16x32_bf16 v[72:75], v[160:163], a[144:147], v[72:75]
    ds_read_b64_tr_b16 v[160:161], v219 offset:49152
    ds_read_b64_tr_b16 v[162:163], v219 offset:53248
    v_mfma_f32_16x16x32_bf16 v[72:75], v[164:167], a[152:155], v[72:75]
    s_waitcnt lgkmcnt(15)
    ds_read_b64_tr_b16 v[164:165], v219 offset:57344
    ds_read_b64_tr_b16 v[166:167], v219 offset:61440
    v_mfma_f32_16x16x32_bf16 v[72:75], v[168:171], a[160:163], v[72:75]
    ds_read_b64_tr_b16 v[168:169], v227 offset:0
    ds_read_b64_tr_b16 v[170:171], v227 offset:4096
    v_mfma_f32_16x16x32_bf16 v[72:75], v[172:175], a[168:171], v[72:75]
    ds_read_b64_tr_b16 v[172:173], v227 offset:8192
    ds_read_b64_tr_b16 v[174:175], v227 offset:12288
    v_mfma_f32_16x16x32_bf16 v[72:75], v[176:179], a[176:179], v[72:75]
    ds_read_b64_tr_b16 v[176:177], v227 offset:16384
    ds_read_b64_tr_b16 v[178:179], v227 offset:20480
    v_mfma_f32_16x16x32_bf16 v[72:75], v[180:183], a[184:187], v[72:75]
    ds_read_b64_tr_b16 v[180:181], v227 offset:24576
    ds_read_b64_tr_b16 v[182:183], v227 offset:28672
    v_mfma_f32_16x16x32_bf16 v[72:75], v[184:187], a[192:195], v[72:75]
    ds_read_b64_tr_b16 v[184:185], v211 offset:0
    ds_read_b64_tr_b16 v[186:187], v211 offset:4096
    v_mfma_f32_16x16x32_bf16 v[72:75], v[188:191], a[200:203], v[72:75]
    s_waitcnt lgkmcnt(15)
    ds_read_b64_tr_b16 v[188:189], v211 offset:8192
    ds_read_b64_tr_b16 v[190:191], v211 offset:12288
    v_mfma_f32_16x16x32_bf16 v[72:75], v[128:131], a[208:211], v[72:75]
    v_mfma_f32_16x16x32_bf16 v[72:75], v[132:135], a[216:219], v[72:75]
    v_mfma_f32_16x16x32_bf16 v[72:75], v[136:139], a[224:227], v[72:75]
    v_mfma_f32_16x16x32_bf16 v[72:75], v[140:143], a[232:235], v[72:75]
    v_mfma_f32_16x16x32_bf16 v[76:79], v[144:147], a[144:147], v[76:79]
    v_mfma_f32_16x16x32_bf16 v[76:79], v[148:151], a[152:155], v[76:79]
    s_waitcnt lgkmcnt(15)
    v_mfma_f32_16x16x32_bf16 v[76:79], v[152:155], a[160:163], v[76:79]
    v_mfma_f32_16x16x32_bf16 v[76:79], v[156:159], a[168:171], v[76:79]
    s_waitcnt lgkmcnt(12)
    v_mfma_f32_16x16x32_bf16 v[76:79], v[160:163], a[176:179], v[76:79]
    v_mfma_f32_16x16x32_bf16 v[76:79], v[164:167], a[184:187], v[76:79]
    s_waitcnt lgkmcnt(8)
    v_mfma_f32_16x16x32_bf16 v[76:79], v[168:171], a[192:195], v[76:79]
    v_mfma_f32_16x16x32_bf16 v[76:79], v[172:175], a[200:203], v[76:79]
    s_waitcnt lgkmcnt(4)
    v_mfma_f32_16x16x32_bf16 v[76:79], v[176:179], a[208:211], v[76:79]
    v_mfma_f32_16x16x32_bf16 v[76:79], v[180:183], a[216:219], v[76:79]
    s_waitcnt lgkmcnt(0)
    v_mfma_f32_16x16x32_bf16 v[76:79], v[184:187], a[224:227], v[76:79]
    v_mfma_f32_16x16x32_bf16 v[76:79], v[188:191], a[232:235], v[76:79]
    s_nop 3
    s_mov_b32 s46, 0x00003f80
    s_mov_b32 s47, 0x3f800000
    s_mov_b32 s44, 0x40000
    s_waitcnt vmcnt(6)
    v_dot2c_f32_bf16 v0, s46, v16
    v_dot2c_f32_bf16 v1, s47, v16
    v_dot2c_f32_bf16 v2, s46, v17
    v_dot2c_f32_bf16 v3, s47, v17
    v_dot2c_f32_bf16 v4, s46, v18
    v_dot2c_f32_bf16 v5, s47, v18
    v_dot2c_f32_bf16 v6, s46, v19
    v_dot2c_f32_bf16 v7, s47, v19
    v_dot2c_f32_bf16 v8, s46, v20
    v_dot2c_f32_bf16 v9, s47, v20
    v_dot2c_f32_bf16 v10, s46, v21
    v_dot2c_f32_bf16 v11, s47, v21
    v_dot2c_f32_bf16 v12, s46, v22
    v_dot2c_f32_bf16 v13, s47, v22
    v_dot2c_f32_bf16 v14, s46, v23
    v_dot2c_f32_bf16 v15, s47, v23
    v_dot2c_f32_bf16 v0, s46, v24
    v_dot2c_f32_bf16 v1, s47, v24
    v_dot2c_f32_bf16 v2, s46, v25
    v_dot2c_f32_bf16 v3, s47, v25
    v_dot2c_f32_bf16 v4, s46, v26
    v_dot2c_f32_bf16 v5, s47, v26
    v_dot2c_f32_bf16 v6, s46, v27
    v_dot2c_f32_bf16 v7, s47, v27
    v_dot2c_f32_bf16 v8, s46, v28
    v_dot2c_f32_bf16 v9, s47, v28
    v_dot2c_f32_bf16 v10, s46, v29
    v_dot2c_f32_bf16 v11, s47, v29
    v_dot2c_f32_bf16 v12, s46, v30
    v_dot2c_f32_bf16 v13, s47, v30
    v_dot2c_f32_bf16 v14, s46, v31
    v_dot2c_f32_bf16 v15, s47, v31
    v_dot2c_f32_bf16 v0, s46, v32
    v_dot2c_f32_bf16 v1, s47, v32
    v_dot2c_f32_bf16 v2, s46, v33
    v_dot2c_f32_bf16 v3, s47, v33
    v_dot2c_f32_bf16 v4, s46, v34
    v_dot2c_f32_bf16 v5, s47, v34
    v_dot2c_f32_bf16 v6, s46, v35
    v_dot2c_f32_bf16 v7, s47, v35
    v_dot2c_f32_bf16 v8, s46, v36
    v_dot2c_f32_bf16 v9, s47, v36
    v_dot2c_f32_bf16 v10, s46, v37
    v_dot2c_f32_bf16 v11, s47, v37
    v_dot2c_f32_bf16 v12, s46, v38
    v_dot2c_f32_bf16 v13, s47, v38
    v_dot2c_f32_bf16 v14, s46, v39
    v_dot2c_f32_bf16 v15, s47, v39
    s_nop 2
    v_cvt_pk_bf16_f32 v48, v0, v1
    v_cvt_pk_bf16_f32 v49, v2, v3
    v_cvt_pk_bf16_f32 v50, v4, v5
    v_cvt_pk_bf16_f32 v51, v6, v7
    v_cvt_pk_bf16_f32 v52, v8, v9
    v_cvt_pk_bf16_f32 v53, v10, v11
    v_cvt_pk_bf16_f32 v54, v12, v13
    v_cvt_pk_bf16_f32 v55, v14, v15
    v_lshlrev_b32 v0, 16, v48
    v_and_b32 v1, 0xffff0000, v48
    v_lshlrev_b32 v2, 16, v49
    v_and_b32 v3, 0xffff0000, v49
    v_lshlrev_b32 v4, 16, v50
    v_and_b32 v5, 0xffff0000, v50
    v_lshlrev_b32 v6, 16, v51
    v_and_b32 v7, 0xffff0000, v51
    v_lshlrev_b32 v8, 16, v52
    v_and_b32 v9, 0xffff0000, v52
    v_lshlrev_b32 v10, 16, v53
    v_and_b32 v11, 0xffff0000, v53
    v_lshlrev_b32 v12, 16, v54
    v_and_b32 v13, 0xffff0000, v54
    v_lshlrev_b32 v14, 16, v55
    v_and_b32 v15, 0xffff0000, v55
    v_mul_f32 v48, 0xbfb8aa3b, v0
    v_mul_f32 v49, 0xbfb8aa3b, v1
    v_mul_f32 v50, 0xbfb8aa3b, v2
    v_mul_f32 v51, 0xbfb8aa3b, v3
    v_mul_f32 v52, 0xbfb8aa3b, v4
    v_mul_f32 v53, 0xbfb8aa3b, v5
    v_mul_f32 v54, 0xbfb8aa3b, v6
    v_mul_f32 v55, 0xbfb8aa3b, v7
    v_mul_f32 v56, 0xbfb8aa3b, v8
    v_mul_f32 v57, 0xbfb8aa3b, v9
    v_mul_f32 v58, 0xbfb8aa3b, v10
    v_mul_f32 v59, 0xbfb8aa3b, v11
    v_mul_f32 v60, 0xbfb8aa3b, v12
    v_mul_f32 v61, 0xbfb8aa3b, v13
    v_mul_f32 v62, 0xbfb8aa3b, v14
    v_mul_f32 v63, 0xbfb8aa3b, v15
    v_exp_f32 v48, v48
    v_exp_f32 v49, v49
    v_exp_f32 v50, v50
    v_exp_f32 v51, v51
    v_exp_f32 v52, v52
    v_exp_f32 v53, v53
    v_exp_f32 v54, v54
    v_exp_f32 v55, v55
    v_exp_f32 v56, v56
    v_exp_f32 v57, v57
    v_exp_f32 v58, v58
    v_exp_f32 v59, v59
    v_exp_f32 v60, v60
    v_exp_f32 v61, v61
    v_exp_f32 v62, v62
    v_exp_f32 v63, v63
    v_add_f32 v48, 1.0, v48
    v_add_f32 v49, 1.0, v49
    v_add_f32 v50, 1.0, v50
    v_add_f32 v51, 1.0, v51
    v_add_f32 v52, 1.0, v52
    v_add_f32 v53, 1.0, v53
    v_add_f32 v54, 1.0, v54
    v_add_f32 v55, 1.0, v55
    v_add_f32 v56, 1.0, v56
    v_add_f32 v57, 1.0, v57
    v_add_f32 v58, 1.0, v58
    v_add_f32 v59, 1.0, v59
    v_add_f32 v60, 1.0, v60
    v_add_f32 v61, 1.0, v61
    v_add_f32 v62, 1.0, v62
    v_add_f32 v63, 1.0, v63
    v_rcp_f32 v48, v48
    v_rcp_f32 v49, v49
    v_rcp_f32 v50, v50
    v_rcp_f32 v51, v51
    v_rcp_f32 v52, v52
    v_rcp_f32 v53, v53
    v_rcp_f32 v54, v54
    v_rcp_f32 v55, v55
    v_rcp_f32 v56, v56
    v_rcp_f32 v57, v57
    v_rcp_f32 v58, v58
    v_rcp_f32 v59, v59
    v_rcp_f32 v60, v60
    v_rcp_f32 v61, v61
    v_rcp_f32 v62, v62
    v_rcp_f32 v63, v63
    v_mul_f32 v0, v0, v48
    v_mul_f32 v1, v1, v49
    v_mul_f32 v2, v2, v50
    v_mul_f32 v3, v3, v51
    v_mul_f32 v4, v4, v52
    v_mul_f32 v5, v5, v53
    v_mul_f32 v6, v6, v54
    v_mul_f32 v7, v7, v55
    v_mul_f32 v8, v8, v56
    v_mul_f32 v9, v9, v57
    v_mul_f32 v10, v10, v58
    v_mul_f32 v11, v11, v59
    v_mul_f32 v12, v12, v60
    v_mul_f32 v13, v13, v61
    v_mul_f32 v14, v14, v62
    v_mul_f32 v15, v15, v63
    v_cvt_pk_bf16_f32 v48, v0, v1
    v_cvt_pk_bf16_f32 v49, v2, v3
    v_cvt_pk_bf16_f32 v50, v4, v5
    v_cvt_pk_bf16_f32 v51, v6, v7
    v_cvt_pk_bf16_f32 v52, v8, v9
    v_cvt_pk_bf16_f32 v53, v10, v11
    v_cvt_pk_bf16_f32 v54, v12, v13
    v_cvt_pk_bf16_f32 v55, v14, v15
    v_lshlrev_b32 v0, 16, v48
    v_and_b32 v1, 0xffff0000, v48
    v_lshlrev_b32 v2, 16, v49
    v_and_b32 v3, 0xffff0000, v49
    v_lshlrev_b32 v4, 16, v50
    v_and_b32 v5, 0xffff0000, v50
    v_lshlrev_b32 v6, 16, v51
    v_and_b32 v7, 0xffff0000, v51
    v_lshlrev_b32 v8, 16, v52
    v_and_b32 v9, 0xffff0000, v52
    v_lshlrev_b32 v10, 16, v53
    v_and_b32 v11, 0xffff0000, v53
    v_lshlrev_b32 v12, 16, v54
    v_and_b32 v13, 0xffff0000, v54
    v_lshlrev_b32 v14, 16, v55
    v_and_b32 v15, 0xffff0000, v55
    v_lshlrev_b32 v128, 16, v192
    v_and_b32 v129, 0xffff0000, v192
    v_lshlrev_b32 v130, 16, v193
    v_and_b32 v131, 0xffff0000, v193
    v_lshlrev_b32 v132, 16, v194
    v_and_b32 v133, 0xffff0000, v194
    v_lshlrev_b32 v134, 16, v195
    v_and_b32 v135, 0xffff0000, v195
    v_lshlrev_b32 v136, 16, v200
    v_and_b32 v137, 0xffff0000, v200
    v_lshlrev_b32 v138, 16, v201
    v_and_b32 v139, 0xffff0000, v201
    v_lshlrev_b32 v140, 16, v202
    v_and_b32 v141, 0xffff0000, v202
    v_lshlrev_b32 v142, 16, v203
    v_and_b32 v143, 0xffff0000, v203
    v_bfe_u32 v244, v254, 4, 1
    v_mul_u32_u24 v244, 24, v244
    v_add_u32 v244, v244, v238
L_o_poll:
    buffer_load_dwordx4 v[144:147], v240, s[20:23], s40 offen offset:2048 sc1
    buffer_load_dwordx4 v[148:151], v240, s[20:23], s40 offen offset:3072 sc1
    buffer_load_dwordx4 v[152:155], v236, s[20:23], s40 offen offset:2048 sc1
    buffer_load_dwordx4 v[156:159], v236, s[20:23], s40 offen offset:3072 sc1
    buffer_load_dwordx4 v[160:163], v237, s[20:23], s40 offen offset:2048 sc1
    buffer_load_dwordx4 v[164:167], v237, s[20:23], s40 offen offset:3072 sc1
L_o_chk:
    s_waitcnt vmcnt(0)
    v_max3_u32 v48, v144, v145, v146
    v_max3_u32 v49, v147, v148, v149
    v_max3_u32 v48, v48, v150, v151
    v_max3_u32 v49, v49, v152, v153
    v_max3_u32 v48, v48, v154, v155
    v_max3_u32 v49, v49, v156, v157
    v_max3_u32 v48, v48, v158, v159
    v_max3_u32 v49, v49, v160, v161
    v_max3_u32 v48, v48, v162, v163
    v_max3_u32 v49, v49, v164, v165
    v_max3_u32 v48, v48, v166, v167
    v_max_u32 v48, v48, v49
    v_cmp_eq_u32 vcc, -1, v48
    s_cbranch_vccz L_o_go
    s_sub_u32 s44, s44, 1
    s_cbranch_scc0 L_o_poll
L_o_go:
    v_dot2c_f32_bf16 v64, s46, v144
    v_dot2c_f32_bf16 v65, s47, v144
    v_dot2c_f32_bf16 v66, s46, v145
    v_dot2c_f32_bf16 v67, s47, v145
    v_dot2c_f32_bf16 v68, s46, v146
    v_dot2c_f32_bf16 v69, s47, v146
    v_dot2c_f32_bf16 v70, s46, v147
    v_dot2c_f32_bf16 v71, s47, v147
    v_dot2c_f32_bf16 v72, s46, v148
    v_dot2c_f32_bf16 v73, s47, v148
    v_dot2c_f32_bf16 v74, s46, v149
    v_dot2c_f32_bf16 v75, s47, v149
    v_dot2c_f32_bf16 v76, s46, v150
    v_dot2c_f32_bf16 v77, s47, v150
    v_dot2c_f32_bf16 v78, s46, v151
    v_dot2c_f32_bf16 v79, s47, v151
    v_dot2c_f32_bf16 v64, s46, v152
    v_dot2c_f32_bf16 v65, s47, v152
    v_dot2c_f32_bf16 v66, s46, v153
    v_dot2c_f32_bf16 v67, s47, v153
    v_dot2c_f32_bf16 v68, s46, v154
    v_dot2c_f32_bf16 v69, s47, v154
    v_dot2c_f32_bf16 v70, s46, v155
    v_dot2c_f32_bf16 v71, s47, v155
    v_dot2c_f32_bf16 v72, s46, v156
    v_dot2c_f32_bf16 v73, s47, v156
    v_dot2c_f32_bf16 v74, s46, v157
    v_dot2c_f32_bf16 v75, s47, v157
    v_dot2c_f32_bf16 v76, s46, v158
    v_dot2c_f32_bf16 v77, s47, v158
    v_dot2c_f32_bf16 v78, s46, v159
    v_dot2c_f32_bf16 v79, s47, v159
    v_dot2c_f32_bf16 v64, s46, v160
    v_dot2c_f32_bf16 v65, s47, v160
    v_dot2c_f32_bf16 v66, s46, v161
    v_dot2c_f32_bf16 v67, s47, v161
    v_dot2c_f32_bf16 v68, s46, v162
    v_dot2c_f32_bf16 v69, s47, v162
    v_dot2c_f32_bf16 v70, s46, v163
    v_dot2c_f32_bf16 v71, s47, v163
    v_dot2c_f32_bf16 v72, s46, v164
    v_dot2c_f32_bf16 v73, s47, v164
    v_dot2c_f32_bf16 v74, s46, v165
    v_dot2c_f32_bf16 v75, s47, v165
    v_dot2c_f32_bf16 v76, s46, v166
    v_dot2c_f32_bf16 v77, s47, v166
    v_dot2c_f32_bf16 v78, s46, v167
    v_dot2c_f32_bf16 v79, s47, v167
    s_nop 2
    v_fmac_f32 v128, v0, v64
    v_fmac_f32 v129, v1, v65
    v_fmac_f32 v130, v2, v66
    v_fmac_f32 v131, v3, v67
    v_fmac_f32 v132, v4, v68
    v_fmac_f32 v133, v5, v69
    v_fmac_f32 v134, v6, v70
    v_fmac_f32 v135, v7, v71
    v_fmac_f32 v136, v8, v72
    v_fmac_f32 v137, v9, v73
    v_fmac_f32 v138, v10, v74
    v_fmac_f32 v139, v11, v75
    v_fmac_f32 v140, v12, v76
    v_fmac_f32 v141, v13, v77
    v_fmac_f32 v142, v14, v78
    v_fmac_f32 v143, v15, v79
    v_cvt_pk_bf16_f32 v16, v128, v129
    v_cvt_pk_bf16_f32 v17, v130, v131
    v_cvt_pk_bf16_f32 v18, v132, v133
    v_cvt_pk_bf16_f32 v19, v134, v135
    v_cvt_pk_bf16_f32 v20, v136, v137
    v_cvt_pk_bf16_f32 v21, v138, v139
    v_cvt_pk_bf16_f32 v22, v140, v141
    v_cvt_pk_bf16_f32 v23, v142, v143
    s_nop 1
    v_permlane16_swap_b32 v16, v18
    v_permlane16_swap_b32 v17, v19
    v_permlane16_swap_b32 v20, v22
    v_permlane16_swap_b32 v21, v23
    buffer_store_dwordx4 v[16:19], v244, s[4:7], s57 offen offset:0
    buffer_store_dwordx4 v[20:23], v244, s[4:7], s57 offen offset:64
L_f_end:
    s_endpgm
L_pu:
    v_mfma_f32_16x16x32_bf16 v[0:3], a[192:195], a[0:3], 0
    s_mov_b32 s61, 0x5d800000
    ds_read_b128 a[240:243], v240 offset:12288
    v_and_b32 v241, 15, v254
    v_mfma_f32_16x16x32_bf16 v[16:19], a[192:195], a[8:11], 0
    s_lshl_b32 s99, s30, 7
    ds_read_b128 a[244:247], v240 offset:13312
    v_lshl_add_u32 v241, v255, 4, v241
    v_mfma_f32_16x16x32_bf16 v[32:35], a[192:195], a[16:19], 0
    s_add_u32 s99, s99, 0x5020000
    ds_read_b128 a[248:251], v240 offset:14336
    v_lshrrev_b32 v245, 4, v254
    v_mfma_f32_16x16x32_bf16 v[48:51], a[192:195], a[24:27], 0
    ds_read_b128 a[252:255], v240 offset:15360
    v_lshlrev_b32 v245, 2, v245
    v_mfma_f32_16x16x32_bf16 v[0:3], a[196:199], a[4:7], v[0:3]
    v_cvt_pk_bf16_f32 v96, v96, v97
    v_cvt_pk_bf16_f32 v97, v98, v99
    v_cvt_pk_bf16_f32 v98, v100, v101
    v_cvt_pk_bf16_f32 v99, v102, v103
    v_cvt_pk_bf16_f32 v104, v104, v105
    v_cvt_pk_bf16_f32 v105, v106, v107
    v_mfma_f32_16x16x32_bf16 v[16:19], a[196:199], a[12:15], v[16:19]
    v_accvgpr_write_b32 a68, v96
    v_accvgpr_write_b32 a69, v97
    v_accvgpr_write_b32 a70, v98
    v_cvt_pk_bf16_f32 v106, v108, v109
    v_accvgpr_write_b32 a71, v99
    v_cvt_pk_bf16_f32 v107, v110, v111
    v_accvgpr_write_b32 a76, v104
    v_cvt_pk_bf16_f32 v112, v112, v113
    v_accvgpr_write_b32 a77, v105
    v_mfma_f32_16x16x32_bf16 v[32:35], a[196:199], a[20:23], v[32:35]
    v_cvt_pk_bf16_f32 v113, v114, v115
    v_accvgpr_write_b32 a78, v106
    v_cvt_pk_bf16_f32 v114, v116, v117
    v_accvgpr_write_b32 a79, v107
    v_cvt_pk_bf16_f32 v115, v118, v119
    v_accvgpr_write_b32 a84, v112
    v_cvt_pk_bf16_f32 v120, v120, v121
    v_mfma_f32_16x16x32_bf16 v[48:51], a[196:199], a[28:31], v[48:51]
    v_accvgpr_write_b32 a85, v113
    v_cvt_pk_bf16_f32 v121, v122, v123
    v_accvgpr_write_b32 a86, v114
    v_cvt_pk_bf16_f32 v122, v124, v125
    v_accvgpr_write_b32 a87, v115
    v_accvgpr_write_b32 a92, v120
    v_mfma_f32_16x16x32_bf16 v[0:3], a[200:203], a[64:67], v[0:3]
    v_cvt_pk_bf16_f32 v123, v126, v127
    v_accvgpr_write_b32 a93, v121
    v_accvgpr_write_b32 a94, v122
    v_mfma_f32_16x16x32_bf16 v[16:19], a[200:203], a[72:75], v[16:19]
    s_lshl_b32 s98, s29, 10
    v_accvgpr_write_b32 a95, v123
    v_sub_u32 v241, v241, v245
    v_mfma_f32_16x16x32_bf16 v[32:35], a[200:203], a[80:83], v[32:35]
    s_add_u32 s98, s98, s99
    v_cvt_f32_i32 v241, v241
    v_add_f32 v241, 0.5, v241
    v_mfma_f32_16x16x32_bf16 v[48:51], a[200:203], a[88:91], v[48:51]
    v_mul_f32 v199, 0x71800000, v241
    v_mov_b32 v200, v240
    v_mfma_f32_16x16x32_bf16 v[0:3], a[204:207], a[68:71], v[0:3]
    s_mov_b32 s52, s49
    v_add_u32 v201, 0x10000, v240
    v_and_b32 v206, 31, v254
    v_mfma_f32_16x16x32_bf16 v[16:19], a[204:207], a[76:79], v[16:19]
    s_add_u32 s53, s49, 114688
    s_add_u32 s54, s49, 131072
    v_lshlrev_b32 v206, 10, v206
    v_mfma_f32_16x16x32_bf16 v[32:35], a[204:207], a[84:87], v[32:35]
    s_add_u32 s55, s49, 114688
    v_and_b32 v252, 0xfff, v252
    v_or_b32 v252, v252, v251
    v_mfma_f32_16x16x32_bf16 v[48:51], a[204:207], a[92:95], v[48:51]
    s_mov_b32 s4, s38
    v_and_b32 v192, 15, v254
    v_mfma_f32_16x16x32_bf16 v[4:7], a[208:211], a[0:3], 0
    s_mov_b32 s5, s39
    s_mov_b32 s6, 0x400000
    v_min_u32 v192, 1, v192
    v_mfma_f32_16x16x32_bf16 v[20:23], a[208:211], a[8:11], 0
    s_mov_b32 s7, 0x20000
    v_subrev_u32 v192, 1, v192
    v_and_b32 v192, 0x3f803f80, v192
    v_mfma_f32_16x16x32_bf16 v[36:39], a[208:211], a[16:19], 0
    s_lshl_b32 s59, s2, 2
    s_add_u32 s59, s59, s28
    v_mov_b32 v193, v192
    v_mfma_f32_16x16x32_bf16 v[52:55], a[208:211], a[24:27], 0
    s_lshl_b32 s50, s59, 12
    v_mov_b32 v194, v192
    v_mfma_f32_16x16x32_bf16 v[4:7], a[212:215], a[4:7], v[4:7]
    v_max3_f32 v128, v0, v1, v2
    v_max_f32 v128, v128, v3
    v_max3_f32 v130, v16, v17, v18
    v_max_f32 v130, v130, v19
    v_max3_f32 v132, v32, v33, v34
    v_max_f32 v132, v132, v35
    v_max3_f32 v134, v48, v49, v50
    v_max_f32 v134, v134, v51
    v_mov_b32 v129, v128
    v_mov_b32 v131, v130
    v_mov_b32 v133, v132
    v_mov_b32 v135, v134
    v_permlane32_swap_b32 v128, v129
    v_permlane32_swap_b32 v130, v131
    v_permlane32_swap_b32 v132, v133
    v_permlane32_swap_b32 v134, v135
    v_max_f32 v128, v128, v129
    v_max_f32 v130, v130, v131
    v_max_f32 v132, v132, v133
    v_max_f32 v134, v134, v135
    v_mov_b32 v129, v128
    v_mov_b32 v131, v130
    v_mov_b32 v133, v132
    v_mov_b32 v135, v134
    v_permlane16_swap_b32 v128, v129
    v_permlane16_swap_b32 v130, v131
    v_permlane16_swap_b32 v132, v133
    v_permlane16_swap_b32 v134, v135
    v_max_f32 v128, v128, v129
    v_max_f32 v130, v130, v131
    v_max_f32 v132, v132, v133
    v_max_f32 v134, v134, v135
    v_add_f32 v128, 0x42800000, v128
    v_add_f32 v130, 0x42800000, v130
    v_add_f32 v132, 0x42800000, v132
    v_add_f32 v134, 0x42800000, v134
    v_sub_f32 v160, 0, v128
    v_mfma_f32_16x16x32_bf16 v[20:23], a[212:215], a[12:15], v[20:23]
    v_sub_f32 v161, 0, v128
    v_sub_f32 v162, 0, v128
    v_sub_f32 v163, 0, v128
    v_mfma_f32_16x16x32_bf16 v[36:39], a[212:215], a[20:23], v[36:39]
    v_sub_f32 v164, 0, v130
    v_sub_f32 v165, 0, v130
    v_sub_f32 v166, 0, v130
    v_mfma_f32_16x16x32_bf16 v[52:55], a[212:215], a[28:31], v[52:55]
    v_sub_f32 v167, 0, v130
    v_sub_f32 v168, 0, v132
    v_sub_f32 v169, 0, v132
    v_mfma_f32_16x16x32_bf16 v[4:7], a[216:219], a[64:67], v[4:7]
    v_sub_f32 v170, 0, v132
    v_sub_f32 v171, 0, v132
    v_sub_f32 v172, 0, v134
    v_mfma_f32_16x16x32_bf16 v[20:23], a[216:219], a[72:75], v[20:23]
    v_sub_f32 v173, 0, v134
    v_sub_f32 v174, 0, v134
    v_sub_f32 v175, 0, v134
    v_mfma_f32_16x16x32_bf16 v[36:39], a[216:219], a[80:83], v[36:39]
    v_sub_f32 v0, v0, v128
    v_sub_f32 v1, v1, v128
    v_sub_f32 v2, v2, v128
    v_mfma_f32_16x16x32_bf16 v[52:55], a[216:219], a[88:91], v[52:55]
    v_sub_f32 v3, v3, v128
    v_sub_f32 v16, v16, v130
    v_sub_f32 v17, v17, v130
    v_mfma_f32_16x16x32_bf16 v[4:7], a[220:223], a[68:71], v[4:7]
    v_sub_f32 v18, v18, v130
    v_sub_f32 v19, v19, v130
    v_sub_f32 v32, v32, v132
    v_mfma_f32_16x16x32_bf16 v[20:23], a[220:223], a[76:79], v[20:23]
    v_sub_f32 v33, v33, v132
    v_sub_f32 v34, v34, v132
    v_sub_f32 v35, v35, v132
    v_mfma_f32_16x16x32_bf16 v[36:39], a[220:223], a[84:87], v[36:39]
    v_sub_f32 v48, v48, v134
    v_sub_f32 v49, v49, v134
    v_sub_f32 v50, v50, v134
    v_mfma_f32_16x16x32_bf16 v[52:55], a[220:223], a[92:95], v[52:55]
    v_sub_f32 v51, v51, v134
    v_mov_b32 v195, v192
    v_mfma_f32_16x16x32_bf16 v[8:11], a[224:227], a[0:3], v[160:163]
    s_mov_b32 s12, s96
    s_mov_b32 s13, s97
    v_lshrrev_b32 v244, 4, v254
    v_mfma_f32_16x16x32_bf16 v[24:27], a[224:227], a[8:11], v[164:167]
    s_mov_b32 s14, 1835008
    v_and_b32 v245, 15, v254
    v_lshlrev_b32 v243, 1, v244
    v_mfma_f32_16x16x32_bf16 v[40:43], a[224:227], a[16:19], v[168:171]
    s_mov_b32 m0, s52
    v_xor_b32 v245, v245, v243
    v_lshlrev_b32 v244, 10, v244
    v_mfma_f32_16x16x32_bf16 v[56:59], a[224:227], a[24:27], v[172:175]
    v_lshl_add_u32 v242, v245, 4, v244
    v_xor_b32 v243, 0x80, v242
    v_mfma_f32_16x16x32_bf16 v[8:11], a[228:231], a[4:7], v[8:11]
    v_sub_f32 v4, v4, v128
    v_sub_f32 v5, v5, v128
    v_sub_f32 v6, v6, v128
    v_sub_f32 v7, v7, v128
    v_sub_f32 v20, v20, v130
    v_sub_f32 v21, v21, v130
    v_sub_f32 v22, v22, v130
    v_sub_f32 v23, v23, v130
    v_sub_f32 v36, v36, v132
    v_sub_f32 v37, v37, v132
    v_sub_f32 v38, v38, v132
    v_sub_f32 v39, v39, v132
    v_sub_f32 v52, v52, v134
    v_sub_f32 v53, v53, v134
    v_sub_f32 v54, v54, v134
    v_sub_f32 v55, v55, v134
    v_mfma_f32_16x16x32_bf16 v[24:27], a[228:231], a[12:15], v[24:27]
    v_exp_f32 v0, v0
    v_exp_f32 v1, v1
    v_mfma_f32_16x16x32_bf16 v[40:43], a[228:231], a[20:23], v[40:43]
    v_exp_f32 v2, v2
    v_mfma_f32_16x16x32_bf16 v[56:59], a[228:231], a[28:31], v[56:59]
    v_exp_f32 v3, v3
    v_exp_f32 v16, v16
    v_mfma_f32_16x16x32_bf16 v[8:11], a[232:235], a[64:67], v[8:11]
    v_exp_f32 v17, v17
    v_mfma_f32_16x16x32_bf16 v[24:27], a[232:235], a[72:75], v[24:27]
    v_exp_f32 v18, v18
    v_exp_f32 v19, v19
    v_mfma_f32_16x16x32_bf16 v[40:43], a[232:235], a[80:83], v[40:43]
    v_exp_f32 v32, v32
    v_mfma_f32_16x16x32_bf16 v[56:59], a[232:235], a[88:91], v[56:59]
    v_exp_f32 v33, v33
    v_exp_f32 v34, v34
    v_mfma_f32_16x16x32_bf16 v[8:11], a[236:239], a[68:71], v[8:11]
    v_exp_f32 v35, v35
    v_mfma_f32_16x16x32_bf16 v[24:27], a[236:239], a[76:79], v[24:27]
    v_exp_f32 v48, v48
    v_exp_f32 v49, v49
    v_mfma_f32_16x16x32_bf16 v[40:43], a[236:239], a[84:87], v[40:43]
    v_exp_f32 v50, v50
    v_mfma_f32_16x16x32_bf16 v[56:59], a[236:239], a[92:95], v[56:59]
    s_waitcnt lgkmcnt(3)
    v_exp_f32 v51, v51
    v_exp_f32 v4, v4
    v_mfma_f32_16x16x32_bf16 v[12:15], a[240:243], a[0:3], v[160:163]
    v_exp_f32 v5, v5
    v_mfma_f32_16x16x32_bf16 v[28:31], a[240:243], a[8:11], v[164:167]
    v_exp_f32 v6, v6
    v_exp_f32 v7, v7
    v_mfma_f32_16x16x32_bf16 v[44:47], a[240:243], a[16:19], v[168:171]
    v_exp_f32 v20, v20
    v_mfma_f32_16x16x32_bf16 v[60:63], a[240:243], a[24:27], v[172:175]
    s_waitcnt lgkmcnt(2)
    v_exp_f32 v21, v21
    v_exp_f32 v22, v22
    v_mfma_f32_16x16x32_bf16 v[12:15], a[244:247], a[4:7], v[12:15]
    v_exp_f32 v23, v23
    v_mfma_f32_16x16x32_bf16 v[28:31], a[244:247], a[12:15], v[28:31]
    v_exp_f32 v36, v36
    v_exp_f32 v37, v37
    v_mfma_f32_16x16x32_bf16 v[44:47], a[244:247], a[20:23], v[44:47]
    v_exp_f32 v38, v38
    v_mfma_f32_16x16x32_bf16 v[60:63], a[244:247], a[28:31], v[60:63]
    s_waitcnt lgkmcnt(1)
    v_exp_f32 v39, v39
    v_exp_f32 v52, v52
    v_mfma_f32_16x16x32_bf16 v[12:15], a[248:251], a[64:67], v[12:15]
    v_exp_f32 v53, v53
    v_mfma_f32_16x16x32_bf16 v[28:31], a[248:251], a[72:75], v[28:31]
    v_exp_f32 v54, v54
    v_exp_f32 v55, v55
    v_mfma_f32_16x16x32_bf16 v[44:47], a[248:251], a[80:83], v[44:47]
    v_exp_f32 v8, v8
    v_mfma_f32_16x16x32_bf16 v[60:63], a[248:251], a[88:91], v[60:63]
    s_waitcnt lgkmcnt(0)
    v_exp_f32 v9, v9
    v_exp_f32 v24, v24
    v_mfma_f32_16x16x32_bf16 v[12:15], a[252:255], a[68:71], v[12:15]
    v_exp_f32 v25, v25
    v_mfma_f32_16x16x32_bf16 v[28:31], a[252:255], a[76:79], v[28:31]
    v_exp_f32 v40, v40
    v_add_u32 v243, 3072, v243
    v_exp_f32 v41, v41
    v_mov_b32 v232, -1
    v_mfma_f32_16x16x32_bf16 v[44:47], a[252:255], a[84:87], v[44:47]
    v_mov_b32 v233, -1
    v_exp_f32 v56, v56
    v_mov_b32 v234, -1
    v_mfma_f32_16x16x32_bf16 v[60:63], a[252:255], a[92:95], v[60:63]
    v_mov_b32 v235, -1
    v_exp_f32 v57, v57
    s_waitcnt vmcnt(20)
    s_barrier
    ds_read_b128 a[192:195], v200 offset:32768
    ds_read_b128 a[196:199], v200 offset:33792
    ds_read_b128 a[200:203], v200 offset:34816
    ds_read_b128 a[204:207], v200 offset:35840
    ds_read_b128 a[208:211], v200 offset:36864
    ds_read_b128 a[212:215], v200 offset:37888
    ds_read_b128 a[216:219], v200 offset:38912
    ds_read_b128 a[220:223], v200 offset:39936
    buffer_load_dword v253, v252, s[4:7], s50 offen
    buffer_load_dword v251, v252, s[12:15], s50 offen
    s_mov_b32 s39, s50
    buffer_load_dwordx4 v240, s[16:19], s54 offen offset:0 sc1 lds
    buffer_load_dwordx4 v240, s[16:19], s54 offen offset:1024 sc1 lds
    buffer_load_dwordx4 v240, s[16:19], s54 offen offset:2048 sc1 lds
    buffer_load_dwordx4 v240, s[16:19], s54 offen offset:3072 sc1 lds
    s_mov_b32 m0, s53
    s_waitcnt lgkmcnt(7)
    v_mfma_f32_16x16x32_bf16 v[64:67], a[192:195], a[0:3], v[160:163]
    s_waitcnt lgkmcnt(6)
    v_exp_f32 v10, v10
    v_mfma_f32_16x16x32_bf16 v[64:67], a[196:199], a[4:7], v[64:67]
    s_waitcnt lgkmcnt(5)
    v_exp_f32 v11, v11
    v_mfma_f32_16x16x32_bf16 v[64:67], a[200:203], a[64:67], v[64:67]
    s_waitcnt lgkmcnt(4)
    v_exp_f32 v12, v12
    v_mfma_f32_16x16x32_bf16 v[64:67], a[204:207], a[68:71], v[64:67]
    s_lshr_b32 s35, s34, 1
    v_exp_f32 v13, v13
    v_mfma_f32_16x16x32_bf16 v[80:83], a[204:207], a[76:79], v[164:167]
    s_sub_u32 s31, 15, s30
    v_exp_f32 v14, v14
    v_mfma_f32_16x16x32_bf16 v[80:83], a[200:203], a[72:75], v[80:83]
    s_bitcmp1_b32 s34, 0
    s_cselect_b32 s31, s31, s30
    v_exp_f32 v15, v15
    v_mfma_f32_16x16x32_bf16 v[80:83], a[196:199], a[12:15], v[80:83]
    s_and_b32 s45, s29, 3
    v_exp_f32 v26, v26
    v_mfma_f32_16x16x32_bf16 v[80:83], a[192:195], a[8:11], v[80:83]
    s_lshl_b32 s46, s31, 3
    v_exp_f32 v27, v27
    v_mfma_f32_16x16x32_bf16 v[96:99], a[192:195], a[16:19], v[168:171]
    s_add_u32 s46, s46, s28
    v_exp_f32 v28, v28
    v_mfma_f32_16x16x32_bf16 v[96:99], a[196:199], a[20:23], v[96:99]
    s_mul_i32 s46, s46, 188416
    v_exp_f32 v29, v29
    v_mfma_f32_16x16x32_bf16 v[96:99], a[200:203], a[80:83], v[96:99]
    s_add_u32 s46, s46, 0x2200000
    ds_read_b128 a[224:227], v200 offset:40960
    v_cvt_pk_bf16_f32 v128, v0, v1
    v_mfma_f32_16x16x32_bf16 v[96:99], a[204:207], a[84:87], v[96:99]
    s_mul_i32 s47, s35, 14336
    ds_read_b128 a[228:231], v200 offset:41984
    v_cvt_pk_bf16_f32 v129, v2, v3
    v_mfma_f32_16x16x32_bf16 v[112:115], a[204:207], a[92:95], v[172:175]
    s_add_u32 s64, s46, s47
    ds_read_b128 a[232:235], v200 offset:43008
    v_cvt_pk_bf16_f32 v130, v4, v5
    v_mfma_f32_16x16x32_bf16 v[112:115], a[200:203], a[88:91], v[112:115]
    s_add_u32 s64, s64, 131072
    ds_read_b128 a[236:239], v200 offset:44032
    v_cvt_pk_bf16_f32 v131, v6, v7
    v_mfma_f32_16x16x32_bf16 v[112:115], a[196:199], a[28:31], v[112:115]
    s_lshl_b32 s47, s35, 15
    v_exp_f32 v30, v30
    v_mfma_f32_16x16x32_bf16 v[112:115], a[192:195], a[24:27], v[112:115]
    s_waitcnt lgkmcnt(7)
    buffer_load_dwordx4 v240, s[16:19], s55 offen offset:0 sc1 lds
    v_mfma_f32_16x16x32_bf16 v[68:71], a[208:211], a[0:3], v[160:163]
    s_waitcnt lgkmcnt(6)
    v_exp_f32 v31, v31
    v_mfma_f32_16x16x32_bf16 v[68:71], a[212:215], a[4:7], v[68:71]
    s_waitcnt lgkmcnt(5)
    v_exp_f32 v42, v42
    v_mfma_f32_16x16x32_bf16 v[68:71], a[216:219], a[64:67], v[68:71]
    s_waitcnt lgkmcnt(4)
    v_exp_f32 v43, v43
    v_mfma_f32_16x16x32_bf16 v[68:71], a[220:223], a[68:71], v[68:71]
    s_add_u32 s65, s46, s47
    v_exp_f32 v44, v44
    v_mfma_f32_16x16x32_bf16 v[84:87], a[220:223], a[76:79], v[164:167]
    s_lshl_b32 s46, s45, 8
    v_exp_f32 v45, v45
    v_mfma_f32_16x16x32_bf16 v[84:87], a[216:219], a[72:75], v[84:87]
    s_lshl_b32 s47, s28, 13
    v_exp_f32 v46, v46
    v_mfma_f32_16x16x32_bf16 v[84:87], a[212:215], a[12:15], v[84:87]
    s_add_u32 s46, s46, s47
    v_exp_f32 v47, v47
    v_mfma_f32_16x16x32_bf16 v[84:87], a[208:211], a[8:11], v[84:87]
    s_mul_i32 s47, s35, 458752
    v_exp_f32 v58, v58
    v_mfma_f32_16x16x32_bf16 v[100:103], a[208:211], a[16:19], v[168:171]
    s_add_u32 s48, s46, s47
    v_cvt_pk_bf16_f32 v136, v16, v17
    v_cvt_pk_bf16_f32 v137, v18, v19
    v_mfma_f32_16x16x32_bf16 v[100:103], a[212:215], a[20:23], v[100:103]
    s_lshl_b32 s47, s35, 20
    v_exp_f32 v59, v59
    v_mfma_f32_16x16x32_bf16 v[100:103], a[216:219], a[80:83], v[100:103]
    s_add_u32 s49, s46, s47
    ds_read_b128 a[240:243], v200 offset:45056
    v_cvt_pk_bf16_f32 v138, v20, v21
    v_mfma_f32_16x16x32_bf16 v[100:103], a[220:223], a[84:87], v[100:103]
    s_lshl_b32 s50, s28, 11
    ds_read_b128 a[244:247], v200 offset:46080
    v_cvt_pk_bf16_f32 v139, v22, v23
    v_mfma_f32_16x16x32_bf16 v[116:119], a[220:223], a[92:95], v[172:175]
    s_mov_b32 s8, s4
    ds_read_b128 a[248:251], v200 offset:47104
    v_cvt_pk_bf16_f32 v144, v32, v33
    v_mfma_f32_16x16x32_bf16 v[116:119], a[216:219], a[88:91], v[116:119]
    s_mov_b32 s9, s5
    ds_read_b128 a[252:255], v200 offset:48128
    v_cvt_pk_bf16_f32 v145, v34, v35
    v_mfma_f32_16x16x32_bf16 v[116:119], a[212:215], a[28:31], v[116:119]
    s_mov_b32 s38, 0
    v_exp_f32 v60, v60
    v_mfma_f32_16x16x32_bf16 v[116:119], a[208:211], a[24:27], v[116:119]
    s_waitcnt lgkmcnt(7)
    v_exp_f32 v61, v61
    v_mfma_f32_16x16x32_bf16 v[72:75], a[224:227], a[0:3], v[160:163]
    s_waitcnt lgkmcnt(6)
    v_cvt_pk_bf16_f32 v146, v36, v37
    v_cvt_pk_bf16_f32 v147, v38, v39
    v_mfma_f32_16x16x32_bf16 v[72:75], a[228:231], a[4:7], v[72:75]
    s_waitcnt lgkmcnt(5)
    v_exp_f32 v62, v62
    v_mfma_f32_16x16x32_bf16 v[72:75], a[232:235], a[64:67], v[72:75]
    s_waitcnt lgkmcnt(4)
    v_cvt_pk_bf16_f32 v152, v48, v49
    v_cvt_pk_bf16_f32 v153, v50, v51
    v_mfma_f32_16x16x32_bf16 v[72:75], a[236:239], a[68:71], v[72:75]
    s_mov_b32 s12, s96
    v_exp_f32 v63, v63
    v_mfma_f32_16x16x32_bf16 v[88:91], a[236:239], a[76:79], v[164:167]
    s_mov_b32 s13, s97
    buffer_load_dwordx4 v240, s[16:19], s55 offen offset:1024 sc1 lds
    v_mfma_f32_16x16x32_bf16 v[88:91], a[232:235], a[72:75], v[88:91]
    s_mov_b32 s14, 1835008
    v_cvt_pk_bf16_f32 v154, v52, v53
    v_cvt_pk_bf16_f32 v155, v54, v55
    v_mfma_f32_16x16x32_bf16 v[88:91], a[228:231], a[12:15], v[88:91]
    s_and_b32 s46, s34, 1
    v_exp_f32 v64, v64
    v_mfma_f32_16x16x32_bf16 v[88:91], a[224:227], a[8:11], v[88:91]
    s_lshl_b32 s46, s46, 2
    v_cvt_pk_bf16_f32 v132, v8, v9
    v_cvt_pk_bf16_f32 v133, v10, v11
    v_mfma_f32_16x16x32_bf16 v[104:107], a[224:227], a[16:19], v[168:171]
    s_add_u32 s3, s99, s46
    v_exp_f32 v65, v65
    v_mfma_f32_16x16x32_bf16 v[104:107], a[228:231], a[20:23], v[104:107]
    s_lshl_b32 s46, s35, 13
    v_cvt_pk_bf16_f32 v134, v12, v13
    v_cvt_pk_bf16_f32 v135, v14, v15
    v_mfma_f32_16x16x32_bf16 v[104:107], a[232:235], a[80:83], v[104:107]
    s_add_u32 s3, s3, s46
    ds_read_b128 a[192:195], v200 offset:16384
    v_cvt_pk_bf16_f32 v140, v24, v25
    v_mfma_f32_16x16x32_bf16 v[104:107], a[236:239], a[84:87], v[104:107]
    s_lshl_b32 s51, s31, 2
    ds_read_b128 a[196:199], v200 offset:24576
    v_cvt_pk_bf16_f32 v141, v26, v27
    v_mfma_f32_16x16x32_bf16 v[120:123], a[236:239], a[92:95], v[172:175]
    s_add_u32 s51, s51, s45
    v_exp_f32 v66, v66
    v_mfma_f32_16x16x32_bf16 v[120:123], a[232:235], a[88:91], v[120:123]
    s_lshl_b32 s56, s51, 18
    v_exp_f32 v67, v67
    v_mfma_f32_16x16x32_bf16 v[120:123], a[228:231], a[28:31], v[120:123]
    s_add_u32 s56, s56, 0x4000000
    v_cvt_pk_bf16_f32 v142, v28, v29
    v_cvt_pk_bf16_f32 v143, v30, v31
    v_mfma_f32_16x16x32_bf16 v[120:123], a[224:227], a[24:27], v[120:123]
    s_waitcnt lgkmcnt(5)
    v_exp_f32 v80, v80
    v_mfma_f32_16x16x32_bf16 v[76:79], a[240:243], a[0:3], v[160:163]
    s_waitcnt lgkmcnt(4)
    v_cvt_pk_bf16_f32 v148, v40, v41
    v_cvt_pk_bf16_f32 v149, v42, v43
    v_mfma_f32_16x16x32_bf16 v[76:79], a[244:247], a[4:7], v[76:79]
    s_waitcnt lgkmcnt(3)
    v_exp_f32 v81, v81
    v_mfma_f32_16x16x32_bf16 v[76:79], a[248:251], a[64:67], v[76:79]
    s_waitcnt lgkmcnt(2)
    ds_read_b128 a[200:203], v200 offset:17408
    v_cvt_pk_bf16_f32 v150, v44, v45
    v_mfma_f32_16x16x32_bf16 v[76:79], a[252:255], a[68:71], v[76:79]
    s_lshl_b32 s46, s28, 12
    ds_read_b128 a[204:207], v200 offset:25600
    v_cvt_pk_bf16_f32 v151, v46, v47
    v_mfma_f32_16x16x32_bf16 v[92:95], a[252:255], a[76:79], v[164:167]
    s_add_u32 s56, s56, s46
    v_exp_f32 v82, v82
    v_mfma_f32_16x16x32_bf16 v[92:95], a[248:251], a[72:75], v[92:95]
    s_lshl_b32 s46, s35, 16
    v_cvt_pk_bf16_f32 v156, v56, v57
    v_cvt_pk_bf16_f32 v157, v58, v59
    v_mfma_f32_16x16x32_bf16 v[92:95], a[244:247], a[12:15], v[92:95]
    s_add_u32 s40, s56, s46
    v_exp_f32 v83, v83
    v_mfma_f32_16x16x32_bf16 v[92:95], a[240:243], a[8:11], v[92:95]
    s_add_u32 s40, s40, 16384
    v_cvt_pk_bf16_f32 v158, v60, v61
    v_cvt_pk_bf16_f32 v159, v62, v63
    v_mfma_f32_16x16x32_bf16 v[108:111], a[240:243], a[16:19], v[168:171]
    s_xor_b32 s46, s35, 1
    v_exp_f32 v96, v96
    v_mfma_f32_16x16x32_bf16 v[108:111], a[244:247], a[20:23], v[108:111]
    s_lshl_b32 s46, s46, 16
    v_exp_f32 v97, v97
    v_mfma_f32_16x16x32_bf16 v[108:111], a[248:251], a[80:83], v[108:111]
    s_add_u32 s46, s46, 16384
    ds_read_b128 a[208:211], v200 offset:18432
    v_mov_b32 v184, v32
    v_mfma_f32_16x16x32_bf16 v[108:111], a[252:255], a[84:87], v[108:111]
    s_add_u32 s36, s56, s46
    ds_read_b128 a[212:215], v200 offset:26624
    v_add_f32 v184, v184, v33
    v_mfma_f32_16x16x32_bf16 v[124:127], a[252:255], a[92:95], v[172:175]
    s_xor_b32 s46, s35, 2
    v_exp_f32 v98, v98
    v_mfma_f32_16x16x32_bf16 v[124:127], a[248:251], a[88:91], v[124:127]
    s_lshl_b32 s46, s46, 16
    v_exp_f32 v99, v99
    v_mfma_f32_16x16x32_bf16 v[124:127], a[244:247], a[28:31], v[124:127]
    s_add_u32 s46, s46, 32768
    buffer_load_dwordx4 v240, s[16:19], s55 offen offset:2048 sc1 lds
    v_mfma_f32_16x16x32_bf16 v[124:127], a[240:243], a[24:27], v[124:127]
    s_waitcnt lgkmcnt(5)
    v_exp_f32 v112, v112
    v_mfma_f32_16x16x32_bf16 a[32:35], a[192:195], v[128:131], 0
    s_waitcnt lgkmcnt(4)
    v_exp_f32 v113, v113
    v_mfma_f32_16x16x32_bf16 a[32:35], a[196:199], v[132:135], a[32:35]
    s_add_u32 s37, s56, s46
    v_exp_f32 v114, v114
    v_mfma_f32_16x16x32_bf16 a[96:99], a[192:195], v[136:139], 0
    s_xor_b32 s46, s35, 3
    ds_read_b128 a[216:219], v200 offset:19456
    v_add_f32 v184, v184, v34
    v_mfma_f32_16x16x32_bf16 a[96:99], a[196:199], v[140:143], a[96:99]
    s_lshl_b32 s46, s46, 16
    ds_read_b128 a[220:223], v200 offset:27648
    v_add_f32 v184, v184, v35
    v_mfma_f32_16x16x32_bf16 a[128:131], a[192:195], v[144:147], 0
    s_add_u32 s46, s46, 49152
    v_exp_f32 v115, v115
    v_mfma_f32_16x16x32_bf16 a[128:131], a[196:199], v[148:151], a[128:131]
    s_add_u32 s41, s56, s46
    v_exp_f32 v68, v68
    v_mfma_f32_16x16x32_bf16 a[160:163], a[192:195], v[152:155], 0
    s_lshl_b32 s94, s51, 9
    v_exp_f32 v69, v69
    v_mfma_f32_16x16x32_bf16 a[160:163], a[196:199], v[156:159], a[160:163]
    s_waitcnt lgkmcnt(5)
    v_exp_f32 v70, v70
    v_mfma_f32_16x16x32_bf16 a[36:39], a[200:203], v[128:131], 0
    s_waitcnt lgkmcnt(4)
    v_exp_f32 v71, v71
    v_mfma_f32_16x16x32_bf16 a[36:39], a[204:207], v[132:135], a[36:39]
    s_add_u32 s94, s94, 0x5000000
    v_exp_f32 v84, v84
    v_mfma_f32_16x16x32_bf16 a[100:103], a[200:203], v[136:139], 0
    s_lshl_b32 s46, s35, 7
    ds_read_b128 a[224:227], v200 offset:20480
    v_add_f32 v184, v184, v36
    v_mfma_f32_16x16x32_bf16 a[100:103], a[204:207], v[140:143], a[100:103]
    s_add_u32 s95, s94, s46
    ds_read_b128 a[228:231], v200 offset:28672
    v_add_f32 v184, v184, v37
    v_mfma_f32_16x16x32_bf16 a[132:135], a[200:203], v[144:147], 0
    s_lshl_b32 s46, s31, 17
    v_exp_f32 v85, v85
    v_mfma_f32_16x16x32_bf16 a[132:135], a[204:207], v[148:151], a[132:135]
    s_lshl_b32 s47, s28, 14
    v_exp_f32 v86, v86
    v_mfma_f32_16x16x32_bf16 a[164:167], a[200:203], v[152:155], 0
    s_add_u32 s46, s46, s47
    v_exp_f32 v87, v87
    v_mfma_f32_16x16x32_bf16 a[164:167], a[204:207], v[156:159], a[164:167]
    s_waitcnt lgkmcnt(5)
    v_exp_f32 v100, v100
    v_mfma_f32_16x16x32_bf16 a[40:43], a[208:211], v[128:131], 0
    s_waitcnt lgkmcnt(4)
    buffer_load_dwordx4 v240, s[16:19], s55 offen offset:3072 sc1 lds
    v_mfma_f32_16x16x32_bf16 a[40:43], a[212:215], v[132:135], a[40:43]
    s_add_u32 s54, s54, 0x8000
    v_exp_f32 v101, v101
    v_mfma_f32_16x16x32_bf16 a[104:107], a[208:211], v[136:139], 0
    s_add_u32 s52, s52, 0x8000
    ds_read_b128 a[232:235], v200 offset:21504
    v_add_f32 v184, v184, v38
    v_mfma_f32_16x16x32_bf16 a[104:107], a[212:215], v[140:143], a[104:107]
    s_and_b32 s52, s52, 0x1ffff
    ds_read_b128 a[236:239], v200 offset:29696
    v_add_f32 v184, v184, v39
    v_mfma_f32_16x16x32_bf16 a[136:139], a[208:211], v[144:147], 0
    s_mov_b32 m0, s52
    v_exp_f32 v102, v102
    v_mfma_f32_16x16x32_bf16 a[136:139], a[212:215], v[148:151], a[136:139]
    s_add_u32 s55, s55, 0x8000
    v_exp_f32 v103, v103
    v_mfma_f32_16x16x32_bf16 a[168:171], a[208:211], v[152:155], 0
    s_add_u32 s53, s53, 0x8000
    v_mov_b32 v188, v48
    v_add_f32 v188, v188, v49
    v_mfma_f32_16x16x32_bf16 a[168:171], a[212:215], v[156:159], a[168:171]
    s_waitcnt lgkmcnt(5)
    v_exp_f32 v116, v116
    v_mfma_f32_16x16x32_bf16 a[44:47], a[216:219], v[128:131], 0
    s_waitcnt lgkmcnt(4)
    v_add_f32 v188, v188, v50
    v_add_f32 v188, v188, v51
    v_mfma_f32_16x16x32_bf16 a[44:47], a[220:223], v[132:135], a[44:47]
    s_and_b32 s53, s53, 0x1ffff
    v_exp_f32 v117, v117
    v_mfma_f32_16x16x32_bf16 a[108:111], a[216:219], v[136:139], 0
    s_lshl_b32 s47, s45, 8
    ds_read_b128 a[240:243], v200 offset:22528
    v_add_f32 v188, v188, v52
    v_mfma_f32_16x16x32_bf16 a[108:111], a[220:223], v[140:143], a[108:111]
    s_add_u32 s46, s46, s47
    ds_read_b128 a[244:247], v200 offset:30720
    v_add_f32 v188, v188, v53
    v_mfma_f32_16x16x32_bf16 a[140:143], a[216:219], v[144:147], 0
    s_lshr_b32 s47, s35, 1
    v_exp_f32 v118, v118
    v_mfma_f32_16x16x32_bf16 a[140:143], a[220:223], v[148:151], a[140:143]
    s_lshl_b32 s47, s47, 7
    v_add_f32 v188, v188, v54
    v_add_f32 v188, v188, v55
    v_mfma_f32_16x16x32_bf16 a[172:175], a[216:219], v[152:155], 0
    s_add_u32 s46, s46, s47
    v_exp_f32 v119, v119
    v_mfma_f32_16x16x32_bf16 a[172:175], a[220:223], v[156:159], a[172:175]
    s_waitcnt lgkmcnt(5)
    v_add_f32 v184, v184, v40
    v_add_f32 v184, v184, v41
    v_mfma_f32_16x16x32_bf16 a[48:51], a[224:227], v[128:131], 0
    s_waitcnt lgkmcnt(4)
    v_exp_f32 v72, v72
    v_mfma_f32_16x16x32_bf16 a[48:51], a[228:231], v[132:135], a[48:51]
    s_and_b32 s47, s35, 1
    v_add_f32 v184, v184, v42
    v_add_f32 v184, v184, v43
    v_mfma_f32_16x16x32_bf16 a[112:115], a[224:227], v[136:139], 0
    s_lshl_b32 s47, s47, 16
    ds_read_b128 a[248:251], v200 offset:23552
    v_add_f32 v184, v184, v44
    v_mfma_f32_16x16x32_bf16 a[112:115], a[228:231], v[140:143], a[112:115]
    s_add_u32 s57, s46, s47
    ds_read_b128 a[252:255], v200 offset:31744
    v_add_f32 v184, v184, v45
    v_mfma_f32_16x16x32_bf16 a[144:147], a[224:227], v[144:147], 0
    s_lshl_b32 s46, s29, 12
    v_exp_f32 v73, v73
    v_mfma_f32_16x16x32_bf16 a[144:147], a[228:231], v[148:151], a[144:147]
    s_add_u32 s100, s46, s32
    v_exp_f32 v88, v88
    v_mfma_f32_16x16x32_bf16 a[176:179], a[224:227], v[152:155], 0
    s_add_u32 s101, s46, s33
    v_add_f32 v184, v184, v46
    v_add_f32 v184, v184, v47
    v_mfma_f32_16x16x32_bf16 a[176:179], a[228:231], v[156:159], a[176:179]
    s_waitcnt lgkmcnt(5)
    v_exp_f32 v89, v89
    v_mfma_f32_16x16x32_bf16 a[52:55], a[232:235], v[128:131], 0
    s_waitcnt lgkmcnt(4)
    v_add_f32 v188, v188, v56
    v_add_f32 v188, v188, v57
    v_mfma_f32_16x16x32_bf16 a[52:55], a[236:239], v[132:135], a[52:55]
    s_and_b32 s32, s30, 1
    v_exp_f32 v104, v104
    v_mfma_f32_16x16x32_bf16 a[116:119], a[232:235], v[136:139], 0
    s_lshl_b32 s32, s32, 16
    v_add_f32 v188, v188, v58
    v_add_f32 v188, v188, v59
    v_mfma_f32_16x16x32_bf16 a[116:119], a[236:239], v[140:143], a[116:119]
    s_xor_b32 s33, s32, 0x10000
    v_exp_f32 v105, v105
    v_mfma_f32_16x16x32_bf16 a[148:151], a[232:235], v[144:147], 0
    s_add_u32 s51, s50, s32
    v_add_f32 v188, v188, v60
    v_add_f32 v188, v188, v61
    v_mfma_f32_16x16x32_bf16 a[148:151], a[236:239], v[148:151], a[148:151]
    s_add_u32 s56, s50, s33
    v_exp_f32 v120, v120
    v_mfma_f32_16x16x32_bf16 a[180:183], a[232:235], v[152:155], 0
    s_waitcnt vmcnt(10) lgkmcnt(0)
    v_xor_b32 v200, 0x10000, v200
    v_add_f32 v188, v188, v62
    v_mfma_f32_16x16x32_bf16 a[180:183], a[236:239], v[156:159], a[180:183]
    s_barrier
    ds_read_b128 a[192:195], v201 offset:0
    v_mfma_f32_16x16x32_bf16 a[56:59], a[240:243], v[128:131], 0
    ds_read_b128 a[196:199], v201 offset:1024
    ds_read_b128 a[200:203], v201 offset:2048
    v_mfma_f32_16x16x32_bf16 a[56:59], a[244:247], v[132:135], a[56:59]
    buffer_load_dwordx4 v240, s[16:19], s54 offen offset:0 sc1 lds
    v_mfma_f32_16x16x32_bf16 a[120:123], a[240:243], v[136:139], 0
    ds_read_b128 a[204:207], v201 offset:3072
    ds_read_b128 a[208:211], v201 offset:4096
    v_mfma_f32_16x16x32_bf16 a[120:123], a[244:247], v[140:143], a[120:123]
    buffer_load_dwordx4 v240, s[16:19], s54 offen offset:1024 sc1 lds
    v_mfma_f32_16x16x32_bf16 a[152:155], a[240:243], v[144:147], 0
    ds_read_b128 a[212:215], v201 offset:5120
    ds_read_b128 a[216:219], v201 offset:6144
    v_mfma_f32_16x16x32_bf16 a[152:155], a[244:247], v[148:151], a[152:155]
    ds_read_b128 a[220:223], v201 offset:7168
    v_add_f32 v188, v188, v63
    v_mfma_f32_16x16x32_bf16 a[184:187], a[240:243], v[152:155], 0
    v_exp_f32 v121, v121
    v_mfma_f32_16x16x32_bf16 a[184:187], a[244:247], v[156:159], a[184:187]
    v_xor_b32 v201, 0x10000, v201
    v_mfma_f32_16x16x32_bf16 a[60:63], a[248:251], v[128:131], 0
    buffer_load_dwordx4 v240, s[16:19], s54 offen offset:2048 sc1 lds
    v_mfma_f32_16x16x32_bf16 a[60:63], a[252:255], v[132:135], a[60:63]
    v_mfma_f32_16x16x32_bf16 a[124:127], a[248:251], v[136:139], 0
    v_mfma_f32_16x16x32_bf16 a[124:127], a[252:255], v[140:143], a[124:127]
    v_mfma_f32_16x16x32_bf16 a[156:159], a[248:251], v[144:147], 0
    buffer_load_dwordx4 v240, s[16:19], s54 offen offset:3072 sc1 lds
    v_mfma_f32_16x16x32_bf16 a[156:159], a[252:255], v[148:151], a[156:159]
    s_mov_b32 m0, s53
    v_mfma_f32_16x16x32_bf16 a[188:191], a[248:251], v[152:155], 0
    v_mfma_f32_16x16x32_bf16 a[188:191], a[252:255], v[156:159], a[188:191]
    v_mfma_f32_16x16x32_bf16 v[176:179], v[192:195], v[128:131], 0
    v_mfma_f32_16x16x32_bf16 v[176:179], v[192:195], v[132:135], v[176:179]
    v_mfma_f32_16x16x32_bf16 v[180:183], v[192:195], v[136:139], 0
    v_mfma_f32_16x16x32_bf16 v[180:183], v[192:195], v[140:143], v[180:183]
    s_waitcnt lgkmcnt(7)
    s_bitcmp1_b32 s35, 0
    s_cselect_b64 vcc, -1, 0
    v_cndmask_b32 v196, v240, v246, vcc
    v_cndmask_b32 v198, v246, v240, vcc
    buffer_store_dword v249, v248, s[20:23], s98 offen sc1
    s_sub_u32 s47, s30, 1
    s_cmp_eq_u32 s47, 0
    s_cbranch_scc1 L_uddm
.p2align 3
L_udd:
    v_mfma_f32_16x16x32_bf16 v[0:3], a[192:195], a[0:3], v[160:163]
    s_waitcnt lgkmcnt(6)
    v_exp_f32 v74, v74
    v_mfma_f32_16x16x32_bf16 v[0:3], a[196:199], a[4:7], v[0:3]
    s_waitcnt lgkmcnt(5)
    v_exp_f32 v75, v75
    v_mfma_f32_16x16x32_bf16 v[0:3], a[200:203], a[64:67], v[0:3]
    s_waitcnt lgkmcnt(4)
    v_exp_f32 v76, v76
    v_mfma_f32_16x16x32_bf16 v[0:3], a[204:207], a[68:71], v[0:3]
    v_exp_f32 v77, v77
    v_mfma_f32_16x16x32_bf16 v[16:19], a[204:207], a[76:79], v[164:167]
    v_exp_f32 v78, v78
    v_mfma_f32_16x16x32_bf16 v[16:19], a[200:203], a[72:75], v[16:19]
    v_exp_f32 v79, v79
    v_mfma_f32_16x16x32_bf16 v[16:19], a[196:199], a[12:15], v[16:19]
    v_exp_f32 v90, v90
    v_mfma_f32_16x16x32_bf16 v[16:19], a[192:195], a[8:11], v[16:19]
    v_exp_f32 v91, v91
    v_mfma_f32_16x16x32_bf16 v[32:35], a[192:195], a[16:19], v[168:171]
    v_exp_f32 v92, v92
    v_mfma_f32_16x16x32_bf16 v[32:35], a[196:199], a[20:23], v[32:35]
    v_exp_f32 v93, v93
    v_mfma_f32_16x16x32_bf16 v[32:35], a[200:203], a[80:83], v[32:35]
    ds_read_b128 a[224:227], v200 offset:8192
    v_cvt_pk_bf16_f32 v128, v64, v65
    v_mfma_f32_16x16x32_bf16 v[32:35], a[204:207], a[84:87], v[32:35]
    ds_read_b128 a[228:231], v200 offset:9216
    v_cvt_pk_bf16_f32 v129, v66, v67
    v_mfma_f32_16x16x32_bf16 v[48:51], a[204:207], a[92:95], v[172:175]
    ds_read_b128 a[232:235], v200 offset:10240
    v_cvt_pk_bf16_f32 v130, v68, v69
    v_mfma_f32_16x16x32_bf16 v[48:51], a[200:203], a[88:91], v[48:51]
    ds_read_b128 a[236:239], v200 offset:11264
    v_cvt_pk_bf16_f32 v131, v70, v71
    v_mfma_f32_16x16x32_bf16 v[48:51], a[196:199], a[28:31], v[48:51]
    v_exp_f32 v94, v94
    v_mfma_f32_16x16x32_bf16 v[48:51], a[192:195], a[24:27], v[48:51]
    s_waitcnt lgkmcnt(7)
    buffer_load_dwordx4 v240, s[16:19], s55 offen offset:0 sc1 lds
    v_mfma_f32_16x16x32_bf16 v[4:7], a[208:211], a[0:3], v[160:163]
    s_waitcnt lgkmcnt(6)
    v_exp_f32 v95, v95
    v_mfma_f32_16x16x32_bf16 v[4:7], a[212:215], a[4:7], v[4:7]
    s_waitcnt lgkmcnt(5)
    v_exp_f32 v106, v106
    v_mfma_f32_16x16x32_bf16 v[4:7], a[216:219], a[64:67], v[4:7]
    s_waitcnt lgkmcnt(4)
    v_exp_f32 v107, v107
    v_mfma_f32_16x16x32_bf16 v[4:7], a[220:223], a[68:71], v[4:7]
    v_exp_f32 v108, v108
    v_mfma_f32_16x16x32_bf16 v[20:23], a[220:223], a[76:79], v[164:167]
    v_exp_f32 v109, v109
    v_mfma_f32_16x16x32_bf16 v[20:23], a[216:219], a[72:75], v[20:23]
    v_exp_f32 v110, v110
    v_mfma_f32_16x16x32_bf16 v[20:23], a[212:215], a[12:15], v[20:23]
    v_exp_f32 v111, v111
    v_mfma_f32_16x16x32_bf16 v[20:23], a[208:211], a[8:11], v[20:23]
    v_exp_f32 v122, v122
    v_mfma_f32_16x16x32_bf16 v[36:39], a[208:211], a[16:19], v[168:171]
    v_cvt_pk_bf16_f32 v136, v80, v81
    v_cvt_pk_bf16_f32 v137, v82, v83
    v_mfma_f32_16x16x32_bf16 v[36:39], a[212:215], a[20:23], v[36:39]
    v_exp_f32 v123, v123
    v_mfma_f32_16x16x32_bf16 v[36:39], a[216:219], a[80:83], v[36:39]
    ds_read_b128 a[240:243], v200 offset:12288
    v_cvt_pk_bf16_f32 v138, v84, v85
    v_mfma_f32_16x16x32_bf16 v[36:39], a[220:223], a[84:87], v[36:39]
    ds_read_b128 a[244:247], v200 offset:13312
    v_cvt_pk_bf16_f32 v139, v86, v87
    v_mfma_f32_16x16x32_bf16 v[52:55], a[220:223], a[92:95], v[172:175]
    ds_read_b128 a[248:251], v200 offset:14336
    v_cvt_pk_bf16_f32 v144, v96, v97
    v_mfma_f32_16x16x32_bf16 v[52:55], a[216:219], a[88:91], v[52:55]
    ds_read_b128 a[252:255], v200 offset:15360
    v_cvt_pk_bf16_f32 v145, v98, v99
    v_mfma_f32_16x16x32_bf16 v[52:55], a[212:215], a[28:31], v[52:55]
    v_exp_f32 v124, v124
    v_mfma_f32_16x16x32_bf16 v[52:55], a[208:211], a[24:27], v[52:55]
    s_waitcnt lgkmcnt(7)
    v_exp_f32 v125, v125
    v_mfma_f32_16x16x32_bf16 v[8:11], a[224:227], a[0:3], v[160:163]
    s_waitcnt lgkmcnt(6)
    v_cvt_pk_bf16_f32 v146, v100, v101
    v_cvt_pk_bf16_f32 v147, v102, v103
    v_mfma_f32_16x16x32_bf16 v[8:11], a[228:231], a[4:7], v[8:11]
    s_waitcnt lgkmcnt(5)
    v_exp_f32 v126, v126
    v_mfma_f32_16x16x32_bf16 v[8:11], a[232:235], a[64:67], v[8:11]
    s_waitcnt lgkmcnt(4)
    v_cvt_pk_bf16_f32 v152, v112, v113
    v_cvt_pk_bf16_f32 v153, v114, v115
    v_mfma_f32_16x16x32_bf16 v[8:11], a[236:239], a[68:71], v[8:11]
    v_exp_f32 v127, v127
    v_mfma_f32_16x16x32_bf16 v[24:27], a[236:239], a[76:79], v[164:167]
    buffer_load_dwordx4 v240, s[16:19], s55 offen offset:1024 sc1 lds
    v_mfma_f32_16x16x32_bf16 v[24:27], a[232:235], a[72:75], v[24:27]
    v_cvt_pk_bf16_f32 v154, v116, v117
    v_cvt_pk_bf16_f32 v155, v118, v119
    v_mfma_f32_16x16x32_bf16 v[24:27], a[228:231], a[12:15], v[24:27]
    v_exp_f32 v0, v0
    v_mfma_f32_16x16x32_bf16 v[24:27], a[224:227], a[8:11], v[24:27]
    v_cvt_pk_bf16_f32 v132, v72, v73
    v_cvt_pk_bf16_f32 v133, v74, v75
    v_mfma_f32_16x16x32_bf16 v[40:43], a[224:227], a[16:19], v[168:171]
    v_exp_f32 v1, v1
    v_mfma_f32_16x16x32_bf16 v[40:43], a[228:231], a[20:23], v[40:43]
    v_cvt_pk_bf16_f32 v134, v76, v77
    v_cvt_pk_bf16_f32 v135, v78, v79
    v_mfma_f32_16x16x32_bf16 v[40:43], a[232:235], a[80:83], v[40:43]
    ds_read_b128 a[192:195], v201 offset:49152
    v_cvt_pk_bf16_f32 v140, v88, v89
    v_mfma_f32_16x16x32_bf16 v[40:43], a[236:239], a[84:87], v[40:43]
    ds_read_b128 a[196:199], v201 offset:57344
    v_cvt_pk_bf16_f32 v141, v90, v91
    v_mfma_f32_16x16x32_bf16 v[56:59], a[236:239], a[92:95], v[172:175]
    v_exp_f32 v2, v2
    v_mfma_f32_16x16x32_bf16 v[56:59], a[232:235], a[88:91], v[56:59]
    v_exp_f32 v3, v3
    v_mfma_f32_16x16x32_bf16 v[56:59], a[228:231], a[28:31], v[56:59]
    v_cvt_pk_bf16_f32 v142, v92, v93
    v_cvt_pk_bf16_f32 v143, v94, v95
    v_mfma_f32_16x16x32_bf16 v[56:59], a[224:227], a[24:27], v[56:59]
    s_waitcnt lgkmcnt(5)
    v_exp_f32 v16, v16
    v_mfma_f32_16x16x32_bf16 v[12:15], a[240:243], a[0:3], v[160:163]
    s_waitcnt lgkmcnt(4)
    v_cvt_pk_bf16_f32 v148, v104, v105
    v_cvt_pk_bf16_f32 v149, v106, v107
    v_mfma_f32_16x16x32_bf16 v[12:15], a[244:247], a[4:7], v[12:15]
    s_waitcnt lgkmcnt(3)
    v_exp_f32 v17, v17
    v_mfma_f32_16x16x32_bf16 v[12:15], a[248:251], a[64:67], v[12:15]
    s_waitcnt lgkmcnt(2)
    ds_read_b128 a[200:203], v201 offset:50176
    v_cvt_pk_bf16_f32 v150, v108, v109
    v_mfma_f32_16x16x32_bf16 v[12:15], a[252:255], a[68:71], v[12:15]
    ds_read_b128 a[204:207], v201 offset:58368
    v_cvt_pk_bf16_f32 v151, v110, v111
    v_mfma_f32_16x16x32_bf16 v[28:31], a[252:255], a[76:79], v[164:167]
    v_exp_f32 v18, v18
    v_mfma_f32_16x16x32_bf16 v[28:31], a[248:251], a[72:75], v[28:31]
    v_cvt_pk_bf16_f32 v156, v120, v121
    v_cvt_pk_bf16_f32 v157, v122, v123
    v_mfma_f32_16x16x32_bf16 v[28:31], a[244:247], a[12:15], v[28:31]
    v_exp_f32 v19, v19
    v_mfma_f32_16x16x32_bf16 v[28:31], a[240:243], a[8:11], v[28:31]
    v_cvt_pk_bf16_f32 v158, v124, v125
    v_cvt_pk_bf16_f32 v159, v126, v127
    v_mfma_f32_16x16x32_bf16 v[44:47], a[240:243], a[16:19], v[168:171]
    v_exp_f32 v32, v32
    v_mfma_f32_16x16x32_bf16 v[44:47], a[244:247], a[20:23], v[44:47]
    v_exp_f32 v33, v33
    v_mfma_f32_16x16x32_bf16 v[44:47], a[248:251], a[80:83], v[44:47]
    ds_read_b128 a[208:211], v201 offset:51200
    v_add_f32 v184, v184, v96
    v_mfma_f32_16x16x32_bf16 v[44:47], a[252:255], a[84:87], v[44:47]
    ds_read_b128 a[212:215], v201 offset:59392
    v_add_f32 v184, v184, v97
    v_mfma_f32_16x16x32_bf16 v[60:63], a[252:255], a[92:95], v[172:175]
    v_exp_f32 v34, v34
    v_mfma_f32_16x16x32_bf16 v[60:63], a[248:251], a[88:91], v[60:63]
    v_exp_f32 v35, v35
    v_mfma_f32_16x16x32_bf16 v[60:63], a[244:247], a[28:31], v[60:63]
    buffer_load_dwordx4 v240, s[16:19], s55 offen offset:2048 sc1 lds
    v_mfma_f32_16x16x32_bf16 v[60:63], a[240:243], a[24:27], v[60:63]
    s_waitcnt lgkmcnt(5)
    v_exp_f32 v48, v48
    v_mfma_f32_16x16x32_bf16 a[32:35], a[192:195], v[128:131], a[32:35]
    s_waitcnt lgkmcnt(4)
    v_exp_f32 v49, v49
    v_mfma_f32_16x16x32_bf16 a[32:35], a[196:199], v[132:135], a[32:35]
    v_exp_f32 v50, v50
    v_mfma_f32_16x16x32_bf16 a[96:99], a[192:195], v[136:139], a[96:99]
    ds_read_b128 a[216:219], v201 offset:52224
    v_add_f32 v184, v184, v98
    v_mfma_f32_16x16x32_bf16 a[96:99], a[196:199], v[140:143], a[96:99]
    ds_read_b128 a[220:223], v201 offset:60416
    v_add_f32 v184, v184, v99
    v_mfma_f32_16x16x32_bf16 a[128:131], a[192:195], v[144:147], a[128:131]
    v_exp_f32 v51, v51
    v_mfma_f32_16x16x32_bf16 a[128:131], a[196:199], v[148:151], a[128:131]
    v_exp_f32 v4, v4
    v_mfma_f32_16x16x32_bf16 a[160:163], a[192:195], v[152:155], a[160:163]
    v_exp_f32 v5, v5
    v_mfma_f32_16x16x32_bf16 a[160:163], a[196:199], v[156:159], a[160:163]
    s_waitcnt lgkmcnt(5)
    v_exp_f32 v6, v6
    v_mfma_f32_16x16x32_bf16 a[36:39], a[200:203], v[128:131], a[36:39]
    s_waitcnt lgkmcnt(4)
    v_exp_f32 v7, v7
    v_mfma_f32_16x16x32_bf16 a[36:39], a[204:207], v[132:135], a[36:39]
    v_exp_f32 v20, v20
    v_mfma_f32_16x16x32_bf16 a[100:103], a[200:203], v[136:139], a[100:103]
    ds_read_b128 a[224:227], v201 offset:53248
    v_add_f32 v184, v184, v100
    v_mfma_f32_16x16x32_bf16 a[100:103], a[204:207], v[140:143], a[100:103]
    ds_read_b128 a[228:231], v201 offset:61440
    v_add_f32 v184, v184, v101
    v_mfma_f32_16x16x32_bf16 a[132:135], a[200:203], v[144:147], a[132:135]
    v_exp_f32 v21, v21
    v_mfma_f32_16x16x32_bf16 a[132:135], a[204:207], v[148:151], a[132:135]
    v_exp_f32 v22, v22
    v_mfma_f32_16x16x32_bf16 a[164:167], a[200:203], v[152:155], a[164:167]
    v_exp_f32 v23, v23
    v_mfma_f32_16x16x32_bf16 a[164:167], a[204:207], v[156:159], a[164:167]
    s_waitcnt lgkmcnt(5)
    v_exp_f32 v36, v36
    v_mfma_f32_16x16x32_bf16 a[40:43], a[208:211], v[128:131], a[40:43]
    s_waitcnt lgkmcnt(4)
    buffer_load_dwordx4 v240, s[16:19], s55 offen offset:3072 sc1 lds
    v_mfma_f32_16x16x32_bf16 a[40:43], a[212:215], v[132:135], a[40:43]
    s_add_u32 s54, s54, 0x8000
    v_exp_f32 v37, v37
    v_mfma_f32_16x16x32_bf16 a[104:107], a[208:211], v[136:139], a[104:107]
    s_add_u32 s52, s52, 0x8000
    ds_read_b128 a[232:235], v201 offset:54272
    v_add_f32 v184, v184, v102
    v_mfma_f32_16x16x32_bf16 a[104:107], a[212:215], v[140:143], a[104:107]
    s_and_b32 s52, s52, 0x1ffff
    ds_read_b128 a[236:239], v201 offset:62464
    v_add_f32 v184, v184, v103
    v_mfma_f32_16x16x32_bf16 a[136:139], a[208:211], v[144:147], a[136:139]
    s_mov_b32 m0, s52
    v_exp_f32 v38, v38
    v_mfma_f32_16x16x32_bf16 a[136:139], a[212:215], v[148:151], a[136:139]
    s_add_u32 s55, s55, 0x8000
    v_exp_f32 v39, v39
    v_mfma_f32_16x16x32_bf16 a[168:171], a[208:211], v[152:155], a[168:171]
    s_add_u32 s53, s53, 0x8000
    v_add_f32 v188, v188, v112
    v_add_f32 v188, v188, v113
    v_mfma_f32_16x16x32_bf16 a[168:171], a[212:215], v[156:159], a[168:171]
    s_waitcnt lgkmcnt(5)
    v_exp_f32 v52, v52
    v_mfma_f32_16x16x32_bf16 a[44:47], a[216:219], v[128:131], a[44:47]
    s_waitcnt lgkmcnt(4)
    v_add_f32 v188, v188, v114
    v_add_f32 v188, v188, v115
    v_mfma_f32_16x16x32_bf16 a[44:47], a[220:223], v[132:135], a[44:47]
    s_and_b32 s53, s53, 0x1ffff
    v_exp_f32 v53, v53
    v_mfma_f32_16x16x32_bf16 a[108:111], a[216:219], v[136:139], a[108:111]
    ds_read_b128 a[240:243], v201 offset:55296
    v_add_f32 v188, v188, v116
    v_mfma_f32_16x16x32_bf16 a[108:111], a[220:223], v[140:143], a[108:111]
    ds_read_b128 a[244:247], v201 offset:63488
    v_add_f32 v188, v188, v117
    v_mfma_f32_16x16x32_bf16 a[140:143], a[216:219], v[144:147], a[140:143]
    v_exp_f32 v54, v54
    v_mfma_f32_16x16x32_bf16 a[140:143], a[220:223], v[148:151], a[140:143]
    v_add_f32 v188, v188, v118
    v_add_f32 v188, v188, v119
    v_mfma_f32_16x16x32_bf16 a[172:175], a[216:219], v[152:155], a[172:175]
    v_exp_f32 v55, v55
    v_mfma_f32_16x16x32_bf16 a[172:175], a[220:223], v[156:159], a[172:175]
    s_waitcnt lgkmcnt(5)
    v_add_f32 v184, v184, v104
    v_add_f32 v184, v184, v105
    v_mfma_f32_16x16x32_bf16 a[48:51], a[224:227], v[128:131], a[48:51]
    s_waitcnt lgkmcnt(4)
    v_exp_f32 v8, v8
    v_mfma_f32_16x16x32_bf16 a[48:51], a[228:231], v[132:135], a[48:51]
    v_add_f32 v184, v184, v106
    v_add_f32 v184, v184, v107
    v_mfma_f32_16x16x32_bf16 a[112:115], a[224:227], v[136:139], a[112:115]
    ds_read_b128 a[248:251], v201 offset:56320
    v_add_f32 v184, v184, v108
    v_mfma_f32_16x16x32_bf16 a[112:115], a[228:231], v[140:143], a[112:115]
    ds_read_b128 a[252:255], v201 offset:64512
    v_add_f32 v184, v184, v109
    v_mfma_f32_16x16x32_bf16 a[144:147], a[224:227], v[144:147], a[144:147]
    v_exp_f32 v9, v9
    v_mfma_f32_16x16x32_bf16 a[144:147], a[228:231], v[148:151], a[144:147]
    v_exp_f32 v24, v24
    v_mfma_f32_16x16x32_bf16 a[176:179], a[224:227], v[152:155], a[176:179]
    v_add_f32 v184, v184, v110
    v_add_f32 v184, v184, v111
    v_mfma_f32_16x16x32_bf16 a[176:179], a[228:231], v[156:159], a[176:179]
    s_waitcnt lgkmcnt(5)
    v_exp_f32 v25, v25
    v_mfma_f32_16x16x32_bf16 a[52:55], a[232:235], v[128:131], a[52:55]
    s_waitcnt lgkmcnt(4)
    v_add_f32 v188, v188, v120
    v_add_f32 v188, v188, v121
    v_mfma_f32_16x16x32_bf16 a[52:55], a[236:239], v[132:135], a[52:55]
    v_exp_f32 v40, v40
    v_mfma_f32_16x16x32_bf16 a[116:119], a[232:235], v[136:139], a[116:119]
    v_add_f32 v188, v188, v122
    v_add_f32 v188, v188, v123
    v_mfma_f32_16x16x32_bf16 a[116:119], a[236:239], v[140:143], a[116:119]
    v_exp_f32 v41, v41
    v_mfma_f32_16x16x32_bf16 a[148:151], a[232:235], v[144:147], a[148:151]
    v_add_f32 v188, v188, v124
    v_add_f32 v188, v188, v125
    v_mfma_f32_16x16x32_bf16 a[148:151], a[236:239], v[148:151], a[148:151]
    v_exp_f32 v56, v56
    v_mfma_f32_16x16x32_bf16 a[180:183], a[232:235], v[152:155], a[180:183]
    s_waitcnt vmcnt(16) lgkmcnt(0)
    v_add_f32 v188, v188, v126
    v_add_f32 v188, v188, v127
    v_mfma_f32_16x16x32_bf16 a[180:183], a[236:239], v[156:159], a[180:183]
    s_barrier
    ds_read_b128 a[192:195], v200 offset:32768
    v_mfma_f32_16x16x32_bf16 a[56:59], a[240:243], v[128:131], a[56:59]
    ds_read_b128 a[196:199], v200 offset:33792
    ds_read_b128 a[200:203], v200 offset:34816
    v_mfma_f32_16x16x32_bf16 a[56:59], a[244:247], v[132:135], a[56:59]
    buffer_load_dwordx4 v240, s[16:19], s54 offen offset:0 sc1 lds
    v_mfma_f32_16x16x32_bf16 a[120:123], a[240:243], v[136:139], a[120:123]
    ds_read_b128 a[204:207], v200 offset:35840
    ds_read_b128 a[208:211], v200 offset:36864
    v_mfma_f32_16x16x32_bf16 a[120:123], a[244:247], v[140:143], a[120:123]
    buffer_load_dwordx4 v240, s[16:19], s54 offen offset:1024 sc1 lds
    v_mfma_f32_16x16x32_bf16 a[152:155], a[240:243], v[144:147], a[152:155]
    ds_read_b128 a[212:215], v200 offset:37888
    ds_read_b128 a[216:219], v200 offset:38912
    v_mfma_f32_16x16x32_bf16 a[152:155], a[244:247], v[148:151], a[152:155]
    ds_read_b128 a[220:223], v200 offset:39936
    v_mfma_f32_16x16x32_bf16 a[184:187], a[240:243], v[152:155], a[184:187]
    v_exp_f32 v57, v57
    v_mfma_f32_16x16x32_bf16 a[184:187], a[244:247], v[156:159], a[184:187]
    v_mfma_f32_16x16x32_bf16 a[60:63], a[248:251], v[128:131], a[60:63]
    buffer_load_dwordx4 v240, s[16:19], s54 offen offset:2048 sc1 lds
    v_mfma_f32_16x16x32_bf16 a[60:63], a[252:255], v[132:135], a[60:63]
    v_mfma_f32_16x16x32_bf16 a[124:127], a[248:251], v[136:139], a[124:127]
    v_mfma_f32_16x16x32_bf16 a[124:127], a[252:255], v[140:143], a[124:127]
    v_mfma_f32_16x16x32_bf16 a[156:159], a[248:251], v[144:147], a[156:159]
    buffer_load_dwordx4 v240, s[16:19], s54 offen offset:3072 sc1 lds
    v_mfma_f32_16x16x32_bf16 a[156:159], a[252:255], v[148:151], a[156:159]
    s_mov_b32 m0, s53
    v_mfma_f32_16x16x32_bf16 a[188:191], a[248:251], v[152:155], a[188:191]
    v_mfma_f32_16x16x32_bf16 a[188:191], a[252:255], v[156:159], a[188:191]
    v_mfma_f32_16x16x32_bf16 v[176:179], v[192:195], v[128:131], v[176:179]
    v_mfma_f32_16x16x32_bf16 v[176:179], v[192:195], v[132:135], v[176:179]
    v_mfma_f32_16x16x32_bf16 v[180:183], v[192:195], v[136:139], v[180:183]
    v_mfma_f32_16x16x32_bf16 v[180:183], v[192:195], v[140:143], v[180:183]
    s_waitcnt lgkmcnt(7)
    v_mfma_f32_16x16x32_bf16 v[64:67], a[192:195], a[0:3], v[160:163]
    s_waitcnt lgkmcnt(6)
    v_exp_f32 v10, v10
    v_mfma_f32_16x16x32_bf16 v[64:67], a[196:199], a[4:7], v[64:67]
    s_waitcnt lgkmcnt(5)
    v_exp_f32 v11, v11
    v_mfma_f32_16x16x32_bf16 v[64:67], a[200:203], a[64:67], v[64:67]
    s_waitcnt lgkmcnt(4)
    v_exp_f32 v12, v12
    v_mfma_f32_16x16x32_bf16 v[64:67], a[204:207], a[68:71], v[64:67]
    v_exp_f32 v13, v13
    v_mfma_f32_16x16x32_bf16 v[80:83], a[204:207], a[76:79], v[164:167]
    v_exp_f32 v14, v14
    v_mfma_f32_16x16x32_bf16 v[80:83], a[200:203], a[72:75], v[80:83]
    v_exp_f32 v15, v15
    v_mfma_f32_16x16x32_bf16 v[80:83], a[196:199], a[12:15], v[80:83]
    v_exp_f32 v26, v26
    v_mfma_f32_16x16x32_bf16 v[80:83], a[192:195], a[8:11], v[80:83]
    v_exp_f32 v27, v27
    v_mfma_f32_16x16x32_bf16 v[96:99], a[192:195], a[16:19], v[168:171]
    v_exp_f32 v28, v28
    v_mfma_f32_16x16x32_bf16 v[96:99], a[196:199], a[20:23], v[96:99]
    v_exp_f32 v29, v29
    v_mfma_f32_16x16x32_bf16 v[96:99], a[200:203], a[80:83], v[96:99]
    ds_read_b128 a[224:227], v200 offset:40960
    v_cvt_pk_bf16_f32 v128, v0, v1
    v_mfma_f32_16x16x32_bf16 v[96:99], a[204:207], a[84:87], v[96:99]
    ds_read_b128 a[228:231], v200 offset:41984
    v_cvt_pk_bf16_f32 v129, v2, v3
    v_mfma_f32_16x16x32_bf16 v[112:115], a[204:207], a[92:95], v[172:175]
    ds_read_b128 a[232:235], v200 offset:43008
    v_cvt_pk_bf16_f32 v130, v4, v5
    v_mfma_f32_16x16x32_bf16 v[112:115], a[200:203], a[88:91], v[112:115]
    ds_read_b128 a[236:239], v200 offset:44032
    v_cvt_pk_bf16_f32 v131, v6, v7
    v_mfma_f32_16x16x32_bf16 v[112:115], a[196:199], a[28:31], v[112:115]
    v_exp_f32 v30, v30
    v_mfma_f32_16x16x32_bf16 v[112:115], a[192:195], a[24:27], v[112:115]
    s_waitcnt lgkmcnt(7)
    buffer_load_dwordx4 v240, s[16:19], s55 offen offset:0 sc1 lds
    v_mfma_f32_16x16x32_bf16 v[68:71], a[208:211], a[0:3], v[160:163]
    s_waitcnt lgkmcnt(6)
    v_exp_f32 v31, v31
    v_mfma_f32_16x16x32_bf16 v[68:71], a[212:215], a[4:7], v[68:71]
    s_waitcnt lgkmcnt(5)
    v_exp_f32 v42, v42
    v_mfma_f32_16x16x32_bf16 v[68:71], a[216:219], a[64:67], v[68:71]
    s_waitcnt lgkmcnt(4)
    v_exp_f32 v43, v43
    v_mfma_f32_16x16x32_bf16 v[68:71], a[220:223], a[68:71], v[68:71]
    v_exp_f32 v44, v44
    v_mfma_f32_16x16x32_bf16 v[84:87], a[220:223], a[76:79], v[164:167]
    v_exp_f32 v45, v45
    v_mfma_f32_16x16x32_bf16 v[84:87], a[216:219], a[72:75], v[84:87]
    v_exp_f32 v46, v46
    v_mfma_f32_16x16x32_bf16 v[84:87], a[212:215], a[12:15], v[84:87]
    v_exp_f32 v47, v47
    v_mfma_f32_16x16x32_bf16 v[84:87], a[208:211], a[8:11], v[84:87]
    v_exp_f32 v58, v58
    v_mfma_f32_16x16x32_bf16 v[100:103], a[208:211], a[16:19], v[168:171]
    v_cvt_pk_bf16_f32 v136, v16, v17
    v_cvt_pk_bf16_f32 v137, v18, v19
    v_mfma_f32_16x16x32_bf16 v[100:103], a[212:215], a[20:23], v[100:103]
    v_exp_f32 v59, v59
    v_mfma_f32_16x16x32_bf16 v[100:103], a[216:219], a[80:83], v[100:103]
    ds_read_b128 a[240:243], v200 offset:45056
    v_cvt_pk_bf16_f32 v138, v20, v21
    v_mfma_f32_16x16x32_bf16 v[100:103], a[220:223], a[84:87], v[100:103]
    ds_read_b128 a[244:247], v200 offset:46080
    v_cvt_pk_bf16_f32 v139, v22, v23
    v_mfma_f32_16x16x32_bf16 v[116:119], a[220:223], a[92:95], v[172:175]
    ds_read_b128 a[248:251], v200 offset:47104
    v_cvt_pk_bf16_f32 v144, v32, v33
    v_mfma_f32_16x16x32_bf16 v[116:119], a[216:219], a[88:91], v[116:119]
    ds_read_b128 a[252:255], v200 offset:48128
    v_cvt_pk_bf16_f32 v145, v34, v35
    v_mfma_f32_16x16x32_bf16 v[116:119], a[212:215], a[28:31], v[116:119]
    v_exp_f32 v60, v60
    v_mfma_f32_16x16x32_bf16 v[116:119], a[208:211], a[24:27], v[116:119]
    s_waitcnt lgkmcnt(7)
    v_exp_f32 v61, v61
    v_mfma_f32_16x16x32_bf16 v[72:75], a[224:227], a[0:3], v[160:163]
    s_waitcnt lgkmcnt(6)
    v_cvt_pk_bf16_f32 v146, v36, v37
    v_cvt_pk_bf16_f32 v147, v38, v39
    v_mfma_f32_16x16x32_bf16 v[72:75], a[228:231], a[4:7], v[72:75]
    s_waitcnt lgkmcnt(5)
    v_exp_f32 v62, v62
    v_mfma_f32_16x16x32_bf16 v[72:75], a[232:235], a[64:67], v[72:75]
    s_waitcnt lgkmcnt(4)
    v_cvt_pk_bf16_f32 v152, v48, v49
    v_cvt_pk_bf16_f32 v153, v50, v51
    v_mfma_f32_16x16x32_bf16 v[72:75], a[236:239], a[68:71], v[72:75]
    v_exp_f32 v63, v63
    v_mfma_f32_16x16x32_bf16 v[88:91], a[236:239], a[76:79], v[164:167]
    buffer_load_dwordx4 v240, s[16:19], s55 offen offset:1024 sc1 lds
    v_mfma_f32_16x16x32_bf16 v[88:91], a[232:235], a[72:75], v[88:91]
    v_cvt_pk_bf16_f32 v154, v52, v53
    v_cvt_pk_bf16_f32 v155, v54, v55
    v_mfma_f32_16x16x32_bf16 v[88:91], a[228:231], a[12:15], v[88:91]
    v_exp_f32 v64, v64
    v_mfma_f32_16x16x32_bf16 v[88:91], a[224:227], a[8:11], v[88:91]
    v_cvt_pk_bf16_f32 v132, v8, v9
    v_cvt_pk_bf16_f32 v133, v10, v11
    v_mfma_f32_16x16x32_bf16 v[104:107], a[224:227], a[16:19], v[168:171]
    v_exp_f32 v65, v65
    v_mfma_f32_16x16x32_bf16 v[104:107], a[228:231], a[20:23], v[104:107]
    v_cvt_pk_bf16_f32 v134, v12, v13
    v_cvt_pk_bf16_f32 v135, v14, v15
    v_mfma_f32_16x16x32_bf16 v[104:107], a[232:235], a[80:83], v[104:107]
    ds_read_b128 a[192:195], v200 offset:16384
    v_cvt_pk_bf16_f32 v140, v24, v25
    v_mfma_f32_16x16x32_bf16 v[104:107], a[236:239], a[84:87], v[104:107]
    ds_read_b128 a[196:199], v200 offset:24576
    v_cvt_pk_bf16_f32 v141, v26, v27
    v_mfma_f32_16x16x32_bf16 v[120:123], a[236:239], a[92:95], v[172:175]
    v_exp_f32 v66, v66
    v_mfma_f32_16x16x32_bf16 v[120:123], a[232:235], a[88:91], v[120:123]
    v_exp_f32 v67, v67
    v_mfma_f32_16x16x32_bf16 v[120:123], a[228:231], a[28:31], v[120:123]
    v_cvt_pk_bf16_f32 v142, v28, v29
    v_cvt_pk_bf16_f32 v143, v30, v31
    v_mfma_f32_16x16x32_bf16 v[120:123], a[224:227], a[24:27], v[120:123]
    s_waitcnt lgkmcnt(5)
    v_exp_f32 v80, v80
    v_mfma_f32_16x16x32_bf16 v[76:79], a[240:243], a[0:3], v[160:163]
    s_waitcnt lgkmcnt(4)
    v_cvt_pk_bf16_f32 v148, v40, v41
    v_cvt_pk_bf16_f32 v149, v42, v43
    v_mfma_f32_16x16x32_bf16 v[76:79], a[244:247], a[4:7], v[76:79]
    s_waitcnt lgkmcnt(3)
    v_exp_f32 v81, v81
    v_mfma_f32_16x16x32_bf16 v[76:79], a[248:251], a[64:67], v[76:79]
    s_waitcnt lgkmcnt(2)
    ds_read_b128 a[200:203], v200 offset:17408
    v_cvt_pk_bf16_f32 v150, v44, v45
    v_mfma_f32_16x16x32_bf16 v[76:79], a[252:255], a[68:71], v[76:79]
    ds_read_b128 a[204:207], v200 offset:25600
    v_cvt_pk_bf16_f32 v151, v46, v47
    v_mfma_f32_16x16x32_bf16 v[92:95], a[252:255], a[76:79], v[164:167]
    v_exp_f32 v82, v82
    v_mfma_f32_16x16x32_bf16 v[92:95], a[248:251], a[72:75], v[92:95]
    v_cvt_pk_bf16_f32 v156, v56, v57
    v_cvt_pk_bf16_f32 v157, v58, v59
    v_mfma_f32_16x16x32_bf16 v[92:95], a[244:247], a[12:15], v[92:95]
    v_exp_f32 v83, v83
    v_mfma_f32_16x16x32_bf16 v[92:95], a[240:243], a[8:11], v[92:95]
    v_cvt_pk_bf16_f32 v158, v60, v61
    v_cvt_pk_bf16_f32 v159, v62, v63
    v_mfma_f32_16x16x32_bf16 v[108:111], a[240:243], a[16:19], v[168:171]
    v_exp_f32 v96, v96
    v_mfma_f32_16x16x32_bf16 v[108:111], a[244:247], a[20:23], v[108:111]
    v_exp_f32 v97, v97
    v_mfma_f32_16x16x32_bf16 v[108:111], a[248:251], a[80:83], v[108:111]
    ds_read_b128 a[208:211], v200 offset:18432
    v_add_f32 v184, v184, v32
    v_mfma_f32_16x16x32_bf16 v[108:111], a[252:255], a[84:87], v[108:111]
    ds_read_b128 a[212:215], v200 offset:26624
    v_add_f32 v184, v184, v33
    v_mfma_f32_16x16x32_bf16 v[124:127], a[252:255], a[92:95], v[172:175]
    v_exp_f32 v98, v98
    v_mfma_f32_16x16x32_bf16 v[124:127], a[248:251], a[88:91], v[124:127]
    v_exp_f32 v99, v99
    v_mfma_f32_16x16x32_bf16 v[124:127], a[244:247], a[28:31], v[124:127]
    buffer_load_dwordx4 v240, s[16:19], s55 offen offset:2048 sc1 lds
    v_mfma_f32_16x16x32_bf16 v[124:127], a[240:243], a[24:27], v[124:127]
    s_waitcnt lgkmcnt(5)
    v_exp_f32 v112, v112
    v_mfma_f32_16x16x32_bf16 a[32:35], a[192:195], v[128:131], a[32:35]
    s_waitcnt lgkmcnt(4)
    v_exp_f32 v113, v113
    v_mfma_f32_16x16x32_bf16 a[32:35], a[196:199], v[132:135], a[32:35]
    v_exp_f32 v114, v114
    v_mfma_f32_16x16x32_bf16 a[96:99], a[192:195], v[136:139], a[96:99]
    ds_read_b128 a[216:219], v200 offset:19456
    v_add_f32 v184, v184, v34
    v_mfma_f32_16x16x32_bf16 a[96:99], a[196:199], v[140:143], a[96:99]
    ds_read_b128 a[220:223], v200 offset:27648
    v_add_f32 v184, v184, v35
    v_mfma_f32_16x16x32_bf16 a[128:131], a[192:195], v[144:147], a[128:131]
    v_exp_f32 v115, v115
    v_mfma_f32_16x16x32_bf16 a[128:131], a[196:199], v[148:151], a[128:131]
    v_exp_f32 v68, v68
    v_mfma_f32_16x16x32_bf16 a[160:163], a[192:195], v[152:155], a[160:163]
    v_exp_f32 v69, v69
    v_mfma_f32_16x16x32_bf16 a[160:163], a[196:199], v[156:159], a[160:163]
    s_waitcnt lgkmcnt(5)
    v_exp_f32 v70, v70
    v_mfma_f32_16x16x32_bf16 a[36:39], a[200:203], v[128:131], a[36:39]
    s_waitcnt lgkmcnt(4)
    v_exp_f32 v71, v71
    v_mfma_f32_16x16x32_bf16 a[36:39], a[204:207], v[132:135], a[36:39]
    v_exp_f32 v84, v84
    v_mfma_f32_16x16x32_bf16 a[100:103], a[200:203], v[136:139], a[100:103]
    ds_read_b128 a[224:227], v200 offset:20480
    v_add_f32 v184, v184, v36
    v_mfma_f32_16x16x32_bf16 a[100:103], a[204:207], v[140:143], a[100:103]
    ds_read_b128 a[228:231], v200 offset:28672
    v_add_f32 v184, v184, v37
    v_mfma_f32_16x16x32_bf16 a[132:135], a[200:203], v[144:147], a[132:135]
    v_exp_f32 v85, v85
    v_mfma_f32_16x16x32_bf16 a[132:135], a[204:207], v[148:151], a[132:135]
    v_exp_f32 v86, v86
    v_mfma_f32_16x16x32_bf16 a[164:167], a[200:203], v[152:155], a[164:167]
    v_exp_f32 v87, v87
    v_mfma_f32_16x16x32_bf16 a[164:167], a[204:207], v[156:159], a[164:167]
    s_waitcnt lgkmcnt(5)
    v_exp_f32 v100, v100
    v_mfma_f32_16x16x32_bf16 a[40:43], a[208:211], v[128:131], a[40:43]
    s_waitcnt lgkmcnt(4)
    buffer_load_dwordx4 v240, s[16:19], s55 offen offset:3072 sc1 lds
    v_mfma_f32_16x16x32_bf16 a[40:43], a[212:215], v[132:135], a[40:43]
    s_add_u32 s54, s54, 0x8000
    v_exp_f32 v101, v101
    v_mfma_f32_16x16x32_bf16 a[104:107], a[208:211], v[136:139], a[104:107]
    s_add_u32 s52, s52, 0x8000
    ds_read_b128 a[232:235], v200 offset:21504
    v_add_f32 v184, v184, v38
    v_mfma_f32_16x16x32_bf16 a[104:107], a[212:215], v[140:143], a[104:107]
    s_and_b32 s52, s52, 0x1ffff
    ds_read_b128 a[236:239], v200 offset:29696
    v_add_f32 v184, v184, v39
    v_mfma_f32_16x16x32_bf16 a[136:139], a[208:211], v[144:147], a[136:139]
    s_mov_b32 m0, s52
    v_exp_f32 v102, v102
    v_mfma_f32_16x16x32_bf16 a[136:139], a[212:215], v[148:151], a[136:139]
    s_add_u32 s55, s55, 0x8000
    v_exp_f32 v103, v103
    v_mfma_f32_16x16x32_bf16 a[168:171], a[208:211], v[152:155], a[168:171]
    s_add_u32 s53, s53, 0x8000
    v_add_f32 v188, v188, v48
    v_add_f32 v188, v188, v49
    v_mfma_f32_16x16x32_bf16 a[168:171], a[212:215], v[156:159], a[168:171]
    s_waitcnt lgkmcnt(5)
    v_exp_f32 v116, v116
    v_mfma_f32_16x16x32_bf16 a[44:47], a[216:219], v[128:131], a[44:47]
    s_waitcnt lgkmcnt(4)
    v_add_f32 v188, v188, v50
    v_add_f32 v188, v188, v51
    v_mfma_f32_16x16x32_bf16 a[44:47], a[220:223], v[132:135], a[44:47]
    s_and_b32 s53, s53, 0x1ffff
    v_exp_f32 v117, v117
    v_mfma_f32_16x16x32_bf16 a[108:111], a[216:219], v[136:139], a[108:111]
    s_sub_u32 s47, s47, 1
    ds_read_b128 a[240:243], v200 offset:22528
    v_add_f32 v188, v188, v52
    v_mfma_f32_16x16x32_bf16 a[108:111], a[220:223], v[140:143], a[108:111]
    s_cmp_lg_u32 s47, 0
    ds_read_b128 a[244:247], v200 offset:30720
    v_add_f32 v188, v188, v53
    v_mfma_f32_16x16x32_bf16 a[140:143], a[216:219], v[144:147], a[140:143]
    v_exp_f32 v118, v118
    v_mfma_f32_16x16x32_bf16 a[140:143], a[220:223], v[148:151], a[140:143]
    v_add_f32 v188, v188, v54
    v_add_f32 v188, v188, v55
    v_mfma_f32_16x16x32_bf16 a[172:175], a[216:219], v[152:155], a[172:175]
    v_exp_f32 v119, v119
    v_mfma_f32_16x16x32_bf16 a[172:175], a[220:223], v[156:159], a[172:175]
    s_waitcnt lgkmcnt(5)
    v_add_f32 v184, v184, v40
    v_add_f32 v184, v184, v41
    v_mfma_f32_16x16x32_bf16 a[48:51], a[224:227], v[128:131], a[48:51]
    s_waitcnt lgkmcnt(4)
    v_exp_f32 v72, v72
    v_mfma_f32_16x16x32_bf16 a[48:51], a[228:231], v[132:135], a[48:51]
    v_add_f32 v184, v184, v42
    v_add_f32 v184, v184, v43
    v_mfma_f32_16x16x32_bf16 a[112:115], a[224:227], v[136:139], a[112:115]
    ds_read_b128 a[248:251], v200 offset:23552
    v_add_f32 v184, v184, v44
    v_mfma_f32_16x16x32_bf16 a[112:115], a[228:231], v[140:143], a[112:115]
    ds_read_b128 a[252:255], v200 offset:31744
    v_add_f32 v184, v184, v45
    v_mfma_f32_16x16x32_bf16 a[144:147], a[224:227], v[144:147], a[144:147]
    v_exp_f32 v73, v73
    v_mfma_f32_16x16x32_bf16 a[144:147], a[228:231], v[148:151], a[144:147]
    v_exp_f32 v88, v88
    v_mfma_f32_16x16x32_bf16 a[176:179], a[224:227], v[152:155], a[176:179]
    v_add_f32 v184, v184, v46
    v_add_f32 v184, v184, v47
    v_mfma_f32_16x16x32_bf16 a[176:179], a[228:231], v[156:159], a[176:179]
    s_waitcnt lgkmcnt(5)
    v_exp_f32 v89, v89
    v_mfma_f32_16x16x32_bf16 a[52:55], a[232:235], v[128:131], a[52:55]
    s_waitcnt lgkmcnt(4)
    v_add_f32 v188, v188, v56
    v_add_f32 v188, v188, v57
    v_mfma_f32_16x16x32_bf16 a[52:55], a[236:239], v[132:135], a[52:55]
    v_exp_f32 v104, v104
    v_mfma_f32_16x16x32_bf16 a[116:119], a[232:235], v[136:139], a[116:119]
    v_add_f32 v188, v188, v58
    v_add_f32 v188, v188, v59
    v_mfma_f32_16x16x32_bf16 a[116:119], a[236:239], v[140:143], a[116:119]
    v_exp_f32 v105, v105
    v_mfma_f32_16x16x32_bf16 a[148:151], a[232:235], v[144:147], a[148:151]
    v_add_f32 v188, v188, v60
    v_add_f32 v188, v188, v61
    v_mfma_f32_16x16x32_bf16 a[148:151], a[236:239], v[148:151], a[148:151]
    v_exp_f32 v120, v120
    v_mfma_f32_16x16x32_bf16 a[180:183], a[232:235], v[152:155], a[180:183]
    s_waitcnt vmcnt(16) lgkmcnt(0)
    v_xor_b32 v200, 0x10000, v200
    v_add_f32 v188, v188, v62
    v_mfma_f32_16x16x32_bf16 a[180:183], a[236:239], v[156:159], a[180:183]
    s_barrier
    ds_read_b128 a[192:195], v201 offset:0
    v_mfma_f32_16x16x32_bf16 a[56:59], a[240:243], v[128:131], a[56:59]
    ds_read_b128 a[196:199], v201 offset:1024
    ds_read_b128 a[200:203], v201 offset:2048
    v_mfma_f32_16x16x32_bf16 a[56:59], a[244:247], v[132:135], a[56:59]
    buffer_load_dwordx4 v240, s[16:19], s54 offen offset:0 sc1 lds
    v_mfma_f32_16x16x32_bf16 a[120:123], a[240:243], v[136:139], a[120:123]
    ds_read_b128 a[204:207], v201 offset:3072
    ds_read_b128 a[208:211], v201 offset:4096
    v_mfma_f32_16x16x32_bf16 a[120:123], a[244:247], v[140:143], a[120:123]
    buffer_load_dwordx4 v240, s[16:19], s54 offen offset:1024 sc1 lds
    v_mfma_f32_16x16x32_bf16 a[152:155], a[240:243], v[144:147], a[152:155]
    ds_read_b128 a[212:215], v201 offset:5120
    ds_read_b128 a[216:219], v201 offset:6144
    v_mfma_f32_16x16x32_bf16 a[152:155], a[244:247], v[148:151], a[152:155]
    ds_read_b128 a[220:223], v201 offset:7168
    v_add_f32 v188, v188, v63
    v_mfma_f32_16x16x32_bf16 a[184:187], a[240:243], v[152:155], a[184:187]
    v_exp_f32 v121, v121
    v_mfma_f32_16x16x32_bf16 a[184:187], a[244:247], v[156:159], a[184:187]
    v_xor_b32 v201, 0x10000, v201
    v_mfma_f32_16x16x32_bf16 a[60:63], a[248:251], v[128:131], a[60:63]
    buffer_load_dwordx4 v240, s[16:19], s54 offen offset:2048 sc1 lds
    v_mfma_f32_16x16x32_bf16 a[60:63], a[252:255], v[132:135], a[60:63]
    v_mfma_f32_16x16x32_bf16 a[124:127], a[248:251], v[136:139], a[124:127]
    v_mfma_f32_16x16x32_bf16 a[124:127], a[252:255], v[140:143], a[124:127]
    v_mfma_f32_16x16x32_bf16 a[156:159], a[248:251], v[144:147], a[156:159]
    buffer_load_dwordx4 v240, s[16:19], s54 offen offset:3072 sc1 lds
    v_mfma_f32_16x16x32_bf16 a[156:159], a[252:255], v[148:151], a[156:159]
    s_mov_b32 m0, s53
    v_mfma_f32_16x16x32_bf16 a[188:191], a[248:251], v[152:155], a[188:191]
    v_mfma_f32_16x16x32_bf16 a[188:191], a[252:255], v[156:159], a[188:191]
    v_mfma_f32_16x16x32_bf16 v[176:179], v[192:195], v[128:131], v[176:179]
    v_mfma_f32_16x16x32_bf16 v[176:179], v[192:195], v[132:135], v[176:179]
    v_mfma_f32_16x16x32_bf16 v[180:183], v[192:195], v[136:139], v[180:183]
    v_mfma_f32_16x16x32_bf16 v[180:183], v[192:195], v[140:143], v[180:183]
    s_waitcnt lgkmcnt(7)
    s_cbranch_scc1 L_udd
    s_cmp_eq_u32 s30, 7
    s_cbranch_scc1 L_last7
L_uddm:
    v_mfma_f32_16x16x32_bf16 v[0:3], a[192:195], a[0:3], v[160:163]
    s_waitcnt lgkmcnt(6)
    v_exp_f32 v74, v74
    v_mfma_f32_16x16x32_bf16 v[0:3], a[196:199], a[4:7], v[0:3]
    s_waitcnt lgkmcnt(5)
    v_exp_f32 v75, v75
    v_mfma_f32_16x16x32_bf16 v[0:3], a[200:203], a[64:67], v[0:3]
    s_waitcnt lgkmcnt(4)
    v_exp_f32 v76, v76
    v_mfma_f32_16x16x32_bf16 v[0:3], a[204:207], a[68:71], v[0:3]
    v_exp_f32 v77, v77
    v_mfma_f32_16x16x32_bf16 v[16:19], a[204:207], a[76:79], v[164:167]
    v_exp_f32 v78, v78
    v_mfma_f32_16x16x32_bf16 v[16:19], a[200:203], a[72:75], v[16:19]
    v_exp_f32 v79, v79
    v_mfma_f32_16x16x32_bf16 v[16:19], a[196:199], a[12:15], v[16:19]
    v_exp_f32 v90, v90
    v_mfma_f32_16x16x32_bf16 v[16:19], a[192:195], a[8:11], v[16:19]
    v_exp_f32 v91, v91
    v_mfma_f32_16x16x32_bf16 v[32:35], a[192:195], a[16:19], v[168:171]
    v_exp_f32 v92, v92
    v_mfma_f32_16x16x32_bf16 v[32:35], a[196:199], a[20:23], v[32:35]
    v_exp_f32 v93, v93
    v_mfma_f32_16x16x32_bf16 v[32:35], a[200:203], a[80:83], v[32:35]
    ds_read_b128 a[224:227], v200 offset:8192
    v_cvt_pk_bf16_f32 v128, v64, v65
    v_mfma_f32_16x16x32_bf16 v[32:35], a[204:207], a[84:87], v[32:35]
    ds_read_b128 a[228:231], v200 offset:9216
    v_cvt_pk_bf16_f32 v129, v66, v67
    v_mfma_f32_16x16x32_bf16 v[48:51], a[204:207], a[92:95], v[172:175]
    ds_read_b128 a[232:235], v200 offset:10240
    v_cvt_pk_bf16_f32 v130, v68, v69
    v_mfma_f32_16x16x32_bf16 v[48:51], a[200:203], a[88:91], v[48:51]
    ds_read_b128 a[236:239], v200 offset:11264
    v_cvt_pk_bf16_f32 v131, v70, v71
    v_mfma_f32_16x16x32_bf16 v[48:51], a[196:199], a[28:31], v[48:51]
    v_exp_f32 v94, v94
    v_mfma_f32_16x16x32_bf16 v[48:51], a[192:195], a[24:27], v[48:51]
    s_waitcnt lgkmcnt(7)
    buffer_load_dwordx4 v240, s[16:19], s55 offen offset:0 sc1 lds
    v_mfma_f32_16x16x32_bf16 v[4:7], a[208:211], a[0:3], v[160:163]
    s_waitcnt lgkmcnt(6)
    v_exp_f32 v95, v95
    v_mfma_f32_16x16x32_bf16 v[4:7], a[212:215], a[4:7], v[4:7]
    s_waitcnt lgkmcnt(5)
    v_exp_f32 v106, v106
    v_mfma_f32_16x16x32_bf16 v[4:7], a[216:219], a[64:67], v[4:7]
    s_waitcnt lgkmcnt(4)
    v_exp_f32 v107, v107
    v_mfma_f32_16x16x32_bf16 v[4:7], a[220:223], a[68:71], v[4:7]
    v_exp_f32 v108, v108
    v_mfma_f32_16x16x32_bf16 v[20:23], a[220:223], a[76:79], v[164:167]
    v_exp_f32 v109, v109
    v_mfma_f32_16x16x32_bf16 v[20:23], a[216:219], a[72:75], v[20:23]
    v_exp_f32 v110, v110
    v_mfma_f32_16x16x32_bf16 v[20:23], a[212:215], a[12:15], v[20:23]
    v_exp_f32 v111, v111
    v_mfma_f32_16x16x32_bf16 v[20:23], a[208:211], a[8:11], v[20:23]
    v_exp_f32 v122, v122
    v_mfma_f32_16x16x32_bf16 v[36:39], a[208:211], a[16:19], v[168:171]
    v_cvt_pk_bf16_f32 v136, v80, v81
    v_cvt_pk_bf16_f32 v137, v82, v83
    v_mfma_f32_16x16x32_bf16 v[36:39], a[212:215], a[20:23], v[36:39]
    v_exp_f32 v123, v123
    v_mfma_f32_16x16x32_bf16 v[36:39], a[216:219], a[80:83], v[36:39]
    ds_read_b128 a[240:243], v200 offset:12288
    v_cvt_pk_bf16_f32 v138, v84, v85
    v_mfma_f32_16x16x32_bf16 v[36:39], a[220:223], a[84:87], v[36:39]
    ds_read_b128 a[244:247], v200 offset:13312
    v_cvt_pk_bf16_f32 v139, v86, v87
    v_mfma_f32_16x16x32_bf16 v[52:55], a[220:223], a[92:95], v[172:175]
    ds_read_b128 a[248:251], v200 offset:14336
    v_cvt_pk_bf16_f32 v144, v96, v97
    v_mfma_f32_16x16x32_bf16 v[52:55], a[216:219], a[88:91], v[52:55]
    ds_read_b128 a[252:255], v200 offset:15360
    v_cvt_pk_bf16_f32 v145, v98, v99
    v_mfma_f32_16x16x32_bf16 v[52:55], a[212:215], a[28:31], v[52:55]
    v_exp_f32 v124, v124
    v_mfma_f32_16x16x32_bf16 v[52:55], a[208:211], a[24:27], v[52:55]
    s_waitcnt lgkmcnt(7)
    v_exp_f32 v125, v125
    v_mfma_f32_16x16x32_bf16 v[8:11], a[224:227], a[0:3], v[160:163]
    s_waitcnt lgkmcnt(6)
    v_cvt_pk_bf16_f32 v146, v100, v101
    v_cvt_pk_bf16_f32 v147, v102, v103
    v_mfma_f32_16x16x32_bf16 v[8:11], a[228:231], a[4:7], v[8:11]
    s_waitcnt lgkmcnt(5)
    v_exp_f32 v126, v126
    v_mfma_f32_16x16x32_bf16 v[8:11], a[232:235], a[64:67], v[8:11]
    s_waitcnt lgkmcnt(4)
    v_cvt_pk_bf16_f32 v152, v112, v113
    v_cvt_pk_bf16_f32 v153, v114, v115
    v_mfma_f32_16x16x32_bf16 v[8:11], a[236:239], a[68:71], v[8:11]
    v_exp_f32 v127, v127
    v_mfma_f32_16x16x32_bf16 v[24:27], a[236:239], a[76:79], v[164:167]
    buffer_load_dwordx4 v240, s[16:19], s55 offen offset:1024 sc1 lds
    v_mfma_f32_16x16x32_bf16 v[24:27], a[232:235], a[72:75], v[24:27]
    v_cvt_pk_bf16_f32 v154, v116, v117
    v_cvt_pk_bf16_f32 v155, v118, v119
    v_mfma_f32_16x16x32_bf16 v[24:27], a[228:231], a[12:15], v[24:27]
    v_exp_f32 v0, v0
    v_mfma_f32_16x16x32_bf16 v[24:27], a[224:227], a[8:11], v[24:27]
    v_cvt_pk_bf16_f32 v132, v72, v73
    v_cvt_pk_bf16_f32 v133, v74, v75
    v_mfma_f32_16x16x32_bf16 v[40:43], a[224:227], a[16:19], v[168:171]
    v_exp_f32 v1, v1
    v_mfma_f32_16x16x32_bf16 v[40:43], a[228:231], a[20:23], v[40:43]
    v_cvt_pk_bf16_f32 v134, v76, v77
    v_cvt_pk_bf16_f32 v135, v78, v79
    v_mfma_f32_16x16x32_bf16 v[40:43], a[232:235], a[80:83], v[40:43]
    ds_read_b128 a[192:195], v201 offset:49152
    v_cvt_pk_bf16_f32 v140, v88, v89
    v_mfma_f32_16x16x32_bf16 v[40:43], a[236:239], a[84:87], v[40:43]
    ds_read_b128 a[196:199], v201 offset:57344
    v_cvt_pk_bf16_f32 v141, v90, v91
    v_mfma_f32_16x16x32_bf16 v[56:59], a[236:239], a[92:95], v[172:175]
    v_exp_f32 v2, v2
    v_mfma_f32_16x16x32_bf16 v[56:59], a[232:235], a[88:91], v[56:59]
    v_exp_f32 v3, v3
    v_mfma_f32_16x16x32_bf16 v[56:59], a[228:231], a[28:31], v[56:59]
    v_cvt_pk_bf16_f32 v142, v92, v93
    v_cvt_pk_bf16_f32 v143, v94, v95
    v_mfma_f32_16x16x32_bf16 v[56:59], a[224:227], a[24:27], v[56:59]
    s_waitcnt lgkmcnt(5)
    v_exp_f32 v16, v16
    v_mfma_f32_16x16x32_bf16 v[12:15], a[240:243], a[0:3], v[160:163]
    s_waitcnt lgkmcnt(4)
    v_cvt_pk_bf16_f32 v148, v104, v105
    v_cvt_pk_bf16_f32 v149, v106, v107
    v_mfma_f32_16x16x32_bf16 v[12:15], a[244:247], a[4:7], v[12:15]
    s_waitcnt lgkmcnt(3)
    v_exp_f32 v17, v17
    v_mfma_f32_16x16x32_bf16 v[12:15], a[248:251], a[64:67], v[12:15]
    s_waitcnt lgkmcnt(2)
    ds_read_b128 a[200:203], v201 offset:50176
    v_cvt_pk_bf16_f32 v150, v108, v109
    v_mfma_f32_16x16x32_bf16 v[12:15], a[252:255], a[68:71], v[12:15]
    ds_read_b128 a[204:207], v201 offset:58368
    v_cvt_pk_bf16_f32 v151, v110, v111
    v_mfma_f32_16x16x32_bf16 v[28:31], a[252:255], a[76:79], v[164:167]
    v_exp_f32 v18, v18
    v_mfma_f32_16x16x32_bf16 v[28:31], a[248:251], a[72:75], v[28:31]
    v_cvt_pk_bf16_f32 v156, v120, v121
    v_cvt_pk_bf16_f32 v157, v122, v123
    v_mfma_f32_16x16x32_bf16 v[28:31], a[244:247], a[12:15], v[28:31]
    v_exp_f32 v19, v19
    v_mfma_f32_16x16x32_bf16 v[28:31], a[240:243], a[8:11], v[28:31]
    v_subrev_f32 v202, 0x0, v199
    v_cvt_pk_bf16_f32 v158, v124, v125
    v_mfma_f32_16x16x32_bf16 v[44:47], a[240:243], a[16:19], v[168:171]
    v_min_f32 v32, v32, v202
    v_cvt_pk_bf16_f32 v159, v126, v127
    v_mfma_f32_16x16x32_bf16 v[44:47], a[244:247], a[20:23], v[44:47]
    v_exp_f32 v32, v32
    v_mfma_f32_16x16x32_bf16 v[44:47], a[248:251], a[80:83], v[44:47]
    ds_read_b128 a[208:211], v201 offset:51200
    v_subrev_f32 v203, 0x71800000, v199
    v_mfma_f32_16x16x32_bf16 v[44:47], a[252:255], a[84:87], v[44:47]
    ds_read_b128 a[212:215], v201 offset:59392
    v_min_f32 v33, v33, v203
    v_mfma_f32_16x16x32_bf16 v[60:63], a[252:255], a[92:95], v[172:175]
    v_exp_f32 v33, v33
    v_mfma_f32_16x16x32_bf16 v[60:63], a[248:251], a[88:91], v[60:63]
    v_subrev_f32 v202, 0x72000000, v199
    v_min_f32 v34, v34, v202
    v_mfma_f32_16x16x32_bf16 v[60:63], a[244:247], a[28:31], v[60:63]
    v_exp_f32 v34, v34
    v_mfma_f32_16x16x32_bf16 v[60:63], a[240:243], a[24:27], v[60:63]
    s_waitcnt lgkmcnt(5)
    v_subrev_f32 v203, 0x72400000, v199
    v_min_f32 v35, v35, v203
    v_mfma_f32_16x16x32_bf16 a[32:35], a[192:195], v[128:131], a[32:35]
    s_waitcnt lgkmcnt(4)
    v_exp_f32 v35, v35
    v_mfma_f32_16x16x32_bf16 a[32:35], a[196:199], v[132:135], a[32:35]
    buffer_load_dwordx4 v240, s[16:19], s55 offen offset:2048 sc1 lds
    v_mfma_f32_16x16x32_bf16 a[96:99], a[192:195], v[136:139], a[96:99]
    v_exp_f32 v48, v48
    v_mfma_f32_16x16x32_bf16 a[96:99], a[196:199], v[140:143], a[96:99]
    ds_read_b128 a[216:219], v201 offset:52224
    ds_read_b128 a[220:223], v201 offset:60416
    v_mfma_f32_16x16x32_bf16 a[128:131], a[192:195], v[144:147], a[128:131]
    v_exp_f32 v49, v49
    v_mfma_f32_16x16x32_bf16 a[128:131], a[196:199], v[148:151], a[128:131]
    v_exp_f32 v50, v50
    v_mfma_f32_16x16x32_bf16 a[160:163], a[192:195], v[152:155], a[160:163]
    v_exp_f32 v51, v51
    v_mfma_f32_16x16x32_bf16 a[160:163], a[196:199], v[156:159], a[160:163]
    s_waitcnt lgkmcnt(5)
    v_exp_f32 v4, v4
    v_mfma_f32_16x16x32_bf16 a[36:39], a[200:203], v[128:131], a[36:39]
    s_waitcnt lgkmcnt(4)
    v_exp_f32 v5, v5
    v_mfma_f32_16x16x32_bf16 a[36:39], a[204:207], v[132:135], a[36:39]
    v_exp_f32 v6, v6
    v_mfma_f32_16x16x32_bf16 a[100:103], a[200:203], v[136:139], a[100:103]
    ds_read_b128 a[224:227], v201 offset:53248
    v_subrev_f32 v202, 0x73800000, v199
    v_mfma_f32_16x16x32_bf16 a[100:103], a[204:207], v[140:143], a[100:103]
    ds_read_b128 a[228:231], v201 offset:61440
    v_min_f32 v36, v36, v202
    v_mfma_f32_16x16x32_bf16 a[132:135], a[200:203], v[144:147], a[132:135]
    v_exp_f32 v7, v7
    v_mfma_f32_16x16x32_bf16 a[132:135], a[204:207], v[148:151], a[132:135]
    v_exp_f32 v20, v20
    v_mfma_f32_16x16x32_bf16 a[164:167], a[200:203], v[152:155], a[164:167]
    v_exp_f32 v21, v21
    v_mfma_f32_16x16x32_bf16 a[164:167], a[204:207], v[156:159], a[164:167]
    s_waitcnt lgkmcnt(5)
    v_exp_f32 v22, v22
    v_mfma_f32_16x16x32_bf16 a[40:43], a[208:211], v[128:131], a[40:43]
    s_waitcnt lgkmcnt(4)
    v_exp_f32 v23, v23
    v_mfma_f32_16x16x32_bf16 a[40:43], a[212:215], v[132:135], a[40:43]
    v_add_f32 v184, v184, v96
    v_subrev_f32 v203, 0x73880000, v199
    v_mfma_f32_16x16x32_bf16 a[104:107], a[208:211], v[136:139], a[104:107]
    ds_read_b128 a[232:235], v201 offset:54272
    v_add_f32 v184, v184, v97
    v_mfma_f32_16x16x32_bf16 a[104:107], a[212:215], v[140:143], a[104:107]
    ds_read_b128 a[236:239], v201 offset:62464
    v_min_f32 v37, v37, v203
    v_mfma_f32_16x16x32_bf16 a[136:139], a[208:211], v[144:147], a[136:139]
    v_exp_f32 v36, v36
    v_mfma_f32_16x16x32_bf16 a[136:139], a[212:215], v[148:151], a[136:139]
    v_add_f32 v184, v184, v98
    v_subrev_f32 v202, 0x73900000, v199
    v_mfma_f32_16x16x32_bf16 a[168:171], a[208:211], v[152:155], a[168:171]
    buffer_load_dwordx4 v240, s[16:19], s55 offen offset:3072 sc1 lds
    v_mfma_f32_16x16x32_bf16 a[168:171], a[212:215], v[156:159], a[168:171]
    s_waitcnt lgkmcnt(5)
    v_exp_f32 v37, v37
    v_mfma_f32_16x16x32_bf16 a[44:47], a[216:219], v[128:131], a[44:47]
    s_waitcnt lgkmcnt(4)
    v_add_f32 v184, v184, v99
    v_min_f32 v38, v38, v202
    v_mfma_f32_16x16x32_bf16 a[44:47], a[220:223], v[132:135], a[44:47]
    s_add_u32 s54, s54, 0x8000
    v_add_f32 v184, v184, v100
    v_subrev_f32 v203, 0x73980000, v199
    v_mfma_f32_16x16x32_bf16 a[108:111], a[216:219], v[136:139], a[108:111]
    s_add_u32 s52, s52, 0x8000
    ds_read_b128 a[240:243], v201 offset:55296
    v_add_f32 v184, v184, v101
    v_mfma_f32_16x16x32_bf16 a[108:111], a[220:223], v[140:143], a[108:111]
    s_and_b32 s52, s52, 0x1ffff
    ds_read_b128 a[244:247], v201 offset:63488
    v_min_f32 v39, v39, v203
    v_mfma_f32_16x16x32_bf16 a[140:143], a[216:219], v[144:147], a[140:143]
    s_mov_b32 m0, s52
    v_exp_f32 v38, v38
    v_mfma_f32_16x16x32_bf16 a[140:143], a[220:223], v[148:151], a[140:143]
    s_add_u32 s55, s55, 0x8000
    v_add_f32 v184, v184, v102
    v_add_f32 v184, v184, v103
    v_mfma_f32_16x16x32_bf16 a[172:175], a[216:219], v[152:155], a[172:175]
    s_add_u32 s53, s53, 0x8000
    v_exp_f32 v39, v39
    v_mfma_f32_16x16x32_bf16 a[172:175], a[220:223], v[156:159], a[172:175]
    s_waitcnt lgkmcnt(5)
    v_add_f32 v188, v188, v112
    v_add_f32 v188, v188, v113
    v_mfma_f32_16x16x32_bf16 a[48:51], a[224:227], v[128:131], a[48:51]
    s_waitcnt lgkmcnt(4)
    v_exp_f32 v52, v52
    v_mfma_f32_16x16x32_bf16 a[48:51], a[228:231], v[132:135], a[48:51]
    s_and_b32 s53, s53, 0x1ffff
    v_add_f32 v188, v188, v114
    v_add_f32 v188, v188, v115
    v_mfma_f32_16x16x32_bf16 a[112:115], a[224:227], v[136:139], a[112:115]
    ds_read_b128 a[248:251], v201 offset:56320
    v_add_f32 v188, v188, v116
    v_mfma_f32_16x16x32_bf16 a[112:115], a[228:231], v[140:143], a[112:115]
    ds_read_b128 a[252:255], v201 offset:64512
    v_add_f32 v188, v188, v117
    v_mfma_f32_16x16x32_bf16 a[144:147], a[224:227], v[144:147], a[144:147]
    v_exp_f32 v53, v53
    v_mfma_f32_16x16x32_bf16 a[144:147], a[228:231], v[148:151], a[144:147]
    v_exp_f32 v54, v54
    v_mfma_f32_16x16x32_bf16 a[176:179], a[224:227], v[152:155], a[176:179]
    v_subrev_f32 v202, 0x74000000, v199
    v_add_f32 v188, v188, v118
    v_mfma_f32_16x16x32_bf16 a[176:179], a[228:231], v[156:159], a[176:179]
    s_waitcnt lgkmcnt(5)
    v_exp_f32 v55, v55
    v_mfma_f32_16x16x32_bf16 a[52:55], a[232:235], v[128:131], a[52:55]
    s_waitcnt lgkmcnt(4)
    v_min_f32 v40, v40, v202
    v_add_f32 v188, v188, v119
    v_mfma_f32_16x16x32_bf16 a[52:55], a[236:239], v[132:135], a[52:55]
    v_subrev_f32 v203, 0x74040000, v199
    v_add_f32 v184, v184, v104
    v_mfma_f32_16x16x32_bf16 a[116:119], a[232:235], v[136:139], a[116:119]
    v_exp_f32 v8, v8
    v_mfma_f32_16x16x32_bf16 a[116:119], a[236:239], v[140:143], a[116:119]
    v_min_f32 v41, v41, v203
    v_add_f32 v184, v184, v105
    v_mfma_f32_16x16x32_bf16 a[148:151], a[232:235], v[144:147], a[148:151]
    v_subrev_f32 v202, 0x74080000, v199
    v_add_f32 v184, v184, v106
    v_mfma_f32_16x16x32_bf16 a[148:151], a[236:239], v[148:151], a[148:151]
    v_exp_f32 v9, v9
    v_mfma_f32_16x16x32_bf16 a[180:183], a[232:235], v[152:155], a[180:183]
    s_waitcnt vmcnt(16) lgkmcnt(0)
    v_min_f32 v42, v42, v202
    v_add_f32 v184, v184, v107
    v_mfma_f32_16x16x32_bf16 a[180:183], a[236:239], v[156:159], a[180:183]
    s_barrier
    ds_read_b128 a[192:195], v200 offset:32768
    v_mfma_f32_16x16x32_bf16 a[56:59], a[240:243], v[128:131], a[56:59]
    ds_read_b128 a[196:199], v200 offset:33792
    ds_read_b128 a[200:203], v200 offset:34816
    v_mfma_f32_16x16x32_bf16 a[56:59], a[244:247], v[132:135], a[56:59]
    buffer_load_dwordx4 v240, s[16:19], s54 offen offset:0 sc1 lds
    v_mfma_f32_16x16x32_bf16 a[120:123], a[240:243], v[136:139], a[120:123]
    ds_read_b128 a[204:207], v200 offset:35840
    v_subrev_f32 v203, 0x740c0000, v199
    v_mfma_f32_16x16x32_bf16 a[120:123], a[244:247], v[140:143], a[120:123]
    buffer_load_dwordx4 v240, s[16:19], s54 offen offset:1024 sc1 lds
    v_mfma_f32_16x16x32_bf16 a[152:155], a[240:243], v[144:147], a[152:155]
    ds_read_b128 a[208:211], v200 offset:36864
    v_add_f32 v184, v184, v108
    v_mfma_f32_16x16x32_bf16 a[152:155], a[244:247], v[148:151], a[152:155]
    v_exp_f32 v24, v24
    v_mfma_f32_16x16x32_bf16 a[184:187], a[240:243], v[152:155], a[184:187]
    v_min_f32 v43, v43, v203
    v_add_f32 v184, v184, v109
    v_mfma_f32_16x16x32_bf16 a[184:187], a[244:247], v[156:159], a[184:187]
    v_subrev_f32 v202, 0x74400000, v199
    v_add_f32 v184, v184, v110
    v_mfma_f32_16x16x32_bf16 a[60:63], a[248:251], v[128:131], a[60:63]
    ds_read_b128 a[212:215], v200 offset:37888
    v_min_f32 v44, v44, v202
    v_mfma_f32_16x16x32_bf16 a[60:63], a[252:255], v[132:135], a[60:63]
    v_exp_f32 v25, v25
    v_mfma_f32_16x16x32_bf16 a[124:127], a[248:251], v[136:139], a[124:127]
    v_add_f32 v184, v184, v111
    v_subrev_f32 v203, 0x74440000, v199
    v_mfma_f32_16x16x32_bf16 a[124:127], a[252:255], v[140:143], a[124:127]
    buffer_load_dwordx4 v240, s[16:19], s54 offen offset:2048 sc1 lds
    v_mfma_f32_16x16x32_bf16 a[156:159], a[248:251], v[144:147], a[156:159]
    ds_read_b128 a[216:219], v200 offset:38912
    v_add_f32 v188, v188, v120
    v_mfma_f32_16x16x32_bf16 a[156:159], a[252:255], v[148:151], a[156:159]
    v_exp_f32 v40, v40
    v_min_f32 v45, v45, v203
    v_add_f32 v188, v188, v121
    v_mfma_f32_16x16x32_bf16 a[188:191], a[248:251], v[152:155], a[188:191]
    v_subrev_f32 v202, 0x74480000, v199
    v_add_f32 v188, v188, v122
    v_mfma_f32_16x16x32_bf16 a[188:191], a[252:255], v[156:159], a[188:191]
    ds_read_b128 a[220:223], v200 offset:39936
    v_exp_f32 v41, v41
    v_min_f32 v46, v46, v202
    v_add_f32 v188, v188, v123
    v_mfma_f32_16x16x32_bf16 v[176:179], v[192:195], v[128:131], v[176:179]
    v_subrev_f32 v203, 0x744c0000, v199
    v_add_f32 v188, v188, v124
    v_mfma_f32_16x16x32_bf16 v[176:179], v[192:195], v[132:135], v[176:179]
    buffer_load_dwordx4 v240, s[16:19], s54 offen offset:3072 sc1 lds
    v_exp_f32 v56, v56
    v_min_f32 v47, v47, v203
    v_add_f32 v188, v188, v125
    v_mfma_f32_16x16x32_bf16 v[180:183], v[192:195], v[136:139], v[180:183]
    s_mov_b32 m0, s53
    v_add_f32 v188, v188, v126
    v_add_f32 v188, v188, v127
    v_mfma_f32_16x16x32_bf16 v[180:183], v[192:195], v[140:143], v[180:183]
    s_waitcnt lgkmcnt(7)
    v_exp_f32 v57, v57
    v_mfma_f32_16x16x32_bf16 v[64:67], a[192:195], a[0:3], v[160:163]
    s_waitcnt lgkmcnt(6)
    v_exp_f32 v10, v10
    v_mfma_f32_16x16x32_bf16 v[64:67], a[196:199], a[4:7], v[64:67]
    s_waitcnt lgkmcnt(5)
    v_exp_f32 v11, v11
    v_mfma_f32_16x16x32_bf16 v[64:67], a[200:203], a[64:67], v[64:67]
    s_waitcnt lgkmcnt(4)
    v_exp_f32 v12, v12
    v_mfma_f32_16x16x32_bf16 v[64:67], a[204:207], a[68:71], v[64:67]
    v_exp_f32 v13, v13
    v_mfma_f32_16x16x32_bf16 v[80:83], a[204:207], a[76:79], v[164:167]
    ds_read_b128 a[224:227], v200 offset:40960
    ds_read_b128 a[228:231], v200 offset:41984
    v_mfma_f32_16x16x32_bf16 v[80:83], a[200:203], a[72:75], v[80:83]
    v_exp_f32 v14, v14
    v_mfma_f32_16x16x32_bf16 v[80:83], a[196:199], a[12:15], v[80:83]
    ds_read_b128 a[232:235], v200 offset:43008
    ds_read_b128 a[236:239], v200 offset:44032
    v_mfma_f32_16x16x32_bf16 v[80:83], a[192:195], a[8:11], v[80:83]
    v_exp_f32 v15, v15
    v_mfma_f32_16x16x32_bf16 v[112:115], a[192:195], a[24:27], v[172:175]
    v_exp_f32 v26, v26
    v_mfma_f32_16x16x32_bf16 v[112:115], a[196:199], a[28:31], v[112:115]
    v_exp_f32 v27, v27
    v_mfma_f32_16x16x32_bf16 v[112:115], a[200:203], a[88:91], v[112:115]
    v_exp_f32 v28, v28
    v_mfma_f32_16x16x32_bf16 v[112:115], a[204:207], a[92:95], v[112:115]
    s_waitcnt lgkmcnt(7)
    v_cvt_pk_bf16_f32 v128, v0, v1
    v_cvt_pk_bf16_f32 v129, v2, v3
    v_mfma_f32_16x16x32_bf16 v[68:71], a[208:211], a[0:3], v[160:163]
    s_waitcnt lgkmcnt(6)
    buffer_load_dwordx4 v240, s[16:19], s55 offen offset:0 sc1 lds
    v_mfma_f32_16x16x32_bf16 v[68:71], a[212:215], a[4:7], v[68:71]
    s_waitcnt lgkmcnt(5)
    v_exp_f32 v29, v29
    v_mfma_f32_16x16x32_bf16 v[68:71], a[216:219], a[64:67], v[68:71]
    s_waitcnt lgkmcnt(4)
    v_cvt_pk_bf16_f32 v130, v4, v5
    v_cvt_pk_bf16_f32 v131, v6, v7
    v_mfma_f32_16x16x32_bf16 v[68:71], a[220:223], a[68:71], v[68:71]
    ds_read_b128 a[240:243], v200 offset:45056
    v_cvt_pk_bf16_f32 v136, v16, v17
    v_mfma_f32_16x16x32_bf16 v[84:87], a[220:223], a[76:79], v[164:167]
    v_exp_f32 v30, v30
    v_mfma_f32_16x16x32_bf16 v[84:87], a[216:219], a[72:75], v[84:87]
    ds_read_b128 a[244:247], v200 offset:46080
    v_cvt_pk_bf16_f32 v137, v18, v19
    v_mfma_f32_16x16x32_bf16 v[84:87], a[212:215], a[12:15], v[84:87]
    ds_read_b128 a[248:251], v200 offset:47104
    v_cvt_pk_bf16_f32 v138, v20, v21
    v_mfma_f32_16x16x32_bf16 v[84:87], a[208:211], a[8:11], v[84:87]
    v_exp_f32 v31, v31
    v_mfma_f32_16x16x32_bf16 v[116:119], a[208:211], a[24:27], v[172:175]
    ds_read_b128 a[252:255], v200 offset:48128
    v_cvt_pk_bf16_f32 v139, v22, v23
    v_mfma_f32_16x16x32_bf16 v[116:119], a[212:215], a[28:31], v[116:119]
    v_exp_f32 v42, v42
    v_mfma_f32_16x16x32_bf16 v[116:119], a[216:219], a[88:91], v[116:119]
    v_cvt_pk_bf16_f32 v144, v32, v33
    v_cvt_pk_bf16_f32 v145, v34, v35
    v_mfma_f32_16x16x32_bf16 v[116:119], a[220:223], a[92:95], v[116:119]
    s_waitcnt lgkmcnt(7)
    v_exp_f32 v43, v43
    v_mfma_f32_16x16x32_bf16 v[72:75], a[224:227], a[0:3], v[160:163]
    s_waitcnt lgkmcnt(6)
    v_cvt_pk_bf16_f32 v146, v36, v37
    v_cvt_pk_bf16_f32 v147, v38, v39
    v_mfma_f32_16x16x32_bf16 v[72:75], a[228:231], a[4:7], v[72:75]
    s_waitcnt lgkmcnt(5)
    v_exp_f32 v44, v44
    v_mfma_f32_16x16x32_bf16 v[72:75], a[232:235], a[64:67], v[72:75]
    s_waitcnt lgkmcnt(4)
    v_cvt_pk_bf16_f32 v152, v48, v49
    v_cvt_pk_bf16_f32 v153, v50, v51
    v_mfma_f32_16x16x32_bf16 v[72:75], a[236:239], a[68:71], v[72:75]
    v_exp_f32 v45, v45
    v_mfma_f32_16x16x32_bf16 v[88:91], a[236:239], a[76:79], v[164:167]
    v_cvt_pk_bf16_f32 v154, v52, v53
    v_cvt_pk_bf16_f32 v155, v54, v55
    v_mfma_f32_16x16x32_bf16 v[88:91], a[232:235], a[72:75], v[88:91]
    ds_read_b128 a[192:195], v200 offset:16384
    v_cvt_pk_bf16_f32 v132, v8, v9
    v_mfma_f32_16x16x32_bf16 v[88:91], a[228:231], a[12:15], v[88:91]
    v_exp_f32 v46, v46
    v_mfma_f32_16x16x32_bf16 v[88:91], a[224:227], a[8:11], v[88:91]
    ds_read_b128 a[196:199], v200 offset:24576
    v_cvt_pk_bf16_f32 v133, v10, v11
    v_mfma_f32_16x16x32_bf16 v[120:123], a[224:227], a[24:27], v[172:175]
    v_exp_f32 v47, v47
    v_mfma_f32_16x16x32_bf16 v[120:123], a[228:231], a[28:31], v[120:123]
    v_cvt_pk_bf16_f32 v134, v12, v13
    v_cvt_pk_bf16_f32 v135, v14, v15
    v_mfma_f32_16x16x32_bf16 v[120:123], a[232:235], a[88:91], v[120:123]
    v_exp_f32 v58, v58
    v_mfma_f32_16x16x32_bf16 v[120:123], a[236:239], a[92:95], v[120:123]
    s_waitcnt lgkmcnt(5)
    v_cvt_pk_bf16_f32 v140, v24, v25
    v_cvt_pk_bf16_f32 v141, v26, v27
    v_mfma_f32_16x16x32_bf16 v[76:79], a[240:243], a[0:3], v[160:163]
    s_waitcnt lgkmcnt(4)
    v_exp_f32 v59, v59
    v_mfma_f32_16x16x32_bf16 v[76:79], a[244:247], a[4:7], v[76:79]
    s_waitcnt lgkmcnt(3)
    v_cvt_pk_bf16_f32 v142, v28, v29
    v_cvt_pk_bf16_f32 v143, v30, v31
    v_mfma_f32_16x16x32_bf16 v[76:79], a[248:251], a[64:67], v[76:79]
    s_waitcnt lgkmcnt(2)
    ds_read_b128 a[200:203], v200 offset:17408
    v_cvt_pk_bf16_f32 v148, v40, v41
    v_mfma_f32_16x16x32_bf16 v[76:79], a[252:255], a[68:71], v[76:79]
    buffer_load_dwordx4 v240, s[16:19], s55 offen offset:1024 sc1 lds
    v_mfma_f32_16x16x32_bf16 v[92:95], a[252:255], a[76:79], v[164:167]
    v_exp_f32 v60, v60
    v_mfma_f32_16x16x32_bf16 v[92:95], a[248:251], a[72:75], v[92:95]
    ds_read_b128 a[204:207], v200 offset:25600
    v_cvt_pk_bf16_f32 v149, v42, v43
    v_mfma_f32_16x16x32_bf16 v[92:95], a[244:247], a[12:15], v[92:95]
    v_exp_f32 v61, v61
    v_mfma_f32_16x16x32_bf16 v[92:95], a[240:243], a[8:11], v[92:95]
    v_cvt_pk_bf16_f32 v150, v44, v45
    v_cvt_pk_bf16_f32 v151, v46, v47
    v_mfma_f32_16x16x32_bf16 v[124:127], a[240:243], a[24:27], v[172:175]
    v_exp_f32 v62, v62
    v_mfma_f32_16x16x32_bf16 v[124:127], a[244:247], a[28:31], v[124:127]
    v_cvt_pk_bf16_f32 v156, v56, v57
    v_cvt_pk_bf16_f32 v157, v58, v59
    v_mfma_f32_16x16x32_bf16 v[124:127], a[248:251], a[88:91], v[124:127]
    v_exp_f32 v63, v63
    v_mfma_f32_16x16x32_bf16 v[124:127], a[252:255], a[92:95], v[124:127]
    s_waitcnt lgkmcnt(3)
    v_cvt_pk_bf16_f32 v158, v60, v61
    v_cvt_pk_bf16_f32 v159, v62, v63
    v_mfma_f32_16x16x32_bf16 a[32:35], a[192:195], v[128:131], a[32:35]
    s_waitcnt lgkmcnt(2)
    ds_read_b128 a[208:211], v200 offset:18432
    ds_read_b128 a[212:215], v200 offset:26624
    v_mfma_f32_16x16x32_bf16 a[32:35], a[196:199], v[132:135], a[32:35]
    v_exp_f32 v64, v64
    v_mfma_f32_16x16x32_bf16 a[96:99], a[192:195], v[136:139], a[96:99]
    ds_read_b128 a[216:219], v200 offset:19456
    v_subrev_f32 v202, 0x0, v199
    v_mfma_f32_16x16x32_bf16 a[96:99], a[196:199], v[140:143], a[96:99]
    ds_read_b128 a[220:223], v200 offset:27648
    v_min_f32 v112, v112, v202
    v_mfma_f32_16x16x32_bf16 a[128:131], a[192:195], v[144:147], a[128:131]
    v_exp_f32 v65, v65
    v_mfma_f32_16x16x32_bf16 a[128:131], a[196:199], v[148:151], a[128:131]
    v_exp_f32 v66, v66
    v_mfma_f32_16x16x32_bf16 a[160:163], a[192:195], v[152:155], a[160:163]
    v_exp_f32 v67, v67
    v_mfma_f32_16x16x32_bf16 a[160:163], a[196:199], v[156:159], a[160:163]
    s_waitcnt lgkmcnt(5)
    buffer_load_dwordx4 v240, s[16:19], s55 offen offset:2048 sc1 lds
    v_mfma_f32_16x16x32_bf16 a[36:39], a[200:203], v[128:131], a[36:39]
    s_waitcnt lgkmcnt(4)
    v_exp_f32 v80, v80
    v_mfma_f32_16x16x32_bf16 a[36:39], a[204:207], v[132:135], a[36:39]
    v_exp_f32 v81, v81
    v_mfma_f32_16x16x32_bf16 a[100:103], a[200:203], v[136:139], a[100:103]
    ds_read_b128 a[224:227], v200 offset:20480
    v_subrev_f32 v203, 0x71800000, v199
    v_mfma_f32_16x16x32_bf16 a[100:103], a[204:207], v[140:143], a[100:103]
    ds_read_b128 a[228:231], v200 offset:28672
    v_min_f32 v113, v113, v203
    v_mfma_f32_16x16x32_bf16 a[132:135], a[200:203], v[144:147], a[132:135]
    v_exp_f32 v82, v82
    v_mfma_f32_16x16x32_bf16 a[132:135], a[204:207], v[148:151], a[132:135]
    v_exp_f32 v83, v83
    v_mfma_f32_16x16x32_bf16 a[164:167], a[200:203], v[152:155], a[164:167]
    v_exp_f32 v112, v112
    v_mfma_f32_16x16x32_bf16 a[164:167], a[204:207], v[156:159], a[164:167]
    s_waitcnt lgkmcnt(5)
    v_exp_f32 v113, v113
    v_mfma_f32_16x16x32_bf16 a[40:43], a[208:211], v[128:131], a[40:43]
    s_waitcnt lgkmcnt(4)
    v_subrev_f32 v202, 0x72000000, v199
    v_min_f32 v114, v114, v202
    v_mfma_f32_16x16x32_bf16 a[40:43], a[212:215], v[132:135], a[40:43]
    v_exp_f32 v114, v114
    v_mfma_f32_16x16x32_bf16 a[104:107], a[208:211], v[136:139], a[104:107]
    ds_read_b128 a[232:235], v200 offset:21504
    v_subrev_f32 v203, 0x72400000, v199
    v_mfma_f32_16x16x32_bf16 a[104:107], a[212:215], v[140:143], a[104:107]
    ds_read_b128 a[236:239], v200 offset:29696
    v_min_f32 v115, v115, v203
    v_mfma_f32_16x16x32_bf16 a[136:139], a[208:211], v[144:147], a[136:139]
    v_exp_f32 v115, v115
    v_mfma_f32_16x16x32_bf16 a[136:139], a[212:215], v[148:151], a[136:139]
    v_exp_f32 v68, v68
    v_mfma_f32_16x16x32_bf16 a[168:171], a[208:211], v[152:155], a[168:171]
    v_exp_f32 v69, v69
    v_mfma_f32_16x16x32_bf16 a[168:171], a[212:215], v[156:159], a[168:171]
    s_waitcnt lgkmcnt(5)
    v_exp_f32 v70, v70
    v_mfma_f32_16x16x32_bf16 a[44:47], a[216:219], v[128:131], a[44:47]
    s_waitcnt lgkmcnt(4)
    buffer_load_dwordx4 v240, s[16:19], s55 offen offset:3072 sc1 lds
    v_mfma_f32_16x16x32_bf16 a[44:47], a[220:223], v[132:135], a[44:47]
    s_add_u32 s54, s54, 0x8000
    v_exp_f32 v71, v71
    v_mfma_f32_16x16x32_bf16 a[108:111], a[216:219], v[136:139], a[108:111]
    s_add_u32 s52, s52, 0x8000
    ds_read_b128 a[240:243], v200 offset:22528
    v_subrev_f32 v202, 0x73800000, v199
    v_mfma_f32_16x16x32_bf16 a[108:111], a[220:223], v[140:143], a[108:111]
    s_and_b32 s52, s52, 0x1ffff
    ds_read_b128 a[244:247], v200 offset:30720
    v_min_f32 v116, v116, v202
    v_mfma_f32_16x16x32_bf16 a[140:143], a[216:219], v[144:147], a[140:143]
    s_mov_b32 m0, s52
    v_exp_f32 v84, v84
    v_mfma_f32_16x16x32_bf16 a[140:143], a[220:223], v[148:151], a[140:143]
    s_add_u32 s55, s55, 0x8000
    v_exp_f32 v85, v85
    v_mfma_f32_16x16x32_bf16 a[172:175], a[216:219], v[152:155], a[172:175]
    s_add_u32 s53, s53, 0x8000
    v_subrev_f32 v203, 0x73880000, v199
    v_min_f32 v117, v117, v203
    v_mfma_f32_16x16x32_bf16 a[172:175], a[220:223], v[156:159], a[172:175]
    s_waitcnt lgkmcnt(5)
    v_exp_f32 v86, v86
    v_mfma_f32_16x16x32_bf16 a[48:51], a[224:227], v[128:131], a[48:51]
    s_waitcnt lgkmcnt(4)
    v_subrev_f32 v202, 0x73900000, v199
    v_min_f32 v118, v118, v202
    v_mfma_f32_16x16x32_bf16 a[48:51], a[228:231], v[132:135], a[48:51]
    s_and_b32 s53, s53, 0x1ffff
    v_exp_f32 v87, v87
    v_mfma_f32_16x16x32_bf16 a[112:115], a[224:227], v[136:139], a[112:115]
    ds_read_b128 a[248:251], v200 offset:23552
    v_subrev_f32 v203, 0x73980000, v199
    v_mfma_f32_16x16x32_bf16 a[112:115], a[228:231], v[140:143], a[112:115]
    ds_read_b128 a[252:255], v200 offset:31744
    v_min_f32 v119, v119, v203
    v_mfma_f32_16x16x32_bf16 a[144:147], a[224:227], v[144:147], a[144:147]
    v_exp_f32 v116, v116
    v_mfma_f32_16x16x32_bf16 a[144:147], a[228:231], v[148:151], a[144:147]
    v_subrev_f32 v202, 0x74000000, v199
    v_min_f32 v120, v120, v202
    v_mfma_f32_16x16x32_bf16 a[176:179], a[224:227], v[152:155], a[176:179]
    v_exp_f32 v117, v117
    v_mfma_f32_16x16x32_bf16 a[176:179], a[228:231], v[156:159], a[176:179]
    s_waitcnt lgkmcnt(5)
    v_subrev_f32 v203, 0x74040000, v199
    v_min_f32 v121, v121, v203
    v_mfma_f32_16x16x32_bf16 a[52:55], a[232:235], v[128:131], a[52:55]
    s_waitcnt lgkmcnt(4)
    v_exp_f32 v118, v118
    v_mfma_f32_16x16x32_bf16 a[52:55], a[236:239], v[132:135], a[52:55]
    v_subrev_f32 v202, 0x74080000, v199
    v_min_f32 v122, v122, v202
    v_mfma_f32_16x16x32_bf16 a[116:119], a[232:235], v[136:139], a[116:119]
    v_exp_f32 v119, v119
    v_mfma_f32_16x16x32_bf16 a[116:119], a[236:239], v[140:143], a[116:119]
    v_subrev_f32 v203, 0x740c0000, v199
    v_min_f32 v123, v123, v203
    v_mfma_f32_16x16x32_bf16 a[148:151], a[232:235], v[144:147], a[148:151]
    v_exp_f32 v72, v72
    v_mfma_f32_16x16x32_bf16 a[148:151], a[236:239], v[148:151], a[148:151]
    v_subrev_f32 v202, 0x74400000, v199
    v_min_f32 v124, v124, v202
    v_mfma_f32_16x16x32_bf16 a[180:183], a[232:235], v[152:155], a[180:183]
    v_exp_f32 v73, v73
    v_mfma_f32_16x16x32_bf16 a[180:183], a[236:239], v[156:159], a[180:183]
    s_waitcnt lgkmcnt(3)
    v_subrev_f32 v203, 0x74440000, v199
    v_min_f32 v125, v125, v203
    v_mfma_f32_16x16x32_bf16 a[56:59], a[240:243], v[128:131], a[56:59]
    s_waitcnt lgkmcnt(2)
    v_exp_f32 v88, v88
    v_mfma_f32_16x16x32_bf16 a[56:59], a[244:247], v[132:135], a[56:59]
    v_subrev_f32 v202, 0x74480000, v199
    v_min_f32 v126, v126, v202
    v_mfma_f32_16x16x32_bf16 a[120:123], a[240:243], v[136:139], a[120:123]
    s_waitcnt vmcnt(16) lgkmcnt(0)
    v_exp_f32 v89, v89
    v_mfma_f32_16x16x32_bf16 a[120:123], a[244:247], v[140:143], a[120:123]
    s_barrier
    ds_read_b128 a[192:195], v201 offset:0
    ds_read_b128 a[196:199], v201 offset:1024
    v_mfma_f32_16x16x32_bf16 a[152:155], a[240:243], v[144:147], a[152:155]
    buffer_load_dwordx4 v240, s[16:19], s54 offen offset:0 sc1 lds
    v_mfma_f32_16x16x32_bf16 a[152:155], a[244:247], v[148:151], a[152:155]
    ds_read_b128 a[200:203], v201 offset:2048
    ds_read_b128 a[204:207], v201 offset:3072
    v_mfma_f32_16x16x32_bf16 a[184:187], a[240:243], v[152:155], a[184:187]
    ds_read_b128 a[208:211], v201 offset:4096
    ds_read_b128 a[212:215], v201 offset:5120
    v_mfma_f32_16x16x32_bf16 a[184:187], a[244:247], v[156:159], a[184:187]
    buffer_load_dwordx4 v240, s[16:19], s54 offen offset:1024 sc1 lds
    v_mfma_f32_16x16x32_bf16 a[60:63], a[248:251], v[128:131], a[60:63]
    ds_read_b128 a[216:219], v201 offset:6144
    ds_read_b128 a[220:223], v201 offset:7168
    v_mfma_f32_16x16x32_bf16 a[60:63], a[252:255], v[132:135], a[60:63]
    v_subrev_f32 v203, 0x744c0000, v199
    v_min_f32 v127, v127, v203
    v_mfma_f32_16x16x32_bf16 a[124:127], a[248:251], v[136:139], a[124:127]
    v_exp_f32 v120, v120
    v_mfma_f32_16x16x32_bf16 a[124:127], a[252:255], v[140:143], a[124:127]
    v_xor_b32 v200, 0x10000, v200
    v_xor_b32 v201, 0x10000, v201
    v_mfma_f32_16x16x32_bf16 a[156:159], a[248:251], v[144:147], a[156:159]
    buffer_load_dwordx4 v240, s[16:19], s54 offen offset:2048 sc1 lds
    v_mfma_f32_16x16x32_bf16 a[156:159], a[252:255], v[148:151], a[156:159]
    v_exp_f32 v121, v121
    v_mfma_f32_16x16x32_bf16 a[188:191], a[248:251], v[152:155], a[188:191]
    v_mfma_f32_16x16x32_bf16 a[188:191], a[252:255], v[156:159], a[188:191]
    v_mfma_f32_16x16x32_bf16 v[176:179], v[192:195], v[128:131], v[176:179]
    buffer_load_dwordx4 v240, s[16:19], s54 offen offset:3072 sc1 lds
    v_mfma_f32_16x16x32_bf16 v[176:179], v[192:195], v[132:135], v[176:179]
    s_mov_b32 m0, s53
    v_mfma_f32_16x16x32_bf16 v[180:183], v[192:195], v[136:139], v[180:183]
    v_mfma_f32_16x16x32_bf16 v[180:183], v[192:195], v[140:143], v[180:183]
    v_mfma_f32_16x16x32_bf16 v[184:187], v[192:195], v[144:147], v[184:187]
    v_mfma_f32_16x16x32_bf16 v[184:187], v[192:195], v[148:151], v[184:187]
    v_mfma_f32_16x16x32_bf16 v[188:191], v[192:195], v[152:155], v[188:191]
    v_mfma_f32_16x16x32_bf16 v[188:191], v[192:195], v[156:159], v[188:191]
    s_waitcnt lgkmcnt(7)
    s_branch L_uds
L_last7:
    v_mfma_f32_16x16x32_bf16 v[0:3], a[192:195], a[0:3], v[160:163]
    s_waitcnt lgkmcnt(6)
    v_exp_f32 v74, v74
    v_mfma_f32_16x16x32_bf16 v[0:3], a[196:199], a[4:7], v[0:3]
    s_waitcnt lgkmcnt(5)
    v_exp_f32 v75, v75
    v_mfma_f32_16x16x32_bf16 v[0:3], a[200:203], a[64:67], v[0:3]
    s_waitcnt lgkmcnt(4)
    v_exp_f32 v76, v76
    v_mfma_f32_16x16x32_bf16 v[0:3], a[204:207], a[68:71], v[0:3]
    s_mov_b32 m0, s53
    v_exp_f32 v77, v77
    v_mfma_f32_16x16x32_bf16 v[16:19], a[204:207], a[76:79], v[164:167]
    buffer_load_dwordx4 v240, s[16:19], s55 offen offset:0 sc1 lds
    v_mfma_f32_16x16x32_bf16 v[16:19], a[200:203], a[72:75], v[16:19]
    v_exp_f32 v78, v78
    v_mfma_f32_16x16x32_bf16 v[16:19], a[196:199], a[12:15], v[16:19]
    v_exp_f32 v79, v79
    v_mfma_f32_16x16x32_bf16 v[16:19], a[192:195], a[8:11], v[16:19]
    v_exp_f32 v90, v90
    v_mfma_f32_16x16x32_bf16 v[32:35], a[192:195], a[16:19], v[168:171]
    v_exp_f32 v91, v91
    v_mfma_f32_16x16x32_bf16 v[32:35], a[196:199], a[20:23], v[32:35]
    v_exp_f32 v92, v92
    v_mfma_f32_16x16x32_bf16 v[32:35], a[200:203], a[80:83], v[32:35]
    ds_read_b128 a[224:227], v200 offset:8192
    v_cvt_pk_bf16_f32 v128, v64, v65
    v_mfma_f32_16x16x32_bf16 v[32:35], a[204:207], a[84:87], v[32:35]
    buffer_load_dwordx4 v240, s[16:19], s55 offen offset:1024 sc1 lds
    v_mfma_f32_16x16x32_bf16 v[48:51], a[204:207], a[92:95], v[172:175]
    ds_read_b128 a[228:231], v200 offset:9216
    ds_read_b128 a[232:235], v200 offset:10240
    v_mfma_f32_16x16x32_bf16 v[48:51], a[200:203], a[88:91], v[48:51]
    v_exp_f32 v93, v93
    v_mfma_f32_16x16x32_bf16 v[48:51], a[196:199], a[28:31], v[48:51]
    ds_read_b128 a[236:239], v200 offset:11264
    v_cvt_pk_bf16_f32 v129, v66, v67
    v_mfma_f32_16x16x32_bf16 v[48:51], a[192:195], a[24:27], v[48:51]
    s_waitcnt lgkmcnt(7)
    v_exp_f32 v94, v94
    v_mfma_f32_16x16x32_bf16 v[4:7], a[208:211], a[0:3], v[160:163]
    s_waitcnt lgkmcnt(6)
    v_exp_f32 v95, v95
    v_mfma_f32_16x16x32_bf16 v[4:7], a[212:215], a[4:7], v[4:7]
    s_waitcnt lgkmcnt(5)
    v_exp_f32 v106, v106
    v_mfma_f32_16x16x32_bf16 v[4:7], a[216:219], a[64:67], v[4:7]
    s_waitcnt lgkmcnt(4)
    v_exp_f32 v107, v107
    v_mfma_f32_16x16x32_bf16 v[4:7], a[220:223], a[68:71], v[4:7]
    v_exp_f32 v108, v108
    v_mfma_f32_16x16x32_bf16 v[20:23], a[220:223], a[76:79], v[164:167]
    buffer_load_dwordx4 v240, s[16:19], s55 offen offset:2048 sc1 lds
    v_mfma_f32_16x16x32_bf16 v[20:23], a[216:219], a[72:75], v[20:23]
    v_exp_f32 v109, v109
    v_mfma_f32_16x16x32_bf16 v[20:23], a[212:215], a[12:15], v[20:23]
    v_exp_f32 v110, v110
    v_mfma_f32_16x16x32_bf16 v[20:23], a[208:211], a[8:11], v[20:23]
    v_exp_f32 v111, v111
    v_mfma_f32_16x16x32_bf16 v[36:39], a[208:211], a[16:19], v[168:171]
    v_cvt_pk_bf16_f32 v130, v68, v69
    v_cvt_pk_bf16_f32 v131, v70, v71
    v_mfma_f32_16x16x32_bf16 v[36:39], a[212:215], a[20:23], v[36:39]
    v_exp_f32 v122, v122
    v_mfma_f32_16x16x32_bf16 v[36:39], a[216:219], a[80:83], v[36:39]
    ds_read_b128 a[240:243], v200 offset:12288
    v_cvt_pk_bf16_f32 v136, v80, v81
    v_mfma_f32_16x16x32_bf16 v[36:39], a[220:223], a[84:87], v[36:39]
    ds_read_b128 a[244:247], v200 offset:13312
    v_cvt_pk_bf16_f32 v137, v82, v83
    v_mfma_f32_16x16x32_bf16 v[52:55], a[220:223], a[92:95], v[172:175]
    ds_read_b128 a[248:251], v200 offset:14336
    v_cvt_pk_bf16_f32 v138, v84, v85
    v_mfma_f32_16x16x32_bf16 v[52:55], a[216:219], a[88:91], v[52:55]
    ds_read_b128 a[252:255], v200 offset:15360
    v_cvt_pk_bf16_f32 v139, v86, v87
    v_mfma_f32_16x16x32_bf16 v[52:55], a[212:215], a[28:31], v[52:55]
    buffer_load_dwordx4 v240, s[16:19], s55 offen offset:3072 sc1 lds
    v_mfma_f32_16x16x32_bf16 v[52:55], a[208:211], a[24:27], v[52:55]
    s_waitcnt lgkmcnt(7)
    v_exp_f32 v123, v123
    v_mfma_f32_16x16x32_bf16 v[8:11], a[224:227], a[0:3], v[160:163]
    s_waitcnt lgkmcnt(6)
    s_add_u32 s55, s55, 0x8000
    s_add_u32 s53, s53, 0x8000
    v_mfma_f32_16x16x32_bf16 v[8:11], a[228:231], a[4:7], v[8:11]
    s_waitcnt lgkmcnt(5)
    v_exp_f32 v124, v124
    v_mfma_f32_16x16x32_bf16 v[8:11], a[232:235], a[64:67], v[8:11]
    s_waitcnt lgkmcnt(4)
    s_and_b32 s53, s53, 0x1ffff
    v_cvt_pk_bf16_f32 v144, v96, v97
    v_mfma_f32_16x16x32_bf16 v[8:11], a[236:239], a[68:71], v[8:11]
    s_add_u32 m0, s50, 131072
    v_exp_f32 v125, v125
    v_mfma_f32_16x16x32_bf16 v[24:27], a[236:239], a[76:79], v[164:167]
    s_add_u32 s58, s48, 0
    v_cvt_pk_bf16_f32 v145, v98, v99
    v_cvt_pk_bf16_f32 v146, v100, v101
    v_mfma_f32_16x16x32_bf16 v[24:27], a[232:235], a[72:75], v[24:27]
    v_exp_f32 v126, v126
    v_mfma_f32_16x16x32_bf16 v[24:27], a[228:231], a[12:15], v[24:27]
    v_cvt_pk_bf16_f32 v147, v102, v103
    v_cvt_pk_bf16_f32 v152, v112, v113
    v_mfma_f32_16x16x32_bf16 v[24:27], a[224:227], a[8:11], v[24:27]
    buffer_load_dwordx4 v242, s[12:15], s58 offen lds
    v_mfma_f32_16x16x32_bf16 v[40:43], a[224:227], a[16:19], v[168:171]
    v_exp_f32 v127, v127
    v_mfma_f32_16x16x32_bf16 v[40:43], a[228:231], a[20:23], v[40:43]
    v_cvt_pk_bf16_f32 v153, v114, v115
    v_cvt_pk_bf16_f32 v154, v116, v117
    v_mfma_f32_16x16x32_bf16 v[40:43], a[232:235], a[80:83], v[40:43]
    v_exp_f32 v0, v0
    v_mfma_f32_16x16x32_bf16 v[40:43], a[236:239], a[84:87], v[40:43]
    ds_read_b128 a[192:195], v201 offset:49152
    v_cvt_pk_bf16_f32 v155, v118, v119
    v_mfma_f32_16x16x32_bf16 v[56:59], a[236:239], a[92:95], v[172:175]
    ds_read_b128 a[196:199], v201 offset:57344
    v_cvt_pk_bf16_f32 v132, v72, v73
    v_mfma_f32_16x16x32_bf16 v[56:59], a[232:235], a[88:91], v[56:59]
    v_exp_f32 v1, v1
    v_mfma_f32_16x16x32_bf16 v[56:59], a[228:231], a[28:31], v[56:59]
    v_cvt_pk_bf16_f32 v133, v74, v75
    v_cvt_pk_bf16_f32 v134, v76, v77
    v_mfma_f32_16x16x32_bf16 v[56:59], a[224:227], a[24:27], v[56:59]
    s_waitcnt lgkmcnt(5)
    v_exp_f32 v2, v2
    v_mfma_f32_16x16x32_bf16 v[12:15], a[240:243], a[0:3], v[160:163]
    s_waitcnt lgkmcnt(4)
    v_cvt_pk_bf16_f32 v135, v78, v79
    v_cvt_pk_bf16_f32 v140, v88, v89
    v_mfma_f32_16x16x32_bf16 v[12:15], a[244:247], a[4:7], v[12:15]
    s_waitcnt lgkmcnt(3)
    v_exp_f32 v3, v3
    v_mfma_f32_16x16x32_bf16 v[12:15], a[248:251], a[64:67], v[12:15]
    s_waitcnt lgkmcnt(2)
    v_cvt_pk_bf16_f32 v141, v90, v91
    v_cvt_pk_bf16_f32 v142, v92, v93
    v_mfma_f32_16x16x32_bf16 v[12:15], a[252:255], a[68:71], v[12:15]
    buffer_load_dwordx4 v243, s[12:15], s58 offen offset:1024 lds
    v_mfma_f32_16x16x32_bf16 v[28:31], a[252:255], a[76:79], v[164:167]
    s_add_u32 m0, s50, 139264
    v_exp_f32 v16, v16
    v_mfma_f32_16x16x32_bf16 v[28:31], a[248:251], a[72:75], v[28:31]
    s_add_u32 s58, s48, 32768
    ds_read_b128 a[200:203], v201 offset:50176
    v_cvt_pk_bf16_f32 v143, v94, v95
    v_mfma_f32_16x16x32_bf16 v[28:31], a[244:247], a[12:15], v[28:31]
    ds_read_b128 a[204:207], v201 offset:58368
    v_cvt_pk_bf16_f32 v148, v104, v105
    v_mfma_f32_16x16x32_bf16 v[28:31], a[240:243], a[8:11], v[28:31]
    v_exp_f32 v17, v17
    v_mfma_f32_16x16x32_bf16 v[44:47], a[240:243], a[16:19], v[168:171]
    v_cvt_pk_bf16_f32 v149, v106, v107
    v_cvt_pk_bf16_f32 v150, v108, v109
    v_mfma_f32_16x16x32_bf16 v[44:47], a[244:247], a[20:23], v[44:47]
    v_exp_f32 v18, v18
    v_mfma_f32_16x16x32_bf16 v[44:47], a[248:251], a[80:83], v[44:47]
    v_cvt_pk_bf16_f32 v151, v110, v111
    v_cvt_pk_bf16_f32 v156, v120, v121
    v_mfma_f32_16x16x32_bf16 v[44:47], a[252:255], a[84:87], v[44:47]
    v_exp_f32 v19, v19
    v_mfma_f32_16x16x32_bf16 v[60:63], a[252:255], a[92:95], v[172:175]
    v_cvt_pk_bf16_f32 v157, v122, v123
    v_subrev_f32 v202, 0x0, v199
    v_mfma_f32_16x16x32_bf16 v[60:63], a[248:251], a[88:91], v[60:63]
    v_cvt_pk_bf16_f32 v158, v124, v125
    v_min_f32 v32, v32, v202
    v_mfma_f32_16x16x32_bf16 v[60:63], a[244:247], a[28:31], v[60:63]
    v_exp_f32 v32, v32
    v_mfma_f32_16x16x32_bf16 v[60:63], a[240:243], a[24:27], v[60:63]
    s_waitcnt lgkmcnt(3)
    v_cvt_pk_bf16_f32 v159, v126, v127
    v_subrev_f32 v203, 0x71800000, v199
    v_mfma_f32_16x16x32_bf16 a[32:35], a[192:195], v[128:131], a[32:35]
    s_waitcnt lgkmcnt(2)
    ds_read_b128 a[208:211], v201 offset:51200
    v_min_f32 v33, v33, v203
    v_mfma_f32_16x16x32_bf16 a[32:35], a[196:199], v[132:135], a[32:35]
    buffer_load_dwordx4 v242, s[12:15], s58 offen lds
    v_mfma_f32_16x16x32_bf16 a[96:99], a[192:195], v[136:139], a[96:99]
    ds_read_b128 a[212:215], v201 offset:59392
    v_subrev_f32 v202, 0x72000000, v199
    v_mfma_f32_16x16x32_bf16 a[96:99], a[196:199], v[140:143], a[96:99]
    v_exp_f32 v33, v33
    v_mfma_f32_16x16x32_bf16 a[128:131], a[192:195], v[144:147], a[128:131]
    v_min_f32 v34, v34, v202
    v_subrev_f32 v203, 0x72400000, v199
    v_mfma_f32_16x16x32_bf16 a[128:131], a[196:199], v[148:151], a[128:131]
    v_exp_f32 v34, v34
    v_mfma_f32_16x16x32_bf16 a[160:163], a[192:195], v[152:155], a[160:163]
    ds_read_b128 a[216:219], v201 offset:52224
    v_min_f32 v35, v35, v203
    v_mfma_f32_16x16x32_bf16 a[160:163], a[196:199], v[156:159], a[160:163]
    s_waitcnt lgkmcnt(4)
    v_exp_f32 v35, v35
    v_mfma_f32_16x16x32_bf16 a[36:39], a[200:203], v[128:131], a[36:39]
    s_waitcnt lgkmcnt(3)
    v_exp_f32 v48, v48
    v_mfma_f32_16x16x32_bf16 a[36:39], a[204:207], v[132:135], a[36:39]
    ds_read_b128 a[220:223], v201 offset:60416
    v_subrev_f32 v202, 0x73800000, v199
    v_mfma_f32_16x16x32_bf16 a[100:103], a[200:203], v[136:139], a[100:103]
    v_exp_f32 v49, v49
    v_mfma_f32_16x16x32_bf16 a[100:103], a[204:207], v[140:143], a[100:103]
    buffer_load_dwordx4 v243, s[12:15], s58 offen offset:1024 lds
    v_mfma_f32_16x16x32_bf16 a[132:135], a[200:203], v[144:147], a[132:135]
    s_add_u32 m0, s50, 147456
    v_exp_f32 v50, v50
    v_mfma_f32_16x16x32_bf16 a[132:135], a[204:207], v[148:151], a[132:135]
    s_add_u32 s58, s48, 65536
    v_exp_f32 v51, v51
    v_mfma_f32_16x16x32_bf16 a[164:167], a[200:203], v[152:155], a[164:167]
    v_exp_f32 v4, v4
    v_mfma_f32_16x16x32_bf16 a[164:167], a[204:207], v[156:159], a[164:167]
    s_waitcnt lgkmcnt(3)
    ds_read_b128 a[224:227], v201 offset:53248
    ds_read_b128 a[228:231], v201 offset:61440
    v_mfma_f32_16x16x32_bf16 a[40:43], a[208:211], v[128:131], a[40:43]
    s_waitcnt lgkmcnt(4)
    v_exp_f32 v5, v5
    v_mfma_f32_16x16x32_bf16 a[40:43], a[212:215], v[132:135], a[40:43]
    v_exp_f32 v6, v6
    v_mfma_f32_16x16x32_bf16 a[104:107], a[208:211], v[136:139], a[104:107]
    buffer_load_dwordx4 v242, s[12:15], s58 offen lds
    v_mfma_f32_16x16x32_bf16 a[104:107], a[212:215], v[140:143], a[104:107]
    v_exp_f32 v7, v7
    v_mfma_f32_16x16x32_bf16 a[136:139], a[208:211], v[144:147], a[136:139]
    v_exp_f32 v20, v20
    v_mfma_f32_16x16x32_bf16 a[136:139], a[212:215], v[148:151], a[136:139]
    ds_read_b128 a[232:235], v201 offset:54272
    ds_read_b128 a[236:239], v201 offset:62464
    v_mfma_f32_16x16x32_bf16 a[168:171], a[208:211], v[152:155], a[168:171]
    v_exp_f32 v21, v21
    v_mfma_f32_16x16x32_bf16 a[168:171], a[212:215], v[156:159], a[168:171]
    s_waitcnt lgkmcnt(5)
    v_exp_f32 v22, v22
    v_mfma_f32_16x16x32_bf16 a[44:47], a[216:219], v[128:131], a[44:47]
    s_waitcnt lgkmcnt(4)
    buffer_load_dwordx4 v243, s[12:15], s58 offen offset:1024 lds
    v_mfma_f32_16x16x32_bf16 a[44:47], a[220:223], v[132:135], a[44:47]
    s_add_u32 m0, s50, 155648
    v_exp_f32 v23, v23
    v_mfma_f32_16x16x32_bf16 a[108:111], a[216:219], v[136:139], a[108:111]
    s_add_u32 s58, s48, 98304
    v_min_f32 v36, v36, v202
    v_add_f32 v184, v184, v96
    v_mfma_f32_16x16x32_bf16 a[108:111], a[220:223], v[140:143], a[108:111]
    v_exp_f32 v36, v36
    v_mfma_f32_16x16x32_bf16 a[140:143], a[216:219], v[144:147], a[140:143]
    v_subrev_f32 v203, 0x73880000, v199
    v_add_f32 v184, v184, v97
    v_mfma_f32_16x16x32_bf16 a[140:143], a[220:223], v[148:151], a[140:143]
    ds_read_b128 a[240:243], v201 offset:55296
    v_min_f32 v37, v37, v203
    v_mfma_f32_16x16x32_bf16 a[172:175], a[216:219], v[152:155], a[172:175]
    ds_read_b128 a[244:247], v201 offset:63488
    v_add_f32 v184, v184, v98
    v_mfma_f32_16x16x32_bf16 a[172:175], a[220:223], v[156:159], a[172:175]
    s_waitcnt lgkmcnt(5)
    v_exp_f32 v37, v37
    v_mfma_f32_16x16x32_bf16 a[48:51], a[224:227], v[128:131], a[48:51]
    s_waitcnt lgkmcnt(4)
    v_subrev_f32 v202, 0x73900000, v199
    v_add_f32 v184, v184, v99
    v_mfma_f32_16x16x32_bf16 a[48:51], a[228:231], v[132:135], a[48:51]
    v_min_f32 v38, v38, v202
    v_add_f32 v184, v184, v100
    v_mfma_f32_16x16x32_bf16 a[112:115], a[224:227], v[136:139], a[112:115]
    ds_read_b128 a[248:251], v201 offset:56320
    v_subrev_f32 v203, 0x73980000, v199
    v_mfma_f32_16x16x32_bf16 a[112:115], a[228:231], v[140:143], a[112:115]
    ds_read_b128 a[252:255], v201 offset:64512
    v_add_f32 v184, v184, v101
    v_mfma_f32_16x16x32_bf16 a[144:147], a[224:227], v[144:147], a[144:147]
    v_exp_f32 v38, v38
    v_mfma_f32_16x16x32_bf16 a[144:147], a[228:231], v[148:151], a[144:147]
    v_min_f32 v39, v39, v203
    v_add_f32 v184, v184, v102
    v_mfma_f32_16x16x32_bf16 a[176:179], a[224:227], v[152:155], a[176:179]
    v_exp_f32 v39, v39
    v_mfma_f32_16x16x32_bf16 a[176:179], a[228:231], v[156:159], a[176:179]
    s_waitcnt lgkmcnt(5)
    v_add_f32 v184, v184, v103
    v_add_f32 v188, v188, v112
    v_mfma_f32_16x16x32_bf16 a[52:55], a[232:235], v[128:131], a[52:55]
    s_waitcnt lgkmcnt(4)
    buffer_load_dwordx4 v242, s[12:15], s58 offen lds
    v_mfma_f32_16x16x32_bf16 a[52:55], a[236:239], v[132:135], a[52:55]
    v_exp_f32 v52, v52
    v_mfma_f32_16x16x32_bf16 a[116:119], a[232:235], v[136:139], a[116:119]
    v_add_f32 v188, v188, v113
    v_add_f32 v188, v188, v114
    v_mfma_f32_16x16x32_bf16 a[116:119], a[236:239], v[140:143], a[116:119]
    v_exp_f32 v53, v53
    v_mfma_f32_16x16x32_bf16 a[148:151], a[232:235], v[144:147], a[148:151]
    v_add_f32 v188, v188, v115
    v_add_f32 v188, v188, v116
    v_mfma_f32_16x16x32_bf16 a[148:151], a[236:239], v[148:151], a[148:151]
    v_exp_f32 v54, v54
    v_mfma_f32_16x16x32_bf16 a[180:183], a[232:235], v[152:155], a[180:183]
    s_waitcnt lgkmcnt(0)
    v_add_f32 v188, v188, v117
    v_subrev_f32 v202, 0x74000000, v199
    v_mfma_f32_16x16x32_bf16 a[180:183], a[236:239], v[156:159], a[180:183]
    s_waitcnt vmcnt(23)
    s_barrier
    v_mfma_f32_16x16x32_bf16 a[56:59], a[240:243], v[128:131], a[56:59]
    ds_read_b128 a[192:195], v200 offset:32768
    v_add_f32 v188, v188, v118
    v_mfma_f32_16x16x32_bf16 a[56:59], a[244:247], v[132:135], a[56:59]
    ds_read_b128 a[196:199], v200 offset:33792
    v_min_f32 v40, v40, v202
    v_mfma_f32_16x16x32_bf16 a[120:123], a[240:243], v[136:139], a[120:123]
    v_exp_f32 v55, v55
    v_mfma_f32_16x16x32_bf16 a[120:123], a[244:247], v[140:143], a[120:123]
    v_add_f32 v188, v188, v119
    v_subrev_f32 v203, 0x74040000, v199
    v_mfma_f32_16x16x32_bf16 a[152:155], a[240:243], v[144:147], a[152:155]
    ds_read_b128 a[200:203], v200 offset:34816
    v_add_f32 v184, v184, v104
    v_mfma_f32_16x16x32_bf16 a[152:155], a[244:247], v[148:151], a[152:155]
    v_exp_f32 v8, v8
    v_min_f32 v41, v41, v203
    v_add_f32 v184, v184, v105
    v_mfma_f32_16x16x32_bf16 a[184:187], a[240:243], v[152:155], a[184:187]
    v_subrev_f32 v202, 0x74080000, v199
    v_add_f32 v184, v184, v106
    v_mfma_f32_16x16x32_bf16 a[184:187], a[244:247], v[156:159], a[184:187]
    ds_read_b128 a[204:207], v200 offset:35840
    buffer_load_dwordx4 v243, s[12:15], s58 offen offset:1024 lds
    v_exp_f32 v9, v9
    v_min_f32 v42, v42, v202
    v_add_f32 v184, v184, v107
    v_mfma_f32_16x16x32_bf16 a[60:63], a[248:251], v[128:131], a[60:63]
    v_subrev_f32 v203, 0x740c0000, v199
    v_add_f32 v184, v184, v108
    v_mfma_f32_16x16x32_bf16 a[60:63], a[252:255], v[132:135], a[60:63]
    ds_read_b128 a[208:211], v200 offset:36864
    v_exp_f32 v24, v24
    v_min_f32 v43, v43, v203
    v_add_f32 v184, v184, v109
    v_mfma_f32_16x16x32_bf16 a[124:127], a[248:251], v[136:139], a[124:127]
    v_subrev_f32 v202, 0x74400000, v199
    v_add_f32 v184, v184, v110
    v_mfma_f32_16x16x32_bf16 a[124:127], a[252:255], v[140:143], a[124:127]
    ds_read_b128 a[212:215], v200 offset:37888
    v_exp_f32 v25, v25
    v_min_f32 v44, v44, v202
    v_add_f32 v184, v184, v111
    v_mfma_f32_16x16x32_bf16 a[156:159], a[248:251], v[144:147], a[156:159]
    v_subrev_f32 v203, 0x74440000, v199
    v_add_f32 v188, v188, v120
    v_mfma_f32_16x16x32_bf16 a[156:159], a[252:255], v[148:151], a[156:159]
    ds_read_b128 a[216:219], v200 offset:38912
    v_exp_f32 v40, v40
    v_min_f32 v45, v45, v203
    v_add_f32 v188, v188, v121
    v_mfma_f32_16x16x32_bf16 a[188:191], a[248:251], v[152:155], a[188:191]
    v_subrev_f32 v202, 0x74480000, v199
    v_add_f32 v188, v188, v122
    v_mfma_f32_16x16x32_bf16 a[188:191], a[252:255], v[156:159], a[188:191]
    ds_read_b128 a[220:223], v200 offset:39936
    v_exp_f32 v41, v41
    v_min_f32 v46, v46, v202
    v_add_f32 v188, v188, v123
    v_mfma_f32_16x16x32_bf16 v[176:179], v[192:195], v[128:131], v[176:179]
    v_subrev_f32 v203, 0x744c0000, v199
    v_add_f32 v188, v188, v124
    v_mfma_f32_16x16x32_bf16 v[176:179], v[192:195], v[132:135], v[176:179]
    buffer_load_dword v207, v206, s[20:23], s99 offen sc1
    v_exp_f32 v56, v56
    v_min_f32 v47, v47, v203
    v_add_f32 v188, v188, v125
    v_mfma_f32_16x16x32_bf16 v[180:183], v[192:195], v[136:139], v[180:183]
    v_add_f32 v188, v188, v126
    v_add_f32 v188, v188, v127
    v_mfma_f32_16x16x32_bf16 v[180:183], v[192:195], v[140:143], v[180:183]
    s_waitcnt lgkmcnt(7)
    v_exp_f32 v57, v57
    v_mfma_f32_16x16x32_bf16 v[64:67], a[192:195], a[0:3], v[160:163]
    s_waitcnt lgkmcnt(6)
    v_exp_f32 v10, v10
    v_mfma_f32_16x16x32_bf16 v[64:67], a[196:199], a[4:7], v[64:67]
    s_waitcnt lgkmcnt(5)
    v_exp_f32 v11, v11
    v_mfma_f32_16x16x32_bf16 v[64:67], a[200:203], a[64:67], v[64:67]
    s_waitcnt lgkmcnt(4)
    v_exp_f32 v12, v12
    v_mfma_f32_16x16x32_bf16 v[64:67], a[204:207], a[68:71], v[64:67]
    s_mov_b32 m0, s53
    v_exp_f32 v13, v13
    v_mfma_f32_16x16x32_bf16 v[80:83], a[204:207], a[76:79], v[164:167]
    ds_read_b128 a[224:227], v200 offset:40960
    ds_read_b128 a[228:231], v200 offset:41984
    v_mfma_f32_16x16x32_bf16 v[80:83], a[200:203], a[72:75], v[80:83]
    buffer_load_dwordx4 v240, s[16:19], s55 offen offset:0 sc1 lds
    v_mfma_f32_16x16x32_bf16 v[80:83], a[196:199], a[12:15], v[80:83]
    v_exp_f32 v14, v14
    v_mfma_f32_16x16x32_bf16 v[80:83], a[192:195], a[8:11], v[80:83]
    ds_read_b128 a[232:235], v200 offset:43008
    ds_read_b128 a[236:239], v200 offset:44032
    v_mfma_f32_16x16x32_bf16 v[112:115], a[192:195], a[24:27], v[172:175]
    v_exp_f32 v15, v15
    v_mfma_f32_16x16x32_bf16 v[112:115], a[196:199], a[28:31], v[112:115]
    v_exp_f32 v26, v26
    v_mfma_f32_16x16x32_bf16 v[112:115], a[200:203], a[88:91], v[112:115]
    v_exp_f32 v27, v27
    v_mfma_f32_16x16x32_bf16 v[112:115], a[204:207], a[92:95], v[112:115]
    s_waitcnt lgkmcnt(7)
    v_exp_f32 v28, v28
    v_mfma_f32_16x16x32_bf16 v[68:71], a[208:211], a[0:3], v[160:163]
    s_waitcnt lgkmcnt(6)
    v_cvt_pk_bf16_f32 v128, v0, v1
    v_cvt_pk_bf16_f32 v129, v2, v3
    v_mfma_f32_16x16x32_bf16 v[68:71], a[212:215], a[4:7], v[68:71]
    s_waitcnt lgkmcnt(5)
    v_exp_f32 v29, v29
    v_mfma_f32_16x16x32_bf16 v[68:71], a[216:219], a[64:67], v[68:71]
    s_waitcnt lgkmcnt(4)
    v_cvt_pk_bf16_f32 v130, v4, v5
    v_cvt_pk_bf16_f32 v131, v6, v7
    v_mfma_f32_16x16x32_bf16 v[68:71], a[220:223], a[68:71], v[68:71]
    buffer_load_dwordx4 v240, s[16:19], s55 offen offset:1024 sc1 lds
    v_mfma_f32_16x16x32_bf16 v[84:87], a[220:223], a[76:79], v[164:167]
    ds_read_b128 a[240:243], v200 offset:45056
    v_cvt_pk_bf16_f32 v136, v16, v17
    v_mfma_f32_16x16x32_bf16 v[84:87], a[216:219], a[72:75], v[84:87]
    v_exp_f32 v30, v30
    v_mfma_f32_16x16x32_bf16 v[84:87], a[212:215], a[12:15], v[84:87]
    ds_read_b128 a[244:247], v200 offset:46080
    v_cvt_pk_bf16_f32 v137, v18, v19
    v_mfma_f32_16x16x32_bf16 v[84:87], a[208:211], a[8:11], v[84:87]
    ds_read_b128 a[248:251], v200 offset:47104
    v_cvt_pk_bf16_f32 v138, v20, v21
    v_mfma_f32_16x16x32_bf16 v[116:119], a[208:211], a[24:27], v[172:175]
    v_exp_f32 v31, v31
    v_mfma_f32_16x16x32_bf16 v[116:119], a[212:215], a[28:31], v[116:119]
    ds_read_b128 a[252:255], v200 offset:48128
    v_cvt_pk_bf16_f32 v139, v22, v23
    v_mfma_f32_16x16x32_bf16 v[116:119], a[216:219], a[88:91], v[116:119]
    v_exp_f32 v42, v42
    v_mfma_f32_16x16x32_bf16 v[116:119], a[220:223], a[92:95], v[116:119]
    s_waitcnt lgkmcnt(7)
    v_cvt_pk_bf16_f32 v144, v32, v33
    v_cvt_pk_bf16_f32 v145, v34, v35
    v_mfma_f32_16x16x32_bf16 v[72:75], a[224:227], a[0:3], v[160:163]
    s_waitcnt lgkmcnt(6)
    v_exp_f32 v43, v43
    v_mfma_f32_16x16x32_bf16 v[72:75], a[228:231], a[4:7], v[72:75]
    s_waitcnt lgkmcnt(5)
    v_cvt_pk_bf16_f32 v146, v36, v37
    v_cvt_pk_bf16_f32 v147, v38, v39
    v_mfma_f32_16x16x32_bf16 v[72:75], a[232:235], a[64:67], v[72:75]
    s_waitcnt lgkmcnt(4)
    v_exp_f32 v44, v44
    v_mfma_f32_16x16x32_bf16 v[72:75], a[236:239], a[68:71], v[72:75]
    v_cvt_pk_bf16_f32 v152, v48, v49
    v_cvt_pk_bf16_f32 v153, v50, v51
    v_mfma_f32_16x16x32_bf16 v[88:91], a[236:239], a[76:79], v[164:167]
    v_exp_f32 v45, v45
    v_mfma_f32_16x16x32_bf16 v[88:91], a[232:235], a[72:75], v[88:91]
    v_cvt_pk_bf16_f32 v154, v52, v53
    v_cvt_pk_bf16_f32 v155, v54, v55
    v_mfma_f32_16x16x32_bf16 v[88:91], a[228:231], a[12:15], v[88:91]
    buffer_load_dwordx4 v240, s[16:19], s55 offen offset:2048 sc1 lds
    v_mfma_f32_16x16x32_bf16 v[88:91], a[224:227], a[8:11], v[88:91]
    ds_read_b128 a[192:195], v200 offset:16384
    v_cvt_pk_bf16_f32 v132, v8, v9
    v_mfma_f32_16x16x32_bf16 v[120:123], a[224:227], a[24:27], v[172:175]
    v_exp_f32 v46, v46
    v_mfma_f32_16x16x32_bf16 v[120:123], a[228:231], a[28:31], v[120:123]
    ds_read_b128 a[196:199], v200 offset:24576
    v_cvt_pk_bf16_f32 v133, v10, v11
    v_mfma_f32_16x16x32_bf16 v[120:123], a[232:235], a[88:91], v[120:123]
    v_exp_f32 v47, v47
    v_mfma_f32_16x16x32_bf16 v[120:123], a[236:239], a[92:95], v[120:123]
    s_waitcnt lgkmcnt(5)
    v_cvt_pk_bf16_f32 v134, v12, v13
    v_cvt_pk_bf16_f32 v135, v14, v15
    v_mfma_f32_16x16x32_bf16 v[76:79], a[240:243], a[0:3], v[160:163]
    s_waitcnt lgkmcnt(4)
    v_exp_f32 v58, v58
    v_mfma_f32_16x16x32_bf16 v[76:79], a[244:247], a[4:7], v[76:79]
    s_waitcnt lgkmcnt(3)
    v_cvt_pk_bf16_f32 v140, v24, v25
    v_cvt_pk_bf16_f32 v141, v26, v27
    v_mfma_f32_16x16x32_bf16 v[76:79], a[248:251], a[64:67], v[76:79]
    s_waitcnt lgkmcnt(2)
    v_exp_f32 v59, v59
    v_mfma_f32_16x16x32_bf16 v[76:79], a[252:255], a[68:71], v[76:79]
    v_cvt_pk_bf16_f32 v142, v28, v29
    v_cvt_pk_bf16_f32 v143, v30, v31
    v_mfma_f32_16x16x32_bf16 v[92:95], a[252:255], a[76:79], v[164:167]
    ds_read_b128 a[200:203], v200 offset:17408
    v_cvt_pk_bf16_f32 v148, v40, v41
    v_mfma_f32_16x16x32_bf16 v[92:95], a[248:251], a[72:75], v[92:95]
    v_exp_f32 v60, v60
    v_mfma_f32_16x16x32_bf16 v[92:95], a[244:247], a[12:15], v[92:95]
    ds_read_b128 a[204:207], v200 offset:25600
    v_cvt_pk_bf16_f32 v149, v42, v43
    v_mfma_f32_16x16x32_bf16 v[92:95], a[240:243], a[8:11], v[92:95]
    buffer_load_dwordx4 v240, s[16:19], s55 offen offset:3072 sc1 lds
    v_mfma_f32_16x16x32_bf16 v[124:127], a[240:243], a[24:27], v[172:175]
    v_exp_f32 v61, v61
    v_mfma_f32_16x16x32_bf16 v[124:127], a[244:247], a[28:31], v[124:127]
    v_cvt_pk_bf16_f32 v150, v44, v45
    v_cvt_pk_bf16_f32 v151, v46, v47
    v_mfma_f32_16x16x32_bf16 v[124:127], a[248:251], a[88:91], v[124:127]
    v_exp_f32 v62, v62
    v_mfma_f32_16x16x32_bf16 v[124:127], a[252:255], a[92:95], v[124:127]
    s_waitcnt lgkmcnt(3)
    v_cvt_pk_bf16_f32 v156, v56, v57
    v_cvt_pk_bf16_f32 v157, v58, v59
    v_mfma_f32_16x16x32_bf16 a[32:35], a[192:195], v[128:131], a[32:35]
    s_waitcnt lgkmcnt(2)
    v_exp_f32 v63, v63
    v_mfma_f32_16x16x32_bf16 a[32:35], a[196:199], v[132:135], a[32:35]
    v_cvt_pk_bf16_f32 v158, v60, v61
    v_cvt_pk_bf16_f32 v159, v62, v63
    v_mfma_f32_16x16x32_bf16 a[96:99], a[192:195], v[136:139], a[96:99]
    ds_read_b128 a[208:211], v200 offset:18432
    ds_read_b128 a[212:215], v200 offset:26624
    v_mfma_f32_16x16x32_bf16 a[96:99], a[196:199], v[140:143], a[96:99]
    buffer_store_dwordx4 v[232:235], v240, s[20:23], s36 offen offset:2048 sc1
    v_mfma_f32_16x16x32_bf16 a[128:131], a[192:195], v[144:147], a[128:131]
    v_exp_f32 v64, v64
    v_mfma_f32_16x16x32_bf16 a[128:131], a[196:199], v[148:151], a[128:131]
    ds_read_b128 a[216:219], v200 offset:19456
    ds_read_b128 a[220:223], v200 offset:27648
    v_mfma_f32_16x16x32_bf16 a[160:163], a[192:195], v[152:155], a[160:163]
    v_exp_f32 v65, v65
    v_mfma_f32_16x16x32_bf16 a[160:163], a[196:199], v[156:159], a[160:163]
    s_waitcnt lgkmcnt(5)
    v_exp_f32 v66, v66
    v_mfma_f32_16x16x32_bf16 a[36:39], a[200:203], v[128:131], a[36:39]
    s_waitcnt lgkmcnt(4)
    v_exp_f32 v67, v67
    v_mfma_f32_16x16x32_bf16 a[36:39], a[204:207], v[132:135], a[36:39]
    v_exp_f32 v80, v80
    v_mfma_f32_16x16x32_bf16 a[100:103], a[200:203], v[136:139], a[100:103]
    ds_read_b128 a[224:227], v200 offset:20480
    v_subrev_f32 v202, 0x0, v199
    v_mfma_f32_16x16x32_bf16 a[100:103], a[204:207], v[140:143], a[100:103]
    ds_read_b128 a[228:231], v200 offset:28672
    v_min_f32 v112, v112, v202
    v_mfma_f32_16x16x32_bf16 a[132:135], a[200:203], v[144:147], a[132:135]
    buffer_store_dwordx4 v[232:235], v240, s[20:23], s36 offen offset:3072 sc1
    v_mfma_f32_16x16x32_bf16 a[132:135], a[204:207], v[148:151], a[132:135]
    v_exp_f32 v81, v81
    v_mfma_f32_16x16x32_bf16 a[164:167], a[200:203], v[152:155], a[164:167]
    v_exp_f32 v82, v82
    v_mfma_f32_16x16x32_bf16 a[164:167], a[204:207], v[156:159], a[164:167]
    s_waitcnt lgkmcnt(5)
    v_exp_f32 v83, v83
    v_mfma_f32_16x16x32_bf16 a[40:43], a[208:211], v[128:131], a[40:43]
    s_waitcnt lgkmcnt(4)
    v_exp_f32 v112, v112
    v_mfma_f32_16x16x32_bf16 a[40:43], a[212:215], v[132:135], a[40:43]
    v_subrev_f32 v203, 0x71800000, v199
    v_min_f32 v113, v113, v203
    v_mfma_f32_16x16x32_bf16 a[104:107], a[208:211], v[136:139], a[104:107]
    ds_read_b128 a[232:235], v200 offset:21504
    v_subrev_f32 v202, 0x72000000, v199
    v_mfma_f32_16x16x32_bf16 a[104:107], a[212:215], v[140:143], a[104:107]
    ds_read_b128 a[236:239], v200 offset:29696
    v_min_f32 v114, v114, v202
    v_mfma_f32_16x16x32_bf16 a[136:139], a[208:211], v[144:147], a[136:139]
    v_exp_f32 v113, v113
    v_mfma_f32_16x16x32_bf16 a[136:139], a[212:215], v[148:151], a[136:139]
    v_exp_f32 v114, v114
    v_mfma_f32_16x16x32_bf16 a[168:171], a[208:211], v[152:155], a[168:171]
    v_subrev_f32 v203, 0x72400000, v199
    v_min_f32 v115, v115, v203
    v_mfma_f32_16x16x32_bf16 a[168:171], a[212:215], v[156:159], a[168:171]
    s_waitcnt lgkmcnt(5)
    buffer_store_dwordx4 v[232:235], v240, s[20:23], s37 offen offset:2048 sc1
    v_mfma_f32_16x16x32_bf16 a[44:47], a[216:219], v[128:131], a[44:47]
    s_waitcnt lgkmcnt(4)
    v_exp_f32 v115, v115
    v_mfma_f32_16x16x32_bf16 a[44:47], a[220:223], v[132:135], a[44:47]
    v_exp_f32 v68, v68
    v_mfma_f32_16x16x32_bf16 a[108:111], a[216:219], v[136:139], a[108:111]
    ds_read_b128 a[240:243], v200 offset:22528
    v_subrev_f32 v202, 0x73800000, v199
    v_mfma_f32_16x16x32_bf16 a[108:111], a[220:223], v[140:143], a[108:111]
    ds_read_b128 a[244:247], v200 offset:30720
    v_min_f32 v116, v116, v202
    v_mfma_f32_16x16x32_bf16 a[140:143], a[216:219], v[144:147], a[140:143]
    v_exp_f32 v69, v69
    v_mfma_f32_16x16x32_bf16 a[140:143], a[220:223], v[148:151], a[140:143]
    v_exp_f32 v70, v70
    v_mfma_f32_16x16x32_bf16 a[172:175], a[216:219], v[152:155], a[172:175]
    v_exp_f32 v71, v71
    v_mfma_f32_16x16x32_bf16 a[172:175], a[220:223], v[156:159], a[172:175]
    s_waitcnt lgkmcnt(5)
    v_exp_f32 v84, v84
    v_mfma_f32_16x16x32_bf16 a[48:51], a[224:227], v[128:131], a[48:51]
    s_waitcnt lgkmcnt(4)
    buffer_store_dwordx4 v[232:235], v240, s[20:23], s37 offen offset:3072 sc1
    v_mfma_f32_16x16x32_bf16 a[48:51], a[228:231], v[132:135], a[48:51]
    v_exp_f32 v85, v85
    v_mfma_f32_16x16x32_bf16 a[112:115], a[224:227], v[136:139], a[112:115]
    ds_read_b128 a[248:251], v200 offset:23552
    v_subrev_f32 v203, 0x73880000, v199
    v_mfma_f32_16x16x32_bf16 a[112:115], a[228:231], v[140:143], a[112:115]
    ds_read_b128 a[252:255], v200 offset:31744
    v_min_f32 v117, v117, v203
    v_mfma_f32_16x16x32_bf16 a[144:147], a[224:227], v[144:147], a[144:147]
    v_exp_f32 v86, v86
    v_mfma_f32_16x16x32_bf16 a[144:147], a[228:231], v[148:151], a[144:147]
    v_subrev_f32 v202, 0x73900000, v199
    v_min_f32 v118, v118, v202
    v_mfma_f32_16x16x32_bf16 a[176:179], a[224:227], v[152:155], a[176:179]
    v_exp_f32 v87, v87
    v_mfma_f32_16x16x32_bf16 a[176:179], a[228:231], v[156:159], a[176:179]
    s_waitcnt lgkmcnt(5)
    v_subrev_f32 v203, 0x73980000, v199
    v_min_f32 v119, v119, v203
    v_mfma_f32_16x16x32_bf16 a[52:55], a[232:235], v[128:131], a[52:55]
    s_waitcnt lgkmcnt(4)
    v_exp_f32 v116, v116
    v_mfma_f32_16x16x32_bf16 a[52:55], a[236:239], v[132:135], a[52:55]
    v_subrev_f32 v202, 0x74000000, v199
    v_min_f32 v120, v120, v202
    v_mfma_f32_16x16x32_bf16 a[116:119], a[232:235], v[136:139], a[116:119]
    v_exp_f32 v117, v117
    v_mfma_f32_16x16x32_bf16 a[116:119], a[236:239], v[140:143], a[116:119]
    v_subrev_f32 v203, 0x74040000, v199
    v_min_f32 v121, v121, v203
    v_mfma_f32_16x16x32_bf16 a[148:151], a[232:235], v[144:147], a[148:151]
    buffer_store_dwordx4 v[232:235], v240, s[20:23], s41 offen offset:2048 sc1
    v_mfma_f32_16x16x32_bf16 a[148:151], a[236:239], v[148:151], a[148:151]
    v_exp_f32 v118, v118
    v_mfma_f32_16x16x32_bf16 a[180:183], a[232:235], v[152:155], a[180:183]
    v_subrev_f32 v202, 0x74080000, v199
    v_min_f32 v122, v122, v202
    v_mfma_f32_16x16x32_bf16 a[180:183], a[236:239], v[156:159], a[180:183]
    s_waitcnt lgkmcnt(3)
    v_exp_f32 v119, v119
    v_mfma_f32_16x16x32_bf16 a[56:59], a[240:243], v[128:131], a[56:59]
    s_waitcnt lgkmcnt(2)
    v_subrev_f32 v203, 0x740c0000, v199
    v_min_f32 v123, v123, v203
    v_mfma_f32_16x16x32_bf16 a[56:59], a[244:247], v[132:135], a[56:59]
    v_exp_f32 v72, v72
    v_mfma_f32_16x16x32_bf16 a[120:123], a[240:243], v[136:139], a[120:123]
    s_waitcnt lgkmcnt(0)
    v_subrev_f32 v202, 0x74400000, v199
    v_min_f32 v124, v124, v202
    v_mfma_f32_16x16x32_bf16 a[120:123], a[244:247], v[140:143], a[120:123]
    s_waitcnt vmcnt(26)
    s_barrier
    ds_read_b128 a[192:195], v201 offset:0
    v_mfma_f32_16x16x32_bf16 a[152:155], a[240:243], v[144:147], a[152:155]
    ds_read_b128 a[196:199], v201 offset:1024
    ds_read_b128 a[200:203], v201 offset:2048
    v_mfma_f32_16x16x32_bf16 a[152:155], a[244:247], v[148:151], a[152:155]
    ds_read_b128 a[204:207], v201 offset:3072
    ds_read_b128 a[208:211], v201 offset:4096
    v_mfma_f32_16x16x32_bf16 a[184:187], a[240:243], v[152:155], a[184:187]
    ds_read_b128 a[212:215], v201 offset:5120
    v_subrev_f32 v203, 0x74440000, v199
    v_mfma_f32_16x16x32_bf16 a[184:187], a[244:247], v[156:159], a[184:187]
    v_exp_f32 v73, v73
    v_mfma_f32_16x16x32_bf16 a[60:63], a[248:251], v[128:131], a[60:63]
    ds_read_b128 a[216:219], v201 offset:6144
    v_min_f32 v125, v125, v203
    v_mfma_f32_16x16x32_bf16 a[60:63], a[252:255], v[132:135], a[60:63]
    v_exp_f32 v88, v88
    v_mfma_f32_16x16x32_bf16 a[124:127], a[248:251], v[136:139], a[124:127]
    ds_read_b128 a[220:223], v201 offset:7168
    v_subrev_f32 v202, 0x74480000, v199
    v_mfma_f32_16x16x32_bf16 a[124:127], a[252:255], v[140:143], a[124:127]
    v_exp_f32 v89, v89
    v_mfma_f32_16x16x32_bf16 a[156:159], a[248:251], v[144:147], a[156:159]
    v_min_f32 v126, v126, v202
    v_subrev_f32 v203, 0x744c0000, v199
    v_mfma_f32_16x16x32_bf16 a[156:159], a[252:255], v[148:151], a[156:159]
    buffer_store_dwordx4 v[232:235], v240, s[20:23], s41 offen offset:3072 sc1
    v_mfma_f32_16x16x32_bf16 a[188:191], a[248:251], v[152:155], a[188:191]
    v_exp_f32 v120, v120
    v_mfma_f32_16x16x32_bf16 a[188:191], a[252:255], v[156:159], a[188:191]
    v_min_f32 v127, v127, v203
    v_xor_b32 v200, 0x10000, v200
    v_mfma_f32_16x16x32_bf16 v[176:179], v[192:195], v[128:131], v[176:179]
    v_exp_f32 v121, v121
    v_mfma_f32_16x16x32_bf16 v[176:179], v[192:195], v[132:135], v[176:179]
    v_xor_b32 v201, 0x10000, v201
    v_mfma_f32_16x16x32_bf16 v[180:183], v[192:195], v[136:139], v[180:183]
    v_mfma_f32_16x16x32_bf16 v[180:183], v[192:195], v[140:143], v[180:183]
    v_mfma_f32_16x16x32_bf16 v[184:187], v[192:195], v[144:147], v[184:187]
    v_mfma_f32_16x16x32_bf16 v[184:187], v[192:195], v[148:151], v[184:187]
    v_mfma_f32_16x16x32_bf16 v[188:191], v[192:195], v[152:155], v[188:191]
    v_mfma_f32_16x16x32_bf16 v[188:191], v[192:195], v[156:159], v[188:191]
    s_waitcnt lgkmcnt(7)
    s_waitcnt vmcnt(10)
    v_cmp_ne_u32 vcc, 1, v207
    s_nop 0
    s_cbranch_vccnz L_h2wait
L_h2ok:
    v_mfma_f32_16x16x32_bf16 v[0:3], a[192:195], a[0:3], v[160:163]
    s_waitcnt lgkmcnt(6)
    v_exp_f32 v74, v74
    v_mfma_f32_16x16x32_bf16 v[0:3], a[196:199], a[4:7], v[0:3]
    s_waitcnt lgkmcnt(5)
    v_exp_f32 v75, v75
    v_mfma_f32_16x16x32_bf16 v[0:3], a[200:203], a[64:67], v[0:3]
    s_waitcnt lgkmcnt(4)
    v_exp_f32 v76, v76
    v_mfma_f32_16x16x32_bf16 v[0:3], a[204:207], a[68:71], v[0:3]
    s_add_u32 m0, s51, 0
    ds_read_b128 a[224:227], v200 offset:8192
    ds_read_b128 a[228:231], v200 offset:9216
    v_mfma_f32_16x16x32_bf16 v[16:19], a[204:207], a[76:79], v[164:167]
    s_add_u32 s58, s48, 131072
    v_exp_f32 v77, v77
    v_mfma_f32_16x16x32_bf16 v[16:19], a[200:203], a[72:75], v[16:19]
    v_cmp_ngt_f32 vcc, s61, v184
    v_nop
    v_mfma_f32_16x16x32_bf16 v[16:19], a[196:199], a[12:15], v[16:19]
    s_mov_b64 s[62:63], vcc
    ds_read_b128 a[232:235], v200 offset:10240
    ds_read_b128 a[236:239], v200 offset:11264
    v_mfma_f32_16x16x32_bf16 v[16:19], a[192:195], a[8:11], v[16:19]
    s_waitcnt lgkmcnt(7)
    v_mov_b32 v185, v184
    v_accvgpr_read_b32 v32, a128
    v_mfma_f32_16x16x32_bf16 v[4:7], a[208:211], a[0:3], v[160:163]
    s_waitcnt lgkmcnt(6)
    v_accvgpr_read_b32 v33, a129
    v_exp_f32 v78, v78
    v_mfma_f32_16x16x32_bf16 v[4:7], a[212:215], a[4:7], v[4:7]
    s_waitcnt lgkmcnt(5)
    buffer_load_dwordx4 v242, s[12:15], s58 offen lds
    v_permlane32_swap_b32 v184, v185
    v_accvgpr_read_b32 v34, a130
    v_mfma_f32_16x16x32_bf16 v[4:7], a[216:219], a[64:67], v[4:7]
    s_waitcnt lgkmcnt(4)
    v_add_f32 v184, v184, v185
    v_exp_f32 v79, v79
    v_mfma_f32_16x16x32_bf16 v[4:7], a[220:223], a[68:71], v[4:7]
    v_mov_b32 v185, v184
    v_cvt_pk_bf16_f32 v128, v64, v65
    v_mfma_f32_16x16x32_bf16 v[20:23], a[220:223], a[76:79], v[164:167]
    v_accvgpr_read_b32 v35, a131
    v_accvgpr_read_b32 v36, a132
    v_exp_f32 v90, v90
    v_mfma_f32_16x16x32_bf16 v[20:23], a[216:219], a[72:75], v[20:23]
    v_permlane16_swap_b32 v184, v185
    v_cvt_pk_bf16_f32 v129, v66, v67
    v_mfma_f32_16x16x32_bf16 v[20:23], a[212:215], a[12:15], v[20:23]
    ds_read_b128 a[240:243], v200 offset:12288
    v_accvgpr_read_b32 v37, a133
    v_add_f32 v184, v184, v185
    v_exp_f32 v91, v91
    v_cvt_pk_bf16_f32 v130, v68, v69
    v_mfma_f32_16x16x32_bf16 v[20:23], a[208:211], a[8:11], v[20:23]
    s_waitcnt lgkmcnt(4)
    ds_read_b128 a[244:247], v200 offset:13312
    v_rcp_f32 v204, v184
    v_cvt_pk_bf16_f32 v131, v70, v71
    v_mfma_f32_16x16x32_bf16 v[8:11], a[224:227], a[0:3], v[160:163]
    s_waitcnt lgkmcnt(4)
    ds_read_b128 a[248:251], v200 offset:14336
    buffer_load_dwordx4 v243, s[12:15], s58 offen offset:1024 lds
    v_accvgpr_read_b32 v38, a134
    v_exp_f32 v92, v92
    v_cvt_pk_bf16_f32 v136, v80, v81
    v_mfma_f32_16x16x32_bf16 v[8:11], a[228:231], a[4:7], v[8:11]
    s_waitcnt lgkmcnt(4)
    ds_read_b128 a[252:255], v200 offset:15360
    v_accvgpr_read_b32 v39, a135
    v_mul_f32 v32, v32, v204
    v_cvt_pk_bf16_f32 v137, v82, v83
    v_mfma_f32_16x16x32_bf16 v[8:11], a[232:235], a[64:67], v[8:11]
    s_waitcnt lgkmcnt(4)
    v_mul_f32 v33, v33, v204
    v_exp_f32 v93, v93
    v_cvt_pk_bf16_f32 v138, v84, v85
    v_mfma_f32_16x16x32_bf16 v[8:11], a[236:239], a[68:71], v[8:11]
    v_mul_f32 v34, v34, v204
    v_mul_f32 v35, v35, v204
    v_cvt_pk_bf16_f32 v139, v86, v87
    v_mfma_f32_16x16x32_bf16 v[24:27], a[236:239], a[76:79], v[164:167]
    s_add_u32 m0, s51, 8192
    v_mul_f32 v36, v36, v204
    v_exp_f32 v94, v94
    v_cvt_pk_bf16_f32 v152, v112, v113
    v_mfma_f32_16x16x32_bf16 v[24:27], a[232:235], a[72:75], v[24:27]
    s_add_u32 s58, s48, 163840
    v_mul_f32 v37, v37, v204
    v_cvt_pk_bf16_f32 v153, v114, v115
    v_mfma_f32_16x16x32_bf16 v[24:27], a[228:231], a[12:15], v[24:27]
    ds_read_b128 a[192:195], v201 offset:49152
    v_mul_f32 v38, v38, v204
    v_mul_f32 v39, v39, v204
    v_exp_f32 v95, v95
    v_cvt_pk_bf16_f32 v154, v116, v117
    v_mfma_f32_16x16x32_bf16 v[24:27], a[224:227], a[8:11], v[24:27]
    s_waitcnt lgkmcnt(4)
    ds_read_b128 a[196:199], v201 offset:57344
    buffer_load_dwordx4 v242, s[12:15], s58 offen lds
    v_cvt_pk_bf16_f32 v32, v32, v33
    v_cvt_pk_bf16_f32 v155, v118, v119
    v_mfma_f32_16x16x32_bf16 v[12:15], a[240:243], a[0:3], v[160:163]
    s_waitcnt lgkmcnt(4)
    v_cvt_pk_bf16_f32 v33, v34, v35
    v_cvt_pk_bf16_f32 v34, v36, v37
    v_exp_f32 v122, v122
    v_cvt_pk_bf16_f32 v132, v72, v73
    v_mfma_f32_16x16x32_bf16 v[12:15], a[244:247], a[4:7], v[12:15]
    s_waitcnt lgkmcnt(3)
    v_cvt_pk_bf16_f32 v35, v38, v39
    v_cvt_pk_bf16_f32 v133, v74, v75
    v_mfma_f32_16x16x32_bf16 v[12:15], a[248:251], a[64:67], v[12:15]
    s_waitcnt lgkmcnt(2)
    buffer_store_dwordx4 v[32:35], v240, s[20:23], s101 offen offset:0 sc1
    v_exp_f32 v123, v123
    v_cvt_pk_bf16_f32 v134, v76, v77
    v_mfma_f32_16x16x32_bf16 v[12:15], a[252:255], a[68:71], v[12:15]
    v_accvgpr_read_b32 v40, a136
    v_accvgpr_read_b32 v41, a137
    v_cvt_pk_bf16_f32 v135, v78, v79
    v_mfma_f32_16x16x32_bf16 v[28:31], a[252:255], a[76:79], v[164:167]
    ds_read_b128 a[200:203], v201 offset:50176
    v_accvgpr_read_b32 v42, a138
    v_exp_f32 v124, v124
    v_cvt_pk_bf16_f32 v140, v88, v89
    v_mfma_f32_16x16x32_bf16 v[28:31], a[248:251], a[72:75], v[28:31]
    ds_read_b128 a[204:207], v201 offset:58368
    buffer_load_dwordx4 v243, s[12:15], s58 offen offset:1024 lds
    v_accvgpr_read_b32 v43, a139
    v_accvgpr_read_b32 v44, a140
    v_cvt_pk_bf16_f32 v141, v90, v91
    v_mfma_f32_16x16x32_bf16 v[28:31], a[244:247], a[12:15], v[28:31]
    v_accvgpr_read_b32 v45, a141
    v_exp_f32 v125, v125
    v_cvt_pk_bf16_f32 v142, v92, v93
    v_mfma_f32_16x16x32_bf16 v[28:31], a[240:243], a[8:11], v[28:31]
    s_waitcnt lgkmcnt(3)
    v_accvgpr_read_b32 v46, a142
    v_cvt_pk_bf16_f32 v143, v94, v95
    v_mfma_f32_16x16x32_bf16 a[32:35], a[192:195], v[128:131], a[32:35]
    s_waitcnt lgkmcnt(2)
    v_accvgpr_read_b32 v47, a143
    v_mul_f32 v40, v40, v204
    v_exp_f32 v126, v126
    v_cvt_pk_bf16_f32 v156, v120, v121
    v_mfma_f32_16x16x32_bf16 a[32:35], a[196:199], v[132:135], a[32:35]
    s_add_u32 m0, s51, 16384
    v_mul_f32 v41, v41, v204
    v_cvt_pk_bf16_f32 v157, v122, v123
    v_mfma_f32_16x16x32_bf16 a[96:99], a[192:195], v[136:139], a[96:99]
    s_add_u32 s58, s48, 196608
    ds_read_b128 a[208:211], v201 offset:51200
    v_mul_f32 v42, v42, v204
    v_mul_f32 v43, v43, v204
    v_exp_f32 v127, v127
    v_cvt_pk_bf16_f32 v158, v124, v125
    v_mfma_f32_16x16x32_bf16 a[96:99], a[196:199], v[140:143], a[96:99]
    ds_read_b128 a[212:215], v201 offset:59392
    v_mul_f32 v44, v44, v204
    v_cvt_pk_bf16_f32 v159, v126, v127
    v_mfma_f32_16x16x32_bf16 a[160:163], a[192:195], v[152:155], a[160:163]
    buffer_load_dwordx4 v242, s[12:15], s58 offen lds
    v_mul_f32 v45, v45, v204
    v_mfma_f32_16x16x32_bf16 a[160:163], a[196:199], v[156:159], a[160:163]
    s_waitcnt lgkmcnt(3)
    v_mul_f32 v46, v46, v204
    v_mul_f32 v47, v47, v204
    v_mfma_f32_16x16x32_bf16 a[36:39], a[200:203], v[128:131], a[36:39]
    s_waitcnt lgkmcnt(2)
    ds_read_b128 a[216:219], v201 offset:52224
    v_cvt_pk_bf16_f32 v40, v40, v41
    v_mfma_f32_16x16x32_bf16 a[36:39], a[204:207], v[132:135], a[36:39]
    v_cvt_pk_bf16_f32 v41, v42, v43
    v_cvt_pk_bf16_f32 v42, v44, v45
    v_mfma_f32_16x16x32_bf16 a[100:103], a[200:203], v[136:139], a[100:103]
    ds_read_b128 a[220:223], v201 offset:60416
    v_cvt_pk_bf16_f32 v43, v46, v47
    v_mfma_f32_16x16x32_bf16 a[100:103], a[204:207], v[140:143], a[100:103]
    buffer_store_dwordx4 v[40:43], v240, s[20:23], s101 offen offset:1024 sc1
    v_mfma_f32_16x16x32_bf16 a[164:167], a[200:203], v[152:155], a[164:167]
    v_accvgpr_read_b32 v48, a144
    v_accvgpr_read_b32 v49, a145
    v_mfma_f32_16x16x32_bf16 a[164:167], a[204:207], v[156:159], a[164:167]
    s_waitcnt lgkmcnt(3)
    buffer_load_dwordx4 v243, s[12:15], s58 offen offset:1024 lds
    v_accvgpr_read_b32 v50, a146
    v_mfma_f32_16x16x32_bf16 a[40:43], a[208:211], v[128:131], a[40:43]
    s_waitcnt lgkmcnt(2)
    v_accvgpr_read_b32 v51, a147
    v_accvgpr_read_b32 v52, a148
    v_mfma_f32_16x16x32_bf16 a[40:43], a[212:215], v[132:135], a[40:43]
    s_add_u32 m0, s51, 24576
    v_accvgpr_read_b32 v53, a149
    v_subrev_f32 v202, 0x0, v199
    v_mfma_f32_16x16x32_bf16 a[104:107], a[208:211], v[136:139], a[104:107]
    ds_read_b128 a[224:227], v201 offset:53248
    v_accvgpr_read_b32 v54, a150
    v_accvgpr_read_b32 v55, a151
    v_min_f32 v0, v0, v202
    v_mfma_f32_16x16x32_bf16 a[104:107], a[212:215], v[140:143], a[104:107]
    s_add_u32 s58, s48, 229376
    ds_read_b128 a[228:231], v201 offset:61440
    v_mul_f32 v48, v48, v204
    v_exp_f32 v0, v0
    v_subrev_f32 v203, 0x71800000, v199
    v_mfma_f32_16x16x32_bf16 a[168:171], a[208:211], v[152:155], a[168:171]
    v_mul_f32 v49, v49, v204
    v_min_f32 v1, v1, v203
    v_mfma_f32_16x16x32_bf16 a[168:171], a[212:215], v[156:159], a[168:171]
    s_waitcnt lgkmcnt(3)
    buffer_load_dwordx4 v242, s[12:15], s58 offen lds
    v_mul_f32 v50, v50, v204
    v_mul_f32 v51, v51, v204
    v_exp_f32 v1, v1
    v_subrev_f32 v202, 0x72000000, v199
    v_mfma_f32_16x16x32_bf16 a[44:47], a[216:219], v[128:131], a[44:47]
    s_waitcnt lgkmcnt(2)
    v_mul_f32 v52, v52, v204
    v_min_f32 v2, v2, v202
    v_mfma_f32_16x16x32_bf16 a[44:47], a[220:223], v[132:135], a[44:47]
    v_mul_f32 v53, v53, v204
    v_mul_f32 v54, v54, v204
    v_exp_f32 v2, v2
    v_subrev_f32 v203, 0x72400000, v199
    v_mfma_f32_16x16x32_bf16 a[108:111], a[216:219], v[136:139], a[108:111]
    ds_read_b128 a[232:235], v201 offset:54272
    v_mul_f32 v55, v55, v204
    v_min_f32 v3, v3, v203
    v_mfma_f32_16x16x32_bf16 a[108:111], a[220:223], v[140:143], a[108:111]
    ds_read_b128 a[236:239], v201 offset:62464
    v_cvt_pk_bf16_f32 v48, v48, v49
    v_exp_f32 v3, v3
    v_mfma_f32_16x16x32_bf16 a[172:175], a[216:219], v[152:155], a[172:175]
    v_cvt_pk_bf16_f32 v49, v50, v51
    v_cvt_pk_bf16_f32 v50, v52, v53
    v_mfma_f32_16x16x32_bf16 a[172:175], a[220:223], v[156:159], a[172:175]
    s_waitcnt lgkmcnt(3)
    v_cvt_pk_bf16_f32 v51, v54, v55
    v_exp_f32 v16, v16
    v_mfma_f32_16x16x32_bf16 a[48:51], a[224:227], v[128:131], a[48:51]
    s_waitcnt lgkmcnt(2)
    buffer_store_dwordx4 v[48:51], v240, s[20:23], s101 offen offset:2048 sc1
    ds_read_b128 a[240:243], v201 offset:55296
    buffer_load_dwordx4 v243, s[12:15], s58 offen offset:1024 lds
    v_accvgpr_read_b32 v56, a152
    v_mfma_f32_16x16x32_bf16 a[48:51], a[228:231], v[132:135], a[48:51]
    ds_read_b128 a[244:247], v201 offset:63488
    v_accvgpr_read_b32 v57, a153
    v_exp_f32 v17, v17
    v_mfma_f32_16x16x32_bf16 a[112:115], a[224:227], v[136:139], a[112:115]
    s_add_u32 m0, s51, 32768
    ds_read_b128 a[248:251], v201 offset:56320
    v_accvgpr_read_b32 v58, a154
    v_mfma_f32_16x16x32_bf16 a[112:115], a[228:231], v[140:143], a[112:115]
    ds_read_b128 a[252:255], v201 offset:64512
    v_accvgpr_read_b32 v59, a155
    v_accvgpr_read_b32 v60, a156
    v_exp_f32 v18, v18
    v_mfma_f32_16x16x32_bf16 a[176:179], a[224:227], v[152:155], a[176:179]
    s_add_u32 s58, s48, 262144
    v_accvgpr_read_b32 v61, a157
    v_subrev_f32 v202, 0x73800000, v199
    v_mfma_f32_16x16x32_bf16 a[176:179], a[228:231], v[156:159], a[176:179]
    s_waitcnt lgkmcnt(5)
    v_accvgpr_read_b32 v62, a158
    v_accvgpr_read_b32 v63, a159
    v_exp_f32 v19, v19
    v_min_f32 v4, v4, v202
    v_mfma_f32_16x16x32_bf16 a[52:55], a[232:235], v[128:131], a[52:55]
    s_waitcnt lgkmcnt(4)
    v_mul_f32 v56, v56, v204
    v_subrev_f32 v203, 0x73880000, v199
    v_mfma_f32_16x16x32_bf16 a[52:55], a[236:239], v[132:135], a[52:55]
    buffer_load_dwordx4 v242, s[12:15], s58 offen lds
    v_mul_f32 v57, v57, v204
    v_exp_f32 v4, v4
    v_min_f32 v5, v5, v203
    v_mfma_f32_16x16x32_bf16 a[116:119], a[232:235], v[136:139], a[116:119]
    s_waitcnt lgkmcnt(0)
    v_mul_f32 v58, v58, v204
    v_mul_f32 v59, v59, v204
    v_subrev_f32 v202, 0x73900000, v199
    v_mfma_f32_16x16x32_bf16 a[116:119], a[236:239], v[140:143], a[116:119]
    s_waitcnt vmcnt(31)
    s_barrier
    v_mul_f32 v60, v60, v204
    v_exp_f32 v5, v5
    v_min_f32 v6, v6, v202
    v_mfma_f32_16x16x32_bf16 a[180:183], a[232:235], v[152:155], a[180:183]
    v_mul_f32 v61, v61, v204
    v_mul_f32 v62, v62, v204
    v_subrev_f32 v203, 0x73980000, v199
    v_mfma_f32_16x16x32_bf16 a[180:183], a[236:239], v[156:159], a[180:183]
    ds_read_b128 a[192:195], v200 offset:32768
    v_mul_f32 v63, v63, v204
    v_exp_f32 v6, v6
    v_min_f32 v7, v7, v203
    v_mfma_f32_16x16x32_bf16 a[56:59], a[240:243], v[128:131], a[56:59]
    v_cvt_pk_bf16_f32 v56, v56, v57
    v_subrev_f32 v202, 0x74000000, v199
    v_mfma_f32_16x16x32_bf16 a[56:59], a[244:247], v[132:135], a[56:59]
    ds_read_b128 a[196:199], v200 offset:33792
    buffer_load_dwordx4 v243, s[12:15], s58 offen offset:1024 lds
    v_cvt_pk_bf16_f32 v57, v58, v59
    v_cvt_pk_bf16_f32 v58, v60, v61
    v_exp_f32 v7, v7
    v_min_f32 v8, v8, v202
    v_mfma_f32_16x16x32_bf16 a[120:123], a[240:243], v[136:139], a[120:123]
    s_add_u32 m0, s51, 40960
    v_cvt_pk_bf16_f32 v59, v62, v63
    v_subrev_f32 v203, 0x74040000, v199
    v_mfma_f32_16x16x32_bf16 a[120:123], a[244:247], v[140:143], a[120:123]
    buffer_store_dwordx4 v[56:59], v240, s[20:23], s101 offen offset:3072 sc1
    ds_read_b128 a[200:203], v200 offset:34816
    v_exp_f32 v20, v20
    v_min_f32 v9, v9, v203
    v_mfma_f32_16x16x32_bf16 a[184:187], a[240:243], v[152:155], a[184:187]
    s_add_u32 s59, s64, 0
    buffer_load_dwordx4 a[128:131], v196, s[20:23], s59 offen offset:0 sc1
    v_subrev_f32 v202, 0x74080000, v199
    v_mfma_f32_16x16x32_bf16 a[184:187], a[244:247], v[156:159], a[184:187]
    buffer_load_dwordx4 a[132:135], v198, s[20:23], s59 offen offset:0 sc1
    ds_read_b128 a[204:207], v200 offset:35840
    v_exp_f32 v21, v21
    v_min_f32 v10, v10, v202
    v_mfma_f32_16x16x32_bf16 a[60:63], a[248:251], v[128:131], a[60:63]
    s_add_u32 s58, s48, 294912
    buffer_load_dwordx4 a[136:139], v196, s[20:23], s59 offen offset:1024 sc1
    buffer_load_dwordx4 a[140:143], v198, s[20:23], s59 offen offset:1024 sc1
    v_subrev_f32 v203, 0x740c0000, v199
    v_mfma_f32_16x16x32_bf16 a[60:63], a[252:255], v[132:135], a[60:63]
    s_add_u32 s59, s64, 2048
    ds_read_b128 a[208:211], v200 offset:36864
    v_exp_f32 v22, v22
    v_min_f32 v11, v11, v203
    v_mfma_f32_16x16x32_bf16 a[124:127], a[248:251], v[136:139], a[124:127]
    buffer_load_dwordx4 v242, s[12:15], s58 offen lds
    buffer_load_dwordx4 a[144:147], v196, s[20:23], s59 offen offset:0 sc1
    v_subrev_f32 v202, 0x74400000, v199
    v_mfma_f32_16x16x32_bf16 a[124:127], a[252:255], v[140:143], a[124:127]
    ds_read_b128 a[212:215], v200 offset:37888
    v_exp_f32 v23, v23
    v_min_f32 v12, v12, v202
    v_mfma_f32_16x16x32_bf16 a[188:191], a[248:251], v[152:155], a[188:191]
    buffer_load_dwordx4 a[148:151], v198, s[20:23], s59 offen offset:0 sc1
    v_subrev_f32 v203, 0x74440000, v199
    v_mfma_f32_16x16x32_bf16 a[188:191], a[252:255], v[156:159], a[188:191]
    ds_read_b128 a[216:219], v200 offset:38912
    v_exp_f32 v8, v8
    v_min_f32 v13, v13, v203
    v_mfma_f32_16x16x32_bf16 v[176:179], v[192:195], v[128:131], v[176:179]
    buffer_load_dwordx4 a[152:155], v196, s[20:23], s59 offen offset:1024 sc1
    v_subrev_f32 v202, 0x74480000, v199
    v_mfma_f32_16x16x32_bf16 v[176:179], v[192:195], v[132:135], v[176:179]
    ds_read_b128 a[220:223], v200 offset:39936
    v_exp_f32 v9, v9
    v_min_f32 v14, v14, v202
    v_mfma_f32_16x16x32_bf16 v[180:183], v[192:195], v[136:139], v[180:183]
    buffer_load_dwordx4 a[156:159], v198, s[20:23], s59 offen offset:1024 sc1
    v_subrev_f32 v203, 0x744c0000, v199
    v_mfma_f32_16x16x32_bf16 v[180:183], v[192:195], v[140:143], v[180:183]
    buffer_load_dwordx4 v243, s[12:15], s58 offen offset:1024 lds
    v_exp_f32 v24, v24
    v_min_f32 v15, v15, v203
    v_mfma_f32_16x16x32_bf16 v[188:191], v[192:195], v[152:155], v[188:191]
    v_exp_f32 v25, v25
    v_mfma_f32_16x16x32_bf16 v[188:191], v[192:195], v[156:159], v[188:191]
    s_waitcnt lgkmcnt(7)
    v_mfma_f32_16x16x32_bf16 v[80:83], a[192:195], a[8:11], v[164:167]
    s_waitcnt lgkmcnt(6)
    ds_read_b128 a[224:227], v200 offset:40960
    ds_read_b128 a[228:231], v200 offset:41984
    ds_read_b128 a[232:235], v200 offset:43008
    v_mfma_f32_16x16x32_bf16 v[80:83], a[196:199], a[12:15], v[80:83]
    s_waitcnt lgkmcnt(8)
    ds_read_b128 a[236:239], v200 offset:44032
    ds_read_b128 a[240:243], v200 offset:45056
    v_mfma_f32_16x16x32_bf16 v[80:83], a[200:203], a[72:75], v[80:83]
    s_waitcnt lgkmcnt(9)
    ds_read_b128 a[244:247], v200 offset:46080
    ds_read_b128 a[248:251], v200 offset:47104
    v_mfma_f32_16x16x32_bf16 v[80:83], a[204:207], a[76:79], v[80:83]
    s_waitcnt lgkmcnt(10)
    ds_read_b128 a[252:255], v200 offset:48128
    ds_read_b128 a[192:195], v200 offset:16384
    v_mfma_f32_16x16x32_bf16 v[84:87], a[208:211], a[8:11], v[164:167]
    s_waitcnt lgkmcnt(11)
    s_add_u32 m0, s51, 49152
    ds_read_b128 a[196:199], v200 offset:24576
    v_mfma_f32_16x16x32_bf16 v[84:87], a[212:215], a[12:15], v[84:87]
    s_waitcnt lgkmcnt(11)
    s_add_u32 s58, s48, 327680
    s_add_u32 s59, s64, 8192
    v_mfma_f32_16x16x32_bf16 v[84:87], a[216:219], a[72:75], v[84:87]
    s_waitcnt lgkmcnt(10)
    buffer_load_dwordx4 v[96:99], v196, s[20:23], s59 offen offset:0 sc1
    v_mfma_f32_16x16x32_bf16 v[84:87], a[220:223], a[76:79], v[84:87]
    s_waitcnt lgkmcnt(9)
    buffer_load_dwordx4 v242, s[12:15], s58 offen lds
    v_mfma_f32_16x16x32_bf16 v[88:91], a[224:227], a[8:11], v[164:167]
    s_waitcnt lgkmcnt(8)
    buffer_load_dwordx4 v[100:103], v198, s[20:23], s59 offen offset:0 sc1
    buffer_load_dwordx4 v[104:107], v196, s[20:23], s59 offen offset:1024 sc1
    v_mfma_f32_16x16x32_bf16 v[88:91], a[228:231], a[12:15], v[88:91]
    s_waitcnt lgkmcnt(7)
    buffer_load_dwordx4 v[108:111], v198, s[20:23], s59 offen offset:1024 sc1
    v_mfma_f32_16x16x32_bf16 v[88:91], a[232:235], a[72:75], v[88:91]
    s_waitcnt lgkmcnt(6)
    s_add_u32 s59, s64, 10240
    ds_read_b128 a[200:203], v200 offset:17408
    buffer_load_dwordx4 v[112:115], v196, s[20:23], s59 offen offset:0 sc1
    buffer_load_dwordx4 v[116:119], v198, s[20:23], s59 offen offset:0 sc1
    v_exp_f32 v10, v10
    v_mfma_f32_16x16x32_bf16 v[88:91], a[236:239], a[76:79], v[88:91]
    s_waitcnt lgkmcnt(6)
    ds_read_b128 a[204:207], v200 offset:25600
    buffer_load_dwordx4 v[120:123], v196, s[20:23], s59 offen offset:1024 sc1
    buffer_load_dwordx4 v[124:127], v198, s[20:23], s59 offen offset:1024 sc1
    v_exp_f32 v11, v11
    v_exp_f32 v12, v12
    v_cmp_ngt_f32 vcc, s61, v188
    v_mfma_f32_16x16x32_bf16 v[92:95], a[240:243], a[8:11], v[164:167]
    s_waitcnt lgkmcnt(6)
    v_exp_f32 v13, v13
    v_nop
    v_cvt_pk_bf16_f32 v128, v0, v1
    v_exp_f32 v14, v14
    v_cvt_pk_bf16_f32 v129, v2, v3
    v_cvt_pk_bf16_f32 v130, v4, v5
    v_mfma_f32_16x16x32_bf16 v[92:95], a[244:247], a[12:15], v[92:95]
    s_waitcnt lgkmcnt(5)
    s_or_b64 s[62:63], s[62:63], vcc
    v_mov_b32 v189, v188
    v_exp_f32 v15, v15
    v_cvt_pk_bf16_f32 v131, v6, v7
    v_accvgpr_read_b32 v32, a160
    v_cvt_pk_bf16_f32 v136, v16, v17
    v_exp_f32 v26, v26
    v_cvt_pk_bf16_f32 v137, v18, v19
    v_accvgpr_read_b32 v33, a161
    v_cvt_pk_bf16_f32 v138, v20, v21
    v_permlane32_swap_b32 v188, v189
    v_mfma_f32_16x16x32_bf16 v[92:95], a[248:251], a[72:75], v[92:95]
    s_waitcnt lgkmcnt(4)
    ds_read_b128 a[208:211], v200 offset:18432
    buffer_load_dwordx4 v243, s[12:15], s58 offen offset:1024 lds
    v_exp_f32 v27, v27
    v_cvt_pk_bf16_f32 v139, v22, v23
    v_accvgpr_read_b32 v34, a162
    v_cvt_pk_bf16_f32 v132, v8, v9
    v_exp_f32 v28, v28
    v_cvt_pk_bf16_f32 v133, v10, v11
    v_cvt_pk_bf16_f32 v134, v12, v13
    v_add_f32 v188, v188, v189
    v_mfma_f32_16x16x32_bf16 v[92:95], a[252:255], a[76:79], v[92:95]
    s_waitcnt lgkmcnt(4)
    ds_read_b128 a[212:215], v200 offset:26624
    v_exp_f32 v29, v29
    v_cvt_pk_bf16_f32 v135, v14, v15
    v_mov_b32 v189, v188
    v_exp_f32 v30, v30
    v_accvgpr_read_b32 v35, a163
    v_accvgpr_read_b32 v36, a164
    v_mfma_f32_16x16x32_bf16 a[32:35], a[192:195], v[128:131], a[32:35]
    s_waitcnt lgkmcnt(4)
    v_exp_f32 v31, v31
    v_permlane16_swap_b32 v188, v189
    v_cvt_pk_bf16_f32 v140, v24, v25
    v_accvgpr_read_b32 v37, a165
    v_cvt_pk_bf16_f32 v141, v26, v27
    v_add_f32 v188, v188, v189
    v_cvt_pk_bf16_f32 v142, v28, v29
    v_mfma_f32_16x16x32_bf16 a[32:35], a[196:199], v[132:135], a[32:35]
    v_cvt_pk_bf16_f32 v143, v30, v31
    v_rcp_f32 v205, v188
    v_accvgpr_read_b32 v38, a166
    v_accvgpr_read_b32 v39, a167
    v_mfma_f32_16x16x32_bf16 a[96:99], a[192:195], v[136:139], a[96:99]
    s_add_u32 m0, s51, 57344
    ds_read_b128 a[216:219], v200 offset:19456
    v_mul_f32 v32, v32, v205
    v_mul_f32 v33, v33, v205
    v_mul_f32 v34, v34, v205
    v_mfma_f32_16x16x32_bf16 a[96:99], a[196:199], v[140:143], a[96:99]
    s_waitcnt lgkmcnt(4)
    s_add_u32 s58, s48, 360448
    ds_read_b128 a[220:223], v200 offset:27648
    v_mul_f32 v35, v35, v205
    v_mul_f32 v36, v36, v205
    v_mul_f32 v37, v37, v205
    v_mfma_f32_16x16x32_bf16 a[36:39], a[200:203], v[128:131], a[36:39]
    s_waitcnt lgkmcnt(4)
    ds_read_b128 a[224:227], v200 offset:20480
    buffer_load_dwordx4 v242, s[12:15], s58 offen lds
    v_mul_f32 v38, v38, v205
    v_mul_f32 v39, v39, v205
    v_cvt_pk_bf16_f32 v32, v32, v33
    v_mfma_f32_16x16x32_bf16 a[36:39], a[204:207], v[132:135], a[36:39]
    ds_read_b128 a[228:231], v200 offset:28672
    v_cvt_pk_bf16_f32 v33, v34, v35
    v_cvt_pk_bf16_f32 v34, v36, v37
    v_mfma_f32_16x16x32_bf16 a[100:103], a[200:203], v[136:139], a[100:103]
    ds_read_b128 a[232:235], v200 offset:21504
    v_cvt_pk_bf16_f32 v35, v38, v39
    v_mfma_f32_16x16x32_bf16 a[100:103], a[204:207], v[140:143], a[100:103]
    s_waitcnt lgkmcnt(6)
    buffer_store_dwordx4 v[32:35], v246, s[20:23], s101 offen offset:0 sc1
    ds_read_b128 a[236:239], v200 offset:29696
    v_accvgpr_read_b32 v40, a168
    v_accvgpr_read_b32 v41, a169
    v_accvgpr_read_b32 v42, a170
    v_accvgpr_read_b32 v43, a171
    v_mfma_f32_16x16x32_bf16 a[40:43], a[208:211], v[128:131], a[40:43]
    s_waitcnt lgkmcnt(6)
    ds_read_b128 a[240:243], v200 offset:22528
    v_accvgpr_read_b32 v44, a172
    v_accvgpr_read_b32 v45, a173
    v_accvgpr_read_b32 v46, a174
    v_mfma_f32_16x16x32_bf16 a[40:43], a[212:215], v[132:135], a[40:43]
    ds_read_b128 a[244:247], v200 offset:30720
    v_accvgpr_read_b32 v47, a175
    v_mul_f32 v40, v40, v205
    v_mul_f32 v41, v41, v205
    v_mfma_f32_16x16x32_bf16 a[104:107], a[208:211], v[136:139], a[104:107]
    ds_read_b128 a[248:251], v200 offset:23552
    buffer_load_dwordx4 v243, s[12:15], s58 offen offset:1024 lds
    v_mul_f32 v42, v42, v205
    v_mul_f32 v43, v43, v205
    v_mul_f32 v44, v44, v205
    v_mfma_f32_16x16x32_bf16 a[104:107], a[212:215], v[140:143], a[104:107]
    s_waitcnt lgkmcnt(8)
    ds_read_b128 a[252:255], v200 offset:31744
    v_mul_f32 v45, v45, v205
    v_mul_f32 v46, v46, v205
    v_mfma_f32_16x16x32_bf16 a[44:47], a[216:219], v[128:131], a[44:47]
    s_waitcnt lgkmcnt(8)
    v_mul_f32 v47, v47, v205
    v_cvt_pk_bf16_f32 v40, v40, v41
    v_cvt_pk_bf16_f32 v41, v42, v43
    v_mfma_f32_16x16x32_bf16 a[44:47], a[220:223], v[132:135], a[44:47]
    s_add_u32 m0, s56, 0
    v_cvt_pk_bf16_f32 v42, v44, v45
    v_cvt_pk_bf16_f32 v43, v46, v47
    v_mfma_f32_16x16x32_bf16 a[108:111], a[216:219], v[136:139], a[108:111]
    s_add_u32 s58, s48, 393216
    buffer_store_dwordx4 v[40:43], v246, s[20:23], s101 offen offset:1024 sc1
    v_accvgpr_read_b32 v48, a176
    v_accvgpr_read_b32 v49, a177
    v_accvgpr_read_b32 v50, a178
    v_mfma_f32_16x16x32_bf16 a[108:111], a[220:223], v[140:143], a[108:111]
    s_waitcnt lgkmcnt(7)
    buffer_load_dwordx4 v242, s[12:15], s58 offen lds
    v_accvgpr_read_b32 v51, a179
    v_accvgpr_read_b32 v52, a180
    v_accvgpr_read_b32 v53, a181
    v_mfma_f32_16x16x32_bf16 a[48:51], a[224:227], v[128:131], a[48:51]
    s_waitcnt lgkmcnt(6)
    s_waitcnt lgkmcnt(0)
    v_accvgpr_read_b32 v54, a182
    v_accvgpr_read_b32 v55, a183
    v_mul_f32 v48, v48, v205
    v_mfma_f32_16x16x32_bf16 a[48:51], a[228:231], v[132:135], a[48:51]
    s_waitcnt vmcnt(45)
    s_barrier
    v_mul_f32 v49, v49, v205
    v_mul_f32 v50, v50, v205
    v_mul_f32 v51, v51, v205
    v_mfma_f32_16x16x32_bf16 a[112:115], a[224:227], v[136:139], a[112:115]
    v_mul_f32 v52, v52, v205
    v_mul_f32 v53, v53, v205
    v_mfma_f32_16x16x32_bf16 a[112:115], a[228:231], v[140:143], a[112:115]
    ds_read_b128 a[192:195], v200 offset:49152
    v_mul_f32 v54, v54, v205
    v_mul_f32 v55, v55, v205
    v_cvt_pk_bf16_f32 v48, v48, v49
    v_mfma_f32_16x16x32_bf16 a[52:55], a[232:235], v[128:131], a[52:55]
    v_cvt_pk_bf16_f32 v49, v50, v51
    v_cvt_pk_bf16_f32 v50, v52, v53
    v_cvt_pk_bf16_f32 v51, v54, v55
    v_mfma_f32_16x16x32_bf16 a[52:55], a[236:239], v[132:135], a[52:55]
    ds_read_b128 a[196:199], v200 offset:57344
    buffer_load_dwordx4 v243, s[12:15], s58 offen offset:1024 lds
    buffer_store_dwordx4 v[48:51], v246, s[20:23], s101 offen offset:2048 sc1
    v_accvgpr_read_b32 v56, a184
    v_accvgpr_read_b32 v57, a185
    v_mfma_f32_16x16x32_bf16 a[116:119], a[232:235], v[136:139], a[116:119]
    v_accvgpr_read_b32 v58, a186
    v_accvgpr_read_b32 v59, a187
    v_accvgpr_read_b32 v60, a188
    v_mfma_f32_16x16x32_bf16 a[116:119], a[236:239], v[140:143], a[116:119]
    ds_read_b128 a[200:203], v200 offset:50176
    v_accvgpr_read_b32 v61, a189
    v_accvgpr_read_b32 v62, a190
    v_accvgpr_read_b32 v63, a191
    v_mfma_f32_16x16x32_bf16 a[56:59], a[240:243], v[128:131], a[56:59]
    v_mul_f32 v56, v56, v205
    v_mul_f32 v57, v57, v205
    v_mul_f32 v58, v58, v205
    v_mfma_f32_16x16x32_bf16 a[56:59], a[244:247], v[132:135], a[56:59]
    s_add_u32 m0, s56, 8192
    ds_read_b128 a[204:207], v200 offset:58368
    v_mul_f32 v59, v59, v205
    v_subrev_f32 v202, 0x0, v199
    v_mul_f32 v60, v60, v205
    v_min_f32 v80, v80, v202
    v_mul_f32 v61, v61, v205
    v_subrev_f32 v203, 0x71800000, v199
    v_mul_f32 v62, v62, v205
    v_mfma_f32_16x16x32_bf16 a[120:123], a[240:243], v[136:139], a[120:123]
    s_add_u32 s58, s48, 425984
    v_min_f32 v81, v81, v203
    v_mul_f32 v63, v63, v205
    v_subrev_f32 v202, 0x72000000, v199
    v_cvt_pk_bf16_f32 v56, v56, v57
    v_min_f32 v82, v82, v202
    v_cvt_pk_bf16_f32 v57, v58, v59
    v_subrev_f32 v203, 0x72400000, v199
    v_cvt_pk_bf16_f32 v58, v60, v61
    v_mfma_f32_16x16x32_bf16 a[120:123], a[244:247], v[140:143], a[120:123]
    ds_read_b128 a[208:211], v200 offset:51200
    buffer_load_dwordx4 v242, s[12:15], s58 offen lds
    v_min_f32 v83, v83, v203
    v_cvt_pk_bf16_f32 v59, v62, v63
    v_subrev_f32 v202, 0x73800000, v199
    v_min_f32 v84, v84, v202
    v_subrev_f32 v203, 0x73880000, v199
    v_mfma_f32_16x16x32_bf16 a[60:63], a[248:251], v[128:131], a[60:63]
    buffer_store_dwordx4 v[56:59], v246, s[20:23], s101 offen offset:3072 sc1
    v_min_f32 v85, v85, v203
    v_subrev_f32 v202, 0x73900000, v199
    v_min_f32 v86, v86, v202
    v_subrev_f32 v203, 0x73980000, v199
    v_mfma_f32_16x16x32_bf16 a[60:63], a[252:255], v[132:135], a[60:63]
    s_add_u32 s59, s64, 4096
    buffer_load_dwordx4 a[160:163], v196, s[20:23], s59 offen offset:0 sc1
    buffer_load_dwordx4 a[164:167], v198, s[20:23], s59 offen offset:0 sc1
    ds_read_b128 a[212:215], v200 offset:59392
    buffer_load_dwordx4 a[168:171], v196, s[20:23], s59 offen offset:1024 sc1
    buffer_load_dwordx4 a[172:175], v198, s[20:23], s59 offen offset:1024 sc1
    v_min_f32 v87, v87, v203
    v_subrev_f32 v202, 0x74000000, v199
    v_min_f32 v88, v88, v202
    v_subrev_f32 v203, 0x74040000, v199
    v_mfma_f32_16x16x32_bf16 a[124:127], a[248:251], v[136:139], a[124:127]
    s_add_u32 s59, s64, 6144
    buffer_load_dwordx4 a[176:179], v196, s[20:23], s59 offen offset:0 sc1
    v_min_f32 v89, v89, v203
    v_subrev_f32 v202, 0x74080000, v199
    v_exp_f32 v80, v80
    v_min_f32 v90, v90, v202
    v_subrev_f32 v203, 0x740c0000, v199
    v_mfma_f32_16x16x32_bf16 a[124:127], a[252:255], v[140:143], a[124:127]
    ds_read_b128 a[216:219], v200 offset:52224
    buffer_load_dwordx4 a[180:183], v198, s[20:23], s59 offen offset:0 sc1
    buffer_load_dwordx4 a[184:187], v196, s[20:23], s59 offen offset:1024 sc1
    v_exp_f32 v81, v81
    v_min_f32 v91, v91, v203
    v_subrev_f32 v202, 0x74400000, v199
    v_exp_f32 v82, v82
    v_min_f32 v92, v92, v202
    v_subrev_f32 v203, 0x74440000, v199
    v_mfma_f32_16x16x32_bf16 v[176:179], v[192:195], v[128:131], v[176:179]
    buffer_load_dwordx4 a[188:191], v198, s[20:23], s59 offen offset:1024 sc1
    v_exp_f32 v83, v83
    v_min_f32 v93, v93, v203
    v_subrev_f32 v202, 0x74480000, v199
    v_exp_f32 v84, v84
    v_min_f32 v94, v94, v202
    v_subrev_f32 v203, 0x744c0000, v199
    v_mfma_f32_16x16x32_bf16 v[176:179], v[192:195], v[132:135], v[176:179]
    ds_read_b128 a[220:223], v200 offset:60416
    buffer_load_dwordx4 v243, s[12:15], s58 offen offset:1024 lds
    v_exp_f32 v85, v85
    v_min_f32 v95, v95, v203
    v_exp_f32 v86, v86
    v_mfma_f32_16x16x32_bf16 v[180:183], v[192:195], v[136:139], v[180:183]
    v_exp_f32 v87, v87
    v_exp_f32 v88, v88
    v_mfma_f32_16x16x32_bf16 v[180:183], v[192:195], v[140:143], v[180:183]
    s_waitcnt lgkmcnt(7)
    v_exp_f32 v89, v89
    s_branch L_fin
L_hwait:
    s_mov_b32 s44, 0x40000
L_hspin:
    s_sub_u32 s44, s44, 1
    s_cbranch_scc1 L_hok
    s_sleep 1
    buffer_load_dword v207, v206, s[20:23], s99 offen sc1
    s_waitcnt vmcnt(0)
    v_cmp_ne_u32 vcc, 1, v207
    s_cbranch_vccnz L_hspin
    s_branch L_hok
L_h2wait:
    s_mov_b32 s44, 0x40000
L_h2spin:
    s_sub_u32 s44, s44, 1
    s_cbranch_scc1 L_h2ok
    s_sleep 1
    buffer_load_dword v207, v206, s[20:23], s99 offen sc1
    s_waitcnt vmcnt(0)
    v_cmp_ne_u32 vcc, 1, v207
    s_cbranch_vccnz L_h2spin
    s_branch L_h2ok
L_cwait:
    s_mov_b32 s44, 0x40000
L_cspin:
    s_sub_u32 s44, s44, 1
    s_cbranch_scc1 L_cok
    s_sleep 1
    buffer_load_dword v207, v206, s[20:23], s3 offen offset:4 sc1
    s_waitcnt vmcnt(0)
    v_cmp_ne_u32 vcc, 1, v207
    s_cbranch_vccnz L_cspin
    s_branch L_cok
L_gwait:
    s_mov_b32 s44, 0x40000
L_gspin:
    s_sub_u32 s44, s44, 1
    s_cbranch_scc1 L_gok
    s_sleep 1
    buffer_load_dword v250, v247, s[20:23], s94 offen offset:4 sc1
    s_waitcnt vmcnt(0)
    v_cmp_ne_u32 vcc, 1, v250
    s_cbranch_vccnz L_gspin
    s_branch L_gok
L_safe:
    s_cmp_eq_u32 s38, 1
    s_cbranch_scc1 L_safe_ret
    s_waitcnt vmcnt(0) lgkmcnt(0)
    s_nop 15
    s_barrier
    v_accvgpr_write_b32 a32, 0
    v_accvgpr_write_b32 a33, 0
    v_accvgpr_write_b32 a34, 0
    v_accvgpr_write_b32 a35, 0
    v_accvgpr_write_b32 a36, 0
    v_accvgpr_write_b32 a37, 0
    v_accvgpr_write_b32 a38, 0
    v_accvgpr_write_b32 a39, 0
    v_accvgpr_write_b32 a40, 0
    v_accvgpr_write_b32 a41, 0
    v_accvgpr_write_b32 a42, 0
    v_accvgpr_write_b32 a43, 0
    v_accvgpr_write_b32 a44, 0
    v_accvgpr_write_b32 a45, 0
    v_accvgpr_write_b32 a46, 0
    v_accvgpr_write_b32 a47, 0
    v_accvgpr_write_b32 a48, 0
    v_accvgpr_write_b32 a49, 0
    v_accvgpr_write_b32 a50, 0
    v_accvgpr_write_b32 a51, 0
    v_accvgpr_write_b32 a52, 0
    v_accvgpr_write_b32 a53, 0
    v_accvgpr_write_b32 a54, 0
    v_accvgpr_write_b32 a55, 0
    v_accvgpr_write_b32 a56, 0
    v_accvgpr_write_b32 a57, 0
    v_accvgpr_write_b32 a58, 0
    v_accvgpr_write_b32 a59, 0
    v_accvgpr_write_b32 a60, 0
    v_accvgpr_write_b32 a61, 0
    v_accvgpr_write_b32 a62, 0
    v_accvgpr_write_b32 a63, 0
    v_mov_b32 v176, 0
    v_mov_b32 v177, 0
    v_mov_b32 v178, 0
    v_mov_b32 v179, 0
    v_mov_b32 v160, 0xfb800000
    v_accvgpr_write_b32 a96, 0
    v_accvgpr_write_b32 a97, 0
    v_accvgpr_write_b32 a98, 0
    v_accvgpr_write_b32 a99, 0
    v_accvgpr_write_b32 a100, 0
    v_accvgpr_write_b32 a101, 0
    v_accvgpr_write_b32 a102, 0
    v_accvgpr_write_b32 a103, 0
    v_accvgpr_write_b32 a104, 0
    v_accvgpr_write_b32 a105, 0
    v_accvgpr_write_b32 a106, 0
    v_accvgpr_write_b32 a107, 0
    v_accvgpr_write_b32 a108, 0
    v_accvgpr_write_b32 a109, 0
    v_accvgpr_write_b32 a110, 0
    v_accvgpr_write_b32 a111, 0
    v_accvgpr_write_b32 a112, 0
    v_accvgpr_write_b32 a113, 0
    v_accvgpr_write_b32 a114, 0
    v_accvgpr_write_b32 a115, 0
    v_accvgpr_write_b32 a116, 0
    v_accvgpr_write_b32 a117, 0
    v_accvgpr_write_b32 a118, 0
    v_accvgpr_write_b32 a119, 0
    v_accvgpr_write_b32 a120, 0
    v_accvgpr_write_b32 a121, 0
    v_accvgpr_write_b32 a122, 0
    v_accvgpr_write_b32 a123, 0
    v_accvgpr_write_b32 a124, 0
    v_accvgpr_write_b32 a125, 0
    v_accvgpr_write_b32 a126, 0
    v_accvgpr_write_b32 a127, 0
    v_mov_b32 v180, 0
    v_mov_b32 v181, 0
    v_mov_b32 v182, 0
    v_mov_b32 v183, 0
    v_mov_b32 v164, 0xfb800000
    v_accvgpr_write_b32 a128, 0
    v_accvgpr_write_b32 a129, 0
    v_accvgpr_write_b32 a130, 0
    v_accvgpr_write_b32 a131, 0
    v_accvgpr_write_b32 a132, 0
    v_accvgpr_write_b32 a133, 0
    v_accvgpr_write_b32 a134, 0
    v_accvgpr_write_b32 a135, 0
    v_accvgpr_write_b32 a136, 0
    v_accvgpr_write_b32 a137, 0
    v_accvgpr_write_b32 a138, 0
    v_accvgpr_write_b32 a139, 0
    v_accvgpr_write_b32 a140, 0
    v_accvgpr_write_b32 a141, 0
    v_accvgpr_write_b32 a142, 0
    v_accvgpr_write_b32 a143, 0
    v_accvgpr_write_b32 a144, 0
    v_accvgpr_write_b32 a145, 0
    v_accvgpr_write_b32 a146, 0
    v_accvgpr_write_b32 a147, 0
    v_accvgpr_write_b32 a148, 0
    v_accvgpr_write_b32 a149, 0
    v_accvgpr_write_b32 a150, 0
    v_accvgpr_write_b32 a151, 0
    v_accvgpr_write_b32 a152, 0
    v_accvgpr_write_b32 a153, 0
    v_accvgpr_write_b32 a154, 0
    v_accvgpr_write_b32 a155, 0
    v_accvgpr_write_b32 a156, 0
    v_accvgpr_write_b32 a157, 0
    v_accvgpr_write_b32 a158, 0
    v_accvgpr_write_b32 a159, 0
    v_mov_b32 v184, 0
    v_mov_b32 v185, 0
    v_mov_b32 v186, 0
    v_mov_b32 v187, 0
    v_mov_b32 v168, 0xfb800000
    v_accvgpr_write_b32 a160, 0
    v_accvgpr_write_b32 a161, 0
    v_accvgpr_write_b32 a162, 0
    v_accvgpr_write_b32 a163, 0
    v_accvgpr_write_b32 a164, 0
    v_accvgpr_write_b32 a165, 0
    v_accvgpr_write_b32 a166, 0
    v_accvgpr_write_b32 a167, 0
    v_accvgpr_write_b32 a168, 0
    v_accvgpr_write_b32 a169, 0
    v_accvgpr_write_b32 a170, 0
    v_accvgpr_write_b32 a171, 0
    v_accvgpr_write_b32 a172, 0
    v_accvgpr_write_b32 a173, 0
    v_accvgpr_write_b32 a174, 0
    v_accvgpr_write_b32 a175, 0
    v_accvgpr_write_b32 a176, 0
    v_accvgpr_write_b32 a177, 0
    v_accvgpr_write_b32 a178, 0
    v_accvgpr_write_b32 a179, 0
    v_accvgpr_write_b32 a180, 0
    v_accvgpr_write_b32 a181, 0
    v_accvgpr_write_b32 a182, 0
    v_accvgpr_write_b32 a183, 0
    v_accvgpr_write_b32 a184, 0
    v_accvgpr_write_b32 a185, 0
    v_accvgpr_write_b32 a186, 0
    v_accvgpr_write_b32 a187, 0
    v_accvgpr_write_b32 a188, 0
    v_accvgpr_write_b32 a189, 0
    v_accvgpr_write_b32 a190, 0
    v_accvgpr_write_b32 a191, 0
    v_mov_b32 v188, 0
    v_mov_b32 v189, 0
    v_mov_b32 v190, 0
    v_mov_b32 v191, 0
    v_mov_b32 v172, 0xfb800000
    s_sub_u32 s46, 15, s30
    s_lshl_b32 s47, s46, 7
    s_lshl_b32 s52, s30, 7
    v_cvt_f32_u32 v202, s47
    v_mul_f32 v202, 0x71800000, v202
    v_add_f32 v161, v199, v202
    v_cvt_f32_u32 v202, s47
    v_add_f32 v202, 0x42800000, v202
    v_mul_f32 v202, 0x71800000, v202
    v_add_f32 v165, v199, v202
    v_cvt_f32_u32 v202, s52
    v_mul_f32 v202, 0x71800000, v202
    v_add_f32 v169, v199, v202
    v_cvt_f32_u32 v202, s52
    v_add_f32 v202, 0x42800000, v202
    v_mul_f32 v202, 0x71800000, v202
    v_add_f32 v173, v199, v202
    v_add_u32 v200, s33, v240
    s_lshl_b32 s47, s46, 1
    s_add_u32 s47, s47, 2
    s_lshl_b32 s54, s28, 12
    s_add_u32 s52, s54, s33
    s_add_u32 s53, s52, 49152
    s_add_u32 s52, s52, 32768
L_safe_loop:
    s_mov_b32 m0, s52
    s_add_u32 s55, s54, 16384
    buffer_load_dwordx4 v240, s[16:19], s54 offen offset:0 sc1 lds
    buffer_load_dwordx4 v240, s[16:19], s54 offen offset:1024 sc1 lds
    buffer_load_dwordx4 v240, s[16:19], s54 offen offset:2048 sc1 lds
    buffer_load_dwordx4 v240, s[16:19], s54 offen offset:3072 sc1 lds
    s_mov_b32 m0, s53
    s_nop 0
    buffer_load_dwordx4 v240, s[16:19], s55 offen offset:0 sc1 lds
    buffer_load_dwordx4 v240, s[16:19], s55 offen offset:1024 sc1 lds
    buffer_load_dwordx4 v240, s[16:19], s55 offen offset:2048 sc1 lds
    buffer_load_dwordx4 v240, s[16:19], s55 offen offset:3072 sc1 lds
    s_waitcnt vmcnt(0)
    s_barrier
    ds_read_b128 a[192:195], v200 offset:32768
    ds_read_b128 a[196:199], v200 offset:33792
    ds_read_b128 a[200:203], v200 offset:34816
    ds_read_b128 a[204:207], v200 offset:35840
    ds_read_b128 a[208:211], v200 offset:36864
    ds_read_b128 a[212:215], v200 offset:37888
    ds_read_b128 a[216:219], v200 offset:38912
    ds_read_b128 a[220:223], v200 offset:39936
    ds_read_b128 a[224:227], v200 offset:40960
    ds_read_b128 a[228:231], v200 offset:41984
    ds_read_b128 a[232:235], v200 offset:43008
    ds_read_b128 a[236:239], v200 offset:44032
    ds_read_b128 a[240:243], v200 offset:45056
    ds_read_b128 a[244:247], v200 offset:46080
    ds_read_b128 a[248:251], v200 offset:47104
    ds_read_b128 a[252:255], v200 offset:48128
    s_waitcnt lgkmcnt(0)
    v_mfma_f32_16x16x32_bf16 v[0:3], a[192:195], a[0:3], 0
    v_mfma_f32_16x16x32_bf16 v[16:19], a[192:195], a[8:11], 0
    v_mfma_f32_16x16x32_bf16 v[32:35], a[192:195], a[16:19], 0
    v_mfma_f32_16x16x32_bf16 v[48:51], a[192:195], a[24:27], 0
    v_mfma_f32_16x16x32_bf16 v[0:3], a[196:199], a[4:7], v[0:3]
    v_mfma_f32_16x16x32_bf16 v[16:19], a[196:199], a[12:15], v[16:19]
    v_mfma_f32_16x16x32_bf16 v[32:35], a[196:199], a[20:23], v[32:35]
    v_mfma_f32_16x16x32_bf16 v[48:51], a[196:199], a[28:31], v[48:51]
    v_mfma_f32_16x16x32_bf16 v[0:3], a[200:203], a[64:67], v[0:3]
    v_mfma_f32_16x16x32_bf16 v[16:19], a[200:203], a[72:75], v[16:19]
    v_mfma_f32_16x16x32_bf16 v[32:35], a[200:203], a[80:83], v[32:35]
    v_mfma_f32_16x16x32_bf16 v[48:51], a[200:203], a[88:91], v[48:51]
    v_mfma_f32_16x16x32_bf16 v[0:3], a[204:207], a[68:71], v[0:3]
    v_mfma_f32_16x16x32_bf16 v[16:19], a[204:207], a[76:79], v[16:19]
    v_mfma_f32_16x16x32_bf16 v[32:35], a[204:207], a[84:87], v[32:35]
    v_mfma_f32_16x16x32_bf16 v[48:51], a[204:207], a[92:95], v[48:51]
    v_mfma_f32_16x16x32_bf16 v[4:7], a[208:211], a[0:3], 0
    v_mfma_f32_16x16x32_bf16 v[20:23], a[208:211], a[8:11], 0
    v_mfma_f32_16x16x32_bf16 v[36:39], a[208:211], a[16:19], 0
    v_mfma_f32_16x16x32_bf16 v[52:55], a[208:211], a[24:27], 0
    v_mfma_f32_16x16x32_bf16 v[4:7], a[212:215], a[4:7], v[4:7]
    v_mfma_f32_16x16x32_bf16 v[20:23], a[212:215], a[12:15], v[20:23]
    v_mfma_f32_16x16x32_bf16 v[36:39], a[212:215], a[20:23], v[36:39]
    v_mfma_f32_16x16x32_bf16 v[52:55], a[212:215], a[28:31], v[52:55]
    v_mfma_f32_16x16x32_bf16 v[4:7], a[216:219], a[64:67], v[4:7]
    v_mfma_f32_16x16x32_bf16 v[20:23], a[216:219], a[72:75], v[20:23]
    v_mfma_f32_16x16x32_bf16 v[36:39], a[216:219], a[80:83], v[36:39]
    v_mfma_f32_16x16x32_bf16 v[52:55], a[216:219], a[88:91], v[52:55]
    v_mfma_f32_16x16x32_bf16 v[4:7], a[220:223], a[68:71], v[4:7]
    v_mfma_f32_16x16x32_bf16 v[20:23], a[220:223], a[76:79], v[20:23]
    v_mfma_f32_16x16x32_bf16 v[36:39], a[220:223], a[84:87], v[36:39]
    v_mfma_f32_16x16x32_bf16 v[52:55], a[220:223], a[92:95], v[52:55]
    v_mfma_f32_16x16x32_bf16 v[8:11], a[224:227], a[0:3], 0
    v_mfma_f32_16x16x32_bf16 v[24:27], a[224:227], a[8:11], 0
    v_mfma_f32_16x16x32_bf16 v[40:43], a[224:227], a[16:19], 0
    v_mfma_f32_16x16x32_bf16 v[56:59], a[224:227], a[24:27], 0
    v_mfma_f32_16x16x32_bf16 v[8:11], a[228:231], a[4:7], v[8:11]
    v_mfma_f32_16x16x32_bf16 v[24:27], a[228:231], a[12:15], v[24:27]
    v_mfma_f32_16x16x32_bf16 v[40:43], a[228:231], a[20:23], v[40:43]
    v_mfma_f32_16x16x32_bf16 v[56:59], a[228:231], a[28:31], v[56:59]
    v_mfma_f32_16x16x32_bf16 v[8:11], a[232:235], a[64:67], v[8:11]
    v_mfma_f32_16x16x32_bf16 v[24:27], a[232:235], a[72:75], v[24:27]
    v_mfma_f32_16x16x32_bf16 v[40:43], a[232:235], a[80:83], v[40:43]
    v_mfma_f32_16x16x32_bf16 v[56:59], a[232:235], a[88:91], v[56:59]
    v_mfma_f32_16x16x32_bf16 v[8:11], a[236:239], a[68:71], v[8:11]
    v_mfma_f32_16x16x32_bf16 v[24:27], a[236:239], a[76:79], v[24:27]
    v_mfma_f32_16x16x32_bf16 v[40:43], a[236:239], a[84:87], v[40:43]
    v_mfma_f32_16x16x32_bf16 v[56:59], a[236:239], a[92:95], v[56:59]
    v_mfma_f32_16x16x32_bf16 v[12:15], a[240:243], a[0:3], 0
    v_mfma_f32_16x16x32_bf16 v[28:31], a[240:243], a[8:11], 0
    v_mfma_f32_16x16x32_bf16 v[44:47], a[240:243], a[16:19], 0
    v_mfma_f32_16x16x32_bf16 v[60:63], a[240:243], a[24:27], 0
    v_mfma_f32_16x16x32_bf16 v[12:15], a[244:247], a[4:7], v[12:15]
    v_mfma_f32_16x16x32_bf16 v[28:31], a[244:247], a[12:15], v[28:31]
    v_mfma_f32_16x16x32_bf16 v[44:47], a[244:247], a[20:23], v[44:47]
    v_mfma_f32_16x16x32_bf16 v[60:63], a[244:247], a[28:31], v[60:63]
    v_mfma_f32_16x16x32_bf16 v[12:15], a[248:251], a[64:67], v[12:15]
    v_mfma_f32_16x16x32_bf16 v[28:31], a[248:251], a[72:75], v[28:31]
    v_mfma_f32_16x16x32_bf16 v[44:47], a[248:251], a[80:83], v[44:47]
    v_mfma_f32_16x16x32_bf16 v[60:63], a[248:251], a[88:91], v[60:63]
    v_mfma_f32_16x16x32_bf16 v[12:15], a[252:255], a[68:71], v[12:15]
    v_mfma_f32_16x16x32_bf16 v[28:31], a[252:255], a[76:79], v[28:31]
    v_mfma_f32_16x16x32_bf16 v[44:47], a[252:255], a[84:87], v[44:47]
    v_mfma_f32_16x16x32_bf16 v[60:63], a[252:255], a[92:95], v[60:63]
    ds_read_b128 a[192:195], v200 offset:49152
    ds_read_b128 a[196:199], v200 offset:50176
    ds_read_b128 a[200:203], v200 offset:51200
    ds_read_b128 a[204:207], v200 offset:52224
    ds_read_b128 a[208:211], v200 offset:53248
    ds_read_b128 a[212:215], v200 offset:54272
    ds_read_b128 a[216:219], v200 offset:55296
    ds_read_b128 a[220:223], v200 offset:56320
    ds_read_b128 a[224:227], v200 offset:57344
    ds_read_b128 a[228:231], v200 offset:58368
    ds_read_b128 a[232:235], v200 offset:59392
    ds_read_b128 a[236:239], v200 offset:60416
    ds_read_b128 a[240:243], v200 offset:61440
    ds_read_b128 a[244:247], v200 offset:62464
    ds_read_b128 a[248:251], v200 offset:63488
    ds_read_b128 a[252:255], v200 offset:64512
    v_subrev_f32 v202, 0x0, v161
    v_min_f32 v0, v0, v202
    v_subrev_f32 v203, 0x71800000, v161
    v_min_f32 v1, v1, v203
    v_subrev_f32 v202, 0x72000000, v161
    v_min_f32 v2, v2, v202
    v_subrev_f32 v203, 0x72400000, v161
    v_min_f32 v3, v3, v203
    v_subrev_f32 v202, 0x73800000, v161
    v_min_f32 v4, v4, v202
    v_subrev_f32 v203, 0x73880000, v161
    v_min_f32 v5, v5, v203
    v_subrev_f32 v202, 0x73900000, v161
    v_min_f32 v6, v6, v202
    v_subrev_f32 v203, 0x73980000, v161
    v_min_f32 v7, v7, v203
    v_subrev_f32 v202, 0x74000000, v161
    v_min_f32 v8, v8, v202
    v_subrev_f32 v203, 0x74040000, v161
    v_min_f32 v9, v9, v203
    v_subrev_f32 v202, 0x74080000, v161
    v_min_f32 v10, v10, v202
    v_subrev_f32 v203, 0x740c0000, v161
    v_min_f32 v11, v11, v203
    v_subrev_f32 v202, 0x74400000, v161
    v_min_f32 v12, v12, v202
    v_subrev_f32 v203, 0x74440000, v161
    v_min_f32 v13, v13, v203
    v_subrev_f32 v202, 0x74480000, v161
    v_min_f32 v14, v14, v202
    v_subrev_f32 v203, 0x744c0000, v161
    v_min_f32 v15, v15, v203
    v_subrev_f32 v161, 0x74800000, v161
    v_max3_f32 v197, v0, v1, v2
    v_max3_f32 v197, v197, v3, v4
    v_max3_f32 v197, v197, v5, v6
    v_max3_f32 v197, v197, v7, v8
    v_max3_f32 v197, v197, v9, v10
    v_max3_f32 v197, v197, v11, v12
    v_max3_f32 v197, v197, v13, v14
    v_max_f32 v197, v197, v15
    v_mov_b32 v202, v197
    v_mov_b32 v203, v197
    s_nop 1
    v_permlane32_swap_b32 v202, v203
    s_nop 1
    v_max_f32 v202, v202, v203
    v_mov_b32 v203, v202
    s_nop 1
    v_permlane16_swap_b32 v202, v203
    s_nop 1
    v_max_f32 v202, v202, v203
    v_max_f32 v202, v202, v160
    v_sub_f32 v203, v160, v202
    v_exp_f32 v203, v203
    v_mov_b32 v160, v202
    v_sub_f32 v0, v0, v202
    v_sub_f32 v1, v1, v202
    v_sub_f32 v2, v2, v202
    v_sub_f32 v3, v3, v202
    v_sub_f32 v4, v4, v202
    v_sub_f32 v5, v5, v202
    v_sub_f32 v6, v6, v202
    v_sub_f32 v7, v7, v202
    v_sub_f32 v8, v8, v202
    v_sub_f32 v9, v9, v202
    v_sub_f32 v10, v10, v202
    v_sub_f32 v11, v11, v202
    v_sub_f32 v12, v12, v202
    v_sub_f32 v13, v13, v202
    v_sub_f32 v14, v14, v202
    v_sub_f32 v15, v15, v202
    v_exp_f32 v0, v0
    v_exp_f32 v1, v1
    v_exp_f32 v2, v2
    v_exp_f32 v3, v3
    v_exp_f32 v4, v4
    v_exp_f32 v5, v5
    v_exp_f32 v6, v6
    v_exp_f32 v7, v7
    v_exp_f32 v8, v8
    v_exp_f32 v9, v9
    v_exp_f32 v10, v10
    v_exp_f32 v11, v11
    v_exp_f32 v12, v12
    v_exp_f32 v13, v13
    v_exp_f32 v14, v14
    v_exp_f32 v15, v15
    v_mul_f32 v176, v176, v203
    v_mul_f32 v177, v177, v203
    v_mul_f32 v178, v178, v203
    v_mul_f32 v179, v179, v203
    v_cvt_pk_bf16_f32 v128, v0, v1
    v_cvt_pk_bf16_f32 v129, v2, v3
    v_cvt_pk_bf16_f32 v130, v4, v5
    v_cvt_pk_bf16_f32 v131, v6, v7
    v_cvt_pk_bf16_f32 v132, v8, v9
    v_cvt_pk_bf16_f32 v133, v10, v11
    v_cvt_pk_bf16_f32 v134, v12, v13
    v_cvt_pk_bf16_f32 v135, v14, v15
    v_accvgpr_read_b32 v204, a32
    v_accvgpr_read_b32 v205, a33
    v_mul_f32 v204, v204, v203
    v_mul_f32 v205, v205, v203
    v_accvgpr_write_b32 a32, v204
    v_accvgpr_write_b32 a33, v205
    v_accvgpr_read_b32 v204, a34
    v_accvgpr_read_b32 v205, a35
    v_mul_f32 v204, v204, v203
    v_mul_f32 v205, v205, v203
    v_accvgpr_write_b32 a34, v204
    v_accvgpr_write_b32 a35, v205
    v_accvgpr_read_b32 v204, a36
    v_accvgpr_read_b32 v205, a37
    v_mul_f32 v204, v204, v203
    v_mul_f32 v205, v205, v203
    v_accvgpr_write_b32 a36, v204
    v_accvgpr_write_b32 a37, v205
    v_accvgpr_read_b32 v204, a38
    v_accvgpr_read_b32 v205, a39
    v_mul_f32 v204, v204, v203
    v_mul_f32 v205, v205, v203
    v_accvgpr_write_b32 a38, v204
    v_accvgpr_write_b32 a39, v205
    v_accvgpr_read_b32 v204, a40
    v_accvgpr_read_b32 v205, a41
    v_mul_f32 v204, v204, v203
    v_mul_f32 v205, v205, v203
    v_accvgpr_write_b32 a40, v204
    v_accvgpr_write_b32 a41, v205
    v_accvgpr_read_b32 v204, a42
    v_accvgpr_read_b32 v205, a43
    v_mul_f32 v204, v204, v203
    v_mul_f32 v205, v205, v203
    v_accvgpr_write_b32 a42, v204
    v_accvgpr_write_b32 a43, v205
    v_accvgpr_read_b32 v204, a44
    v_accvgpr_read_b32 v205, a45
    v_mul_f32 v204, v204, v203
    v_mul_f32 v205, v205, v203
    v_accvgpr_write_b32 a44, v204
    v_accvgpr_write_b32 a45, v205
    v_accvgpr_read_b32 v204, a46
    v_accvgpr_read_b32 v205, a47
    v_mul_f32 v204, v204, v203
    v_mul_f32 v205, v205, v203
    v_accvgpr_write_b32 a46, v204
    v_accvgpr_write_b32 a47, v205
    v_accvgpr_read_b32 v204, a48
    v_accvgpr_read_b32 v205, a49
    v_mul_f32 v204, v204, v203
    v_mul_f32 v205, v205, v203
    v_accvgpr_write_b32 a48, v204
    v_accvgpr_write_b32 a49, v205
    v_accvgpr_read_b32 v204, a50
    v_accvgpr_read_b32 v205, a51
    v_mul_f32 v204, v204, v203
    v_mul_f32 v205, v205, v203
    v_accvgpr_write_b32 a50, v204
    v_accvgpr_write_b32 a51, v205
    v_accvgpr_read_b32 v204, a52
    v_accvgpr_read_b32 v205, a53
    v_mul_f32 v204, v204, v203
    v_mul_f32 v205, v205, v203
    v_accvgpr_write_b32 a52, v204
    v_accvgpr_write_b32 a53, v205
    v_accvgpr_read_b32 v204, a54
    v_accvgpr_read_b32 v205, a55
    v_mul_f32 v204, v204, v203
    v_mul_f32 v205, v205, v203
    v_accvgpr_write_b32 a54, v204
    v_accvgpr_write_b32 a55, v205
    v_accvgpr_read_b32 v204, a56
    v_accvgpr_read_b32 v205, a57
    v_mul_f32 v204, v204, v203
    v_mul_f32 v205, v205, v203
    v_accvgpr_write_b32 a56, v204
    v_accvgpr_write_b32 a57, v205
    v_accvgpr_read_b32 v204, a58
    v_accvgpr_read_b32 v205, a59
    v_mul_f32 v204, v204, v203
    v_mul_f32 v205, v205, v203
    v_accvgpr_write_b32 a58, v204
    v_accvgpr_write_b32 a59, v205
    v_accvgpr_read_b32 v204, a60
    v_accvgpr_read_b32 v205, a61
    v_mul_f32 v204, v204, v203
    v_mul_f32 v205, v205, v203
    v_accvgpr_write_b32 a60, v204
    v_accvgpr_write_b32 a61, v205
    v_accvgpr_read_b32 v204, a62
    v_accvgpr_read_b32 v205, a63
    v_mul_f32 v204, v204, v203
    v_mul_f32 v205, v205, v203
    v_accvgpr_write_b32 a62, v204
    v_accvgpr_write_b32 a63, v205
    v_subrev_f32 v202, 0x0, v165
    v_min_f32 v16, v16, v202
    v_subrev_f32 v203, 0x71800000, v165
    v_min_f32 v17, v17, v203
    v_subrev_f32 v202, 0x72000000, v165
    v_min_f32 v18, v18, v202
    v_subrev_f32 v203, 0x72400000, v165
    v_min_f32 v19, v19, v203
    v_subrev_f32 v202, 0x73800000, v165
    v_min_f32 v20, v20, v202
    v_subrev_f32 v203, 0x73880000, v165
    v_min_f32 v21, v21, v203
    v_subrev_f32 v202, 0x73900000, v165
    v_min_f32 v22, v22, v202
    v_subrev_f32 v203, 0x73980000, v165
    v_min_f32 v23, v23, v203
    v_subrev_f32 v202, 0x74000000, v165
    v_min_f32 v24, v24, v202
    v_subrev_f32 v203, 0x74040000, v165
    v_min_f32 v25, v25, v203
    v_subrev_f32 v202, 0x74080000, v165
    v_min_f32 v26, v26, v202
    v_subrev_f32 v203, 0x740c0000, v165
    v_min_f32 v27, v27, v203
    v_subrev_f32 v202, 0x74400000, v165
    v_min_f32 v28, v28, v202
    v_subrev_f32 v203, 0x74440000, v165
    v_min_f32 v29, v29, v203
    v_subrev_f32 v202, 0x74480000, v165
    v_min_f32 v30, v30, v202
    v_subrev_f32 v203, 0x744c0000, v165
    v_min_f32 v31, v31, v203
    v_subrev_f32 v165, 0x74800000, v165
    v_max3_f32 v197, v16, v17, v18
    v_max3_f32 v197, v197, v19, v20
    v_max3_f32 v197, v197, v21, v22
    v_max3_f32 v197, v197, v23, v24
    v_max3_f32 v197, v197, v25, v26
    v_max3_f32 v197, v197, v27, v28
    v_max3_f32 v197, v197, v29, v30
    v_max_f32 v197, v197, v31
    v_mov_b32 v202, v197
    v_mov_b32 v203, v197
    s_nop 1
    v_permlane32_swap_b32 v202, v203
    s_nop 1
    v_max_f32 v202, v202, v203
    v_mov_b32 v203, v202
    s_nop 1
    v_permlane16_swap_b32 v202, v203
    s_nop 1
    v_max_f32 v202, v202, v203
    v_max_f32 v202, v202, v164
    v_sub_f32 v203, v164, v202
    v_exp_f32 v203, v203
    v_mov_b32 v164, v202
    v_sub_f32 v16, v16, v202
    v_sub_f32 v17, v17, v202
    v_sub_f32 v18, v18, v202
    v_sub_f32 v19, v19, v202
    v_sub_f32 v20, v20, v202
    v_sub_f32 v21, v21, v202
    v_sub_f32 v22, v22, v202
    v_sub_f32 v23, v23, v202
    v_sub_f32 v24, v24, v202
    v_sub_f32 v25, v25, v202
    v_sub_f32 v26, v26, v202
    v_sub_f32 v27, v27, v202
    v_sub_f32 v28, v28, v202
    v_sub_f32 v29, v29, v202
    v_sub_f32 v30, v30, v202
    v_sub_f32 v31, v31, v202
    v_exp_f32 v16, v16
    v_exp_f32 v17, v17
    v_exp_f32 v18, v18
    v_exp_f32 v19, v19
    v_exp_f32 v20, v20
    v_exp_f32 v21, v21
    v_exp_f32 v22, v22
    v_exp_f32 v23, v23
    v_exp_f32 v24, v24
    v_exp_f32 v25, v25
    v_exp_f32 v26, v26
    v_exp_f32 v27, v27
    v_exp_f32 v28, v28
    v_exp_f32 v29, v29
    v_exp_f32 v30, v30
    v_exp_f32 v31, v31
    v_mul_f32 v180, v180, v203
    v_mul_f32 v181, v181, v203
    v_mul_f32 v182, v182, v203
    v_mul_f32 v183, v183, v203
    v_cvt_pk_bf16_f32 v136, v16, v17
    v_cvt_pk_bf16_f32 v137, v18, v19
    v_cvt_pk_bf16_f32 v138, v20, v21
    v_cvt_pk_bf16_f32 v139, v22, v23
    v_cvt_pk_bf16_f32 v140, v24, v25
    v_cvt_pk_bf16_f32 v141, v26, v27
    v_cvt_pk_bf16_f32 v142, v28, v29
    v_cvt_pk_bf16_f32 v143, v30, v31
    v_accvgpr_read_b32 v204, a96
    v_accvgpr_read_b32 v205, a97
    v_mul_f32 v204, v204, v203
    v_mul_f32 v205, v205, v203
    v_accvgpr_write_b32 a96, v204
    v_accvgpr_write_b32 a97, v205
    v_accvgpr_read_b32 v204, a98
    v_accvgpr_read_b32 v205, a99
    v_mul_f32 v204, v204, v203
    v_mul_f32 v205, v205, v203
    v_accvgpr_write_b32 a98, v204
    v_accvgpr_write_b32 a99, v205
    v_accvgpr_read_b32 v204, a100
    v_accvgpr_read_b32 v205, a101
    v_mul_f32 v204, v204, v203
    v_mul_f32 v205, v205, v203
    v_accvgpr_write_b32 a100, v204
    v_accvgpr_write_b32 a101, v205
    v_accvgpr_read_b32 v204, a102
    v_accvgpr_read_b32 v205, a103
    v_mul_f32 v204, v204, v203
    v_mul_f32 v205, v205, v203
    v_accvgpr_write_b32 a102, v204
    v_accvgpr_write_b32 a103, v205
    v_accvgpr_read_b32 v204, a104
    v_accvgpr_read_b32 v205, a105
    v_mul_f32 v204, v204, v203
    v_mul_f32 v205, v205, v203
    v_accvgpr_write_b32 a104, v204
    v_accvgpr_write_b32 a105, v205
    v_accvgpr_read_b32 v204, a106
    v_accvgpr_read_b32 v205, a107
    v_mul_f32 v204, v204, v203
    v_mul_f32 v205, v205, v203
    v_accvgpr_write_b32 a106, v204
    v_accvgpr_write_b32 a107, v205
    v_accvgpr_read_b32 v204, a108
    v_accvgpr_read_b32 v205, a109
    v_mul_f32 v204, v204, v203
    v_mul_f32 v205, v205, v203
    v_accvgpr_write_b32 a108, v204
    v_accvgpr_write_b32 a109, v205
    v_accvgpr_read_b32 v204, a110
    v_accvgpr_read_b32 v205, a111
    v_mul_f32 v204, v204, v203
    v_mul_f32 v205, v205, v203
    v_accvgpr_write_b32 a110, v204
    v_accvgpr_write_b32 a111, v205
    v_accvgpr_read_b32 v204, a112
    v_accvgpr_read_b32 v205, a113
    v_mul_f32 v204, v204, v203
    v_mul_f32 v205, v205, v203
    v_accvgpr_write_b32 a112, v204
    v_accvgpr_write_b32 a113, v205
    v_accvgpr_read_b32 v204, a114
    v_accvgpr_read_b32 v205, a115
    v_mul_f32 v204, v204, v203
    v_mul_f32 v205, v205, v203
    v_accvgpr_write_b32 a114, v204
    v_accvgpr_write_b32 a115, v205
    v_accvgpr_read_b32 v204, a116
    v_accvgpr_read_b32 v205, a117
    v_mul_f32 v204, v204, v203
    v_mul_f32 v205, v205, v203
    v_accvgpr_write_b32 a116, v204
    v_accvgpr_write_b32 a117, v205
    v_accvgpr_read_b32 v204, a118
    v_accvgpr_read_b32 v205, a119
    v_mul_f32 v204, v204, v203
    v_mul_f32 v205, v205, v203
    v_accvgpr_write_b32 a118, v204
    v_accvgpr_write_b32 a119, v205
    v_accvgpr_read_b32 v204, a120
    v_accvgpr_read_b32 v205, a121
    v_mul_f32 v204, v204, v203
    v_mul_f32 v205, v205, v203
    v_accvgpr_write_b32 a120, v204
    v_accvgpr_write_b32 a121, v205
    v_accvgpr_read_b32 v204, a122
    v_accvgpr_read_b32 v205, a123
    v_mul_f32 v204, v204, v203
    v_mul_f32 v205, v205, v203
    v_accvgpr_write_b32 a122, v204
    v_accvgpr_write_b32 a123, v205
    v_accvgpr_read_b32 v204, a124
    v_accvgpr_read_b32 v205, a125
    v_mul_f32 v204, v204, v203
    v_mul_f32 v205, v205, v203
    v_accvgpr_write_b32 a124, v204
    v_accvgpr_write_b32 a125, v205
    v_accvgpr_read_b32 v204, a126
    v_accvgpr_read_b32 v205, a127
    v_mul_f32 v204, v204, v203
    v_mul_f32 v205, v205, v203
    v_accvgpr_write_b32 a126, v204
    v_accvgpr_write_b32 a127, v205
    v_subrev_f32 v202, 0x0, v169
    v_min_f32 v32, v32, v202
    v_subrev_f32 v203, 0x71800000, v169
    v_min_f32 v33, v33, v203
    v_subrev_f32 v202, 0x72000000, v169
    v_min_f32 v34, v34, v202
    v_subrev_f32 v203, 0x72400000, v169
    v_min_f32 v35, v35, v203
    v_subrev_f32 v202, 0x73800000, v169
    v_min_f32 v36, v36, v202
    v_subrev_f32 v203, 0x73880000, v169
    v_min_f32 v37, v37, v203
    v_subrev_f32 v202, 0x73900000, v169
    v_min_f32 v38, v38, v202
    v_subrev_f32 v203, 0x73980000, v169
    v_min_f32 v39, v39, v203
    v_subrev_f32 v202, 0x74000000, v169
    v_min_f32 v40, v40, v202
    v_subrev_f32 v203, 0x74040000, v169
    v_min_f32 v41, v41, v203
    v_subrev_f32 v202, 0x74080000, v169
    v_min_f32 v42, v42, v202
    v_subrev_f32 v203, 0x740c0000, v169
    v_min_f32 v43, v43, v203
    v_subrev_f32 v202, 0x74400000, v169
    v_min_f32 v44, v44, v202
    v_subrev_f32 v203, 0x74440000, v169
    v_min_f32 v45, v45, v203
    v_subrev_f32 v202, 0x74480000, v169
    v_min_f32 v46, v46, v202
    v_subrev_f32 v203, 0x744c0000, v169
    v_min_f32 v47, v47, v203
    v_subrev_f32 v169, 0x74800000, v169
    v_max3_f32 v197, v32, v33, v34
    v_max3_f32 v197, v197, v35, v36
    v_max3_f32 v197, v197, v37, v38
    v_max3_f32 v197, v197, v39, v40
    v_max3_f32 v197, v197, v41, v42
    v_max3_f32 v197, v197, v43, v44
    v_max3_f32 v197, v197, v45, v46
    v_max_f32 v197, v197, v47
    v_mov_b32 v202, v197
    v_mov_b32 v203, v197
    s_nop 1
    v_permlane32_swap_b32 v202, v203
    s_nop 1
    v_max_f32 v202, v202, v203
    v_mov_b32 v203, v202
    s_nop 1
    v_permlane16_swap_b32 v202, v203
    s_nop 1
    v_max_f32 v202, v202, v203
    v_max_f32 v202, v202, v168
    v_sub_f32 v203, v168, v202
    v_exp_f32 v203, v203
    v_mov_b32 v168, v202
    v_sub_f32 v32, v32, v202
    v_sub_f32 v33, v33, v202
    v_sub_f32 v34, v34, v202
    v_sub_f32 v35, v35, v202
    v_sub_f32 v36, v36, v202
    v_sub_f32 v37, v37, v202
    v_sub_f32 v38, v38, v202
    v_sub_f32 v39, v39, v202
    v_sub_f32 v40, v40, v202
    v_sub_f32 v41, v41, v202
    v_sub_f32 v42, v42, v202
    v_sub_f32 v43, v43, v202
    v_sub_f32 v44, v44, v202
    v_sub_f32 v45, v45, v202
    v_sub_f32 v46, v46, v202
    v_sub_f32 v47, v47, v202
    v_exp_f32 v32, v32
    v_exp_f32 v33, v33
    v_exp_f32 v34, v34
    v_exp_f32 v35, v35
    v_exp_f32 v36, v36
    v_exp_f32 v37, v37
    v_exp_f32 v38, v38
    v_exp_f32 v39, v39
    v_exp_f32 v40, v40
    v_exp_f32 v41, v41
    v_exp_f32 v42, v42
    v_exp_f32 v43, v43
    v_exp_f32 v44, v44
    v_exp_f32 v45, v45
    v_exp_f32 v46, v46
    v_exp_f32 v47, v47
    v_mul_f32 v184, v184, v203
    v_mul_f32 v185, v185, v203
    v_mul_f32 v186, v186, v203
    v_mul_f32 v187, v187, v203
    v_cvt_pk_bf16_f32 v144, v32, v33
    v_cvt_pk_bf16_f32 v145, v34, v35
    v_cvt_pk_bf16_f32 v146, v36, v37
    v_cvt_pk_bf16_f32 v147, v38, v39
    v_cvt_pk_bf16_f32 v148, v40, v41
    v_cvt_pk_bf16_f32 v149, v42, v43
    v_cvt_pk_bf16_f32 v150, v44, v45
    v_cvt_pk_bf16_f32 v151, v46, v47
    v_accvgpr_read_b32 v204, a128
    v_accvgpr_read_b32 v205, a129
    v_mul_f32 v204, v204, v203
    v_mul_f32 v205, v205, v203
    v_accvgpr_write_b32 a128, v204
    v_accvgpr_write_b32 a129, v205
    v_accvgpr_read_b32 v204, a130
    v_accvgpr_read_b32 v205, a131
    v_mul_f32 v204, v204, v203
    v_mul_f32 v205, v205, v203
    v_accvgpr_write_b32 a130, v204
    v_accvgpr_write_b32 a131, v205
    v_accvgpr_read_b32 v204, a132
    v_accvgpr_read_b32 v205, a133
    v_mul_f32 v204, v204, v203
    v_mul_f32 v205, v205, v203
    v_accvgpr_write_b32 a132, v204
    v_accvgpr_write_b32 a133, v205
    v_accvgpr_read_b32 v204, a134
    v_accvgpr_read_b32 v205, a135
    v_mul_f32 v204, v204, v203
    v_mul_f32 v205, v205, v203
    v_accvgpr_write_b32 a134, v204
    v_accvgpr_write_b32 a135, v205
    v_accvgpr_read_b32 v204, a136
    v_accvgpr_read_b32 v205, a137
    v_mul_f32 v204, v204, v203
    v_mul_f32 v205, v205, v203
    v_accvgpr_write_b32 a136, v204
    v_accvgpr_write_b32 a137, v205
    v_accvgpr_read_b32 v204, a138
    v_accvgpr_read_b32 v205, a139
    v_mul_f32 v204, v204, v203
    v_mul_f32 v205, v205, v203
    v_accvgpr_write_b32 a138, v204
    v_accvgpr_write_b32 a139, v205
    v_accvgpr_read_b32 v204, a140
    v_accvgpr_read_b32 v205, a141
    v_mul_f32 v204, v204, v203
    v_mul_f32 v205, v205, v203
    v_accvgpr_write_b32 a140, v204
    v_accvgpr_write_b32 a141, v205
    v_accvgpr_read_b32 v204, a142
    v_accvgpr_read_b32 v205, a143
    v_mul_f32 v204, v204, v203
    v_mul_f32 v205, v205, v203
    v_accvgpr_write_b32 a142, v204
    v_accvgpr_write_b32 a143, v205
    v_accvgpr_read_b32 v204, a144
    v_accvgpr_read_b32 v205, a145
    v_mul_f32 v204, v204, v203
    v_mul_f32 v205, v205, v203
    v_accvgpr_write_b32 a144, v204
    v_accvgpr_write_b32 a145, v205
    v_accvgpr_read_b32 v204, a146
    v_accvgpr_read_b32 v205, a147
    v_mul_f32 v204, v204, v203
    v_mul_f32 v205, v205, v203
    v_accvgpr_write_b32 a146, v204
    v_accvgpr_write_b32 a147, v205
    v_accvgpr_read_b32 v204, a148
    v_accvgpr_read_b32 v205, a149
    v_mul_f32 v204, v204, v203
    v_mul_f32 v205, v205, v203
    v_accvgpr_write_b32 a148, v204
    v_accvgpr_write_b32 a149, v205
    v_accvgpr_read_b32 v204, a150
    v_accvgpr_read_b32 v205, a151
    v_mul_f32 v204, v204, v203
    v_mul_f32 v205, v205, v203
    v_accvgpr_write_b32 a150, v204
    v_accvgpr_write_b32 a151, v205
    v_accvgpr_read_b32 v204, a152
    v_accvgpr_read_b32 v205, a153
    v_mul_f32 v204, v204, v203
    v_mul_f32 v205, v205, v203
    v_accvgpr_write_b32 a152, v204
    v_accvgpr_write_b32 a153, v205
    v_accvgpr_read_b32 v204, a154
    v_accvgpr_read_b32 v205, a155
    v_mul_f32 v204, v204, v203
    v_mul_f32 v205, v205, v203
    v_accvgpr_write_b32 a154, v204
    v_accvgpr_write_b32 a155, v205
    v_accvgpr_read_b32 v204, a156
    v_accvgpr_read_b32 v205, a157
    v_mul_f32 v204, v204, v203
    v_mul_f32 v205, v205, v203
    v_accvgpr_write_b32 a156, v204
    v_accvgpr_write_b32 a157, v205
    v_accvgpr_read_b32 v204, a158
    v_accvgpr_read_b32 v205, a159
    v_mul_f32 v204, v204, v203
    v_mul_f32 v205, v205, v203
    v_accvgpr_write_b32 a158, v204
    v_accvgpr_write_b32 a159, v205
    v_subrev_f32 v202, 0x0, v173
    v_min_f32 v48, v48, v202
    v_subrev_f32 v203, 0x71800000, v173
    v_min_f32 v49, v49, v203
    v_subrev_f32 v202, 0x72000000, v173
    v_min_f32 v50, v50, v202
    v_subrev_f32 v203, 0x72400000, v173
    v_min_f32 v51, v51, v203
    v_subrev_f32 v202, 0x73800000, v173
    v_min_f32 v52, v52, v202
    v_subrev_f32 v203, 0x73880000, v173
    v_min_f32 v53, v53, v203
    v_subrev_f32 v202, 0x73900000, v173
    v_min_f32 v54, v54, v202
    v_subrev_f32 v203, 0x73980000, v173
    v_min_f32 v55, v55, v203
    v_subrev_f32 v202, 0x74000000, v173
    v_min_f32 v56, v56, v202
    v_subrev_f32 v203, 0x74040000, v173
    v_min_f32 v57, v57, v203
    v_subrev_f32 v202, 0x74080000, v173
    v_min_f32 v58, v58, v202
    v_subrev_f32 v203, 0x740c0000, v173
    v_min_f32 v59, v59, v203
    v_subrev_f32 v202, 0x74400000, v173
    v_min_f32 v60, v60, v202
    v_subrev_f32 v203, 0x74440000, v173
    v_min_f32 v61, v61, v203
    v_subrev_f32 v202, 0x74480000, v173
    v_min_f32 v62, v62, v202
    v_subrev_f32 v203, 0x744c0000, v173
    v_min_f32 v63, v63, v203
    v_subrev_f32 v173, 0x74800000, v173
    v_max3_f32 v197, v48, v49, v50
    v_max3_f32 v197, v197, v51, v52
    v_max3_f32 v197, v197, v53, v54
    v_max3_f32 v197, v197, v55, v56
    v_max3_f32 v197, v197, v57, v58
    v_max3_f32 v197, v197, v59, v60
    v_max3_f32 v197, v197, v61, v62
    v_max_f32 v197, v197, v63
    v_mov_b32 v202, v197
    v_mov_b32 v203, v197
    s_nop 1
    v_permlane32_swap_b32 v202, v203
    s_nop 1
    v_max_f32 v202, v202, v203
    v_mov_b32 v203, v202
    s_nop 1
    v_permlane16_swap_b32 v202, v203
    s_nop 1
    v_max_f32 v202, v202, v203
    v_max_f32 v202, v202, v172
    v_sub_f32 v203, v172, v202
    v_exp_f32 v203, v203
    v_mov_b32 v172, v202
    v_sub_f32 v48, v48, v202
    v_sub_f32 v49, v49, v202
    v_sub_f32 v50, v50, v202
    v_sub_f32 v51, v51, v202
    v_sub_f32 v52, v52, v202
    v_sub_f32 v53, v53, v202
    v_sub_f32 v54, v54, v202
    v_sub_f32 v55, v55, v202
    v_sub_f32 v56, v56, v202
    v_sub_f32 v57, v57, v202
    v_sub_f32 v58, v58, v202
    v_sub_f32 v59, v59, v202
    v_sub_f32 v60, v60, v202
    v_sub_f32 v61, v61, v202
    v_sub_f32 v62, v62, v202
    v_sub_f32 v63, v63, v202
    v_exp_f32 v48, v48
    v_exp_f32 v49, v49
    v_exp_f32 v50, v50
    v_exp_f32 v51, v51
    v_exp_f32 v52, v52
    v_exp_f32 v53, v53
    v_exp_f32 v54, v54
    v_exp_f32 v55, v55
    v_exp_f32 v56, v56
    v_exp_f32 v57, v57
    v_exp_f32 v58, v58
    v_exp_f32 v59, v59
    v_exp_f32 v60, v60
    v_exp_f32 v61, v61
    v_exp_f32 v62, v62
    v_exp_f32 v63, v63
    v_mul_f32 v188, v188, v203
    v_mul_f32 v189, v189, v203
    v_mul_f32 v190, v190, v203
    v_mul_f32 v191, v191, v203
    v_cvt_pk_bf16_f32 v152, v48, v49
    v_cvt_pk_bf16_f32 v153, v50, v51
    v_cvt_pk_bf16_f32 v154, v52, v53
    v_cvt_pk_bf16_f32 v155, v54, v55
    v_cvt_pk_bf16_f32 v156, v56, v57
    v_cvt_pk_bf16_f32 v157, v58, v59
    v_cvt_pk_bf16_f32 v158, v60, v61
    v_cvt_pk_bf16_f32 v159, v62, v63
    v_accvgpr_read_b32 v204, a160
    v_accvgpr_read_b32 v205, a161
    v_mul_f32 v204, v204, v203
    v_mul_f32 v205, v205, v203
    v_accvgpr_write_b32 a160, v204
    v_accvgpr_write_b32 a161, v205
    v_accvgpr_read_b32 v204, a162
    v_accvgpr_read_b32 v205, a163
    v_mul_f32 v204, v204, v203
    v_mul_f32 v205, v205, v203
    v_accvgpr_write_b32 a162, v204
    v_accvgpr_write_b32 a163, v205
    v_accvgpr_read_b32 v204, a164
    v_accvgpr_read_b32 v205, a165
    v_mul_f32 v204, v204, v203
    v_mul_f32 v205, v205, v203
    v_accvgpr_write_b32 a164, v204
    v_accvgpr_write_b32 a165, v205
    v_accvgpr_read_b32 v204, a166
    v_accvgpr_read_b32 v205, a167
    v_mul_f32 v204, v204, v203
    v_mul_f32 v205, v205, v203
    v_accvgpr_write_b32 a166, v204
    v_accvgpr_write_b32 a167, v205
    v_accvgpr_read_b32 v204, a168
    v_accvgpr_read_b32 v205, a169
    v_mul_f32 v204, v204, v203
    v_mul_f32 v205, v205, v203
    v_accvgpr_write_b32 a168, v204
    v_accvgpr_write_b32 a169, v205
    v_accvgpr_read_b32 v204, a170
    v_accvgpr_read_b32 v205, a171
    v_mul_f32 v204, v204, v203
    v_mul_f32 v205, v205, v203
    v_accvgpr_write_b32 a170, v204
    v_accvgpr_write_b32 a171, v205
    v_accvgpr_read_b32 v204, a172
    v_accvgpr_read_b32 v205, a173
    v_mul_f32 v204, v204, v203
    v_mul_f32 v205, v205, v203
    v_accvgpr_write_b32 a172, v204
    v_accvgpr_write_b32 a173, v205
    v_accvgpr_read_b32 v204, a174
    v_accvgpr_read_b32 v205, a175
    v_mul_f32 v204, v204, v203
    v_mul_f32 v205, v205, v203
    v_accvgpr_write_b32 a174, v204
    v_accvgpr_write_b32 a175, v205
    v_accvgpr_read_b32 v204, a176
    v_accvgpr_read_b32 v205, a177
    v_mul_f32 v204, v204, v203
    v_mul_f32 v205, v205, v203
    v_accvgpr_write_b32 a176, v204
    v_accvgpr_write_b32 a177, v205
    v_accvgpr_read_b32 v204, a178
    v_accvgpr_read_b32 v205, a179
    v_mul_f32 v204, v204, v203
    v_mul_f32 v205, v205, v203
    v_accvgpr_write_b32 a178, v204
    v_accvgpr_write_b32 a179, v205
    v_accvgpr_read_b32 v204, a180
    v_accvgpr_read_b32 v205, a181
    v_mul_f32 v204, v204, v203
    v_mul_f32 v205, v205, v203
    v_accvgpr_write_b32 a180, v204
    v_accvgpr_write_b32 a181, v205
    v_accvgpr_read_b32 v204, a182
    v_accvgpr_read_b32 v205, a183
    v_mul_f32 v204, v204, v203
    v_mul_f32 v205, v205, v203
    v_accvgpr_write_b32 a182, v204
    v_accvgpr_write_b32 a183, v205
    v_accvgpr_read_b32 v204, a184
    v_accvgpr_read_b32 v205, a185
    v_mul_f32 v204, v204, v203
    v_mul_f32 v205, v205, v203
    v_accvgpr_write_b32 a184, v204
    v_accvgpr_write_b32 a185, v205
    v_accvgpr_read_b32 v204, a186
    v_accvgpr_read_b32 v205, a187
    v_mul_f32 v204, v204, v203
    v_mul_f32 v205, v205, v203
    v_accvgpr_write_b32 a186, v204
    v_accvgpr_write_b32 a187, v205
    v_accvgpr_read_b32 v204, a188
    v_accvgpr_read_b32 v205, a189
    v_mul_f32 v204, v204, v203
    v_mul_f32 v205, v205, v203
    v_accvgpr_write_b32 a188, v204
    v_accvgpr_write_b32 a189, v205
    v_accvgpr_read_b32 v204, a190
    v_accvgpr_read_b32 v205, a191
    v_mul_f32 v204, v204, v203
    v_mul_f32 v205, v205, v203
    v_accvgpr_write_b32 a190, v204
    v_accvgpr_write_b32 a191, v205
    s_waitcnt lgkmcnt(0)
    s_barrier
    v_mfma_f32_16x16x32_bf16 a[32:35], a[192:195], v[128:131], a[32:35]
    v_mfma_f32_16x16x32_bf16 a[96:99], a[192:195], v[136:139], a[96:99]
    v_mfma_f32_16x16x32_bf16 a[128:131], a[192:195], v[144:147], a[128:131]
    v_mfma_f32_16x16x32_bf16 a[160:163], a[192:195], v[152:155], a[160:163]
    v_mfma_f32_16x16x32_bf16 a[36:39], a[196:199], v[128:131], a[36:39]
    v_mfma_f32_16x16x32_bf16 a[100:103], a[196:199], v[136:139], a[100:103]
    v_mfma_f32_16x16x32_bf16 a[132:135], a[196:199], v[144:147], a[132:135]
    v_mfma_f32_16x16x32_bf16 a[164:167], a[196:199], v[152:155], a[164:167]
    v_mfma_f32_16x16x32_bf16 a[40:43], a[200:203], v[128:131], a[40:43]
    v_mfma_f32_16x16x32_bf16 a[104:107], a[200:203], v[136:139], a[104:107]
    v_mfma_f32_16x16x32_bf16 a[136:139], a[200:203], v[144:147], a[136:139]
    v_mfma_f32_16x16x32_bf16 a[168:171], a[200:203], v[152:155], a[168:171]
    v_mfma_f32_16x16x32_bf16 a[44:47], a[204:207], v[128:131], a[44:47]
    v_mfma_f32_16x16x32_bf16 a[108:111], a[204:207], v[136:139], a[108:111]
    v_mfma_f32_16x16x32_bf16 a[140:143], a[204:207], v[144:147], a[140:143]
    v_mfma_f32_16x16x32_bf16 a[172:175], a[204:207], v[152:155], a[172:175]
    v_mfma_f32_16x16x32_bf16 a[48:51], a[208:211], v[128:131], a[48:51]
    v_mfma_f32_16x16x32_bf16 a[112:115], a[208:211], v[136:139], a[112:115]
    v_mfma_f32_16x16x32_bf16 a[144:147], a[208:211], v[144:147], a[144:147]
    v_mfma_f32_16x16x32_bf16 a[176:179], a[208:211], v[152:155], a[176:179]
    v_mfma_f32_16x16x32_bf16 a[52:55], a[212:215], v[128:131], a[52:55]
    v_mfma_f32_16x16x32_bf16 a[116:119], a[212:215], v[136:139], a[116:119]
    v_mfma_f32_16x16x32_bf16 a[148:151], a[212:215], v[144:147], a[148:151]
    v_mfma_f32_16x16x32_bf16 a[180:183], a[212:215], v[152:155], a[180:183]
    v_mfma_f32_16x16x32_bf16 a[56:59], a[216:219], v[128:131], a[56:59]
    v_mfma_f32_16x16x32_bf16 a[120:123], a[216:219], v[136:139], a[120:123]
    v_mfma_f32_16x16x32_bf16 a[152:155], a[216:219], v[144:147], a[152:155]
    v_mfma_f32_16x16x32_bf16 a[184:187], a[216:219], v[152:155], a[184:187]
    v_mfma_f32_16x16x32_bf16 a[60:63], a[220:223], v[128:131], a[60:63]
    v_mfma_f32_16x16x32_bf16 a[124:127], a[220:223], v[136:139], a[124:127]
    v_mfma_f32_16x16x32_bf16 a[156:159], a[220:223], v[144:147], a[156:159]
    v_mfma_f32_16x16x32_bf16 a[188:191], a[220:223], v[152:155], a[188:191]
    v_mfma_f32_16x16x32_bf16 v[176:179], v[192:195], v[128:131], v[176:179]
    v_mfma_f32_16x16x32_bf16 v[180:183], v[192:195], v[136:139], v[180:183]
    v_mfma_f32_16x16x32_bf16 v[184:187], v[192:195], v[144:147], v[184:187]
    v_mfma_f32_16x16x32_bf16 v[188:191], v[192:195], v[152:155], v[188:191]
    v_mfma_f32_16x16x32_bf16 a[32:35], a[224:227], v[132:135], a[32:35]
    v_mfma_f32_16x16x32_bf16 a[96:99], a[224:227], v[140:143], a[96:99]
    v_mfma_f32_16x16x32_bf16 a[128:131], a[224:227], v[148:151], a[128:131]
    v_mfma_f32_16x16x32_bf16 a[160:163], a[224:227], v[156:159], a[160:163]
    v_mfma_f32_16x16x32_bf16 a[36:39], a[228:231], v[132:135], a[36:39]
    v_mfma_f32_16x16x32_bf16 a[100:103], a[228:231], v[140:143], a[100:103]
    v_mfma_f32_16x16x32_bf16 a[132:135], a[228:231], v[148:151], a[132:135]
    v_mfma_f32_16x16x32_bf16 a[164:167], a[228:231], v[156:159], a[164:167]
    v_mfma_f32_16x16x32_bf16 a[40:43], a[232:235], v[132:135], a[40:43]
    v_mfma_f32_16x16x32_bf16 a[104:107], a[232:235], v[140:143], a[104:107]
    v_mfma_f32_16x16x32_bf16 a[136:139], a[232:235], v[148:151], a[136:139]
    v_mfma_f32_16x16x32_bf16 a[168:171], a[232:235], v[156:159], a[168:171]
    v_mfma_f32_16x16x32_bf16 a[44:47], a[236:239], v[132:135], a[44:47]
    v_mfma_f32_16x16x32_bf16 a[108:111], a[236:239], v[140:143], a[108:111]
    v_mfma_f32_16x16x32_bf16 a[140:143], a[236:239], v[148:151], a[140:143]
    v_mfma_f32_16x16x32_bf16 a[172:175], a[236:239], v[156:159], a[172:175]
    v_mfma_f32_16x16x32_bf16 a[48:51], a[240:243], v[132:135], a[48:51]
    v_mfma_f32_16x16x32_bf16 a[112:115], a[240:243], v[140:143], a[112:115]
    v_mfma_f32_16x16x32_bf16 a[144:147], a[240:243], v[148:151], a[144:147]
    v_mfma_f32_16x16x32_bf16 a[176:179], a[240:243], v[156:159], a[176:179]
    v_mfma_f32_16x16x32_bf16 a[52:55], a[244:247], v[132:135], a[52:55]
    v_mfma_f32_16x16x32_bf16 a[116:119], a[244:247], v[140:143], a[116:119]
    v_mfma_f32_16x16x32_bf16 a[148:151], a[244:247], v[148:151], a[148:151]
    v_mfma_f32_16x16x32_bf16 a[180:183], a[244:247], v[156:159], a[180:183]
    v_mfma_f32_16x16x32_bf16 a[56:59], a[248:251], v[132:135], a[56:59]
    v_mfma_f32_16x16x32_bf16 a[120:123], a[248:251], v[140:143], a[120:123]
    v_mfma_f32_16x16x32_bf16 a[152:155], a[248:251], v[148:151], a[152:155]
    v_mfma_f32_16x16x32_bf16 a[184:187], a[248:251], v[156:159], a[184:187]
    v_mfma_f32_16x16x32_bf16 a[60:63], a[252:255], v[132:135], a[60:63]
    v_mfma_f32_16x16x32_bf16 a[124:127], a[252:255], v[140:143], a[124:127]
    v_mfma_f32_16x16x32_bf16 a[156:159], a[252:255], v[148:151], a[156:159]
    v_mfma_f32_16x16x32_bf16 a[188:191], a[252:255], v[156:159], a[188:191]
    v_mfma_f32_16x16x32_bf16 v[176:179], v[192:195], v[132:135], v[176:179]
    v_mfma_f32_16x16x32_bf16 v[180:183], v[192:195], v[140:143], v[180:183]
    v_mfma_f32_16x16x32_bf16 v[184:187], v[192:195], v[148:151], v[184:187]
    v_mfma_f32_16x16x32_bf16 v[188:191], v[192:195], v[156:159], v[188:191]
    s_add_u32 s54, s54, 32768
    s_sub_u32 s47, s47, 1
    s_cmp_lg_u32 s47, 0
    s_cbranch_scc1 L_safe_loop
    s_nop 15
    s_mov_b32 s61, 0x7f800000
    v_cmp_ngt_f32 vcc, s61, v184
    v_nop
    s_mov_b64 s[62:63], vcc
    v_cmp_ngt_f32 vcc, s61, v188
    v_nop
    s_or_b64 s[62:63], s[62:63], vcc
    v_mov_b32 v185, v184
    v_accvgpr_read_b32 v32, a128
    v_accvgpr_read_b32 v33, a129
    v_permlane32_swap_b32 v184, v185
    v_accvgpr_read_b32 v34, a130
    v_add_f32 v184, v184, v185
    v_mov_b32 v185, v184
    buffer_store_dwordx4 v[232:235], v240, s[20:23], s36 offen offset:2048 sc1
    v_accvgpr_read_b32 v35, a131
    v_accvgpr_read_b32 v36, a132
    v_permlane16_swap_b32 v184, v185
    v_accvgpr_read_b32 v37, a133
    v_add_f32 v184, v184, v185
    v_rcp_f32 v204, v184
    v_accvgpr_read_b32 v38, a134
    buffer_store_dwordx4 v[232:235], v240, s[20:23], s36 offen offset:3072 sc1
    v_accvgpr_read_b32 v39, a135
    v_mul_f32 v32, v32, v204
    v_mul_f32 v33, v33, v204
    v_mul_f32 v34, v34, v204
    v_mul_f32 v35, v35, v204
    v_mul_f32 v36, v36, v204
    v_mul_f32 v37, v37, v204
    v_mul_f32 v38, v38, v204
    v_mul_f32 v39, v39, v204
    v_cvt_pk_bf16_f32 v32, v32, v33
    v_cvt_pk_bf16_f32 v33, v34, v35
    v_cvt_pk_bf16_f32 v34, v36, v37
    v_cvt_pk_bf16_f32 v35, v38, v39
    buffer_store_dwordx4 v[32:35], v240, s[20:23], s101 offen offset:0 sc1
    v_accvgpr_read_b32 v40, a136
    v_accvgpr_read_b32 v41, a137
    v_accvgpr_read_b32 v42, a138
    v_accvgpr_read_b32 v43, a139
    v_accvgpr_read_b32 v44, a140
    v_accvgpr_read_b32 v45, a141
    v_accvgpr_read_b32 v46, a142
    buffer_store_dwordx4 v[232:235], v240, s[20:23], s37 offen offset:2048 sc1
    v_accvgpr_read_b32 v47, a143
    v_mul_f32 v40, v40, v204
    v_mul_f32 v41, v41, v204
    v_mul_f32 v42, v42, v204
    v_mul_f32 v43, v43, v204
    v_mul_f32 v44, v44, v204
    v_mul_f32 v45, v45, v204
    v_mul_f32 v46, v46, v204
    v_mul_f32 v47, v47, v204
    v_cvt_pk_bf16_f32 v40, v40, v41
    v_cvt_pk_bf16_f32 v41, v42, v43
    v_cvt_pk_bf16_f32 v42, v44, v45
    v_cvt_pk_bf16_f32 v43, v46, v47
    buffer_store_dwordx4 v[40:43], v240, s[20:23], s101 offen offset:1024 sc1
    v_accvgpr_read_b32 v48, a144
    v_accvgpr_read_b32 v49, a145
    v_accvgpr_read_b32 v50, a146
    v_accvgpr_read_b32 v51, a147
    v_accvgpr_read_b32 v52, a148
    v_accvgpr_read_b32 v53, a149
    v_accvgpr_read_b32 v54, a150
    buffer_store_dwordx4 v[232:235], v240, s[20:23], s37 offen offset:3072 sc1
    v_accvgpr_read_b32 v55, a151
    v_mul_f32 v48, v48, v204
    v_mul_f32 v49, v49, v204
    v_mul_f32 v50, v50, v204
    v_mul_f32 v51, v51, v204
    v_mul_f32 v52, v52, v204
    v_mul_f32 v53, v53, v204
    v_mul_f32 v54, v54, v204
    v_mul_f32 v55, v55, v204
    v_cvt_pk_bf16_f32 v48, v48, v49
    v_cvt_pk_bf16_f32 v49, v50, v51
    v_cvt_pk_bf16_f32 v50, v52, v53
    v_cvt_pk_bf16_f32 v51, v54, v55
    buffer_store_dwordx4 v[48:51], v240, s[20:23], s101 offen offset:2048 sc1
    v_accvgpr_read_b32 v56, a152
    v_accvgpr_read_b32 v57, a153
    v_accvgpr_read_b32 v58, a154
    v_accvgpr_read_b32 v59, a155
    v_accvgpr_read_b32 v60, a156
    v_accvgpr_read_b32 v61, a157
    v_accvgpr_read_b32 v62, a158
    buffer_store_dwordx4 v[232:235], v240, s[20:23], s41 offen offset:2048 sc1
    v_accvgpr_read_b32 v63, a159
    v_mul_f32 v56, v56, v204
    v_mul_f32 v57, v57, v204
    v_mul_f32 v58, v58, v204
    v_mul_f32 v59, v59, v204
    v_mul_f32 v60, v60, v204
    v_mul_f32 v61, v61, v204
    v_mul_f32 v62, v62, v204
    v_mul_f32 v63, v63, v204
    v_cvt_pk_bf16_f32 v56, v56, v57
    v_cvt_pk_bf16_f32 v57, v58, v59
    v_cvt_pk_bf16_f32 v58, v60, v61
    v_cvt_pk_bf16_f32 v59, v62, v63
    buffer_store_dwordx4 v[56:59], v240, s[20:23], s101 offen offset:3072 sc1
    v_mov_b32 v189, v188
    v_accvgpr_read_b32 v96, a160
    v_accvgpr_read_b32 v97, a161
    v_permlane32_swap_b32 v188, v189
    v_accvgpr_read_b32 v98, a162
    v_add_f32 v188, v188, v189
    v_mov_b32 v189, v188
    buffer_store_dwordx4 v[232:235], v240, s[20:23], s41 offen offset:3072 sc1
    v_accvgpr_read_b32 v99, a163
    v_accvgpr_read_b32 v100, a164
    v_permlane16_swap_b32 v188, v189
    v_accvgpr_read_b32 v101, a165
    v_add_f32 v188, v188, v189
    v_rcp_f32 v205, v188
    v_accvgpr_read_b32 v102, a166
    v_accvgpr_read_b32 v103, a167
    v_mul_f32 v96, v96, v205
    v_mul_f32 v97, v97, v205
    v_mul_f32 v98, v98, v205
    v_mul_f32 v99, v99, v205
    v_mul_f32 v100, v100, v205
    v_mul_f32 v101, v101, v205
    v_mul_f32 v102, v102, v205
    v_mul_f32 v103, v103, v205
    v_cvt_pk_bf16_f32 v96, v96, v97
    v_cvt_pk_bf16_f32 v97, v98, v99
    v_cvt_pk_bf16_f32 v98, v100, v101
    v_cvt_pk_bf16_f32 v99, v102, v103
    buffer_store_dwordx4 v[96:99], v246, s[20:23], s101 offen offset:0 sc1
    v_accvgpr_read_b32 v104, a168
    v_accvgpr_read_b32 v105, a169
    v_accvgpr_read_b32 v106, a170
    v_accvgpr_read_b32 v107, a171
    v_accvgpr_read_b32 v108, a172
    v_accvgpr_read_b32 v109, a173
    v_accvgpr_read_b32 v110, a174
    v_accvgpr_read_b32 v111, a175
    v_mul_f32 v104, v104, v205
    v_mul_f32 v105, v105, v205
    v_mul_f32 v106, v106, v205
    v_mul_f32 v107, v107, v205
    v_mul_f32 v108, v108, v205
    v_mul_f32 v109, v109, v205
    v_mul_f32 v110, v110, v205
    v_mul_f32 v111, v111, v205
    v_cvt_pk_bf16_f32 v104, v104, v105
    v_cvt_pk_bf16_f32 v105, v106, v107
    v_cvt_pk_bf16_f32 v106, v108, v109
    v_cvt_pk_bf16_f32 v107, v110, v111
    buffer_store_dwordx4 v[104:107], v246, s[20:23], s101 offen offset:1024 sc1
    v_accvgpr_read_b32 v112, a176
    v_accvgpr_read_b32 v113, a177
    v_accvgpr_read_b32 v114, a178
    v_accvgpr_read_b32 v115, a179
    v_accvgpr_read_b32 v116, a180
    v_accvgpr_read_b32 v117, a181
    v_accvgpr_read_b32 v118, a182
    v_accvgpr_read_b32 v119, a183
    v_mul_f32 v112, v112, v205
    v_mul_f32 v113, v113, v205
    v_mul_f32 v114, v114, v205
    v_mul_f32 v115, v115, v205
    v_mul_f32 v116, v116, v205
    v_mul_f32 v117, v117, v205
    v_mul_f32 v118, v118, v205
    v_mul_f32 v119, v119, v205
    v_cvt_pk_bf16_f32 v112, v112, v113
    v_cvt_pk_bf16_f32 v113, v114, v115
    v_cvt_pk_bf16_f32 v114, v116, v117
    v_cvt_pk_bf16_f32 v115, v118, v119
    buffer_store_dwordx4 v[112:115], v246, s[20:23], s101 offen offset:2048 sc1
    v_accvgpr_read_b32 v120, a184
    v_accvgpr_read_b32 v121, a185
    v_accvgpr_read_b32 v122, a186
    v_accvgpr_read_b32 v123, a187
    v_accvgpr_read_b32 v124, a188
    v_accvgpr_read_b32 v125, a189
    v_accvgpr_read_b32 v126, a190
    v_accvgpr_read_b32 v127, a191
    v_mul_f32 v120, v120, v205
    v_mul_f32 v121, v121, v205
    v_mul_f32 v122, v122, v205
    v_mul_f32 v123, v123, v205
    v_mul_f32 v124, v124, v205
    v_mul_f32 v125, v125, v205
    v_mul_f32 v126, v126, v205
    v_mul_f32 v127, v127, v205
    v_cvt_pk_bf16_f32 v120, v120, v121
    v_cvt_pk_bf16_f32 v121, v122, v123
    v_cvt_pk_bf16_f32 v122, v124, v125
    v_cvt_pk_bf16_f32 v123, v126, v127
    buffer_store_dwordx4 v[120:123], v246, s[20:23], s101 offen offset:3072 sc1
    v_mov_b32 v80, 0x0
    v_mov_b32 v81, 0x0
    v_mov_b32 v82, 0x0
    v_mov_b32 v83, 0x0
    v_mov_b32 v84, 0x0
    v_mov_b32 v85, 0x0
    v_mov_b32 v86, 0x0
    v_mov_b32 v87, 0x0
    v_mov_b32 v88, 0x0
    v_mov_b32 v89, 0x0
    v_mov_b32 v90, 0xf1800000
    v_mov_b32 v91, 0xf1800000
    v_mov_b32 v92, 0xf1800000
    v_mov_b32 v93, 0xf1800000
    v_mov_b32 v94, 0xf1800000
    v_mov_b32 v95, 0xf1800000
    s_add_u32 m0, s50, 131072
    s_add_u32 s58, s48, 0
    buffer_load_dwordx4 v242, s[12:15], s58 offen lds
    buffer_load_dwordx4 v243, s[12:15], s58 offen offset:1024 lds
    s_add_u32 m0, s50, 139264
    s_add_u32 s58, s48, 32768
    buffer_load_dwordx4 v242, s[12:15], s58 offen lds
    buffer_load_dwordx4 v243, s[12:15], s58 offen offset:1024 lds
    s_add_u32 s59, s64, 0
    buffer_load_dwordx4 a[128:131], v196, s[20:23], s59 offen offset:0 sc1
    buffer_load_dwordx4 a[132:135], v198, s[20:23], s59 offen offset:0 sc1
    buffer_load_dwordx4 a[136:139], v196, s[20:23], s59 offen offset:1024 sc1
    buffer_load_dwordx4 a[140:143], v198, s[20:23], s59 offen offset:1024 sc1
    s_add_u32 m0, s50, 147456
    s_add_u32 s58, s48, 65536
    buffer_load_dwordx4 v242, s[12:15], s58 offen lds
    buffer_load_dwordx4 v243, s[12:15], s58 offen offset:1024 lds
    s_add_u32 m0, s50, 155648
    s_add_u32 s58, s48, 98304
    buffer_load_dwordx4 v242, s[12:15], s58 offen lds
    buffer_load_dwordx4 v243, s[12:15], s58 offen offset:1024 lds
    s_add_u32 s59, s64, 2048
    buffer_load_dwordx4 a[144:147], v196, s[20:23], s59 offen offset:0 sc1
    buffer_load_dwordx4 a[148:151], v198, s[20:23], s59 offen offset:0 sc1
    buffer_load_dwordx4 a[152:155], v196, s[20:23], s59 offen offset:1024 sc1
    buffer_load_dwordx4 a[156:159], v198, s[20:23], s59 offen offset:1024 sc1
    s_add_u32 s59, s64, 4096
    buffer_load_dwordx4 a[160:163], v196, s[20:23], s59 offen offset:0 sc1
    buffer_load_dwordx4 a[164:167], v198, s[20:23], s59 offen offset:0 sc1
    buffer_load_dwordx4 a[168:171], v196, s[20:23], s59 offen offset:1024 sc1
    buffer_load_dwordx4 a[172:175], v198, s[20:23], s59 offen offset:1024 sc1
    s_add_u32 s59, s64, 6144
    buffer_load_dwordx4 a[176:179], v196, s[20:23], s59 offen offset:0 sc1
    buffer_load_dwordx4 a[180:183], v198, s[20:23], s59 offen offset:0 sc1
    buffer_load_dwordx4 a[184:187], v196, s[20:23], s59 offen offset:1024 sc1
    buffer_load_dwordx4 a[188:191], v198, s[20:23], s59 offen offset:1024 sc1
    s_add_u32 s59, s64, 8192
    buffer_load_dwordx4 v[96:99], v196, s[20:23], s59 offen offset:0 sc1
    buffer_load_dwordx4 v[100:103], v198, s[20:23], s59 offen offset:0 sc1
    buffer_load_dwordx4 v[104:107], v196, s[20:23], s59 offen offset:1024 sc1
    buffer_load_dwordx4 v[108:111], v198, s[20:23], s59 offen offset:1024 sc1
    s_add_u32 m0, s51, 0
    s_add_u32 s58, s48, 131072
    buffer_load_dwordx4 v242, s[12:15], s58 offen lds
    buffer_load_dwordx4 v243, s[12:15], s58 offen offset:1024 lds
    s_add_u32 m0, s51, 8192
    s_add_u32 s58, s48, 163840
    buffer_load_dwordx4 v242, s[12:15], s58 offen lds
    buffer_load_dwordx4 v243, s[12:15], s58 offen offset:1024 lds
    s_add_u32 m0, s51, 16384
    s_add_u32 s58, s48, 196608
    buffer_load_dwordx4 v242, s[12:15], s58 offen lds
    buffer_load_dwordx4 v243, s[12:15], s58 offen offset:1024 lds
    s_add_u32 m0, s51, 24576
    s_add_u32 s58, s48, 229376
    buffer_load_dwordx4 v242, s[12:15], s58 offen lds
    buffer_load_dwordx4 v243, s[12:15], s58 offen offset:1024 lds
    s_add_u32 m0, s51, 32768
    s_add_u32 s58, s48, 262144
    buffer_load_dwordx4 v242, s[12:15], s58 offen lds
    buffer_load_dwordx4 v243, s[12:15], s58 offen offset:1024 lds
    s_add_u32 m0, s51, 40960
    s_add_u32 s58, s48, 294912
    buffer_load_dwordx4 v242, s[12:15], s58 offen lds
    buffer_load_dwordx4 v243, s[12:15], s58 offen offset:1024 lds
    s_add_u32 s59, s64, 10240
    buffer_load_dwordx4 v[112:115], v196, s[20:23], s59 offen offset:0 sc1
    buffer_load_dwordx4 v[116:119], v198, s[20:23], s59 offen offset:0 sc1
    buffer_load_dwordx4 v[120:123], v196, s[20:23], s59 offen offset:1024 sc1
    buffer_load_dwordx4 v[124:127], v198, s[20:23], s59 offen offset:1024 sc1
    s_add_u32 m0, s51, 49152
    s_add_u32 s58, s48, 327680
    buffer_load_dwordx4 v242, s[12:15], s58 offen lds
    buffer_load_dwordx4 v243, s[12:15], s58 offen offset:1024 lds
    s_add_u32 m0, s51, 57344
    s_add_u32 s58, s48, 360448
    buffer_load_dwordx4 v242, s[12:15], s58 offen lds
    buffer_load_dwordx4 v243, s[12:15], s58 offen offset:1024 lds
    s_add_u32 m0, s56, 0
    s_add_u32 s58, s48, 393216
    buffer_load_dwordx4 v242, s[12:15], s58 offen lds
    buffer_load_dwordx4 v243, s[12:15], s58 offen offset:1024 lds
    s_add_u32 m0, s56, 8192
    s_add_u32 s58, s48, 425984
    buffer_load_dwordx4 v242, s[12:15], s58 offen lds
    buffer_load_dwordx4 v243, s[12:15], s58 offen offset:1024 lds
    s_mov_b32 s38, 1
    s_branch L_fin
L_xnwait:
    s_mov_b32 s44, 0x40000
L_xnspin:
    s_sub_u32 s44, s44, 1
    s_cbranch_scc1 L_xnok
    s_sleep 2
    buffer_load_dword v244, v243, s[4:7], 0 offen sc1
    s_waitcnt vmcnt(0)
    v_cmp_gt_u32 vcc, 16, v244
    s_cbranch_vccnz L_xnspin
    s_branch L_xnok
L_kvwait:
    s_mov_b32 s44, 0x40000
L_kvspin:
    s_sub_u32 s44, s44, 1
    s_cbranch_scc1 L_kvok
    s_sleep 2
    buffer_load_dword v244, v243, s[20:23], s59 offen sc1
    s_waitcnt vmcnt(0)
    v_cmp_ne_u32 vcc, 1, v244
    s_cbranch_vccnz L_kvspin
    s_branch L_kvok
L_code_end:
    s_endpgm
.section .rodata,"a"
.p2align 6
.amdhsa_kernel recurrent_scan__compressed_kv_cla__glu_gated_geglu__prompt_kernel
  .amdhsa_next_free_vgpr 512
  .amdhsa_next_free_sgpr 102
  .amdhsa_accum_offset 256
  .amdhsa_group_segment_fixed_size 0
  .amdhsa_kernarg_size 104
  .amdhsa_user_sgpr_count 2
  .amdhsa_user_sgpr_kernarg_segment_ptr 1
  .amdhsa_system_sgpr_workgroup_id_x 1
  .amdhsa_float_denorm_mode_32 3
.end_amdhsa_kernel
```
